```python
import torch

def _softmax(x, axis=-1):
    return torch.softmax(x, dim=axis)
def _gelu(x):
    return torch.nn.functional.gelu(x, approximate="tanh")
def _silu(x):
    return torch.nn.functional.silu(x)
def _sigmoid(x):
    return torch.sigmoid(x)
def _layernorm(x, axis=-1, eps=1e-5):
    m = x.mean(dim=axis, keepdim=True)
    v = x.var(dim=axis, keepdim=True, unbiased=False)
    return (x - m) / torch.sqrt(v + eps)
def _scatter_add(tgt, idx, src, axis=0):
    return tgt.clone().index_add_(axis, idx, src)
def _segment_sum(src, seg, n):
    out = torch.zeros((n,) + src.shape[1:], dtype=src.dtype)
    return out.index_add_(0, seg, src)
def _pad(x, pw):
    flat = tuple(v for pair in reversed(pw) for v in pair)
    return torch.nn.functional.pad(x, flat)

kernel_name = 'standalone__mha_softmax__near_ridge'

def setup_inputs():

    _w = (lambda a: (lambda t: t.to(torch.bfloat16) if t.is_floating_point() else t)(torch.as_tensor(a)))
    B, H, Sq, Sk, D = 16, 32, 256, 512, 128
    return {
        "q": _w((lambda *s: torch.randn(*s, dtype=torch.bfloat16) * 0.8)(B, H, Sq, D)),
        "k": _w((lambda *s: torch.randn(*s, dtype=torch.bfloat16) * 0.8)(B, H, Sk, D)),
        "v": _w((lambda *s: torch.randn(*s, dtype=torch.bfloat16) * 0.05)(B, H, Sk, D)),
    }

def reference(q, k, v):
    scale = q.shape[-1] ** -0.5
    scores = torch.einsum("bhqd,bhkd->bhqk", q, k) * scale
    p = _softmax(scores, axis=-1)
    return torch.einsum("bhqk,bhkd->bhqd", p, v)
```

```asm
; @launch grid=(256,1,1) block=(256,1,1) lds=163840
.amdgcn_target "amdgcn-amd-amdhsa--gfx950"
.text
.globl standalone__mha_softmax__near_ridge_kernel
.p2align 12
.type standalone__mha_softmax__near_ridge_kernel,@function
standalone__mha_softmax__near_ridge_kernel:
  s_cmp_ge_u32 s2, 256
  s_cbranch_scc1 L_end
  s_load_dwordx4 s[92:95], s[0:1], 0
  s_load_dwordx4 s[96:99], s[0:1], 16
  v_lshrrev_b32 v25, 6, v0
  v_and_b32 v0, 63, v0
  v_readfirstlane_b32 s3, v25
  s_getpc_b64 s[4:5]
L_pc:
  s_lshr_b32 s53, s2, 3
  s_and_b32 s53, s53, 1
  s_lshl_b32 s53, s53, 15
  v_lshlrev_b32 v20, 13, v25
  v_lshl_add_u32 v20, v0, 7, v20
  v_add_u32 v20, s53, v20
  v_min_u32 v20, L_end-L_pc, v20
  global_load_dword v36, v20, s[4:5]
  v_lshrrev_b32 v23, 4, v0
  v_and_b32 v24, 15, v0
  v_xor_b32 v22, v24, v23
  v_lshlrev_b32 v22, 4, v22
  v_lshl_add_u32 v1, v23, 8, v22
  v_xor_b32 v2, 64, v1
  v_xor_b32 v3, 128, v1
  v_xor_b32 v4, 192, v1
  s_lshl_b32 s44, s3, 12
  s_lshl_b32 s45, s3, 14
  s_add_u32 s55, s45, 98304
  s_lshl_b32 s54, s2, 16
  s_lshl_b32 s56, s2, 17
  s_mov_b32 s82, s44
  s_mov_b32 s11, 0x20000
  s_mov_b32 s27, 0x20000
  s_mov_b32 s10, 131072
  s_mov_b32 s26, 65536
  s_waitcnt lgkmcnt(0)
  s_add_u32 s8, s94, s56
  s_addc_u32 s9, s95, 0
  s_and_b32 s9, s9, 0xffff
  s_add_u32 m0, s44, 0
  s_nop 0
  buffer_load_dwordx4 v1, s[8:11], s82 offen offset:0 nt lds
  buffer_load_dwordx4 v2, s[8:11], s82 offen offset:1024 nt lds
  buffer_load_dwordx4 v3, s[8:11], s82 offen offset:2048 nt lds
  buffer_load_dwordx4 v4, s[8:11], s82 offen offset:3072 nt lds
  s_add_u32 s24, s92, s54
  s_addc_u32 s25, s93, 0
  s_and_b32 s25, s25, 0xffff
  s_add_u32 m0, s55, 0
  s_add_u32 s46, s45, 0
  buffer_load_dwordx4 v1, s[24:27], s46 offen offset:0 nt lds
  buffer_load_dwordx4 v2, s[24:27], s46 offen offset:1024 nt lds
  buffer_load_dwordx4 v3, s[24:27], s46 offen offset:2048 nt lds
  buffer_load_dwordx4 v4, s[24:27], s46 offen offset:3072 nt lds
  s_add_u32 m0, s55, 4096
  s_add_u32 s46, s45, 4096
  buffer_load_dwordx4 v1, s[24:27], s46 offen offset:0 nt lds
  buffer_load_dwordx4 v2, s[24:27], s46 offen offset:1024 nt lds
  buffer_load_dwordx4 v3, s[24:27], s46 offen offset:2048 nt lds
  buffer_load_dwordx4 v4, s[24:27], s46 offen offset:3072 nt lds
  s_add_u32 s12, s96, s56
  s_addc_u32 s13, s97, 0
  s_and_b32 s13, s13, 0xffff
  s_mov_b32 s14, 131072
  s_mov_b32 s15, 0x20000
  s_add_u32 s83, s82, 16384
  s_add_u32 s84, s82, 32768
  s_add_u32 s85, s82, 49152
  s_add_u32 s86, s82, 65536
  s_add_u32 s87, s82, 81920
  s_add_u32 s88, s82, 98304
  s_add_u32 s89, s82, 114688
  v_lshl_add_u32 v8, v24, 8, v22
  v_xor_b32 v9, 64, v8
  v_xor_b32 v10, 128, v8
  v_xor_b32 v11, 192, v8
  v_lshlrev_b32 v22, 1, v23
  v_xor_b32 v22, v24, v22
  v_lshlrev_b32 v22, 4, v22
  v_lshl_add_u32 v5, v23, 8, v22
  v_xor_b32 v6, 128, v5
  v_lshrrev_b32 v20, 2, v0
  v_and_b32 v21, 7, v20
  v_lshlrev_b32 v20, 8, v20
  v_lshl_add_u32 v20, v21, 5, v20
  v_and_b32 v21, 3, v0
  v_lshl_add_u32 v20, v21, 3, v20
  v_add_u32 v12, 49152, v20
  v_xor_b32 v13, 32, v12
  v_xor_b32 v14, 64, v12
  v_xor_b32 v15, 96, v12
  v_xor_b32 v16, 128, v12
  v_xor_b32 v17, 160, v12
  v_xor_b32 v18, 192, v12
  v_xor_b32 v19, 224, v12
  v_lshrrev_b32 v20, 5, v0
  v_and_b32 v21, 7, v0
  v_xor_b32 v20, v20, v21
  v_lshlrev_b32 v20, 4, v20
  v_lshl_add_u32 v20, v24, 8, v20
  v_and_b32 v21, 1, v23
  v_lshl_add_u32 v20, v21, 3, v20
  v_add_u32 v32, s55, v20
  v_xor_b32 v33, 32, v32
  v_xor_b32 v34, 64, v32
  v_xor_b32 v35, 96, v32
  v_lshlrev_b32 v47, 4, v0
  v_add_u32 v46, s55, v1
  v_and_b32 v22, 3, v0
  v_cmp_eq_u32 vcc, 0, v22
  v_mov_b32 v21, 0x3f803f80
  s_nop 0
  v_cndmask_b32 v22, 0, v21, vcc
  v_accvgpr_write_b32 a240, v22
  v_accvgpr_write_b32 a241, v22
  v_accvgpr_write_b32 a242, v22
  v_accvgpr_write_b32 a243, v22
  s_mov_b32 s47, 0x3e0293ee
  s_mov_b32 s48, 0x4f800000
  s_mov_b64 s[50:51], 0
  s_add_u32 s28, s92, s54
  s_addc_u32 s29, s93, 0
  s_add_u32 s28, s28, 16777216
  s_addc_u32 s29, s29, 0
  s_and_b32 s29, s29, 0xffff
  s_mov_b32 s30, 65536
  s_mov_b32 s31, 0x20000
  s_add_u32 s16, s94, s56
  s_addc_u32 s17, s95, 0
  s_add_u32 s16, s16, 33554432
  s_addc_u32 s17, s17, 0
  s_and_b32 s17, s17, 0xffff
  s_mov_b32 s18, 131072
  s_mov_b32 s19, 0x20000
  s_add_u32 s20, s96, s56
  s_addc_u32 s21, s97, 0
  s_add_u32 s20, s20, 33554432
  s_addc_u32 s21, s21, 0
  s_and_b32 s21, s21, 0xffff
  s_mov_b32 s22, 131072
  s_mov_b32 s23, 0x20000
  s_lshl_b32 s54, s2, 16
  s_add_u32 s32, s98, s54
  s_addc_u32 s33, s99, 0
  s_and_b32 s33, s33, 0xffff
  s_mov_b32 s34, 65536
  s_mov_b32 s35, 0x20000
  s_add_u32 s36, s98, s54
  s_addc_u32 s37, s99, 0
  s_add_u32 s36, s36, 16777216
  s_addc_u32 s37, s37, 0
  s_and_b32 s37, s37, 0xffff
  s_mov_b32 s38, 65536
  s_mov_b32 s39, 0x20000
  v_add_u32 v28, s55, v8
  v_add_u32 v29, s55, v9
  v_add_u32 v30, s55, v10
  v_add_u32 v31, s55, v11
  s_waitcnt vmcnt(8)
  s_barrier
  s_add_u32 m0, s55, 8192
  s_add_u32 s46, s45, 8192
  buffer_load_dwordx4 v1, s[24:27], s46 offen offset:0 nt lds
  buffer_load_dwordx4 v2, s[24:27], s46 offen offset:1024 nt lds
  buffer_load_dwordx4 v3, s[24:27], s46 offen offset:2048 nt lds
  buffer_load_dwordx4 v4, s[24:27], s46 offen offset:3072 nt lds
  ds_read_b128 a[0:3], v8 offset:0
  ds_read_b128 a[4:7], v9 offset:0
  ds_read_b128 a[8:11], v10 offset:0
  ds_read_b128 a[12:15], v11 offset:0
  ds_read_b128 a[16:19], v8 offset:4096
  ds_read_b128 a[20:23], v9 offset:4096
  ds_read_b128 a[24:27], v10 offset:4096
  ds_read_b128 a[28:31], v11 offset:4096
  ds_read_b128 a[32:35], v8 offset:8192
  ds_read_b128 a[36:39], v9 offset:8192
  ds_read_b128 a[40:43], v10 offset:8192
  ds_read_b128 a[44:47], v11 offset:8192
  ds_read_b128 a[48:51], v8 offset:12288
  ds_read_b128 a[52:55], v9 offset:12288
  ds_read_b128 a[56:59], v10 offset:12288
  ds_read_b128 a[60:63], v11 offset:12288
  s_waitcnt vmcnt(8)
  ds_read_b128 v[192:195], v28 offset:0
  ds_read_b128 v[196:199], v29 offset:0
  ds_read_b128 v[200:203], v30 offset:0
  ds_read_b128 v[204:207], v31 offset:0
  s_add_u32 m0, s55, 12288
  s_add_u32 s46, s45, 12288
  buffer_load_dwordx4 v1, s[24:27], s46 offen offset:0 nt lds
  buffer_load_dwordx4 v2, s[24:27], s46 offen offset:1024 nt lds
  buffer_load_dwordx4 v3, s[24:27], s46 offen offset:2048 nt lds
  buffer_load_dwordx4 v4, s[24:27], s46 offen offset:3072 nt lds
  s_waitcnt lgkmcnt(3)
  v_lshlrev_b32 v40, 16, v192
  v_lshlrev_b32 v41, 16, v193
  v_lshlrev_b32 v42, 16, v194
  v_lshlrev_b32 v43, 16, v195
  v_and_b32 v192, 0xffff0000, v192
  v_and_b32 v193, 0xffff0000, v193
  v_and_b32 v194, 0xffff0000, v194
  v_and_b32 v195, 0xffff0000, v195
  v_mul_f32 v40, s47, v40
  v_mul_f32 v41, s47, v41
  v_mul_f32 v42, s47, v42
  v_mul_f32 v43, s47, v43
  v_mul_f32 v192, s47, v192
  v_mul_f32 v193, s47, v193
  v_mul_f32 v194, s47, v194
  v_mul_f32 v195, s47, v195
  v_cvt_pk_bf16_f32 v192, v40, v192
  v_cvt_pk_bf16_f32 v193, v41, v193
  v_cvt_pk_bf16_f32 v194, v42, v194
  v_cvt_pk_bf16_f32 v195, v43, v195
  s_waitcnt lgkmcnt(2)
  v_lshlrev_b32 v40, 16, v196
  v_lshlrev_b32 v41, 16, v197
  v_lshlrev_b32 v42, 16, v198
  v_lshlrev_b32 v43, 16, v199
  v_and_b32 v196, 0xffff0000, v196
  v_and_b32 v197, 0xffff0000, v197
  v_and_b32 v198, 0xffff0000, v198
  v_and_b32 v199, 0xffff0000, v199
  v_mul_f32 v40, s47, v40
  v_mul_f32 v41, s47, v41
  v_mul_f32 v42, s47, v42
  v_mul_f32 v43, s47, v43
  v_mul_f32 v196, s47, v196
  v_mul_f32 v197, s47, v197
  v_mul_f32 v198, s47, v198
  v_mul_f32 v199, s47, v199
  v_cvt_pk_bf16_f32 v196, v40, v196
  v_cvt_pk_bf16_f32 v197, v41, v197
  v_cvt_pk_bf16_f32 v198, v42, v198
  v_cvt_pk_bf16_f32 v199, v43, v199
  s_waitcnt lgkmcnt(1)
  v_lshlrev_b32 v40, 16, v200
  v_lshlrev_b32 v41, 16, v201
  v_lshlrev_b32 v42, 16, v202
  v_lshlrev_b32 v43, 16, v203
  v_and_b32 v200, 0xffff0000, v200
  v_and_b32 v201, 0xffff0000, v201
  v_and_b32 v202, 0xffff0000, v202
  v_and_b32 v203, 0xffff0000, v203
  v_mul_f32 v40, s47, v40
  v_mul_f32 v41, s47, v41
  v_mul_f32 v42, s47, v42
  v_mul_f32 v43, s47, v43
  v_mul_f32 v200, s47, v200
  v_mul_f32 v201, s47, v201
  v_mul_f32 v202, s47, v202
  v_mul_f32 v203, s47, v203
  v_cvt_pk_bf16_f32 v200, v40, v200
  v_cvt_pk_bf16_f32 v201, v41, v201
  v_cvt_pk_bf16_f32 v202, v42, v202
  v_cvt_pk_bf16_f32 v203, v43, v203
  s_waitcnt lgkmcnt(0)
  v_lshlrev_b32 v40, 16, v204
  v_lshlrev_b32 v41, 16, v205
  v_lshlrev_b32 v42, 16, v206
  v_lshlrev_b32 v43, 16, v207
  v_and_b32 v204, 0xffff0000, v204
  v_and_b32 v205, 0xffff0000, v205
  v_and_b32 v206, 0xffff0000, v206
  v_and_b32 v207, 0xffff0000, v207
  v_mul_f32 v40, s47, v40
  v_mul_f32 v41, s47, v41
  v_mul_f32 v42, s47, v42
  v_mul_f32 v43, s47, v43
  v_mul_f32 v204, s47, v204
  v_mul_f32 v205, s47, v205
  v_mul_f32 v206, s47, v206
  v_mul_f32 v207, s47, v207
  v_cvt_pk_bf16_f32 v204, v40, v204
  v_cvt_pk_bf16_f32 v205, v41, v205
  v_cvt_pk_bf16_f32 v206, v42, v206
  v_cvt_pk_bf16_f32 v207, v43, v207
  v_mfma_f32_16x16x32_bf16 v[128:131], a[0:3], v[192:195], 0
  v_accvgpr_write_b32 a128, v192
  v_mfma_f32_16x16x32_bf16 v[128:131], a[4:7], v[196:199], v[128:131]
  v_accvgpr_write_b32 a129, v193
  v_mfma_f32_16x16x32_bf16 v[128:131], a[8:11], v[200:203], v[128:131]
  v_accvgpr_write_b32 a130, v194
  v_mfma_f32_16x16x32_bf16 v[128:131], a[12:15], v[204:207], v[128:131]
  v_accvgpr_write_b32 a131, v195
  v_mfma_f32_16x16x32_bf16 v[132:135], a[16:19], v[192:195], 0
  v_accvgpr_write_b32 a132, v196
  v_mfma_f32_16x16x32_bf16 v[132:135], a[20:23], v[196:199], v[132:135]
  v_accvgpr_write_b32 a133, v197
  v_mfma_f32_16x16x32_bf16 v[132:135], a[24:27], v[200:203], v[132:135]
  v_accvgpr_write_b32 a134, v198
  v_mfma_f32_16x16x32_bf16 v[132:135], a[28:31], v[204:207], v[132:135]
  v_accvgpr_write_b32 a135, v199
  v_mfma_f32_16x16x32_bf16 v[160:163], a[32:35], v[192:195], 0
  v_accvgpr_write_b32 a136, v200
  v_mfma_f32_16x16x32_bf16 v[160:163], a[36:39], v[196:199], v[160:163]
  v_accvgpr_write_b32 a137, v201
  v_mfma_f32_16x16x32_bf16 v[160:163], a[40:43], v[200:203], v[160:163]
  v_accvgpr_write_b32 a138, v202
  v_mfma_f32_16x16x32_bf16 v[160:163], a[44:47], v[204:207], v[160:163]
  v_accvgpr_write_b32 a139, v203
  v_mfma_f32_16x16x32_bf16 v[164:167], a[48:51], v[192:195], 0
  v_accvgpr_write_b32 a140, v204
  v_mfma_f32_16x16x32_bf16 v[164:167], a[52:55], v[196:199], v[164:167]
  v_accvgpr_write_b32 a141, v205
  v_mfma_f32_16x16x32_bf16 v[164:167], a[56:59], v[200:203], v[164:167]
  v_accvgpr_write_b32 a142, v206
  v_mfma_f32_16x16x32_bf16 v[164:167], a[60:63], v[204:207], v[164:167]
  v_accvgpr_write_b32 a143, v207
  v_max3_f32 v44, v128, v129, v130
  v_max3_f32 v45, v131, v132, v133
  v_max3_f32 v44, v44, v134, v135
  v_max3_f32 v45, v45, v160, v161
  v_max3_f32 v44, v44, v162, v163
  s_nop 1
  v_max3_f32 v45, v45, v164, v165
  v_max3_f32 v44, v44, v166, v167
  v_max_f32 v44, v44, v45
  v_mov_b32 v24, v44
  s_nop 1
  v_permlane32_swap_b32 v44, v24
  v_max_f32 v44, v44, v24
  v_mov_b32 v24, v44
  s_nop 1
  v_permlane16_swap_b32 v44, v24
  v_max_f32 v44, v44, v24
  v_sub_f32 v20, 0, v44
  v_sub_f32 v21, 0, v44
  v_sub_f32 v22, 0, v44
  v_sub_f32 v23, 0, v44
  v_add_f32 v128, v128, v20
  v_add_f32 v129, v129, v20
  v_exp_f32 v128, v128
  v_add_f32 v130, v130, v20
  v_exp_f32 v129, v129
  v_add_f32 v131, v131, v20
  v_exp_f32 v130, v130
  v_add_f32 v132, v132, v20
  v_exp_f32 v131, v131
  v_cvt_pk_bf16_f32 v128, v128, v129
  v_add_f32 v133, v133, v20
  v_exp_f32 v132, v132
  v_add_f32 v134, v134, v20
  v_exp_f32 v133, v133
  v_cvt_pk_bf16_f32 v129, v130, v131
  v_add_f32 v135, v135, v20
  v_exp_f32 v134, v134
  v_exp_f32 v135, v135
  v_cvt_pk_bf16_f32 v130, v132, v133
  v_cvt_pk_bf16_f32 v131, v134, v135
  s_waitcnt vmcnt(8)
  ds_read_b128 v[208:211], v28 offset:4096
  ds_read_b128 v[212:215], v29 offset:4096
  ds_read_b128 v[216:219], v30 offset:4096
  ds_read_b128 v[220:223], v31 offset:4096
  s_add_u32 m0, s44, 16384
  s_nop 0
  buffer_load_dwordx4 v1, s[8:11], s83 offen offset:0 nt lds
  buffer_load_dwordx4 v2, s[8:11], s83 offen offset:1024 nt lds
  buffer_load_dwordx4 v3, s[8:11], s83 offen offset:2048 nt lds
  buffer_load_dwordx4 v4, s[8:11], s83 offen offset:3072 nt lds
  s_waitcnt lgkmcnt(3)
  v_lshlrev_b32 v40, 16, v208
  v_lshlrev_b32 v41, 16, v209
  v_lshlrev_b32 v42, 16, v210
  v_lshlrev_b32 v43, 16, v211
  v_and_b32 v208, 0xffff0000, v208
  v_and_b32 v209, 0xffff0000, v209
  v_and_b32 v210, 0xffff0000, v210
  v_and_b32 v211, 0xffff0000, v211
  v_mul_f32 v40, s47, v40
  v_mul_f32 v41, s47, v41
  v_mul_f32 v42, s47, v42
  v_mul_f32 v43, s47, v43
  v_mul_f32 v208, s47, v208
  v_mul_f32 v209, s47, v209
  v_mul_f32 v210, s47, v210
  v_mul_f32 v211, s47, v211
  v_cvt_pk_bf16_f32 v208, v40, v208
  v_cvt_pk_bf16_f32 v209, v41, v209
  v_cvt_pk_bf16_f32 v210, v42, v210
  v_cvt_pk_bf16_f32 v211, v43, v211
  s_waitcnt lgkmcnt(2)
  v_lshlrev_b32 v40, 16, v212
  v_lshlrev_b32 v41, 16, v213
  v_lshlrev_b32 v42, 16, v214
  v_lshlrev_b32 v43, 16, v215
  v_and_b32 v212, 0xffff0000, v212
  v_and_b32 v213, 0xffff0000, v213
  v_and_b32 v214, 0xffff0000, v214
  v_and_b32 v215, 0xffff0000, v215
  v_mul_f32 v40, s47, v40
  v_mul_f32 v41, s47, v41
  v_mul_f32 v42, s47, v42
  v_mul_f32 v43, s47, v43
  v_mul_f32 v212, s47, v212
  v_mul_f32 v213, s47, v213
  v_mul_f32 v214, s47, v214
  v_mul_f32 v215, s47, v215
  v_cvt_pk_bf16_f32 v212, v40, v212
  v_cvt_pk_bf16_f32 v213, v41, v213
  v_cvt_pk_bf16_f32 v214, v42, v214
  v_cvt_pk_bf16_f32 v215, v43, v215
  s_waitcnt lgkmcnt(1)
  v_lshlrev_b32 v40, 16, v216
  v_lshlrev_b32 v41, 16, v217
  v_lshlrev_b32 v42, 16, v218
  v_lshlrev_b32 v43, 16, v219
  v_and_b32 v216, 0xffff0000, v216
  v_and_b32 v217, 0xffff0000, v217
  v_and_b32 v218, 0xffff0000, v218
  v_and_b32 v219, 0xffff0000, v219
  v_mul_f32 v40, s47, v40
  v_mul_f32 v41, s47, v41
  v_mul_f32 v42, s47, v42
  v_mul_f32 v43, s47, v43
  v_mul_f32 v216, s47, v216
  v_mul_f32 v217, s47, v217
  v_mul_f32 v218, s47, v218
  v_mul_f32 v219, s47, v219
  v_cvt_pk_bf16_f32 v216, v40, v216
  v_cvt_pk_bf16_f32 v217, v41, v217
  v_cvt_pk_bf16_f32 v218, v42, v218
  v_cvt_pk_bf16_f32 v219, v43, v219
  s_waitcnt lgkmcnt(0)
  v_lshlrev_b32 v40, 16, v220
  v_lshlrev_b32 v41, 16, v221
  v_lshlrev_b32 v42, 16, v222
  v_lshlrev_b32 v43, 16, v223
  v_and_b32 v220, 0xffff0000, v220
  v_and_b32 v221, 0xffff0000, v221
  v_and_b32 v222, 0xffff0000, v222
  v_and_b32 v223, 0xffff0000, v223
  v_mul_f32 v40, s47, v40
  v_mul_f32 v41, s47, v41
  v_mul_f32 v42, s47, v42
  v_mul_f32 v43, s47, v43
  v_mul_f32 v220, s47, v220
  v_mul_f32 v221, s47, v221
  v_mul_f32 v222, s47, v222
  v_mul_f32 v223, s47, v223
  v_cvt_pk_bf16_f32 v220, v40, v220
  v_cvt_pk_bf16_f32 v221, v41, v221
  v_cvt_pk_bf16_f32 v222, v42, v222
  v_cvt_pk_bf16_f32 v223, v43, v223
  v_mfma_f32_16x16x32_bf16 v[136:139], a[0:3], v[208:211], 0
  v_accvgpr_write_b32 a144, v208
  v_mfma_f32_16x16x32_bf16 v[136:139], a[4:7], v[212:215], v[136:139]
  v_accvgpr_write_b32 a145, v209
  v_mfma_f32_16x16x32_bf16 v[136:139], a[8:11], v[216:219], v[136:139]
  v_accvgpr_write_b32 a146, v210
  v_mfma_f32_16x16x32_bf16 v[136:139], a[12:15], v[220:223], v[136:139]
  v_accvgpr_write_b32 a147, v211
  v_mfma_f32_16x16x32_bf16 v[140:143], a[16:19], v[208:211], 0
  v_accvgpr_write_b32 a148, v212
  v_mfma_f32_16x16x32_bf16 v[140:143], a[20:23], v[212:215], v[140:143]
  v_accvgpr_write_b32 a149, v213
  v_mfma_f32_16x16x32_bf16 v[140:143], a[24:27], v[216:219], v[140:143]
  v_accvgpr_write_b32 a150, v214
  v_mfma_f32_16x16x32_bf16 v[140:143], a[28:31], v[220:223], v[140:143]
  v_accvgpr_write_b32 a151, v215
  v_mfma_f32_16x16x32_bf16 v[168:171], a[32:35], v[208:211], 0
  v_accvgpr_write_b32 a152, v216
  v_mfma_f32_16x16x32_bf16 v[168:171], a[36:39], v[212:215], v[168:171]
  v_accvgpr_write_b32 a153, v217
  v_mfma_f32_16x16x32_bf16 v[168:171], a[40:43], v[216:219], v[168:171]
  v_accvgpr_write_b32 a154, v218
  v_mfma_f32_16x16x32_bf16 v[168:171], a[44:47], v[220:223], v[168:171]
  v_accvgpr_write_b32 a155, v219
  v_mfma_f32_16x16x32_bf16 v[172:175], a[48:51], v[208:211], 0
  v_accvgpr_write_b32 a156, v220
  v_mfma_f32_16x16x32_bf16 v[172:175], a[52:55], v[212:215], v[172:175]
  v_accvgpr_write_b32 a157, v221
  v_mfma_f32_16x16x32_bf16 v[172:175], a[56:59], v[216:219], v[172:175]
  v_accvgpr_write_b32 a158, v222
  v_mfma_f32_16x16x32_bf16 v[172:175], a[60:63], v[220:223], v[172:175]
  v_accvgpr_write_b32 a159, v223
  v_max3_f32 v44, v136, v137, v138
  v_max3_f32 v45, v139, v140, v141
  v_max3_f32 v44, v44, v142, v143
  v_max3_f32 v45, v45, v168, v169
  v_max3_f32 v44, v44, v170, v171
  s_nop 1
  v_max3_f32 v45, v45, v172, v173
  v_max3_f32 v44, v44, v174, v175
  v_max_f32 v44, v44, v45
  v_mov_b32 v24, v44
  s_nop 1
  v_permlane32_swap_b32 v44, v24
  v_max_f32 v44, v44, v24
  v_mov_b32 v24, v44
  s_nop 1
  v_permlane16_swap_b32 v44, v24
  v_max_f32 v44, v44, v24
  v_sub_f32 v52, 0, v44
  v_sub_f32 v53, 0, v44
  v_sub_f32 v54, 0, v44
  v_sub_f32 v55, 0, v44
  v_add_f32 v136, v136, v52
  v_add_f32 v137, v137, v52
  v_exp_f32 v136, v136
  v_add_f32 v138, v138, v52
  v_exp_f32 v137, v137
  v_add_f32 v139, v139, v52
  v_exp_f32 v138, v138
  v_add_f32 v140, v140, v52
  v_exp_f32 v139, v139
  v_cvt_pk_bf16_f32 v136, v136, v137
  v_add_f32 v141, v141, v52
  v_exp_f32 v140, v140
  v_add_f32 v142, v142, v52
  v_exp_f32 v141, v141
  v_cvt_pk_bf16_f32 v137, v138, v139
  v_add_f32 v143, v143, v52
  v_exp_f32 v142, v142
  v_exp_f32 v143, v143
  v_cvt_pk_bf16_f32 v138, v140, v141
  v_cvt_pk_bf16_f32 v139, v142, v143
  s_mov_b64 exec, 0
  s_cmp_eq_u32 s3, 0
  s_cbranch_scc1 L_pad0
  s_cmp_eq_u32 s3, 1
  s_cbranch_scc1 L_pad1
  s_cmp_eq_u32 s3, 2
  s_cbranch_scc1 L_pad2
  s_branch L_pad3
L_padret:
  s_mov_b64 exec, -1
  s_waitcnt vmcnt(8)
  ds_read_b128 v[224:227], v28 offset:8192
  ds_read_b128 v[228:231], v29 offset:8192
  ds_read_b128 v[232:235], v30 offset:8192
  ds_read_b128 v[236:239], v31 offset:8192
  s_add_u32 m0, s44, 49152
  s_nop 0
  buffer_load_dwordx4 v5, s[12:15], s82 offen offset:0 nt lds
  buffer_load_dwordx4 v6, s[12:15], s82 offen offset:1024 nt lds
  buffer_load_dwordx4 v5, s[12:15], s82 offen offset:2048 nt lds
  buffer_load_dwordx4 v6, s[12:15], s82 offen offset:3072 nt lds
  s_waitcnt lgkmcnt(3)
  v_lshlrev_b32 v40, 16, v224
  v_lshlrev_b32 v41, 16, v225
  v_lshlrev_b32 v42, 16, v226
  v_lshlrev_b32 v43, 16, v227
  v_and_b32 v224, 0xffff0000, v224
  v_and_b32 v225, 0xffff0000, v225
  v_and_b32 v226, 0xffff0000, v226
  v_and_b32 v227, 0xffff0000, v227
  v_mul_f32 v40, s47, v40
  v_mul_f32 v41, s47, v41
  v_mul_f32 v42, s47, v42
  v_mul_f32 v43, s47, v43
  v_mul_f32 v224, s47, v224
  v_mul_f32 v225, s47, v225
  v_mul_f32 v226, s47, v226
  v_mul_f32 v227, s47, v227
  v_cvt_pk_bf16_f32 v224, v40, v224
  v_cvt_pk_bf16_f32 v225, v41, v225
  v_cvt_pk_bf16_f32 v226, v42, v226
  v_cvt_pk_bf16_f32 v227, v43, v227
  s_waitcnt lgkmcnt(2)
  v_lshlrev_b32 v40, 16, v228
  v_lshlrev_b32 v41, 16, v229
  v_lshlrev_b32 v42, 16, v230
  v_lshlrev_b32 v43, 16, v231
  v_and_b32 v228, 0xffff0000, v228
  v_and_b32 v229, 0xffff0000, v229
  v_and_b32 v230, 0xffff0000, v230
  v_and_b32 v231, 0xffff0000, v231
  v_mul_f32 v40, s47, v40
  v_mul_f32 v41, s47, v41
  v_mul_f32 v42, s47, v42
  v_mul_f32 v43, s47, v43
  v_mul_f32 v228, s47, v228
  v_mul_f32 v229, s47, v229
  v_mul_f32 v230, s47, v230
  v_mul_f32 v231, s47, v231
  v_cvt_pk_bf16_f32 v228, v40, v228
  v_cvt_pk_bf16_f32 v229, v41, v229
  v_cvt_pk_bf16_f32 v230, v42, v230
  v_cvt_pk_bf16_f32 v231, v43, v231
  s_waitcnt lgkmcnt(1)
  v_lshlrev_b32 v40, 16, v232
  v_lshlrev_b32 v41, 16, v233
  v_lshlrev_b32 v42, 16, v234
  v_lshlrev_b32 v43, 16, v235
  v_and_b32 v232, 0xffff0000, v232
  v_and_b32 v233, 0xffff0000, v233
  v_and_b32 v234, 0xffff0000, v234
  v_and_b32 v235, 0xffff0000, v235
  v_mul_f32 v40, s47, v40
  v_mul_f32 v41, s47, v41
  v_mul_f32 v42, s47, v42
  v_mul_f32 v43, s47, v43
  v_mul_f32 v232, s47, v232
  v_mul_f32 v233, s47, v233
  v_mul_f32 v234, s47, v234
  v_mul_f32 v235, s47, v235
  v_cvt_pk_bf16_f32 v232, v40, v232
  v_cvt_pk_bf16_f32 v233, v41, v233
  v_cvt_pk_bf16_f32 v234, v42, v234
  v_cvt_pk_bf16_f32 v235, v43, v235
  s_waitcnt lgkmcnt(0)
  v_lshlrev_b32 v40, 16, v236
  v_lshlrev_b32 v41, 16, v237
  v_lshlrev_b32 v42, 16, v238
  v_lshlrev_b32 v43, 16, v239
  v_and_b32 v236, 0xffff0000, v236
  v_and_b32 v237, 0xffff0000, v237
  v_and_b32 v238, 0xffff0000, v238
  v_and_b32 v239, 0xffff0000, v239
  v_mul_f32 v40, s47, v40
  v_mul_f32 v41, s47, v41
  v_mul_f32 v42, s47, v42
  v_mul_f32 v43, s47, v43
  v_mul_f32 v236, s47, v236
  v_mul_f32 v237, s47, v237
  v_mul_f32 v238, s47, v238
  v_mul_f32 v239, s47, v239
  v_cvt_pk_bf16_f32 v236, v40, v236
  v_cvt_pk_bf16_f32 v237, v41, v237
  v_cvt_pk_bf16_f32 v238, v42, v238
  v_cvt_pk_bf16_f32 v239, v43, v239
  v_mfma_f32_16x16x32_bf16 v[144:147], a[0:3], v[224:227], 0
  v_accvgpr_write_b32 a160, v224
  v_mfma_f32_16x16x32_bf16 v[144:147], a[4:7], v[228:231], v[144:147]
  v_accvgpr_write_b32 a161, v225
  v_mfma_f32_16x16x32_bf16 v[144:147], a[8:11], v[232:235], v[144:147]
  v_accvgpr_write_b32 a162, v226
  v_mfma_f32_16x16x32_bf16 v[144:147], a[12:15], v[236:239], v[144:147]
  v_accvgpr_write_b32 a163, v227
  v_mfma_f32_16x16x32_bf16 v[148:151], a[16:19], v[224:227], 0
  v_accvgpr_write_b32 a164, v228
  v_mfma_f32_16x16x32_bf16 v[148:151], a[20:23], v[228:231], v[148:151]
  v_accvgpr_write_b32 a165, v229
  v_mfma_f32_16x16x32_bf16 v[148:151], a[24:27], v[232:235], v[148:151]
  v_accvgpr_write_b32 a166, v230
  v_mfma_f32_16x16x32_bf16 v[148:151], a[28:31], v[236:239], v[148:151]
  v_accvgpr_write_b32 a167, v231
  v_mfma_f32_16x16x32_bf16 v[176:179], a[32:35], v[224:227], 0
  v_accvgpr_write_b32 a168, v232
  v_mfma_f32_16x16x32_bf16 v[176:179], a[36:39], v[228:231], v[176:179]
  v_accvgpr_write_b32 a169, v233
  v_mfma_f32_16x16x32_bf16 v[176:179], a[40:43], v[232:235], v[176:179]
  v_accvgpr_write_b32 a170, v234
  v_mfma_f32_16x16x32_bf16 v[176:179], a[44:47], v[236:239], v[176:179]
  v_accvgpr_write_b32 a171, v235
  v_mfma_f32_16x16x32_bf16 v[180:183], a[48:51], v[224:227], 0
  v_accvgpr_write_b32 a172, v236
  v_mfma_f32_16x16x32_bf16 v[180:183], a[52:55], v[228:231], v[180:183]
  v_accvgpr_write_b32 a173, v237
  v_mfma_f32_16x16x32_bf16 v[180:183], a[56:59], v[232:235], v[180:183]
  v_accvgpr_write_b32 a174, v238
  v_mfma_f32_16x16x32_bf16 v[180:183], a[60:63], v[236:239], v[180:183]
  v_accvgpr_write_b32 a175, v239
  v_max3_f32 v44, v144, v145, v146
  v_max3_f32 v45, v147, v148, v149
  v_max3_f32 v44, v44, v150, v151
  v_max3_f32 v45, v45, v176, v177
  v_max3_f32 v44, v44, v178, v179
  s_nop 1
  v_max3_f32 v45, v45, v180, v181
  v_max3_f32 v44, v44, v182, v183
  v_max_f32 v44, v44, v45
  v_mov_b32 v24, v44
  s_nop 1
  v_permlane32_swap_b32 v44, v24
  v_max_f32 v44, v44, v24
  v_mov_b32 v24, v44
  s_nop 1
  v_permlane16_swap_b32 v44, v24
  v_max_f32 v44, v44, v24
  v_sub_f32 v56, 0, v44
L_pad0:
  s_cbranch_execz L_pad4
  v_sub_f32 v57, 0, v44
  v_sub_f32 v58, 0, v44
  v_sub_f32 v59, 0, v44
  v_add_f32 v144, v144, v56
  v_add_f32 v145, v145, v56
  v_exp_f32 v144, v144
  v_add_f32 v146, v146, v56
  v_exp_f32 v145, v145
  v_add_f32 v147, v147, v56
  v_exp_f32 v146, v146
  v_add_f32 v148, v148, v56
  v_exp_f32 v147, v147
  v_cvt_pk_bf16_f32 v144, v144, v145
  v_add_f32 v149, v149, v56
  v_exp_f32 v148, v148
  v_add_f32 v150, v150, v56
  v_exp_f32 v149, v149
  v_cvt_pk_bf16_f32 v145, v146, v147
  v_add_f32 v151, v151, v56
  v_exp_f32 v150, v150
  v_exp_f32 v151, v151
  v_cvt_pk_bf16_f32 v146, v148, v149
  v_cvt_pk_bf16_f32 v147, v150, v151
  s_waitcnt vmcnt(8)
  ds_read_b128 v[240:243], v28 offset:12288
  ds_read_b128 v[244:247], v29 offset:12288
  ds_read_b128 v[248:251], v30 offset:12288
  ds_read_b128 v[252:255], v31 offset:12288
  s_add_u32 m0, s44, 32768
  s_nop 0
  buffer_load_dwordx4 v1, s[8:11], s84 offen offset:0 nt lds
  buffer_load_dwordx4 v2, s[8:11], s84 offen offset:1024 nt lds
  buffer_load_dwordx4 v3, s[8:11], s84 offen offset:2048 nt lds
  buffer_load_dwordx4 v4, s[8:11], s84 offen offset:3072 nt lds
  s_waitcnt lgkmcnt(3)
  v_lshlrev_b32 v40, 16, v240
  v_lshlrev_b32 v41, 16, v241
  v_lshlrev_b32 v42, 16, v242
  v_lshlrev_b32 v43, 16, v243
  v_and_b32 v240, 0xffff0000, v240
  v_and_b32 v241, 0xffff0000, v241
  v_and_b32 v242, 0xffff0000, v242
  v_and_b32 v243, 0xffff0000, v243
  v_mul_f32 v40, s47, v40
  v_mul_f32 v41, s47, v41
  v_mul_f32 v42, s47, v42
  v_mul_f32 v43, s47, v43
  v_mul_f32 v240, s47, v240
  v_mul_f32 v241, s47, v241
  v_mul_f32 v242, s47, v242
  v_mul_f32 v243, s47, v243
  v_cvt_pk_bf16_f32 v240, v40, v240
  v_cvt_pk_bf16_f32 v241, v41, v241
  v_cvt_pk_bf16_f32 v242, v42, v242
  v_cvt_pk_bf16_f32 v243, v43, v243
  s_waitcnt lgkmcnt(2)
  v_lshlrev_b32 v40, 16, v244
  v_lshlrev_b32 v41, 16, v245
  v_lshlrev_b32 v42, 16, v246
  v_lshlrev_b32 v43, 16, v247
  v_and_b32 v244, 0xffff0000, v244
  v_and_b32 v245, 0xffff0000, v245
  v_and_b32 v246, 0xffff0000, v246
  v_and_b32 v247, 0xffff0000, v247
  v_mul_f32 v40, s47, v40
  v_mul_f32 v41, s47, v41
  v_mul_f32 v42, s47, v42
  v_mul_f32 v43, s47, v43
  v_mul_f32 v244, s47, v244
  v_mul_f32 v245, s47, v245
  v_mul_f32 v246, s47, v246
  v_mul_f32 v247, s47, v247
  v_cvt_pk_bf16_f32 v244, v40, v244
  v_cvt_pk_bf16_f32 v245, v41, v245
  v_cvt_pk_bf16_f32 v246, v42, v246
  v_cvt_pk_bf16_f32 v247, v43, v247
  s_waitcnt lgkmcnt(1)
  v_lshlrev_b32 v40, 16, v248
  v_lshlrev_b32 v41, 16, v249
  v_lshlrev_b32 v42, 16, v250
  v_lshlrev_b32 v43, 16, v251
  v_and_b32 v248, 0xffff0000, v248
  v_and_b32 v249, 0xffff0000, v249
  v_and_b32 v250, 0xffff0000, v250
  v_and_b32 v251, 0xffff0000, v251
  v_mul_f32 v40, s47, v40
  v_mul_f32 v41, s47, v41
  v_mul_f32 v42, s47, v42
  v_mul_f32 v43, s47, v43
  v_mul_f32 v248, s47, v248
  v_mul_f32 v249, s47, v249
  v_mul_f32 v250, s47, v250
  v_mul_f32 v251, s47, v251
  v_cvt_pk_bf16_f32 v248, v40, v248
  v_cvt_pk_bf16_f32 v249, v41, v249
  v_cvt_pk_bf16_f32 v250, v42, v250
  v_cvt_pk_bf16_f32 v251, v43, v251
  s_waitcnt lgkmcnt(0)
  v_lshlrev_b32 v40, 16, v252
  v_lshlrev_b32 v41, 16, v253
  v_lshlrev_b32 v42, 16, v254
  v_lshlrev_b32 v43, 16, v255
  v_and_b32 v252, 0xffff0000, v252
  v_and_b32 v253, 0xffff0000, v253
  v_and_b32 v254, 0xffff0000, v254
  v_and_b32 v255, 0xffff0000, v255
  v_mul_f32 v40, s47, v40
  v_mul_f32 v41, s47, v41
  v_mul_f32 v42, s47, v42
  v_mul_f32 v43, s47, v43
  v_mul_f32 v252, s47, v252
  v_mul_f32 v253, s47, v253
  v_mul_f32 v254, s47, v254
  v_mul_f32 v255, s47, v255
  v_cvt_pk_bf16_f32 v252, v40, v252
  v_cvt_pk_bf16_f32 v253, v41, v253
  v_cvt_pk_bf16_f32 v254, v42, v254
  v_cvt_pk_bf16_f32 v255, v43, v255
  v_mfma_f32_16x16x32_bf16 v[152:155], a[0:3], v[240:243], 0
  v_accvgpr_write_b32 a176, v240
  v_mfma_f32_16x16x32_bf16 v[152:155], a[4:7], v[244:247], v[152:155]
  v_accvgpr_write_b32 a177, v241
  v_mfma_f32_16x16x32_bf16 v[152:155], a[8:11], v[248:251], v[152:155]
  v_accvgpr_write_b32 a178, v242
  v_mfma_f32_16x16x32_bf16 v[152:155], a[12:15], v[252:255], v[152:155]
  v_accvgpr_write_b32 a179, v243
  v_mfma_f32_16x16x32_bf16 v[156:159], a[16:19], v[240:243], 0
  v_accvgpr_write_b32 a180, v244
  v_mfma_f32_16x16x32_bf16 v[156:159], a[20:23], v[244:247], v[156:159]
  v_accvgpr_write_b32 a181, v245
  v_mfma_f32_16x16x32_bf16 v[156:159], a[24:27], v[248:251], v[156:159]
  v_accvgpr_write_b32 a182, v246
  v_mfma_f32_16x16x32_bf16 v[156:159], a[28:31], v[252:255], v[156:159]
  v_accvgpr_write_b32 a183, v247
  v_mfma_f32_16x16x32_bf16 v[184:187], a[32:35], v[240:243], 0
  v_accvgpr_write_b32 a184, v248
  v_mfma_f32_16x16x32_bf16 v[184:187], a[36:39], v[244:247], v[184:187]
  v_accvgpr_write_b32 a185, v249
  v_mfma_f32_16x16x32_bf16 v[184:187], a[40:43], v[248:251], v[184:187]
  v_accvgpr_write_b32 a186, v250
  v_mfma_f32_16x16x32_bf16 v[184:187], a[44:47], v[252:255], v[184:187]
  v_accvgpr_write_b32 a187, v251
  v_mfma_f32_16x16x32_bf16 v[188:191], a[48:51], v[240:243], 0
  v_accvgpr_write_b32 a188, v252
  v_mfma_f32_16x16x32_bf16 v[188:191], a[52:55], v[244:247], v[188:191]
  v_accvgpr_write_b32 a189, v253
  v_mfma_f32_16x16x32_bf16 v[188:191], a[56:59], v[248:251], v[188:191]
  v_accvgpr_write_b32 a190, v254
  v_mfma_f32_16x16x32_bf16 v[188:191], a[60:63], v[252:255], v[188:191]
  v_accvgpr_write_b32 a191, v255
  v_max3_f32 v44, v152, v153, v154
  v_max3_f32 v45, v155, v156, v157
  v_max3_f32 v44, v44, v158, v159
  v_max3_f32 v45, v45, v184, v185
  v_max3_f32 v44, v44, v186, v187
  s_nop 1
  v_max3_f32 v45, v45, v188, v189
  v_max3_f32 v44, v44, v190, v191
  v_max_f32 v44, v44, v45
  v_mov_b32 v24, v44
  s_nop 1
  v_permlane32_swap_b32 v44, v24
  v_max_f32 v44, v44, v24
  v_mov_b32 v24, v44
  s_nop 1
  v_permlane16_swap_b32 v44, v24
  v_max_f32 v44, v44, v24
  v_sub_f32 v60, 0, v44
  v_sub_f32 v61, 0, v44
  v_sub_f32 v62, 0, v44
  v_sub_f32 v63, 0, v44
  v_add_f32 v152, v152, v60
  v_add_f32 v153, v153, v60
  v_exp_f32 v152, v152
  v_add_f32 v154, v154, v60
  v_exp_f32 v153, v153
  v_add_f32 v155, v155, v60
  v_exp_f32 v154, v154
  v_add_f32 v156, v156, v60
  v_exp_f32 v155, v155
  v_cvt_pk_bf16_f32 v152, v152, v153
  v_add_f32 v157, v157, v60
  v_exp_f32 v156, v156
  v_add_f32 v158, v158, v60
  v_exp_f32 v157, v157
  v_cvt_pk_bf16_f32 v153, v154, v155
  v_add_f32 v159, v159, v60
  v_exp_f32 v158, v158
  v_exp_f32 v159, v159
  v_cvt_pk_bf16_f32 v154, v156, v157
  v_cvt_pk_bf16_f32 v155, v158, v159
  s_waitcnt vmcnt(8)
  s_barrier
  ds_read_b128 a[192:195], v8 offset:16384
  ds_read_b128 a[196:199], v9 offset:16384
  ds_read_b128 a[200:203], v10 offset:16384
  ds_read_b128 a[204:207], v11 offset:16384
  s_waitcnt lgkmcnt(3)
  v_mfma_f32_16x16x32_bf16 v[192:195], a[192:195], a[128:131], v[20:23]
  s_waitcnt lgkmcnt(2)
  v_mfma_f32_16x16x32_bf16 v[192:195], a[196:199], a[132:135], v[192:195]
  s_waitcnt lgkmcnt(1)
  v_mfma_f32_16x16x32_bf16 v[192:195], a[200:203], a[136:139], v[192:195]
  s_waitcnt lgkmcnt(0)
  v_mfma_f32_16x16x32_bf16 v[192:195], a[204:207], a[140:143], v[192:195]
  v_add_f32 v160, v160, v20
  v_add_f32 v161, v161, v20
  v_exp_f32 v160, v160
  v_add_f32 v162, v162, v20
  v_exp_f32 v161, v161
  v_add_f32 v163, v163, v20
  v_exp_f32 v162, v162
  ds_read_b128 a[208:211], v8 offset:20480
  ds_read_b128 a[212:215], v9 offset:20480
  v_mfma_f32_16x16x32_bf16 v[200:203], a[192:195], a[144:147], v[52:55]
  v_mfma_f32_16x16x32_bf16 v[200:203], a[196:199], a[148:151], v[200:203]
  v_mfma_f32_16x16x32_bf16 v[200:203], a[200:203], a[152:155], v[200:203]
  v_mfma_f32_16x16x32_bf16 v[200:203], a[204:207], a[156:159], v[200:203]
  v_add_f32 v164, v164, v20
  v_exp_f32 v163, v163
  v_cvt_pk_bf16_f32 v160, v160, v161
  v_add_f32 v165, v165, v20
  v_exp_f32 v164, v164
  v_add_f32 v166, v166, v20
  ds_read_b128 a[216:219], v10 offset:20480
  v_mfma_f32_16x16x32_bf16 v[208:211], a[192:195], a[160:163], v[56:59]
  v_mfma_f32_16x16x32_bf16 v[208:211], a[196:199], a[164:167], v[208:211]
  v_mfma_f32_16x16x32_bf16 v[208:211], a[200:203], a[168:171], v[208:211]
  v_mfma_f32_16x16x32_bf16 v[208:211], a[204:207], a[172:175], v[208:211]
  v_exp_f32 v165, v165
  v_cvt_pk_bf16_f32 v161, v162, v163
  v_add_f32 v167, v167, v20
  v_exp_f32 v166, v166
  v_add_f32 v168, v168, v52
  v_exp_f32 v167, v167
  ds_read_b128 a[220:223], v11 offset:20480
  v_mfma_f32_16x16x32_bf16 v[216:219], a[192:195], a[176:179], v[60:63]
  v_mfma_f32_16x16x32_bf16 v[216:219], a[196:199], a[180:183], v[216:219]
  v_mfma_f32_16x16x32_bf16 v[216:219], a[200:203], a[184:187], v[216:219]
  v_mfma_f32_16x16x32_bf16 v[216:219], a[204:207], a[188:191], v[216:219]
  v_cvt_pk_bf16_f32 v162, v164, v165
  v_add_f32 v169, v169, v52
  v_exp_f32 v168, v168
  v_add_f32 v170, v170, v52
  v_exp_f32 v169, v169
  v_cvt_pk_bf16_f32 v163, v166, v167
  s_waitcnt lgkmcnt(0)
  v_mfma_f32_16x16x32_bf16 v[196:199], a[208:211], a[128:131], v[20:23]
  v_mfma_f32_16x16x32_bf16 v[196:199], a[212:215], a[132:135], v[196:199]
  v_mfma_f32_16x16x32_bf16 v[196:199], a[216:219], a[136:139], v[196:199]
  v_mfma_f32_16x16x32_bf16 v[196:199], a[220:223], a[140:143], v[196:199]
  v_add_f32 v171, v171, v52
  v_exp_f32 v170, v170
  v_add_f32 v172, v172, v52
  v_exp_f32 v171, v171
  v_cvt_pk_bf16_f32 v168, v168, v169
  v_add_f32 v173, v173, v52
  v_exp_f32 v172, v172
  ds_read_b128 a[192:195], v8 offset:24576
  ds_read_b128 a[196:199], v9 offset:24576
  v_mfma_f32_16x16x32_bf16 v[204:207], a[208:211], a[144:147], v[52:55]
  v_mfma_f32_16x16x32_bf16 v[204:207], a[212:215], a[148:151], v[204:207]
  v_mfma_f32_16x16x32_bf16 v[204:207], a[216:219], a[152:155], v[204:207]
  v_mfma_f32_16x16x32_bf16 v[204:207], a[220:223], a[156:159], v[204:207]
  v_add_f32 v174, v174, v52
  v_exp_f32 v173, v173
  v_cvt_pk_bf16_f32 v169, v170, v171
  v_add_f32 v175, v175, v52
  v_exp_f32 v174, v174
  v_add_f32 v176, v176, v56
  ds_read_b128 a[200:203], v10 offset:24576
  v_mfma_f32_16x16x32_bf16 v[212:215], a[208:211], a[160:163], v[56:59]
  v_mfma_f32_16x16x32_bf16 v[212:215], a[212:215], a[164:167], v[212:215]
  v_mfma_f32_16x16x32_bf16 v[212:215], a[216:219], a[168:171], v[212:215]
  v_mfma_f32_16x16x32_bf16 v[212:215], a[220:223], a[172:175], v[212:215]
  v_exp_f32 v175, v175
  v_cvt_pk_bf16_f32 v170, v172, v173
  v_add_f32 v177, v177, v56
  v_exp_f32 v176, v176
  v_add_f32 v178, v178, v56
  v_exp_f32 v177, v177
  ds_read_b128 a[204:207], v11 offset:24576
  v_mfma_f32_16x16x32_bf16 v[220:223], a[208:211], a[176:179], v[60:63]
  v_mfma_f32_16x16x32_bf16 v[220:223], a[212:215], a[180:183], v[220:223]
  v_mfma_f32_16x16x32_bf16 v[220:223], a[216:219], a[184:187], v[220:223]
  v_mfma_f32_16x16x32_bf16 v[220:223], a[220:223], a[188:191], v[220:223]
  v_cvt_pk_bf16_f32 v171, v174, v175
  v_add_f32 v179, v179, v56
  v_exp_f32 v178, v178
  v_add_f32 v180, v180, v56
  v_exp_f32 v179, v179
  v_cvt_pk_bf16_f32 v176, v176, v177
  s_waitcnt lgkmcnt(0)
  v_mfma_f32_16x16x32_bf16 v[224:227], a[192:195], a[128:131], v[20:23]
  v_mfma_f32_16x16x32_bf16 v[224:227], a[196:199], a[132:135], v[224:227]
  v_mfma_f32_16x16x32_bf16 v[224:227], a[200:203], a[136:139], v[224:227]
  v_mfma_f32_16x16x32_bf16 v[224:227], a[204:207], a[140:143], v[224:227]
  v_add_f32 v181, v181, v56
  v_exp_f32 v180, v180
  v_add_f32 v182, v182, v56
  v_exp_f32 v181, v181
  v_cvt_pk_bf16_f32 v177, v178, v179
  v_add_f32 v183, v183, v56
  v_exp_f32 v182, v182
  ds_read_b128 a[208:211], v8 offset:28672
  ds_read_b128 a[212:215], v9 offset:28672
  v_mfma_f32_16x16x32_bf16 v[232:235], a[192:195], a[144:147], v[52:55]
  v_mfma_f32_16x16x32_bf16 v[232:235], a[196:199], a[148:151], v[232:235]
  v_mfma_f32_16x16x32_bf16 v[232:235], a[200:203], a[152:155], v[232:235]
  v_mfma_f32_16x16x32_bf16 v[232:235], a[204:207], a[156:159], v[232:235]
  v_add_f32 v184, v184, v60
  v_exp_f32 v183, v183
  v_cvt_pk_bf16_f32 v178, v180, v181
  v_add_f32 v185, v185, v60
  v_exp_f32 v184, v184
  v_add_f32 v186, v186, v60
  ds_read_b128 a[216:219], v10 offset:28672
  v_mfma_f32_16x16x32_bf16 v[240:243], a[192:195], a[160:163], v[56:59]
  v_mfma_f32_16x16x32_bf16 v[240:243], a[196:199], a[164:167], v[240:243]
  v_mfma_f32_16x16x32_bf16 v[240:243], a[200:203], a[168:171], v[240:243]
  v_mfma_f32_16x16x32_bf16 v[240:243], a[204:207], a[172:175], v[240:243]
  v_exp_f32 v185, v185
  v_cvt_pk_bf16_f32 v179, v182, v183
  v_add_f32 v187, v187, v60
  v_exp_f32 v186, v186
  v_add_f32 v188, v188, v60
  v_exp_f32 v187, v187
  ds_read_b128 a[220:223], v11 offset:28672
  v_mfma_f32_16x16x32_bf16 v[248:251], a[192:195], a[176:179], v[60:63]
  s_waitcnt vmcnt(4)
  s_barrier
  v_mfma_f32_16x16x32_bf16 v[248:251], a[196:199], a[180:183], v[248:251]
  s_add_u32 m0, s44, 65536
  v_mfma_f32_16x16x32_bf16 v[248:251], a[200:203], a[184:187], v[248:251]
  v_mfma_f32_16x16x32_bf16 v[248:251], a[204:207], a[188:191], v[248:251]
  v_cvt_pk_bf16_f32 v184, v184, v185
  v_add_f32 v189, v189, v60
  v_exp_f32 v188, v188
  v_add_f32 v190, v190, v60
  s_waitcnt lgkmcnt(0)
  v_mfma_f32_16x16x32_bf16 v[228:231], a[208:211], a[128:131], v[20:23]
  buffer_load_dwordx4 v5, s[12:15], s83 offen offset:0 nt lds
  v_mfma_f32_16x16x32_bf16 v[228:231], a[212:215], a[132:135], v[228:231]
  v_mfma_f32_16x16x32_bf16 v[228:231], a[216:219], a[136:139], v[228:231]
  v_mfma_f32_16x16x32_bf16 v[228:231], a[220:223], a[140:143], v[228:231]
  v_exp_f32 v189, v189
  v_cvt_pk_bf16_f32 v185, v186, v187
  v_add_f32 v191, v191, v60
  v_exp_f32 v190, v190
  v_exp_f32 v191, v191
  ds_read_b64_tr_b16 a[192:193], v12 offset:0
  ds_read_b64_tr_b16 a[194:195], v12 offset:4096
  ds_read_b64_tr_b16 a[196:197], v12 offset:8192
  ds_read_b64_tr_b16 a[198:199], v12 offset:12288
  v_mfma_f32_16x16x32_bf16 v[236:239], a[208:211], a[144:147], v[52:55]
  v_mfma_f32_16x16x32_bf16 v[236:239], a[212:215], a[148:151], v[236:239]
  v_mfma_f32_16x16x32_bf16 v[236:239], a[216:219], a[152:155], v[236:239]
  buffer_load_dwordx4 v6, s[12:15], s83 offen offset:1024 nt lds
  v_mfma_f32_16x16x32_bf16 v[236:239], a[220:223], a[156:159], v[236:239]
  v_cvt_pk_bf16_f32 v186, v188, v189
  v_cvt_pk_bf16_f32 v187, v190, v191
  ds_read_b64_tr_b16 a[200:201], v13 offset:0
  ds_read_b64_tr_b16 a[202:203], v13 offset:4096
  v_mfma_f32_16x16x32_bf16 v[244:247], a[208:211], a[160:163], v[56:59]
  v_mfma_f32_16x16x32_bf16 v[244:247], a[212:215], a[164:167], v[244:247]
  v_mfma_f32_16x16x32_bf16 v[244:247], a[216:219], a[168:171], v[244:247]
  v_mfma_f32_16x16x32_bf16 v[244:247], a[220:223], a[172:175], v[244:247]
  ds_read_b64_tr_b16 a[204:205], v13 offset:8192
  ds_read_b64_tr_b16 a[206:207], v13 offset:12288
  v_mfma_f32_16x16x32_bf16 v[252:255], a[208:211], a[176:179], v[60:63]
  buffer_load_dwordx4 v5, s[12:15], s83 offen offset:2048 nt lds
  v_mfma_f32_16x16x32_bf16 v[252:255], a[212:215], a[180:183], v[252:255]
  v_mfma_f32_16x16x32_bf16 v[252:255], a[216:219], a[184:187], v[252:255]
  v_mfma_f32_16x16x32_bf16 v[252:255], a[220:223], a[188:191], v[252:255]
  s_waitcnt lgkmcnt(0)
  v_mfma_f32_16x16x32_bf16 a[0:3], a[192:195], v[128:131], 0
  buffer_load_dwordx4 v6, s[12:15], s83 offen offset:3072 nt lds
  v_mfma_f32_16x16x32_bf16 a[0:3], a[196:199], v[160:163], a[0:3]
  ds_read_b64_tr_b16 a[208:209], v14 offset:0
  ds_read_b64_tr_b16 a[210:211], v14 offset:4096
  v_mfma_f32_16x16x32_bf16 a[32:35], a[192:195], v[136:139], 0
  v_mfma_f32_16x16x32_bf16 a[32:35], a[196:199], v[168:171], a[32:35]
  v_exp_f32 v192, v192
  v_exp_f32 v193, v193
  v_exp_f32 v194, v194
  v_exp_f32 v195, v195
  v_cvt_pk_bf16_f32 v192, v192, v193
  v_exp_f32 v196, v196
  ds_read_b64_tr_b16 a[212:213], v14 offset:8192
  ds_read_b64_tr_b16 a[214:215], v14 offset:12288
  v_mfma_f32_16x16x32_bf16 a[64:67], a[192:195], v[144:147], 0
  v_mfma_f32_16x16x32_bf16 a[64:67], a[196:199], v[176:179], a[64:67]
  v_exp_f32 v197, v197
  ds_read_b64_tr_b16 a[216:217], v15 offset:0
  ds_read_b64_tr_b16 a[218:219], v15 offset:4096
  v_mfma_f32_16x16x32_bf16 a[96:99], a[192:195], v[152:155], 0
  v_mfma_f32_16x16x32_bf16 a[96:99], a[196:199], v[184:187], a[96:99]
  v_cvt_pk_bf16_f32 v193, v194, v195
  v_exp_f32 v198, v198
  ds_read_b64_tr_b16 a[220:221], v15 offset:8192
  ds_read_b64_tr_b16 a[222:223], v15 offset:12288
  v_mfma_f32_16x16x32_bf16 a[4:7], a[200:203], v[128:131], 0
  v_mfma_f32_16x16x32_bf16 a[4:7], a[204:207], v[160:163], a[4:7]
  v_exp_f32 v199, v199
  v_mfma_f32_16x16x32_bf16 a[224:227], a[240:243], v[128:131], 0
  v_cvt_pk_bf16_f32 v194, v196, v197
  v_exp_f32 v224, v224
  v_mfma_f32_16x16x32_bf16 a[224:227], a[240:243], v[160:163], a[224:227]
  v_exp_f32 v225, v225
  v_mfma_f32_16x16x32_bf16 a[36:39], a[200:203], v[136:139], 0
  v_mfma_f32_16x16x32_bf16 a[36:39], a[204:207], v[168:171], a[36:39]
  v_cvt_pk_bf16_f32 v195, v198, v199
  v_exp_f32 v226, v226
  v_mfma_f32_16x16x32_bf16 a[68:71], a[200:203], v[144:147], 0
  v_mfma_f32_16x16x32_bf16 a[68:71], a[204:207], v[176:179], a[68:71]
  v_exp_f32 v227, v227
  v_mfma_f32_16x16x32_bf16 a[100:103], a[200:203], v[152:155], 0
  v_mfma_f32_16x16x32_bf16 a[100:103], a[204:207], v[184:187], a[100:103]
  v_cvt_pk_bf16_f32 v224, v224, v225
  s_waitcnt lgkmcnt(0)
  v_mfma_f32_16x16x32_bf16 a[8:11], a[208:211], v[128:131], 0
  v_mfma_f32_16x16x32_bf16 a[8:11], a[212:215], v[160:163], a[8:11]
  v_exp_f32 v228, v228
  v_exp_f32 v229, v229
  ds_read_b64_tr_b16 a[192:193], v16 offset:0
  ds_read_b64_tr_b16 a[194:195], v16 offset:4096
  v_mfma_f32_16x16x32_bf16 a[40:43], a[208:211], v[136:139], 0
  v_mfma_f32_16x16x32_bf16 a[40:43], a[212:215], v[168:171], a[40:43]
  v_cvt_pk_bf16_f32 v225, v226, v227
  v_exp_f32 v230, v230
  ds_read_b64_tr_b16 a[196:197], v16 offset:8192
  ds_read_b64_tr_b16 a[198:199], v16 offset:12288
  v_mfma_f32_16x16x32_bf16 a[72:75], a[208:211], v[144:147], 0
  v_mfma_f32_16x16x32_bf16 a[72:75], a[212:215], v[176:179], a[72:75]
  v_exp_f32 v231, v231
  ds_read_b64_tr_b16 a[200:201], v17 offset:0
  ds_read_b64_tr_b16 a[202:203], v17 offset:4096
  v_mfma_f32_16x16x32_bf16 a[104:107], a[208:211], v[152:155], 0
  v_mfma_f32_16x16x32_bf16 a[104:107], a[212:215], v[184:187], a[104:107]
  v_cvt_pk_bf16_f32 v226, v228, v229
  v_exp_f32 v200, v200
  ds_read_b64_tr_b16 a[204:205], v17 offset:8192
  ds_read_b64_tr_b16 a[206:207], v17 offset:12288
  v_mfma_f32_16x16x32_bf16 a[12:15], a[216:219], v[128:131], 0
  v_mfma_f32_16x16x32_bf16 a[12:15], a[220:223], v[160:163], a[12:15]
  v_exp_f32 v201, v201
  v_mfma_f32_16x16x32_bf16 a[228:231], a[240:243], v[136:139], 0
  v_cvt_pk_bf16_f32 v227, v230, v231
  v_exp_f32 v202, v202
  v_mfma_f32_16x16x32_bf16 a[228:231], a[240:243], v[168:171], a[228:231]
  v_exp_f32 v203, v203
  v_mfma_f32_16x16x32_bf16 a[44:47], a[216:219], v[136:139], 0
  v_mfma_f32_16x16x32_bf16 a[44:47], a[220:223], v[168:171], a[44:47]
  v_cvt_pk_bf16_f32 v200, v200, v201
  v_exp_f32 v204, v204
  v_mfma_f32_16x16x32_bf16 a[76:79], a[216:219], v[144:147], 0
  v_mfma_f32_16x16x32_bf16 a[76:79], a[220:223], v[176:179], a[76:79]
  v_exp_f32 v205, v205
  s_add_u32 m0, s55, 0
  s_add_u32 s46, s45, 0
  v_mfma_f32_16x16x32_bf16 a[108:111], a[216:219], v[152:155], 0
  buffer_load_dwordx4 v1, s[28:31], s46 offen offset:0 nt lds
  v_mfma_f32_16x16x32_bf16 a[108:111], a[220:223], v[184:187], a[108:111]
  s_waitcnt lgkmcnt(0)
  v_mfma_f32_16x16x32_bf16 a[16:19], a[192:195], v[128:131], 0
  v_mfma_f32_16x16x32_bf16 a[16:19], a[196:199], v[160:163], a[16:19]
  v_cvt_pk_bf16_f32 v201, v202, v203
  v_exp_f32 v206, v206
  ds_read_b64_tr_b16 a[208:209], v18 offset:0
  ds_read_b64_tr_b16 a[210:211], v18 offset:4096
  v_mfma_f32_16x16x32_bf16 a[48:51], a[192:195], v[136:139], 0
  v_mfma_f32_16x16x32_bf16 a[48:51], a[196:199], v[168:171], a[48:51]
  v_exp_f32 v207, v207
  ds_read_b64_tr_b16 a[212:213], v18 offset:8192
  ds_read_b64_tr_b16 a[214:215], v18 offset:12288
  v_mfma_f32_16x16x32_bf16 a[80:83], a[192:195], v[144:147], 0
  buffer_load_dwordx4 v2, s[28:31], s46 offen offset:1024 nt lds
  v_mfma_f32_16x16x32_bf16 a[80:83], a[196:199], v[176:179], a[80:83]
  ds_read_b64_tr_b16 a[216:217], v19 offset:0
  ds_read_b64_tr_b16 a[218:219], v19 offset:4096
  v_mfma_f32_16x16x32_bf16 a[112:115], a[192:195], v[152:155], 0
  v_mfma_f32_16x16x32_bf16 a[112:115], a[196:199], v[184:187], a[112:115]
  v_cvt_pk_bf16_f32 v202, v204, v205
  v_exp_f32 v232, v232
  ds_read_b64_tr_b16 a[220:221], v19 offset:8192
  ds_read_b64_tr_b16 a[222:223], v19 offset:12288
  v_mfma_f32_16x16x32_bf16 a[20:23], a[200:203], v[128:131], 0
  v_mfma_f32_16x16x32_bf16 a[20:23], a[204:207], v[160:163], a[20:23]
  v_exp_f32 v233, v233
  v_mfma_f32_16x16x32_bf16 a[232:235], a[240:243], v[144:147], 0
  v_cvt_pk_bf16_f32 v203, v206, v207
  v_exp_f32 v234, v234
  v_mfma_f32_16x16x32_bf16 a[232:235], a[240:243], v[176:179], a[232:235]
  v_exp_f32 v235, v235
  v_mfma_f32_16x16x32_bf16 a[52:55], a[200:203], v[136:139], 0
  v_mfma_f32_16x16x32_bf16 a[52:55], a[204:207], v[168:171], a[52:55]
  v_cvt_pk_bf16_f32 v232, v232, v233
  v_exp_f32 v236, v236
  v_mfma_f32_16x16x32_bf16 a[84:87], a[200:203], v[144:147], 0
  s_waitcnt vmcnt(6)
  s_barrier
  v_mfma_f32_16x16x32_bf16 a[84:87], a[204:207], v[176:179], a[84:87]
  v_exp_f32 v237, v237
  s_add_u32 m0, s44, 0
  v_mfma_f32_16x16x32_bf16 a[116:119], a[200:203], v[152:155], 0
  v_mfma_f32_16x16x32_bf16 a[116:119], a[204:207], v[184:187], a[116:119]
  v_cvt_pk_bf16_f32 v233, v234, v235
  s_waitcnt lgkmcnt(0)
  v_mfma_f32_16x16x32_bf16 a[24:27], a[208:211], v[128:131], 0
  buffer_load_dwordx4 v1, s[8:11], s85 offen offset:0 nt lds
  v_mfma_f32_16x16x32_bf16 a[24:27], a[212:215], v[160:163], a[24:27]
  ds_read_b128 a[192:195], v8 offset:32768
  v_mfma_f32_16x16x32_bf16 a[56:59], a[208:211], v[136:139], 0
  v_mfma_f32_16x16x32_bf16 a[56:59], a[212:215], v[168:171], a[56:59]
  v_exp_f32 v238, v238
  ds_read_b128 a[196:199], v9 offset:32768
  v_mfma_f32_16x16x32_bf16 a[88:91], a[208:211], v[144:147], 0
  v_mfma_f32_16x16x32_bf16 a[88:91], a[212:215], v[176:179], a[88:91]
  v_exp_f32 v239, v239
  ds_read_b128 a[200:203], v10 offset:32768
  v_mfma_f32_16x16x32_bf16 a[120:123], a[208:211], v[152:155], 0
  buffer_load_dwordx4 v2, s[8:11], s85 offen offset:1024 nt lds
  v_mfma_f32_16x16x32_bf16 a[120:123], a[212:215], v[184:187], a[120:123]
  ds_read_b128 a[204:207], v11 offset:32768
  v_mfma_f32_16x16x32_bf16 a[28:31], a[216:219], v[128:131], 0
  v_mfma_f32_16x16x32_bf16 a[28:31], a[220:223], v[160:163], a[28:31]
  v_cvt_pk_bf16_f32 v234, v236, v237
  v_exp_f32 v208, v208
  v_mfma_f32_16x16x32_bf16 a[236:239], a[240:243], v[152:155], 0
  v_exp_f32 v209, v209
  v_mfma_f32_16x16x32_bf16 a[236:239], a[240:243], v[184:187], a[236:239]
  v_cvt_pk_bf16_f32 v235, v238, v239
  v_exp_f32 v210, v210
  v_mfma_f32_16x16x32_bf16 a[60:63], a[216:219], v[136:139], 0
  v_mfma_f32_16x16x32_bf16 a[60:63], a[220:223], v[168:171], a[60:63]
  v_exp_f32 v211, v211
  v_mfma_f32_16x16x32_bf16 a[92:95], a[216:219], v[144:147], 0
  buffer_load_dwordx4 v3, s[8:11], s85 offen offset:2048 nt lds
  v_mfma_f32_16x16x32_bf16 a[92:95], a[220:223], v[176:179], a[92:95]
  v_mfma_f32_16x16x32_bf16 a[124:127], a[216:219], v[152:155], 0
  v_mfma_f32_16x16x32_bf16 a[124:127], a[220:223], v[184:187], a[124:127]
  v_cvt_pk_bf16_f32 v208, v208, v209
  s_waitcnt lgkmcnt(0)
  v_mfma_f32_16x16x32_bf16 v[128:131], a[192:195], a[128:131], v[20:23]
  buffer_load_dwordx4 v4, s[8:11], s85 offen offset:3072 nt lds
  v_mfma_f32_16x16x32_bf16 v[128:131], a[196:199], a[132:135], v[128:131]
  v_mfma_f32_16x16x32_bf16 v[128:131], a[200:203], a[136:139], v[128:131]
  v_mfma_f32_16x16x32_bf16 v[128:131], a[204:207], a[140:143], v[128:131]
  v_exp_f32 v212, v212
  v_exp_f32 v213, v213
  v_mfma_f32_16x16x32_bf16 v[136:139], a[192:195], a[144:147], v[52:55]
  v_mfma_f32_16x16x32_bf16 v[136:139], a[196:199], a[148:151], v[136:139]
  v_mfma_f32_16x16x32_bf16 v[136:139], a[200:203], a[152:155], v[136:139]
  v_mfma_f32_16x16x32_bf16 v[136:139], a[204:207], a[156:159], v[136:139]
  v_cvt_pk_bf16_f32 v209, v210, v211
  v_exp_f32 v214, v214
  v_exp_f32 v215, v215
  v_cvt_pk_bf16_f32 v210, v212, v213
  ds_read_b128 a[208:211], v8 offset:36864
  v_mfma_f32_16x16x32_bf16 v[144:147], a[192:195], a[160:163], v[56:59]
  v_mfma_f32_16x16x32_bf16 v[144:147], a[196:199], a[164:167], v[144:147]
  v_mfma_f32_16x16x32_bf16 v[144:147], a[200:203], a[168:171], v[144:147]
  v_mfma_f32_16x16x32_bf16 v[144:147], a[204:207], a[172:175], v[144:147]
  v_exp_f32 v240, v240
  v_exp_f32 v241, v241
  v_cvt_pk_bf16_f32 v211, v214, v215
  v_exp_f32 v242, v242
  ds_read_b128 a[212:215], v9 offset:36864
  ds_read_b128 a[216:219], v10 offset:36864
  v_mfma_f32_16x16x32_bf16 v[152:155], a[192:195], a[176:179], v[60:63]
  v_mfma_f32_16x16x32_bf16 v[152:155], a[196:199], a[180:183], v[152:155]
  v_mfma_f32_16x16x32_bf16 v[152:155], a[200:203], a[184:187], v[152:155]
  v_mfma_f32_16x16x32_bf16 v[152:155], a[204:207], a[188:191], v[152:155]
  v_exp_f32 v243, v243
  v_cvt_pk_bf16_f32 v240, v240, v241
  v_exp_f32 v244, v244
  ds_read_b128 a[220:223], v11 offset:36864
  s_waitcnt lgkmcnt(0)
  v_mfma_f32_16x16x32_bf16 v[132:135], a[208:211], a[128:131], v[20:23]
  v_mfma_f32_16x16x32_bf16 v[132:135], a[212:215], a[132:135], v[132:135]
  v_mfma_f32_16x16x32_bf16 v[132:135], a[216:219], a[136:139], v[132:135]
  v_mfma_f32_16x16x32_bf16 v[132:135], a[220:223], a[140:143], v[132:135]
  v_exp_f32 v245, v245
  v_cvt_pk_bf16_f32 v241, v242, v243
  v_exp_f32 v246, v246
  v_mfma_f32_16x16x32_bf16 v[140:143], a[208:211], a[144:147], v[52:55]
  v_mfma_f32_16x16x32_bf16 v[140:143], a[212:215], a[148:151], v[140:143]
  v_mfma_f32_16x16x32_bf16 v[140:143], a[216:219], a[152:155], v[140:143]
  v_mfma_f32_16x16x32_bf16 v[140:143], a[220:223], a[156:159], v[140:143]
  v_exp_f32 v247, v247
  v_cvt_pk_bf16_f32 v242, v244, v245
  v_exp_f32 v216, v216
  v_exp_f32 v217, v217
  ds_read_b128 a[192:195], v8 offset:40960
  v_mfma_f32_16x16x32_bf16 v[148:151], a[208:211], a[160:163], v[56:59]
  v_mfma_f32_16x16x32_bf16 v[148:151], a[212:215], a[164:167], v[148:151]
  v_mfma_f32_16x16x32_bf16 v[148:151], a[216:219], a[168:171], v[148:151]
  v_mfma_f32_16x16x32_bf16 v[148:151], a[220:223], a[172:175], v[148:151]
  v_cvt_pk_bf16_f32 v243, v246, v247
  v_exp_f32 v218, v218
  v_exp_f32 v219, v219
  v_cvt_pk_bf16_f32 v216, v216, v217
  ds_read_b128 a[196:199], v9 offset:40960
  ds_read_b128 a[200:203], v10 offset:40960
  v_mfma_f32_16x16x32_bf16 v[156:159], a[208:211], a[176:179], v[60:63]
  v_mfma_f32_16x16x32_bf16 v[156:159], a[212:215], a[180:183], v[156:159]
  v_mfma_f32_16x16x32_bf16 v[156:159], a[216:219], a[184:187], v[156:159]
  v_mfma_f32_16x16x32_bf16 v[156:159], a[220:223], a[188:191], v[156:159]
  v_exp_f32 v220, v220
  v_exp_f32 v221, v221
  v_cvt_pk_bf16_f32 v217, v218, v219
  ds_read_b128 a[204:207], v11 offset:40960
  s_waitcnt lgkmcnt(0)
  v_mfma_f32_16x16x32_bf16 v[160:163], a[192:195], a[128:131], v[20:23]
  v_mfma_f32_16x16x32_bf16 v[160:163], a[196:199], a[132:135], v[160:163]
  v_mfma_f32_16x16x32_bf16 v[160:163], a[200:203], a[136:139], v[160:163]
  v_mfma_f32_16x16x32_bf16 v[160:163], a[204:207], a[140:143], v[160:163]
  v_exp_f32 v222, v222
  v_exp_f32 v223, v223
  v_cvt_pk_bf16_f32 v218, v220, v221
  v_mfma_f32_16x16x32_bf16 v[168:171], a[192:195], a[144:147], v[52:55]
  v_mfma_f32_16x16x32_bf16 v[168:171], a[196:199], a[148:151], v[168:171]
  v_mfma_f32_16x16x32_bf16 v[168:171], a[200:203], a[152:155], v[168:171]
  v_mfma_f32_16x16x32_bf16 v[168:171], a[204:207], a[156:159], v[168:171]
  v_exp_f32 v248, v248
  v_exp_f32 v249, v249
  v_cvt_pk_bf16_f32 v219, v222, v223
  v_exp_f32 v250, v250
  v_exp_f32 v251, v251
  ds_read_b128 a[208:211], v8 offset:45056
  v_mfma_f32_16x16x32_bf16 v[176:179], a[192:195], a[160:163], v[56:59]
  v_mfma_f32_16x16x32_bf16 v[176:179], a[196:199], a[164:167], v[176:179]
  v_mfma_f32_16x16x32_bf16 v[176:179], a[200:203], a[168:171], v[176:179]
  v_mfma_f32_16x16x32_bf16 v[176:179], a[204:207], a[172:175], v[176:179]
  v_cvt_pk_bf16_f32 v248, v248, v249
  v_exp_f32 v252, v252
  v_exp_f32 v253, v253
  ds_read_b128 a[212:215], v9 offset:45056
L_pad1:
  s_cbranch_execz L_pad5
  ds_read_b128 a[216:219], v10 offset:45056
  v_mfma_f32_16x16x32_bf16 v[184:187], a[192:195], a[176:179], v[60:63]
  s_waitcnt vmcnt(6)
  s_barrier
  v_mfma_f32_16x16x32_bf16 v[184:187], a[196:199], a[180:183], v[184:187]
  s_add_u32 m0, s44, 81920
  v_mfma_f32_16x16x32_bf16 v[184:187], a[200:203], a[184:187], v[184:187]
  v_mfma_f32_16x16x32_bf16 v[184:187], a[204:207], a[188:191], v[184:187]
  v_cvt_pk_bf16_f32 v249, v250, v251
  ds_read_b128 a[220:223], v11 offset:45056
  s_waitcnt lgkmcnt(0)
  v_mfma_f32_16x16x32_bf16 v[164:167], a[208:211], a[128:131], v[20:23]
  buffer_load_dwordx4 v5, s[12:15], s84 offen offset:0 nt lds
  v_mfma_f32_16x16x32_bf16 v[164:167], a[212:215], a[132:135], v[164:167]
  v_mfma_f32_16x16x32_bf16 v[164:167], a[216:219], a[136:139], v[164:167]
  v_mfma_f32_16x16x32_bf16 v[164:167], a[220:223], a[140:143], v[164:167]
  v_exp_f32 v254, v254
  v_exp_f32 v255, v255
  v_mfma_f32_16x16x32_bf16 v[172:175], a[208:211], a[144:147], v[52:55]
  v_mfma_f32_16x16x32_bf16 v[172:175], a[212:215], a[148:151], v[172:175]
  v_mfma_f32_16x16x32_bf16 v[172:175], a[216:219], a[152:155], v[172:175]
  buffer_load_dwordx4 v6, s[12:15], s84 offen offset:1024 nt lds
  v_mfma_f32_16x16x32_bf16 v[172:175], a[220:223], a[156:159], v[172:175]
  v_cvt_pk_bf16_f32 v250, v252, v253
  v_cvt_pk_bf16_f32 v251, v254, v255
  ds_read_b64_tr_b16 a[192:193], v12 offset:16384
  ds_read_b64_tr_b16 a[194:195], v12 offset:20480
  v_mfma_f32_16x16x32_bf16 v[180:183], a[208:211], a[160:163], v[56:59]
  v_mfma_f32_16x16x32_bf16 v[180:183], a[212:215], a[164:167], v[180:183]
  v_mfma_f32_16x16x32_bf16 v[180:183], a[216:219], a[168:171], v[180:183]
  v_mfma_f32_16x16x32_bf16 v[180:183], a[220:223], a[172:175], v[180:183]
  ds_read_b64_tr_b16 a[196:197], v12 offset:24576
  ds_read_b64_tr_b16 a[198:199], v12 offset:28672
  ds_read_b64_tr_b16 a[200:201], v13 offset:16384
  ds_read_b64_tr_b16 a[202:203], v13 offset:20480
  v_mfma_f32_16x16x32_bf16 v[188:191], a[208:211], a[176:179], v[60:63]
  buffer_load_dwordx4 v5, s[12:15], s84 offen offset:2048 nt lds
  v_mfma_f32_16x16x32_bf16 v[188:191], a[212:215], a[180:183], v[188:191]
  v_mfma_f32_16x16x32_bf16 v[188:191], a[216:219], a[184:187], v[188:191]
  v_mfma_f32_16x16x32_bf16 v[188:191], a[220:223], a[188:191], v[188:191]
  ds_read_b64_tr_b16 a[204:205], v13 offset:24576
  ds_read_b64_tr_b16 a[206:207], v13 offset:28672
  s_waitcnt lgkmcnt(0)
  v_mfma_f32_16x16x32_bf16 a[0:3], a[192:195], v[192:195], a[0:3]
  buffer_load_dwordx4 v6, s[12:15], s84 offen offset:3072 nt lds
  v_mfma_f32_16x16x32_bf16 a[0:3], a[196:199], v[224:227], a[0:3]
  ds_read_b64_tr_b16 a[208:209], v14 offset:16384
  ds_read_b64_tr_b16 a[210:211], v14 offset:20480
  v_mfma_f32_16x16x32_bf16 a[32:35], a[192:195], v[200:203], a[32:35]
  v_mfma_f32_16x16x32_bf16 a[32:35], a[196:199], v[232:235], a[32:35]
  v_exp_f32 v128, v128
  v_exp_f32 v129, v129
  v_exp_f32 v130, v130
  v_exp_f32 v131, v131
  v_cvt_pk_bf16_f32 v128, v128, v129
  v_exp_f32 v132, v132
  ds_read_b64_tr_b16 a[212:213], v14 offset:24576
  ds_read_b64_tr_b16 a[214:215], v14 offset:28672
  v_mfma_f32_16x16x32_bf16 a[64:67], a[192:195], v[208:211], a[64:67]
  v_mfma_f32_16x16x32_bf16 a[64:67], a[196:199], v[240:243], a[64:67]
  v_exp_f32 v133, v133
  ds_read_b64_tr_b16 a[216:217], v15 offset:16384
  ds_read_b64_tr_b16 a[218:219], v15 offset:20480
  v_mfma_f32_16x16x32_bf16 a[96:99], a[192:195], v[216:219], a[96:99]
  v_mfma_f32_16x16x32_bf16 a[96:99], a[196:199], v[248:251], a[96:99]
  v_cvt_pk_bf16_f32 v129, v130, v131
  v_exp_f32 v134, v134
  ds_read_b64_tr_b16 a[220:221], v15 offset:24576
  ds_read_b64_tr_b16 a[222:223], v15 offset:28672
  v_mfma_f32_16x16x32_bf16 a[4:7], a[200:203], v[192:195], a[4:7]
  s_add_u32 m0, s55, 0
  s_add_u32 s46, s45, 0
  v_mfma_f32_16x16x32_bf16 a[4:7], a[204:207], v[224:227], a[4:7]
  v_mfma_f32_16x16x32_bf16 a[224:227], a[240:243], v[192:195], a[224:227]
  v_exp_f32 v135, v135
  v_mfma_f32_16x16x32_bf16 a[224:227], a[240:243], v[224:227], a[224:227]
  v_cvt_pk_bf16_f32 v130, v132, v133
  v_exp_f32 v160, v160
  v_mfma_f32_16x16x32_bf16 a[36:39], a[200:203], v[200:203], a[36:39]
  v_mfma_f32_16x16x32_bf16 a[36:39], a[204:207], v[232:235], a[36:39]
  v_exp_f32 v161, v161
  v_mfma_f32_16x16x32_bf16 a[68:71], a[200:203], v[208:211], a[68:71]
  buffer_load_dwordx4 v3, s[28:31], s46 offen offset:2048 nt lds
  v_mfma_f32_16x16x32_bf16 a[68:71], a[204:207], v[240:243], a[68:71]
  v_mfma_f32_16x16x32_bf16 a[100:103], a[200:203], v[216:219], a[100:103]
  v_mfma_f32_16x16x32_bf16 a[100:103], a[204:207], v[248:251], a[100:103]
  v_cvt_pk_bf16_f32 v131, v134, v135
  s_waitcnt lgkmcnt(0)
  v_mfma_f32_16x16x32_bf16 a[8:11], a[208:211], v[192:195], a[8:11]
  v_mfma_f32_16x16x32_bf16 a[8:11], a[212:215], v[224:227], a[8:11]
  v_exp_f32 v162, v162
  v_exp_f32 v163, v163
  ds_read_b64_tr_b16 a[192:193], v16 offset:16384
  ds_read_b64_tr_b16 a[194:195], v16 offset:20480
  v_mfma_f32_16x16x32_bf16 a[40:43], a[208:211], v[200:203], a[40:43]
  buffer_load_dwordx4 v4, s[28:31], s46 offen offset:3072 nt lds
  v_mfma_f32_16x16x32_bf16 a[40:43], a[212:215], v[232:235], a[40:43]
  ds_read_b64_tr_b16 a[196:197], v16 offset:24576
  ds_read_b64_tr_b16 a[198:199], v16 offset:28672
  v_mfma_f32_16x16x32_bf16 a[72:75], a[208:211], v[208:211], a[72:75]
  v_mfma_f32_16x16x32_bf16 a[72:75], a[212:215], v[240:243], a[72:75]
  v_cvt_pk_bf16_f32 v160, v160, v161
  v_exp_f32 v164, v164
  ds_read_b64_tr_b16 a[200:201], v17 offset:16384
  ds_read_b64_tr_b16 a[202:203], v17 offset:20480
  v_mfma_f32_16x16x32_bf16 a[104:107], a[208:211], v[216:219], a[104:107]
  v_mfma_f32_16x16x32_bf16 a[104:107], a[212:215], v[248:251], a[104:107]
  v_exp_f32 v165, v165
  ds_read_b64_tr_b16 a[204:205], v17 offset:24576
  ds_read_b64_tr_b16 a[206:207], v17 offset:28672
  v_mfma_f32_16x16x32_bf16 a[12:15], a[216:219], v[192:195], a[12:15]
  v_mfma_f32_16x16x32_bf16 a[12:15], a[220:223], v[224:227], a[12:15]
  v_cvt_pk_bf16_f32 v161, v162, v163
  v_exp_f32 v166, v166
  v_mfma_f32_16x16x32_bf16 a[228:231], a[240:243], v[200:203], a[228:231]
  v_exp_f32 v167, v167
  v_mfma_f32_16x16x32_bf16 a[228:231], a[240:243], v[232:235], a[228:231]
  v_cvt_pk_bf16_f32 v162, v164, v165
  v_exp_f32 v136, v136
  v_mfma_f32_16x16x32_bf16 a[44:47], a[216:219], v[200:203], a[44:47]
  v_mfma_f32_16x16x32_bf16 a[44:47], a[220:223], v[232:235], a[44:47]
  v_exp_f32 v137, v137
  v_mfma_f32_16x16x32_bf16 a[76:79], a[216:219], v[208:211], a[76:79]
  v_mfma_f32_16x16x32_bf16 a[76:79], a[220:223], v[240:243], a[76:79]
  v_cvt_pk_bf16_f32 v163, v166, v167
  v_exp_f32 v138, v138
  v_mfma_f32_16x16x32_bf16 a[108:111], a[216:219], v[216:219], a[108:111]
  v_mfma_f32_16x16x32_bf16 a[108:111], a[220:223], v[248:251], a[108:111]
  v_exp_f32 v139, v139
  s_waitcnt lgkmcnt(0)
  v_mfma_f32_16x16x32_bf16 a[16:19], a[192:195], v[192:195], a[16:19]
  v_mfma_f32_16x16x32_bf16 a[16:19], a[196:199], v[224:227], a[16:19]
  v_cvt_pk_bf16_f32 v136, v136, v137
  v_exp_f32 v140, v140
  ds_read_b64_tr_b16 a[208:209], v18 offset:16384
  ds_read_b64_tr_b16 a[210:211], v18 offset:20480
  v_mfma_f32_16x16x32_bf16 a[48:51], a[192:195], v[200:203], a[48:51]
  v_mfma_f32_16x16x32_bf16 a[48:51], a[196:199], v[232:235], a[48:51]
  v_exp_f32 v141, v141
  ds_read_b64_tr_b16 a[212:213], v18 offset:24576
  ds_read_b64_tr_b16 a[214:215], v18 offset:28672
  v_mfma_f32_16x16x32_bf16 a[80:83], a[192:195], v[208:211], a[80:83]
  v_mfma_f32_16x16x32_bf16 a[80:83], a[196:199], v[240:243], a[80:83]
  v_cvt_pk_bf16_f32 v137, v138, v139
  v_exp_f32 v142, v142
  ds_read_b64_tr_b16 a[216:217], v19 offset:16384
  ds_read_b64_tr_b16 a[218:219], v19 offset:20480
  v_mfma_f32_16x16x32_bf16 a[112:115], a[192:195], v[216:219], a[112:115]
  v_mfma_f32_16x16x32_bf16 a[112:115], a[196:199], v[248:251], a[112:115]
  v_exp_f32 v143, v143
  ds_read_b64_tr_b16 a[220:221], v19 offset:24576
  ds_read_b64_tr_b16 a[222:223], v19 offset:28672
  v_mfma_f32_16x16x32_bf16 a[20:23], a[200:203], v[192:195], a[20:23]
  v_mfma_f32_16x16x32_bf16 a[20:23], a[204:207], v[224:227], a[20:23]
  v_cvt_pk_bf16_f32 v138, v140, v141
  v_exp_f32 v168, v168
  v_mfma_f32_16x16x32_bf16 a[232:235], a[240:243], v[208:211], a[232:235]
  v_exp_f32 v169, v169
  v_mfma_f32_16x16x32_bf16 a[232:235], a[240:243], v[240:243], a[232:235]
  v_cvt_pk_bf16_f32 v139, v142, v143
  v_exp_f32 v170, v170
  v_mfma_f32_16x16x32_bf16 a[52:55], a[200:203], v[200:203], a[52:55]
  v_mfma_f32_16x16x32_bf16 a[52:55], a[204:207], v[232:235], a[52:55]
  v_exp_f32 v171, v171
  v_mfma_f32_16x16x32_bf16 a[84:87], a[200:203], v[208:211], a[84:87]
  s_waitcnt vmcnt(6)
  s_barrier
  v_mfma_f32_16x16x32_bf16 a[84:87], a[204:207], v[240:243], a[84:87]
  v_cvt_pk_bf16_f32 v168, v168, v169
  v_exp_f32 v172, v172
  s_add_u32 m0, s44, 16384
  v_mfma_f32_16x16x32_bf16 a[116:119], a[200:203], v[216:219], a[116:119]
  v_mfma_f32_16x16x32_bf16 a[116:119], a[204:207], v[248:251], a[116:119]
  v_exp_f32 v173, v173
  s_waitcnt lgkmcnt(0)
  v_mfma_f32_16x16x32_bf16 a[24:27], a[208:211], v[192:195], a[24:27]
  buffer_load_dwordx4 v1, s[8:11], s86 offen offset:0 nt lds
  v_mfma_f32_16x16x32_bf16 a[24:27], a[212:215], v[224:227], a[24:27]
  ds_read_b128 a[192:195], v8 offset:0
  v_mfma_f32_16x16x32_bf16 a[56:59], a[208:211], v[200:203], a[56:59]
  v_mfma_f32_16x16x32_bf16 a[56:59], a[212:215], v[232:235], a[56:59]
  v_cvt_pk_bf16_f32 v169, v170, v171
  v_exp_f32 v174, v174
  ds_read_b128 a[196:199], v9 offset:0
  v_mfma_f32_16x16x32_bf16 a[88:91], a[208:211], v[208:211], a[88:91]
  v_mfma_f32_16x16x32_bf16 a[88:91], a[212:215], v[240:243], a[88:91]
  v_exp_f32 v175, v175
  ds_read_b128 a[200:203], v10 offset:0
  v_mfma_f32_16x16x32_bf16 a[120:123], a[208:211], v[216:219], a[120:123]
  buffer_load_dwordx4 v2, s[8:11], s86 offen offset:1024 nt lds
  v_mfma_f32_16x16x32_bf16 a[120:123], a[212:215], v[248:251], a[120:123]
  ds_read_b128 a[204:207], v11 offset:0
  v_mfma_f32_16x16x32_bf16 a[28:31], a[216:219], v[192:195], a[28:31]
  v_mfma_f32_16x16x32_bf16 a[28:31], a[220:223], v[224:227], a[28:31]
  v_cvt_pk_bf16_f32 v170, v172, v173
  v_exp_f32 v144, v144
  v_mfma_f32_16x16x32_bf16 a[236:239], a[240:243], v[216:219], a[236:239]
  v_exp_f32 v145, v145
  v_mfma_f32_16x16x32_bf16 a[236:239], a[240:243], v[248:251], a[236:239]
  v_cvt_pk_bf16_f32 v171, v174, v175
  v_exp_f32 v146, v146
  v_mfma_f32_16x16x32_bf16 a[60:63], a[216:219], v[200:203], a[60:63]
  v_mfma_f32_16x16x32_bf16 a[60:63], a[220:223], v[232:235], a[60:63]
  v_exp_f32 v147, v147
  v_mfma_f32_16x16x32_bf16 a[92:95], a[216:219], v[208:211], a[92:95]
  buffer_load_dwordx4 v3, s[8:11], s86 offen offset:2048 nt lds
  v_mfma_f32_16x16x32_bf16 a[92:95], a[220:223], v[240:243], a[92:95]
  v_mfma_f32_16x16x32_bf16 a[124:127], a[216:219], v[216:219], a[124:127]
  v_mfma_f32_16x16x32_bf16 a[124:127], a[220:223], v[248:251], a[124:127]
  v_cvt_pk_bf16_f32 v144, v144, v145
  s_waitcnt lgkmcnt(0)
  v_mfma_f32_16x16x32_bf16 v[192:195], a[192:195], a[128:131], v[20:23]
  buffer_load_dwordx4 v4, s[8:11], s86 offen offset:3072 nt lds
  v_mfma_f32_16x16x32_bf16 v[192:195], a[196:199], a[132:135], v[192:195]
  v_mfma_f32_16x16x32_bf16 v[192:195], a[200:203], a[136:139], v[192:195]
  v_mfma_f32_16x16x32_bf16 v[192:195], a[204:207], a[140:143], v[192:195]
  v_exp_f32 v148, v148
  ds_read_b128 a[208:211], v8 offset:4096
  ds_read_b128 a[212:215], v9 offset:4096
  v_mfma_f32_16x16x32_bf16 v[200:203], a[192:195], a[144:147], v[52:55]
  v_mfma_f32_16x16x32_bf16 v[200:203], a[196:199], a[148:151], v[200:203]
  v_mfma_f32_16x16x32_bf16 v[200:203], a[200:203], a[152:155], v[200:203]
  v_mfma_f32_16x16x32_bf16 v[200:203], a[204:207], a[156:159], v[200:203]
  ds_read_b128 a[216:219], v10 offset:4096
  v_exp_f32 v149, v149
  v_cvt_pk_bf16_f32 v145, v146, v147
  v_exp_f32 v150, v150
  v_mfma_f32_16x16x32_bf16 v[208:211], a[192:195], a[160:163], v[56:59]
  v_mfma_f32_16x16x32_bf16 v[208:211], a[196:199], a[164:167], v[208:211]
  v_mfma_f32_16x16x32_bf16 v[208:211], a[200:203], a[168:171], v[208:211]
  v_mfma_f32_16x16x32_bf16 v[208:211], a[204:207], a[172:175], v[208:211]
  ds_read_b128 a[220:223], v11 offset:4096
  v_exp_f32 v151, v151
  v_cvt_pk_bf16_f32 v146, v148, v149
  v_exp_f32 v176, v176
  v_exp_f32 v177, v177
  v_mfma_f32_16x16x32_bf16 v[216:219], a[192:195], a[176:179], v[60:63]
  v_mfma_f32_16x16x32_bf16 v[216:219], a[196:199], a[180:183], v[216:219]
  v_mfma_f32_16x16x32_bf16 v[216:219], a[200:203], a[184:187], v[216:219]
  s_add_u32 m0, s55, 4096
  s_add_u32 s46, s45, 4096
  v_mfma_f32_16x16x32_bf16 v[216:219], a[204:207], a[188:191], v[216:219]
  v_cvt_pk_bf16_f32 v147, v150, v151
  v_exp_f32 v178, v178
  s_waitcnt lgkmcnt(0)
  v_mfma_f32_16x16x32_bf16 v[196:199], a[208:211], a[128:131], v[20:23]
  v_mfma_f32_16x16x32_bf16 v[196:199], a[212:215], a[132:135], v[196:199]
  v_mfma_f32_16x16x32_bf16 v[196:199], a[216:219], a[136:139], v[196:199]
  buffer_load_dwordx4 v1, s[28:31], s46 offen offset:0 nt lds
  v_mfma_f32_16x16x32_bf16 v[196:199], a[220:223], a[140:143], v[196:199]
  v_exp_f32 v179, v179
  v_cvt_pk_bf16_f32 v176, v176, v177
  v_exp_f32 v180, v180
  ds_read_b128 a[192:195], v8 offset:8192
  ds_read_b128 a[196:199], v9 offset:8192
  v_mfma_f32_16x16x32_bf16 v[204:207], a[208:211], a[144:147], v[52:55]
  v_mfma_f32_16x16x32_bf16 v[204:207], a[212:215], a[148:151], v[204:207]
  v_mfma_f32_16x16x32_bf16 v[204:207], a[216:219], a[152:155], v[204:207]
  v_mfma_f32_16x16x32_bf16 v[204:207], a[220:223], a[156:159], v[204:207]
  ds_read_b128 a[200:203], v10 offset:8192
  v_exp_f32 v181, v181
  v_cvt_pk_bf16_f32 v177, v178, v179
  v_exp_f32 v182, v182
  v_mfma_f32_16x16x32_bf16 v[212:215], a[208:211], a[160:163], v[56:59]
  buffer_load_dwordx4 v2, s[28:31], s46 offen offset:1024 nt lds
  v_mfma_f32_16x16x32_bf16 v[212:215], a[212:215], a[164:167], v[212:215]
  v_mfma_f32_16x16x32_bf16 v[212:215], a[216:219], a[168:171], v[212:215]
  v_mfma_f32_16x16x32_bf16 v[212:215], a[220:223], a[172:175], v[212:215]
  ds_read_b128 a[204:207], v11 offset:8192
  v_exp_f32 v183, v183
  v_cvt_pk_bf16_f32 v178, v180, v181
  v_mfma_f32_16x16x32_bf16 v[220:223], a[208:211], a[176:179], v[60:63]
  v_mfma_f32_16x16x32_bf16 v[220:223], a[212:215], a[180:183], v[220:223]
  v_mfma_f32_16x16x32_bf16 v[220:223], a[216:219], a[184:187], v[220:223]
  v_mfma_f32_16x16x32_bf16 v[220:223], a[220:223], a[188:191], v[220:223]
  v_exp_f32 v152, v152
  v_exp_f32 v153, v153
  v_cvt_pk_bf16_f32 v179, v182, v183
  v_exp_f32 v154, v154
  s_waitcnt lgkmcnt(0)
  v_mfma_f32_16x16x32_bf16 v[224:227], a[192:195], a[128:131], v[20:23]
  v_mfma_f32_16x16x32_bf16 v[224:227], a[196:199], a[132:135], v[224:227]
  v_mfma_f32_16x16x32_bf16 v[224:227], a[200:203], a[136:139], v[224:227]
  v_mfma_f32_16x16x32_bf16 v[224:227], a[204:207], a[140:143], v[224:227]
  v_exp_f32 v155, v155
  v_cvt_pk_bf16_f32 v152, v152, v153
  v_exp_f32 v156, v156
  v_exp_f32 v157, v157
  ds_read_b128 a[208:211], v8 offset:12288
  ds_read_b128 a[212:215], v9 offset:12288
  v_mfma_f32_16x16x32_bf16 v[232:235], a[192:195], a[144:147], v[52:55]
  v_mfma_f32_16x16x32_bf16 v[232:235], a[196:199], a[148:151], v[232:235]
  v_mfma_f32_16x16x32_bf16 v[232:235], a[200:203], a[152:155], v[232:235]
  v_mfma_f32_16x16x32_bf16 v[232:235], a[204:207], a[156:159], v[232:235]
  ds_read_b128 a[216:219], v10 offset:12288
  v_cvt_pk_bf16_f32 v153, v154, v155
  v_exp_f32 v158, v158
  v_exp_f32 v159, v159
  v_mfma_f32_16x16x32_bf16 v[240:243], a[192:195], a[160:163], v[56:59]
  v_mfma_f32_16x16x32_bf16 v[240:243], a[196:199], a[164:167], v[240:243]
  v_mfma_f32_16x16x32_bf16 v[240:243], a[200:203], a[168:171], v[240:243]
  v_mfma_f32_16x16x32_bf16 v[240:243], a[204:207], a[172:175], v[240:243]
  ds_read_b128 a[220:223], v11 offset:12288
  v_cvt_pk_bf16_f32 v154, v156, v157
  v_exp_f32 v184, v184
  v_exp_f32 v185, v185
  v_mfma_f32_16x16x32_bf16 v[248:251], a[192:195], a[176:179], v[60:63]
  s_waitcnt vmcnt(8)
  s_barrier
  v_mfma_f32_16x16x32_bf16 v[248:251], a[196:199], a[180:183], v[248:251]
  s_add_u32 m0, s44, 49152
  v_mfma_f32_16x16x32_bf16 v[248:251], a[200:203], a[184:187], v[248:251]
  v_mfma_f32_16x16x32_bf16 v[248:251], a[204:207], a[188:191], v[248:251]
  v_cvt_pk_bf16_f32 v155, v158, v159
  v_exp_f32 v186, v186
  s_waitcnt lgkmcnt(0)
  v_mfma_f32_16x16x32_bf16 v[228:231], a[208:211], a[128:131], v[20:23]
  buffer_load_dwordx4 v5, s[12:15], s85 offen offset:0 nt lds
  v_mfma_f32_16x16x32_bf16 v[228:231], a[212:215], a[132:135], v[228:231]
  v_mfma_f32_16x16x32_bf16 v[228:231], a[216:219], a[136:139], v[228:231]
  v_mfma_f32_16x16x32_bf16 v[228:231], a[220:223], a[140:143], v[228:231]
  v_exp_f32 v187, v187
  v_cvt_pk_bf16_f32 v184, v184, v185
  v_exp_f32 v188, v188
  ds_read_b64_tr_b16 a[192:193], v12 offset:32768
  ds_read_b64_tr_b16 a[194:195], v12 offset:36864
  ds_read_b64_tr_b16 a[196:197], v12 offset:40960
  ds_read_b64_tr_b16 a[198:199], v12 offset:45056
  v_mfma_f32_16x16x32_bf16 v[236:239], a[208:211], a[144:147], v[52:55]
  v_mfma_f32_16x16x32_bf16 v[236:239], a[212:215], a[148:151], v[236:239]
  v_mfma_f32_16x16x32_bf16 v[236:239], a[216:219], a[152:155], v[236:239]
  buffer_load_dwordx4 v6, s[12:15], s85 offen offset:1024 nt lds
  v_mfma_f32_16x16x32_bf16 v[236:239], a[220:223], a[156:159], v[236:239]
  ds_read_b64_tr_b16 a[200:201], v13 offset:32768
  ds_read_b64_tr_b16 a[202:203], v13 offset:36864
  v_mfma_f32_16x16x32_bf16 v[244:247], a[208:211], a[160:163], v[56:59]
  v_mfma_f32_16x16x32_bf16 v[244:247], a[212:215], a[164:167], v[244:247]
  v_mfma_f32_16x16x32_bf16 v[244:247], a[216:219], a[168:171], v[244:247]
  v_mfma_f32_16x16x32_bf16 v[244:247], a[220:223], a[172:175], v[244:247]
  ds_read_b64_tr_b16 a[204:205], v13 offset:40960
  ds_read_b64_tr_b16 a[206:207], v13 offset:45056
  v_exp_f32 v189, v189
  v_cvt_pk_bf16_f32 v185, v186, v187
  v_exp_f32 v190, v190
  v_mfma_f32_16x16x32_bf16 v[252:255], a[208:211], a[176:179], v[60:63]
  buffer_load_dwordx4 v5, s[12:15], s85 offen offset:2048 nt lds
  v_mfma_f32_16x16x32_bf16 v[252:255], a[212:215], a[180:183], v[252:255]
  v_mfma_f32_16x16x32_bf16 v[252:255], a[216:219], a[184:187], v[252:255]
  v_mfma_f32_16x16x32_bf16 v[252:255], a[220:223], a[188:191], v[252:255]
  v_exp_f32 v191, v191
  v_cvt_pk_bf16_f32 v186, v188, v189
  v_cvt_pk_bf16_f32 v187, v190, v191
  s_waitcnt lgkmcnt(0)
  v_mfma_f32_16x16x32_bf16 a[0:3], a[192:195], v[128:131], a[0:3]
  buffer_load_dwordx4 v6, s[12:15], s85 offen offset:3072 nt lds
  v_mfma_f32_16x16x32_bf16 a[0:3], a[196:199], v[160:163], a[0:3]
  ds_read_b64_tr_b16 a[208:209], v14 offset:32768
  ds_read_b64_tr_b16 a[210:211], v14 offset:36864
  v_mfma_f32_16x16x32_bf16 a[32:35], a[192:195], v[136:139], a[32:35]
  v_mfma_f32_16x16x32_bf16 a[32:35], a[196:199], v[168:171], a[32:35]
  v_exp_f32 v192, v192
  v_exp_f32 v193, v193
  ds_read_b64_tr_b16 a[212:213], v14 offset:40960
  ds_read_b64_tr_b16 a[214:215], v14 offset:45056
  v_mfma_f32_16x16x32_bf16 a[64:67], a[192:195], v[144:147], a[64:67]
  v_mfma_f32_16x16x32_bf16 a[64:67], a[196:199], v[176:179], a[64:67]
  ds_read_b64_tr_b16 a[216:217], v15 offset:32768
  ds_read_b64_tr_b16 a[218:219], v15 offset:36864
  v_mfma_f32_16x16x32_bf16 a[96:99], a[192:195], v[152:155], a[96:99]
  v_mfma_f32_16x16x32_bf16 a[96:99], a[196:199], v[184:187], a[96:99]
  ds_read_b64_tr_b16 a[220:221], v15 offset:40960
  ds_read_b64_tr_b16 a[222:223], v15 offset:45056
  v_mfma_f32_16x16x32_bf16 a[4:7], a[200:203], v[128:131], a[4:7]
  v_mfma_f32_16x16x32_bf16 a[4:7], a[204:207], v[160:163], a[4:7]
  v_exp_f32 v194, v194
  v_exp_f32 v195, v195
  v_add_u32 v36, s55, v8
  v_mfma_f32_16x16x32_bf16 a[224:227], a[240:243], v[128:131], a[224:227]
  v_cvt_pk_bf16_f32 v192, v192, v193
  v_add_u32 v37, s55, v9
  v_mfma_f32_16x16x32_bf16 a[224:227], a[240:243], v[160:163], a[224:227]
  v_exp_f32 v196, v196
  v_mfma_f32_16x16x32_bf16 a[36:39], a[200:203], v[136:139], a[36:39]
  v_mfma_f32_16x16x32_bf16 a[36:39], a[204:207], v[168:171], a[36:39]
  v_exp_f32 v197, v197
  v_cvt_pk_bf16_f32 v193, v194, v195
  v_exp_f32 v198, v198
  v_add_u32 v38, s55, v10
  v_mfma_f32_16x16x32_bf16 a[68:71], a[200:203], v[144:147], a[68:71]
  v_mfma_f32_16x16x32_bf16 a[68:71], a[204:207], v[176:179], a[68:71]
  v_exp_f32 v199, v199
  v_cvt_pk_bf16_f32 v194, v196, v197
  v_add_u32 v39, s55, v11
  v_mfma_f32_16x16x32_bf16 a[100:103], a[200:203], v[152:155], a[100:103]
  s_waitcnt vmcnt(10)
  ds_read_b128 v[64:67], v36 offset:0
  ds_read_b128 v[68:71], v37 offset:0
  ds_read_b128 v[72:75], v38 offset:0
  ds_read_b128 v[76:79], v39 offset:0
  v_mfma_f32_16x16x32_bf16 a[100:103], a[204:207], v[184:187], a[100:103]
  v_exp_f32 v224, v224
  s_waitcnt lgkmcnt(4)
  v_mfma_f32_16x16x32_bf16 a[8:11], a[208:211], v[128:131], a[8:11]
  v_mfma_f32_16x16x32_bf16 a[8:11], a[212:215], v[160:163], a[8:11]
  v_exp_f32 v225, v225
  v_cvt_pk_bf16_f32 v195, v198, v199
  ds_read_b64_tr_b16 a[192:193], v16 offset:32768
  ds_read_b64_tr_b16 a[194:195], v16 offset:36864
  v_mfma_f32_16x16x32_bf16 a[40:43], a[208:211], v[136:139], a[40:43]
  v_mfma_f32_16x16x32_bf16 a[40:43], a[212:215], v[168:171], a[40:43]
  v_exp_f32 v226, v226
  ds_read_b64_tr_b16 a[196:197], v16 offset:40960
  ds_read_b64_tr_b16 a[198:199], v16 offset:45056
  v_mfma_f32_16x16x32_bf16 a[72:75], a[208:211], v[144:147], a[72:75]
  v_mfma_f32_16x16x32_bf16 a[72:75], a[212:215], v[176:179], a[72:75]
  ds_read_b64_tr_b16 a[200:201], v17 offset:32768
  ds_read_b64_tr_b16 a[202:203], v17 offset:36864
  v_mfma_f32_16x16x32_bf16 a[104:107], a[208:211], v[152:155], a[104:107]
  v_mfma_f32_16x16x32_bf16 a[104:107], a[212:215], v[184:187], a[104:107]
  ds_read_b64_tr_b16 a[204:205], v17 offset:40960
  ds_read_b64_tr_b16 a[206:207], v17 offset:45056
  v_exp_f32 v227, v227
  v_mfma_f32_16x16x32_bf16 a[12:15], a[216:219], v[128:131], a[12:15]
  v_mfma_f32_16x16x32_bf16 a[12:15], a[220:223], v[160:163], a[12:15]
  v_cvt_pk_bf16_f32 v224, v224, v225
  v_exp_f32 v228, v228
  s_waitcnt lgkmcnt(11)
  v_lshlrev_b32 v40, 16, v64
  v_mfma_f32_16x16x32_bf16 a[228:231], a[240:243], v[136:139], a[228:231]
  v_exp_f32 v229, v229
  v_mfma_f32_16x16x32_bf16 a[228:231], a[240:243], v[168:171], a[228:231]
  v_cvt_pk_bf16_f32 v225, v226, v227
  v_lshlrev_b32 v41, 16, v65
  v_mfma_f32_16x16x32_bf16 a[44:47], a[216:219], v[136:139], a[44:47]
  v_mfma_f32_16x16x32_bf16 a[44:47], a[220:223], v[168:171], a[44:47]
  v_exp_f32 v230, v230
  v_exp_f32 v231, v231
  v_mfma_f32_16x16x32_bf16 a[76:79], a[216:219], v[144:147], a[76:79]
  v_mfma_f32_16x16x32_bf16 a[76:79], a[220:223], v[176:179], a[76:79]
  v_cvt_pk_bf16_f32 v226, v228, v229
  v_exp_f32 v200, v200
  v_and_b32 v64, 0xffff0000, v64
  v_and_b32 v65, 0xffff0000, v65
  s_add_u32 m0, s55, 4096
  s_add_u32 s46, s45, 4096
  v_mfma_f32_16x16x32_bf16 a[108:111], a[216:219], v[152:155], a[108:111]
  buffer_load_dwordx4 v3, s[28:31], s46 offen offset:2048 nt lds
  v_mfma_f32_16x16x32_bf16 a[108:111], a[220:223], v[184:187], a[108:111]
  v_mul_f32 v40, s47, v40
  s_waitcnt lgkmcnt(0)
  v_mfma_f32_16x16x32_bf16 a[16:19], a[192:195], v[128:131], a[16:19]
  v_mfma_f32_16x16x32_bf16 a[16:19], a[196:199], v[160:163], a[16:19]
  v_exp_f32 v201, v201
  v_cvt_pk_bf16_f32 v227, v230, v231
  v_mul_f32 v41, s47, v41
  ds_read_b64_tr_b16 a[208:209], v18 offset:32768
  ds_read_b64_tr_b16 a[210:211], v18 offset:36864
  v_mfma_f32_16x16x32_bf16 a[48:51], a[192:195], v[136:139], a[48:51]
  v_mfma_f32_16x16x32_bf16 a[48:51], a[196:199], v[168:171], a[48:51]
  v_exp_f32 v202, v202
  v_mul_f32 v64, s47, v64
  ds_read_b64_tr_b16 a[212:213], v18 offset:40960
  ds_read_b64_tr_b16 a[214:215], v18 offset:45056
  v_mfma_f32_16x16x32_bf16 a[80:83], a[192:195], v[144:147], a[80:83]
  buffer_load_dwordx4 v4, s[28:31], s46 offen offset:3072 nt lds
  v_mfma_f32_16x16x32_bf16 a[80:83], a[196:199], v[176:179], a[80:83]
  ds_read_b64_tr_b16 a[216:217], v19 offset:32768
  ds_read_b64_tr_b16 a[218:219], v19 offset:36864
  v_mul_f32 v65, s47, v65
  v_mfma_f32_16x16x32_bf16 a[112:115], a[192:195], v[152:155], a[112:115]
  v_mfma_f32_16x16x32_bf16 a[112:115], a[196:199], v[184:187], a[112:115]
  ds_read_b64_tr_b16 a[220:221], v19 offset:40960
  ds_read_b64_tr_b16 a[222:223], v19 offset:45056
  v_cvt_pk_bf16_f32 v64, v40, v64
  v_cvt_pk_bf16_f32 v65, v41, v65
  v_mfma_f32_16x16x32_bf16 a[20:23], a[200:203], v[128:131], a[20:23]
  v_mfma_f32_16x16x32_bf16 a[20:23], a[204:207], v[160:163], a[20:23]
  v_exp_f32 v203, v203
  v_lshlrev_b32 v40, 16, v66
  v_mfma_f32_16x16x32_bf16 a[232:235], a[240:243], v[144:147], a[232:235]
  v_cvt_pk_bf16_f32 v200, v200, v201
  v_exp_f32 v204, v204
  v_mfma_f32_16x16x32_bf16 a[232:235], a[240:243], v[176:179], a[232:235]
  v_lshlrev_b32 v41, 16, v67
  v_and_b32 v66, 0xffff0000, v66
  v_mfma_f32_16x16x32_bf16 a[52:55], a[200:203], v[136:139], a[52:55]
  v_mfma_f32_16x16x32_bf16 a[52:55], a[204:207], v[168:171], a[52:55]
  v_exp_f32 v205, v205
  v_cvt_pk_bf16_f32 v201, v202, v203
  v_exp_f32 v206, v206
  v_mfma_f32_16x16x32_bf16 a[84:87], a[200:203], v[144:147], a[84:87]
  s_waitcnt vmcnt(8)
  s_barrier
  v_mfma_f32_16x16x32_bf16 a[84:87], a[204:207], v[176:179], a[84:87]
  v_and_b32 v67, 0xffff0000, v67
  v_mul_f32 v40, s47, v40
  s_add_u32 m0, s44, 32768
  v_mfma_f32_16x16x32_bf16 a[116:119], a[200:203], v[152:155], a[116:119]
  v_mfma_f32_16x16x32_bf16 a[116:119], a[204:207], v[184:187], a[116:119]
  v_exp_f32 v207, v207
  v_cvt_pk_bf16_f32 v202, v204, v205
  s_waitcnt lgkmcnt(0)
  v_mfma_f32_16x16x32_bf16 a[24:27], a[208:211], v[128:131], a[24:27]
  buffer_load_dwordx4 v1, s[8:11], s87 offen offset:0 nt lds
  v_mfma_f32_16x16x32_bf16 a[24:27], a[212:215], v[160:163], a[24:27]
  v_exp_f32 v232, v232
  v_mul_f32 v41, s47, v41
  ds_read_b128 a[192:195], v8 offset:16384
  v_mfma_f32_16x16x32_bf16 a[56:59], a[208:211], v[136:139], a[56:59]
  v_mfma_f32_16x16x32_bf16 a[56:59], a[212:215], v[168:171], a[56:59]
  v_exp_f32 v233, v233
  v_mul_f32 v66, s47, v66
  ds_read_b128 a[196:199], v9 offset:16384
  v_mfma_f32_16x16x32_bf16 a[88:91], a[208:211], v[144:147], a[88:91]
  v_mfma_f32_16x16x32_bf16 a[88:91], a[212:215], v[176:179], a[88:91]
  ds_read_b128 a[200:203], v10 offset:16384
  v_cvt_pk_bf16_f32 v203, v206, v207
  v_mul_f32 v67, s47, v67
  v_mfma_f32_16x16x32_bf16 a[120:123], a[208:211], v[152:155], a[120:123]
  buffer_load_dwordx4 v2, s[8:11], s87 offen offset:1024 nt lds
  v_mfma_f32_16x16x32_bf16 a[120:123], a[212:215], v[184:187], a[120:123]
  ds_read_b128 a[204:207], v11 offset:16384
  v_cvt_pk_bf16_f32 v66, v40, v66
  v_mfma_f32_16x16x32_bf16 a[28:31], a[216:219], v[128:131], a[28:31]
  v_mfma_f32_16x16x32_bf16 a[28:31], a[220:223], v[160:163], a[28:31]
  v_exp_f32 v234, v234
  v_exp_f32 v235, v235
  v_cvt_pk_bf16_f32 v67, v41, v67
  v_mfma_f32_16x16x32_bf16 a[236:239], a[240:243], v[152:155], a[236:239]
  v_cvt_pk_bf16_f32 v232, v232, v233
  v_exp_f32 v236, v236
  v_mfma_f32_16x16x32_bf16 a[236:239], a[240:243], v[184:187], a[236:239]
  v_exp_f32 v237, v237
  v_mfma_f32_16x16x32_bf16 a[60:63], a[216:219], v[136:139], a[60:63]
  v_mfma_f32_16x16x32_bf16 a[60:63], a[220:223], v[168:171], a[60:63]
  v_cvt_pk_bf16_f32 v233, v234, v235
  v_exp_f32 v238, v238
  v_lshlrev_b32 v40, 16, v68
  v_mfma_f32_16x16x32_bf16 a[92:95], a[216:219], v[144:147], a[92:95]
  buffer_load_dwordx4 v3, s[8:11], s87 offen offset:2048 nt lds
  v_mfma_f32_16x16x32_bf16 a[92:95], a[220:223], v[176:179], a[92:95]
  v_exp_f32 v239, v239
  v_lshlrev_b32 v41, 16, v69
  v_and_b32 v68, 0xffff0000, v68
  v_mfma_f32_16x16x32_bf16 a[124:127], a[216:219], v[152:155], a[124:127]
  v_mfma_f32_16x16x32_bf16 a[124:127], a[220:223], v[184:187], a[124:127]
  v_cvt_pk_bf16_f32 v234, v236, v237
  v_and_b32 v69, 0xffff0000, v69
  s_waitcnt lgkmcnt(0)
  v_mfma_f32_16x16x32_bf16 v[128:131], a[192:195], a[128:131], v[20:23]
  buffer_load_dwordx4 v4, s[8:11], s87 offen offset:3072 nt lds
  v_mfma_f32_16x16x32_bf16 v[128:131], a[196:199], a[132:135], v[128:131]
  v_mfma_f32_16x16x32_bf16 v[128:131], a[200:203], a[136:139], v[128:131]
  v_mfma_f32_16x16x32_bf16 v[128:131], a[204:207], a[140:143], v[128:131]
  ds_read_b128 a[208:211], v8 offset:20480
  ds_read_b128 a[212:215], v9 offset:20480
  v_exp_f32 v208, v208
  v_exp_f32 v209, v209
  v_mul_f32 v40, s47, v40
  v_mul_f32 v41, s47, v41
  v_mfma_f32_16x16x32_bf16 v[136:139], a[192:195], a[144:147], v[52:55]
  v_mfma_f32_16x16x32_bf16 v[136:139], a[196:199], a[148:151], v[136:139]
  v_mfma_f32_16x16x32_bf16 v[136:139], a[200:203], a[152:155], v[136:139]
  v_mfma_f32_16x16x32_bf16 v[136:139], a[204:207], a[156:159], v[136:139]
  ds_read_b128 a[216:219], v10 offset:20480
  v_cvt_pk_bf16_f32 v235, v238, v239
  v_exp_f32 v210, v210
  v_exp_f32 v211, v211
  v_cvt_pk_bf16_f32 v208, v208, v209
  v_mul_f32 v68, s47, v68
  v_mul_f32 v69, s47, v69
  v_cvt_pk_bf16_f32 v68, v40, v68
  v_mfma_f32_16x16x32_bf16 v[144:147], a[192:195], a[160:163], v[56:59]
  v_mfma_f32_16x16x32_bf16 v[144:147], a[196:199], a[164:167], v[144:147]
  v_mfma_f32_16x16x32_bf16 v[144:147], a[200:203], a[168:171], v[144:147]
  v_mfma_f32_16x16x32_bf16 v[144:147], a[204:207], a[172:175], v[144:147]
  ds_read_b128 a[220:223], v11 offset:20480
  v_exp_f32 v212, v212
  v_exp_f32 v213, v213
  v_cvt_pk_bf16_f32 v209, v210, v211
  v_exp_f32 v214, v214
  v_cvt_pk_bf16_f32 v69, v41, v69
  v_lshlrev_b32 v40, 16, v70
  v_mfma_f32_16x16x32_bf16 v[152:155], a[192:195], a[176:179], v[60:63]
  v_mfma_f32_16x16x32_bf16 v[152:155], a[196:199], a[180:183], v[152:155]
  v_mfma_f32_16x16x32_bf16 v[152:155], a[200:203], a[184:187], v[152:155]
  v_mfma_f32_16x16x32_bf16 v[152:155], a[204:207], a[188:191], v[152:155]
  v_exp_f32 v215, v215
  v_cvt_pk_bf16_f32 v210, v212, v213
L_pad2:
  s_cbranch_execz L_pad6
  v_exp_f32 v240, v240
  v_lshlrev_b32 v41, 16, v71
  v_and_b32 v70, 0xffff0000, v70
  s_waitcnt lgkmcnt(0)
  v_mfma_f32_16x16x32_bf16 v[132:135], a[208:211], a[128:131], v[20:23]
  v_mfma_f32_16x16x32_bf16 v[132:135], a[212:215], a[132:135], v[132:135]
  v_mfma_f32_16x16x32_bf16 v[132:135], a[216:219], a[136:139], v[132:135]
  v_mfma_f32_16x16x32_bf16 v[132:135], a[220:223], a[140:143], v[132:135]
  ds_read_b128 a[192:195], v8 offset:24576
  ds_read_b128 a[196:199], v9 offset:24576
  v_exp_f32 v241, v241
  v_cvt_pk_bf16_f32 v211, v214, v215
  v_exp_f32 v242, v242
  v_and_b32 v71, 0xffff0000, v71
  v_mul_f32 v40, s47, v40
  v_mul_f32 v41, s47, v41
  v_mfma_f32_16x16x32_bf16 v[140:143], a[208:211], a[144:147], v[52:55]
  v_mfma_f32_16x16x32_bf16 v[140:143], a[212:215], a[148:151], v[140:143]
  v_mfma_f32_16x16x32_bf16 v[140:143], a[216:219], a[152:155], v[140:143]
  v_mfma_f32_16x16x32_bf16 v[140:143], a[220:223], a[156:159], v[140:143]
  ds_read_b128 a[200:203], v10 offset:24576
  v_exp_f32 v243, v243
  v_cvt_pk_bf16_f32 v240, v240, v241
  v_exp_f32 v244, v244
  v_exp_f32 v245, v245
  v_mul_f32 v70, s47, v70
  v_mul_f32 v71, s47, v71
  v_mfma_f32_16x16x32_bf16 v[148:151], a[208:211], a[160:163], v[56:59]
  v_mfma_f32_16x16x32_bf16 v[148:151], a[212:215], a[164:167], v[148:151]
  v_mfma_f32_16x16x32_bf16 v[148:151], a[216:219], a[168:171], v[148:151]
  v_mfma_f32_16x16x32_bf16 v[148:151], a[220:223], a[172:175], v[148:151]
  ds_read_b128 a[204:207], v11 offset:24576
  v_cvt_pk_bf16_f32 v241, v242, v243
  v_exp_f32 v246, v246
  v_exp_f32 v247, v247
  v_cvt_pk_bf16_f32 v242, v244, v245
  v_cvt_pk_bf16_f32 v70, v40, v70
  v_cvt_pk_bf16_f32 v71, v41, v71
  v_mfma_f32_16x16x32_bf16 v[156:159], a[208:211], a[176:179], v[60:63]
  v_mfma_f32_16x16x32_bf16 v[156:159], a[212:215], a[180:183], v[156:159]
  v_mfma_f32_16x16x32_bf16 v[156:159], a[216:219], a[184:187], v[156:159]
  v_mfma_f32_16x16x32_bf16 v[156:159], a[220:223], a[188:191], v[156:159]
  v_exp_f32 v216, v216
  v_exp_f32 v217, v217
  v_cvt_pk_bf16_f32 v243, v246, v247
  v_lshlrev_b32 v40, 16, v72
  v_lshlrev_b32 v41, 16, v73
  v_and_b32 v72, 0xffff0000, v72
  s_waitcnt lgkmcnt(0)
  v_mfma_f32_16x16x32_bf16 v[160:163], a[192:195], a[128:131], v[20:23]
  v_mfma_f32_16x16x32_bf16 v[160:163], a[196:199], a[132:135], v[160:163]
  v_mfma_f32_16x16x32_bf16 v[160:163], a[200:203], a[136:139], v[160:163]
  v_mfma_f32_16x16x32_bf16 v[160:163], a[204:207], a[140:143], v[160:163]
  ds_read_b128 a[208:211], v8 offset:28672
  ds_read_b128 a[212:215], v9 offset:28672
  v_exp_f32 v218, v218
  v_exp_f32 v219, v219
  v_cvt_pk_bf16_f32 v216, v216, v217
  v_exp_f32 v220, v220
  v_and_b32 v73, 0xffff0000, v73
  v_mul_f32 v40, s47, v40
  v_mfma_f32_16x16x32_bf16 v[168:171], a[192:195], a[144:147], v[52:55]
  v_mfma_f32_16x16x32_bf16 v[168:171], a[196:199], a[148:151], v[168:171]
  v_mfma_f32_16x16x32_bf16 v[168:171], a[200:203], a[152:155], v[168:171]
  v_mfma_f32_16x16x32_bf16 v[168:171], a[204:207], a[156:159], v[168:171]
  ds_read_b128 a[216:219], v10 offset:28672
  v_exp_f32 v221, v221
  v_cvt_pk_bf16_f32 v217, v218, v219
  v_exp_f32 v222, v222
  v_mul_f32 v41, s47, v41
  v_mul_f32 v72, s47, v72
  v_mul_f32 v73, s47, v73
  v_mfma_f32_16x16x32_bf16 v[176:179], a[192:195], a[160:163], v[56:59]
  v_mfma_f32_16x16x32_bf16 v[176:179], a[196:199], a[164:167], v[176:179]
  v_mfma_f32_16x16x32_bf16 v[176:179], a[200:203], a[168:171], v[176:179]
  v_mfma_f32_16x16x32_bf16 v[176:179], a[204:207], a[172:175], v[176:179]
  ds_read_b128 a[220:223], v11 offset:28672
  v_exp_f32 v223, v223
  v_cvt_pk_bf16_f32 v218, v220, v221
  v_exp_f32 v248, v248
  v_exp_f32 v249, v249
  v_cvt_pk_bf16_f32 v72, v40, v72
  v_cvt_pk_bf16_f32 v73, v41, v73
  v_mfma_f32_16x16x32_bf16 v[184:187], a[192:195], a[176:179], v[60:63]
  s_waitcnt vmcnt(6)
  s_barrier
  v_mfma_f32_16x16x32_bf16 v[184:187], a[196:199], a[180:183], v[184:187]
  s_add_u32 m0, s44, 65536
  v_mfma_f32_16x16x32_bf16 v[184:187], a[200:203], a[184:187], v[184:187]
  v_mfma_f32_16x16x32_bf16 v[184:187], a[204:207], a[188:191], v[184:187]
  v_cvt_pk_bf16_f32 v219, v222, v223
  v_exp_f32 v250, v250
  v_lshlrev_b32 v40, 16, v74
  v_lshlrev_b32 v41, 16, v75
  s_waitcnt lgkmcnt(0)
  v_mfma_f32_16x16x32_bf16 v[164:167], a[208:211], a[128:131], v[20:23]
  buffer_load_dwordx4 v5, s[12:15], s86 offen offset:0 nt lds
  v_mfma_f32_16x16x32_bf16 v[164:167], a[212:215], a[132:135], v[164:167]
  v_mfma_f32_16x16x32_bf16 v[164:167], a[216:219], a[136:139], v[164:167]
  v_mfma_f32_16x16x32_bf16 v[164:167], a[220:223], a[140:143], v[164:167]
  ds_read_b64_tr_b16 a[192:193], v12 offset:0
  ds_read_b64_tr_b16 a[194:195], v12 offset:4096
  ds_read_b64_tr_b16 a[196:197], v12 offset:8192
  ds_read_b64_tr_b16 a[198:199], v12 offset:12288
  v_and_b32 v74, 0xffff0000, v74
  v_and_b32 v75, 0xffff0000, v75
  v_mul_f32 v40, s47, v40
  v_mfma_f32_16x16x32_bf16 v[172:175], a[208:211], a[144:147], v[52:55]
  v_mfma_f32_16x16x32_bf16 v[172:175], a[212:215], a[148:151], v[172:175]
  v_mfma_f32_16x16x32_bf16 v[172:175], a[216:219], a[152:155], v[172:175]
  buffer_load_dwordx4 v6, s[12:15], s86 offen offset:1024 nt lds
  v_mfma_f32_16x16x32_bf16 v[172:175], a[220:223], a[156:159], v[172:175]
  ds_read_b64_tr_b16 a[200:201], v13 offset:0
  ds_read_b64_tr_b16 a[202:203], v13 offset:4096
  v_exp_f32 v251, v251
  v_cvt_pk_bf16_f32 v248, v248, v249
  v_mul_f32 v41, s47, v41
  v_mul_f32 v74, s47, v74
  v_mfma_f32_16x16x32_bf16 v[180:183], a[208:211], a[160:163], v[56:59]
  v_mfma_f32_16x16x32_bf16 v[180:183], a[212:215], a[164:167], v[180:183]
  v_mfma_f32_16x16x32_bf16 v[180:183], a[216:219], a[168:171], v[180:183]
  v_mfma_f32_16x16x32_bf16 v[180:183], a[220:223], a[172:175], v[180:183]
  ds_read_b64_tr_b16 a[204:205], v13 offset:8192
  ds_read_b64_tr_b16 a[206:207], v13 offset:12288
  v_exp_f32 v252, v252
  v_exp_f32 v253, v253
  v_cvt_pk_bf16_f32 v249, v250, v251
  v_exp_f32 v254, v254
  v_mul_f32 v75, s47, v75
  v_cvt_pk_bf16_f32 v74, v40, v74
  v_mfma_f32_16x16x32_bf16 v[188:191], a[208:211], a[176:179], v[60:63]
  buffer_load_dwordx4 v5, s[12:15], s86 offen offset:2048 nt lds
  v_mfma_f32_16x16x32_bf16 v[188:191], a[212:215], a[180:183], v[188:191]
  v_mfma_f32_16x16x32_bf16 v[188:191], a[216:219], a[184:187], v[188:191]
  v_mfma_f32_16x16x32_bf16 v[188:191], a[220:223], a[188:191], v[188:191]
  v_exp_f32 v255, v255
  v_cvt_pk_bf16_f32 v250, v252, v253
  v_cvt_pk_bf16_f32 v75, v41, v75
  v_lshlrev_b32 v40, 16, v76
  v_lshlrev_b32 v41, 16, v77
  s_waitcnt lgkmcnt(0)
  v_mfma_f32_16x16x32_bf16 a[0:3], a[192:195], v[192:195], a[0:3]
  buffer_load_dwordx4 v6, s[12:15], s86 offen offset:3072 nt lds
  v_mfma_f32_16x16x32_bf16 a[0:3], a[196:199], v[224:227], a[0:3]
  ds_read_b64_tr_b16 a[208:209], v14 offset:0
  ds_read_b64_tr_b16 a[210:211], v14 offset:4096
  v_and_b32 v76, 0xffff0000, v76
  v_mfma_f32_16x16x32_bf16 a[32:35], a[192:195], v[200:203], a[32:35]
  v_mfma_f32_16x16x32_bf16 a[32:35], a[196:199], v[232:235], a[32:35]
  ds_read_b64_tr_b16 a[212:213], v14 offset:8192
  ds_read_b64_tr_b16 a[214:215], v14 offset:12288
  v_cvt_pk_bf16_f32 v251, v254, v255
  v_and_b32 v77, 0xffff0000, v77
  v_mfma_f32_16x16x32_bf16 a[64:67], a[192:195], v[208:211], a[64:67]
  v_mfma_f32_16x16x32_bf16 a[64:67], a[196:199], v[240:243], a[64:67]
  ds_read_b64_tr_b16 a[216:217], v15 offset:0
  ds_read_b64_tr_b16 a[218:219], v15 offset:4096
  v_exp_f32 v128, v128
  v_mul_f32 v40, s47, v40
  v_mfma_f32_16x16x32_bf16 a[96:99], a[192:195], v[216:219], a[96:99]
  v_mfma_f32_16x16x32_bf16 a[96:99], a[196:199], v[248:251], a[96:99]
  ds_read_b64_tr_b16 a[220:221], v15 offset:8192
  ds_read_b64_tr_b16 a[222:223], v15 offset:12288
  v_exp_f32 v129, v129
  v_mul_f32 v41, s47, v41
  v_mfma_f32_16x16x32_bf16 a[4:7], a[200:203], v[192:195], a[4:7]
  s_add_u32 m0, s55, 8192
  s_add_u32 s46, s45, 8192
  v_mfma_f32_16x16x32_bf16 a[4:7], a[204:207], v[224:227], a[4:7]
  v_exp_f32 v130, v130
  v_mul_f32 v76, s47, v76
  v_mul_f32 v77, s47, v77
  v_mfma_f32_16x16x32_bf16 a[224:227], a[240:243], v[192:195], a[224:227]
  v_cvt_pk_bf16_f32 v76, v40, v76
  v_cvt_pk_bf16_f32 v77, v41, v77
  v_mfma_f32_16x16x32_bf16 a[224:227], a[240:243], v[224:227], a[224:227]
  v_exp_f32 v131, v131
  v_cvt_pk_bf16_f32 v128, v128, v129
  v_mfma_f32_16x16x32_bf16 a[36:39], a[200:203], v[200:203], a[36:39]
  v_mfma_f32_16x16x32_bf16 a[36:39], a[204:207], v[232:235], a[36:39]
  v_exp_f32 v132, v132
  v_exp_f32 v133, v133
  v_mfma_f32_16x16x32_bf16 a[68:71], a[200:203], v[208:211], a[68:71]
  buffer_load_dwordx4 v1, s[28:31], s46 offen offset:0 nt lds
  v_mfma_f32_16x16x32_bf16 a[68:71], a[204:207], v[240:243], a[68:71]
  v_cvt_pk_bf16_f32 v129, v130, v131
  v_lshlrev_b32 v40, 16, v78
  v_mfma_f32_16x16x32_bf16 a[100:103], a[200:203], v[216:219], a[100:103]
  v_mfma_f32_16x16x32_bf16 a[100:103], a[204:207], v[248:251], a[100:103]
  v_exp_f32 v134, v134
  s_waitcnt lgkmcnt(0)
  v_mfma_f32_16x16x32_bf16 a[8:11], a[208:211], v[192:195], a[8:11]
  v_mfma_f32_16x16x32_bf16 a[8:11], a[212:215], v[224:227], a[8:11]
  ds_read_b64_tr_b16 a[192:193], v16 offset:0
  ds_read_b64_tr_b16 a[194:195], v16 offset:4096
  v_exp_f32 v135, v135
  v_lshlrev_b32 v41, 16, v79
  v_mfma_f32_16x16x32_bf16 a[40:43], a[208:211], v[200:203], a[40:43]
  buffer_load_dwordx4 v2, s[28:31], s46 offen offset:1024 nt lds
  v_mfma_f32_16x16x32_bf16 a[40:43], a[212:215], v[232:235], a[40:43]
  ds_read_b64_tr_b16 a[196:197], v16 offset:8192
  ds_read_b64_tr_b16 a[198:199], v16 offset:12288
  v_and_b32 v78, 0xffff0000, v78
  v_and_b32 v79, 0xffff0000, v79
  v_mfma_f32_16x16x32_bf16 a[72:75], a[208:211], v[208:211], a[72:75]
  v_mfma_f32_16x16x32_bf16 a[72:75], a[212:215], v[240:243], a[72:75]
  ds_read_b64_tr_b16 a[200:201], v17 offset:0
  ds_read_b64_tr_b16 a[202:203], v17 offset:4096
  v_cvt_pk_bf16_f32 v130, v132, v133
  v_mul_f32 v40, s47, v40
  v_mfma_f32_16x16x32_bf16 a[104:107], a[208:211], v[216:219], a[104:107]
  v_mfma_f32_16x16x32_bf16 a[104:107], a[212:215], v[248:251], a[104:107]
  ds_read_b64_tr_b16 a[204:205], v17 offset:8192
  ds_read_b64_tr_b16 a[206:207], v17 offset:12288
  v_exp_f32 v160, v160
  v_mul_f32 v41, s47, v41
  v_mfma_f32_16x16x32_bf16 a[12:15], a[216:219], v[192:195], a[12:15]
  v_mfma_f32_16x16x32_bf16 a[12:15], a[220:223], v[224:227], a[12:15]
  v_exp_f32 v161, v161
  v_cvt_pk_bf16_f32 v131, v134, v135
  v_mul_f32 v78, s47, v78
  v_mfma_f32_16x16x32_bf16 a[228:231], a[240:243], v[200:203], a[228:231]
  v_exp_f32 v162, v162
  v_mfma_f32_16x16x32_bf16 a[228:231], a[240:243], v[232:235], a[228:231]
  v_exp_f32 v163, v163
  v_mfma_f32_16x16x32_bf16 a[44:47], a[216:219], v[200:203], a[44:47]
  v_mfma_f32_16x16x32_bf16 a[44:47], a[220:223], v[232:235], a[44:47]
  v_cvt_pk_bf16_f32 v160, v160, v161
  v_exp_f32 v164, v164
  v_mul_f32 v79, s47, v79
  v_mfma_f32_16x16x32_bf16 a[76:79], a[216:219], v[208:211], a[76:79]
  v_mfma_f32_16x16x32_bf16 a[76:79], a[220:223], v[240:243], a[76:79]
  v_exp_f32 v165, v165
  v_cvt_pk_bf16_f32 v161, v162, v163
  v_cvt_pk_bf16_f32 v78, v40, v78
  v_cvt_pk_bf16_f32 v79, v41, v79
  v_mfma_f32_16x16x32_bf16 a[108:111], a[216:219], v[216:219], a[108:111]
  s_waitcnt vmcnt(10)
  v_mfma_f32_16x16x32_bf16 a[108:111], a[220:223], v[248:251], a[108:111]
  ds_read_b128 v[80:83], v36 offset:4096
  v_exp_f32 v166, v166
  v_exp_f32 v167, v167
  s_waitcnt lgkmcnt(1)
  v_mfma_f32_16x16x32_bf16 a[16:19], a[192:195], v[192:195], a[16:19]
  ds_read_b128 v[84:87], v37 offset:4096
  v_mfma_f32_16x16x32_bf16 a[16:19], a[196:199], v[224:227], a[16:19]
  ds_read_b64_tr_b16 a[208:209], v18 offset:0
  ds_read_b64_tr_b16 a[210:211], v18 offset:4096
  v_cvt_pk_bf16_f32 v162, v164, v165
  v_mfma_f32_16x16x32_bf16 a[48:51], a[192:195], v[200:203], a[48:51]
  ds_read_b128 v[88:91], v38 offset:4096
  v_mfma_f32_16x16x32_bf16 a[48:51], a[196:199], v[232:235], a[48:51]
  ds_read_b64_tr_b16 a[212:213], v18 offset:8192
  ds_read_b64_tr_b16 a[214:215], v18 offset:12288
  ds_read_b128 v[92:95], v39 offset:4096
  v_exp_f32 v136, v136
  v_mfma_f32_16x16x32_bf16 a[80:83], a[192:195], v[208:211], a[80:83]
  v_mfma_f32_16x16x32_bf16 a[80:83], a[196:199], v[240:243], a[80:83]
  ds_read_b64_tr_b16 a[216:217], v19 offset:0
  ds_read_b64_tr_b16 a[218:219], v19 offset:4096
  v_exp_f32 v137, v137
  v_mfma_f32_16x16x32_bf16 a[112:115], a[192:195], v[216:219], a[112:115]
  v_mfma_f32_16x16x32_bf16 a[112:115], a[196:199], v[248:251], a[112:115]
  ds_read_b64_tr_b16 a[220:221], v19 offset:8192
  ds_read_b64_tr_b16 a[222:223], v19 offset:12288
  v_cvt_pk_bf16_f32 v163, v166, v167
  v_mfma_f32_16x16x32_bf16 a[20:23], a[200:203], v[192:195], a[20:23]
  v_mfma_f32_16x16x32_bf16 a[20:23], a[204:207], v[224:227], a[20:23]
  v_exp_f32 v138, v138
  v_exp_f32 v139, v139
  v_mfma_f32_16x16x32_bf16 a[232:235], a[240:243], v[208:211], a[232:235]
  v_cvt_pk_bf16_f32 v136, v136, v137
  v_exp_f32 v140, v140
  v_mfma_f32_16x16x32_bf16 a[232:235], a[240:243], v[240:243], a[232:235]
  v_exp_f32 v141, v141
  v_mfma_f32_16x16x32_bf16 a[52:55], a[200:203], v[200:203], a[52:55]
  v_mfma_f32_16x16x32_bf16 a[52:55], a[204:207], v[232:235], a[52:55]
  v_cvt_pk_bf16_f32 v137, v138, v139
  s_waitcnt lgkmcnt(11)
  v_lshlrev_b32 v40, 16, v80
  v_mfma_f32_16x16x32_bf16 a[84:87], a[200:203], v[208:211], a[84:87]
  s_waitcnt vmcnt(6)
  s_barrier
  v_mfma_f32_16x16x32_bf16 a[84:87], a[204:207], v[240:243], a[84:87]
  s_add_u32 m0, s44, 0
  v_exp_f32 v142, v142
  v_mfma_f32_16x16x32_bf16 a[116:119], a[200:203], v[216:219], a[116:119]
  v_mfma_f32_16x16x32_bf16 a[116:119], a[204:207], v[248:251], a[116:119]
  v_exp_f32 v143, v143
  v_lshlrev_b32 v41, 16, v81
  s_waitcnt lgkmcnt(0)
  v_mfma_f32_16x16x32_bf16 a[24:27], a[208:211], v[192:195], a[24:27]
  buffer_load_dwordx4 v1, s[8:11], s88 offen offset:0 nt lds
  v_mfma_f32_16x16x32_bf16 a[24:27], a[212:215], v[224:227], a[24:27]
  ds_read_b128 a[192:195], v8 offset:32768
  v_and_b32 v80, 0xffff0000, v80
  v_mfma_f32_16x16x32_bf16 a[56:59], a[208:211], v[200:203], a[56:59]
  v_mfma_f32_16x16x32_bf16 a[56:59], a[212:215], v[232:235], a[56:59]
  ds_read_b128 a[196:199], v9 offset:32768
  v_cvt_pk_bf16_f32 v138, v140, v141
  v_exp_f32 v168, v168
  v_and_b32 v81, 0xffff0000, v81
  v_mfma_f32_16x16x32_bf16 a[88:91], a[208:211], v[208:211], a[88:91]
  v_mfma_f32_16x16x32_bf16 a[88:91], a[212:215], v[240:243], a[88:91]
  ds_read_b128 a[200:203], v10 offset:32768
  v_exp_f32 v169, v169
  v_mul_f32 v40, s47, v40
  v_mfma_f32_16x16x32_bf16 a[120:123], a[208:211], v[216:219], a[120:123]
  buffer_load_dwordx4 v2, s[8:11], s88 offen offset:1024 nt lds
  v_mfma_f32_16x16x32_bf16 a[120:123], a[212:215], v[248:251], a[120:123]
  ds_read_b128 a[204:207], v11 offset:32768
  v_cvt_pk_bf16_f32 v139, v142, v143
  v_mul_f32 v41, s47, v41
  v_mfma_f32_16x16x32_bf16 a[28:31], a[216:219], v[192:195], a[28:31]
  v_mfma_f32_16x16x32_bf16 a[28:31], a[220:223], v[224:227], a[28:31]
  v_exp_f32 v170, v170
  v_exp_f32 v171, v171
  v_mul_f32 v80, s47, v80
  v_mfma_f32_16x16x32_bf16 a[236:239], a[240:243], v[216:219], a[236:239]
  v_cvt_pk_bf16_f32 v168, v168, v169
  v_mul_f32 v81, s47, v81
  v_mfma_f32_16x16x32_bf16 a[236:239], a[240:243], v[248:251], a[236:239]
  v_exp_f32 v172, v172
  v_mfma_f32_16x16x32_bf16 a[60:63], a[216:219], v[200:203], a[60:63]
  v_mfma_f32_16x16x32_bf16 a[60:63], a[220:223], v[232:235], a[60:63]
  v_exp_f32 v173, v173
  v_cvt_pk_bf16_f32 v169, v170, v171
  v_mfma_f32_16x16x32_bf16 a[92:95], a[216:219], v[208:211], a[92:95]
  buffer_load_dwordx4 v3, s[8:11], s88 offen offset:2048 nt lds
  v_mfma_f32_16x16x32_bf16 a[92:95], a[220:223], v[240:243], a[92:95]
  v_exp_f32 v174, v174
  v_cvt_pk_bf16_f32 v80, v40, v80
  v_mfma_f32_16x16x32_bf16 a[124:127], a[216:219], v[216:219], a[124:127]
  v_mfma_f32_16x16x32_bf16 a[124:127], a[220:223], v[248:251], a[124:127]
  v_exp_f32 v175, v175
  v_cvt_pk_bf16_f32 v170, v172, v173
  v_cvt_pk_bf16_f32 v81, v41, v81
  s_waitcnt lgkmcnt(0)
  v_mfma_f32_16x16x32_bf16 v[192:195], a[192:195], a[128:131], v[20:23]
  buffer_load_dwordx4 v4, s[8:11], s88 offen offset:3072 nt lds
  v_mfma_f32_16x16x32_bf16 v[192:195], a[196:199], a[132:135], v[192:195]
  ds_read_b128 a[208:211], v8 offset:36864
  v_mfma_f32_16x16x32_bf16 v[192:195], a[200:203], a[136:139], v[192:195]
  v_mfma_f32_16x16x32_bf16 v[192:195], a[204:207], a[140:143], v[192:195]
  v_exp_f32 v144, v144
  v_exp_f32 v145, v145
  v_lshlrev_b32 v40, 16, v82
  v_lshlrev_b32 v41, 16, v83
  v_mfma_f32_16x16x32_bf16 v[200:203], a[192:195], a[144:147], v[52:55]
  ds_read_b128 a[212:215], v9 offset:36864
  v_mfma_f32_16x16x32_bf16 v[200:203], a[196:199], a[148:151], v[200:203]
  v_mfma_f32_16x16x32_bf16 v[200:203], a[200:203], a[152:155], v[200:203]
  v_mfma_f32_16x16x32_bf16 v[200:203], a[204:207], a[156:159], v[200:203]
  ds_read_b128 a[216:219], v10 offset:36864
  v_cvt_pk_bf16_f32 v171, v174, v175
  v_exp_f32 v146, v146
  v_exp_f32 v147, v147
  v_and_b32 v82, 0xffff0000, v82
  v_and_b32 v83, 0xffff0000, v83
  v_mfma_f32_16x16x32_bf16 v[208:211], a[192:195], a[160:163], v[56:59]
  v_mfma_f32_16x16x32_bf16 v[208:211], a[196:199], a[164:167], v[208:211]
  v_mfma_f32_16x16x32_bf16 v[208:211], a[200:203], a[168:171], v[208:211]
  ds_read_b128 a[220:223], v11 offset:36864
  v_mfma_f32_16x16x32_bf16 v[208:211], a[204:207], a[172:175], v[208:211]
  s_add_u32 m0, s55, 8192
  s_add_u32 s46, s45, 8192
  v_cvt_pk_bf16_f32 v144, v144, v145
  v_exp_f32 v148, v148
  v_exp_f32 v149, v149
  v_mul_f32 v40, s47, v40
  v_mul_f32 v41, s47, v41
  v_mfma_f32_16x16x32_bf16 v[216:219], a[192:195], a[176:179], v[60:63]
  buffer_load_dwordx4 v3, s[28:31], s46 offen offset:2048 nt lds
  v_mfma_f32_16x16x32_bf16 v[216:219], a[196:199], a[180:183], v[216:219]
  v_mfma_f32_16x16x32_bf16 v[216:219], a[200:203], a[184:187], v[216:219]
  v_mfma_f32_16x16x32_bf16 v[216:219], a[204:207], a[188:191], v[216:219]
  v_cvt_pk_bf16_f32 v145, v146, v147
  v_exp_f32 v150, v150
  v_mul_f32 v82, s47, v82
  v_mul_f32 v83, s47, v83
  s_waitcnt lgkmcnt(0)
  v_mfma_f32_16x16x32_bf16 v[196:199], a[208:211], a[128:131], v[20:23]
  v_mfma_f32_16x16x32_bf16 v[196:199], a[212:215], a[132:135], v[196:199]
  ds_read_b128 a[192:195], v8 offset:40960
  v_mfma_f32_16x16x32_bf16 v[196:199], a[216:219], a[136:139], v[196:199]
  buffer_load_dwordx4 v4, s[28:31], s46 offen offset:3072 nt lds
  v_mfma_f32_16x16x32_bf16 v[196:199], a[220:223], a[140:143], v[196:199]
  v_exp_f32 v151, v151
  v_cvt_pk_bf16_f32 v146, v148, v149
  v_exp_f32 v176, v176
  v_cvt_pk_bf16_f32 v82, v40, v82
  v_cvt_pk_bf16_f32 v83, v41, v83
  v_mfma_f32_16x16x32_bf16 v[204:207], a[208:211], a[144:147], v[52:55]
  ds_read_b128 a[196:199], v9 offset:40960
  v_mfma_f32_16x16x32_bf16 v[204:207], a[212:215], a[148:151], v[204:207]
  v_mfma_f32_16x16x32_bf16 v[204:207], a[216:219], a[152:155], v[204:207]
  v_mfma_f32_16x16x32_bf16 v[204:207], a[220:223], a[156:159], v[204:207]
  ds_read_b128 a[200:203], v10 offset:40960
  v_exp_f32 v177, v177
  v_cvt_pk_bf16_f32 v147, v150, v151
  v_exp_f32 v178, v178
  v_lshlrev_b32 v40, 16, v84
  v_lshlrev_b32 v41, 16, v85
  v_mfma_f32_16x16x32_bf16 v[212:215], a[208:211], a[160:163], v[56:59]
  v_mfma_f32_16x16x32_bf16 v[212:215], a[212:215], a[164:167], v[212:215]
  v_mfma_f32_16x16x32_bf16 v[212:215], a[216:219], a[168:171], v[212:215]
  ds_read_b128 a[204:207], v11 offset:40960
  v_mfma_f32_16x16x32_bf16 v[212:215], a[220:223], a[172:175], v[212:215]
  v_exp_f32 v179, v179
  v_cvt_pk_bf16_f32 v176, v176, v177
  v_exp_f32 v180, v180
  v_and_b32 v84, 0xffff0000, v84
  v_and_b32 v85, 0xffff0000, v85
  v_mfma_f32_16x16x32_bf16 v[220:223], a[208:211], a[176:179], v[60:63]
  v_mfma_f32_16x16x32_bf16 v[220:223], a[212:215], a[180:183], v[220:223]
  v_mfma_f32_16x16x32_bf16 v[220:223], a[216:219], a[184:187], v[220:223]
  v_mfma_f32_16x16x32_bf16 v[220:223], a[220:223], a[188:191], v[220:223]
  v_exp_f32 v181, v181
  v_cvt_pk_bf16_f32 v177, v178, v179
  v_exp_f32 v182, v182
  v_exp_f32 v183, v183
  v_mul_f32 v40, s47, v40
  v_mul_f32 v41, s47, v41
  s_waitcnt lgkmcnt(0)
  v_mfma_f32_16x16x32_bf16 v[224:227], a[192:195], a[128:131], v[20:23]
  v_mfma_f32_16x16x32_bf16 v[224:227], a[196:199], a[132:135], v[224:227]
  ds_read_b128 a[208:211], v8 offset:45056
  v_mfma_f32_16x16x32_bf16 v[224:227], a[200:203], a[136:139], v[224:227]
  v_mfma_f32_16x16x32_bf16 v[224:227], a[204:207], a[140:143], v[224:227]
  v_cvt_pk_bf16_f32 v178, v180, v181
  v_exp_f32 v152, v152
  v_exp_f32 v153, v153
  v_cvt_pk_bf16_f32 v179, v182, v183
  v_mul_f32 v84, s47, v84
  v_mul_f32 v85, s47, v85
  v_mfma_f32_16x16x32_bf16 v[232:235], a[192:195], a[144:147], v[52:55]
  ds_read_b128 a[212:215], v9 offset:45056
  v_mfma_f32_16x16x32_bf16 v[232:235], a[196:199], a[148:151], v[232:235]
  v_mfma_f32_16x16x32_bf16 v[232:235], a[200:203], a[152:155], v[232:235]
  v_mfma_f32_16x16x32_bf16 v[232:235], a[204:207], a[156:159], v[232:235]
  ds_read_b128 a[216:219], v10 offset:45056
  v_exp_f32 v154, v154
  v_exp_f32 v155, v155
  v_cvt_pk_bf16_f32 v152, v152, v153
  v_cvt_pk_bf16_f32 v84, v40, v84
  v_cvt_pk_bf16_f32 v85, v41, v85
  v_mfma_f32_16x16x32_bf16 v[240:243], a[192:195], a[160:163], v[56:59]
  v_mfma_f32_16x16x32_bf16 v[240:243], a[196:199], a[164:167], v[240:243]
  v_mfma_f32_16x16x32_bf16 v[240:243], a[200:203], a[168:171], v[240:243]
  ds_read_b128 a[220:223], v11 offset:45056
  v_mfma_f32_16x16x32_bf16 v[240:243], a[204:207], a[172:175], v[240:243]
  v_exp_f32 v156, v156
  v_exp_f32 v157, v157
  v_cvt_pk_bf16_f32 v153, v154, v155
  v_exp_f32 v158, v158
  v_lshlrev_b32 v40, 16, v86
  v_lshlrev_b32 v41, 16, v87
  v_mfma_f32_16x16x32_bf16 v[248:251], a[192:195], a[176:179], v[60:63]
  s_waitcnt vmcnt(8)
  s_barrier
  v_mfma_f32_16x16x32_bf16 v[248:251], a[196:199], a[180:183], v[248:251]
  s_add_u32 m0, s44, 81920
  v_mfma_f32_16x16x32_bf16 v[248:251], a[200:203], a[184:187], v[248:251]
  v_mfma_f32_16x16x32_bf16 v[248:251], a[204:207], a[188:191], v[248:251]
  v_exp_f32 v159, v159
  v_cvt_pk_bf16_f32 v154, v156, v157
  v_and_b32 v86, 0xffff0000, v86
  v_and_b32 v87, 0xffff0000, v87
  s_waitcnt lgkmcnt(0)
  v_mfma_f32_16x16x32_bf16 v[228:231], a[208:211], a[128:131], v[20:23]
  buffer_load_dwordx4 v5, s[12:15], s87 offen offset:0 nt lds
  v_mfma_f32_16x16x32_bf16 v[228:231], a[212:215], a[132:135], v[228:231]
  ds_read_b64_tr_b16 a[192:193], v12 offset:16384
  ds_read_b64_tr_b16 a[194:195], v12 offset:20480
  v_mfma_f32_16x16x32_bf16 v[228:231], a[216:219], a[136:139], v[228:231]
  v_mfma_f32_16x16x32_bf16 v[228:231], a[220:223], a[140:143], v[228:231]
  v_exp_f32 v184, v184
  v_mul_f32 v40, s47, v40
  v_mul_f32 v41, s47, v41
  v_mfma_f32_16x16x32_bf16 v[236:239], a[208:211], a[144:147], v[52:55]
  ds_read_b64_tr_b16 a[196:197], v12 offset:24576
  ds_read_b64_tr_b16 a[198:199], v12 offset:28672
  v_mfma_f32_16x16x32_bf16 v[236:239], a[212:215], a[148:151], v[236:239]
  v_mfma_f32_16x16x32_bf16 v[236:239], a[216:219], a[152:155], v[236:239]
  buffer_load_dwordx4 v6, s[12:15], s87 offen offset:1024 nt lds
  v_mfma_f32_16x16x32_bf16 v[236:239], a[220:223], a[156:159], v[236:239]
  ds_read_b64_tr_b16 a[200:201], v13 offset:16384
  ds_read_b64_tr_b16 a[202:203], v13 offset:20480
  v_exp_f32 v185, v185
  v_mul_f32 v86, s47, v86
  v_mul_f32 v87, s47, v87
  v_mfma_f32_16x16x32_bf16 v[244:247], a[208:211], a[160:163], v[56:59]
  v_mfma_f32_16x16x32_bf16 v[244:247], a[212:215], a[164:167], v[244:247]
  v_mfma_f32_16x16x32_bf16 v[244:247], a[216:219], a[168:171], v[244:247]
  ds_read_b64_tr_b16 a[204:205], v13 offset:24576
  ds_read_b64_tr_b16 a[206:207], v13 offset:28672
  v_mfma_f32_16x16x32_bf16 v[244:247], a[220:223], a[172:175], v[244:247]
  v_cvt_pk_bf16_f32 v155, v158, v159
  v_exp_f32 v186, v186
  v_exp_f32 v187, v187
  v_cvt_pk_bf16_f32 v86, v40, v86
  v_cvt_pk_bf16_f32 v87, v41, v87
  v_mfma_f32_16x16x32_bf16 v[252:255], a[208:211], a[176:179], v[60:63]
  buffer_load_dwordx4 v5, s[12:15], s87 offen offset:2048 nt lds
  v_mfma_f32_16x16x32_bf16 v[252:255], a[212:215], a[180:183], v[252:255]
  v_mfma_f32_16x16x32_bf16 v[252:255], a[216:219], a[184:187], v[252:255]
  v_mfma_f32_16x16x32_bf16 v[252:255], a[220:223], a[188:191], v[252:255]
  v_cvt_pk_bf16_f32 v184, v184, v185
  v_exp_f32 v188, v188
  v_exp_f32 v189, v189
  v_lshlrev_b32 v40, 16, v88
  v_lshlrev_b32 v41, 16, v89
  s_waitcnt lgkmcnt(0)
  v_mfma_f32_16x16x32_bf16 a[0:3], a[192:195], v[128:131], a[0:3]
  buffer_load_dwordx4 v6, s[12:15], s87 offen offset:3072 nt lds
  v_mfma_f32_16x16x32_bf16 a[0:3], a[196:199], v[160:163], a[0:3]
  ds_read_b64_tr_b16 a[208:209], v14 offset:16384
  ds_read_b64_tr_b16 a[210:211], v14 offset:20480
  v_and_b32 v88, 0xffff0000, v88
  v_mfma_f32_16x16x32_bf16 a[32:35], a[192:195], v[136:139], a[32:35]
  v_mfma_f32_16x16x32_bf16 a[32:35], a[196:199], v[168:171], a[32:35]
  v_cvt_pk_bf16_f32 v185, v186, v187
  v_exp_f32 v190, v190
  v_and_b32 v89, 0xffff0000, v89
  v_mfma_f32_16x16x32_bf16 a[64:67], a[192:195], v[144:147], a[64:67]
  ds_read_b64_tr_b16 a[212:213], v14 offset:24576
  ds_read_b64_tr_b16 a[214:215], v14 offset:28672
  v_mfma_f32_16x16x32_bf16 a[64:67], a[196:199], v[176:179], a[64:67]
  v_mul_f32 v40, s47, v40
  v_mul_f32 v41, s47, v41
  v_mfma_f32_16x16x32_bf16 a[96:99], a[192:195], v[152:155], a[96:99]
  v_exp_f32 v191, v191
  v_cvt_pk_bf16_f32 v186, v188, v189
  v_cvt_pk_bf16_f32 v187, v190, v191
  s_nop 1
  v_mfma_f32_16x16x32_bf16 a[96:99], a[196:199], v[184:187], a[96:99]
  ds_read_b64_tr_b16 a[216:217], v15 offset:16384
  ds_read_b64_tr_b16 a[218:219], v15 offset:20480
  v_exp_f32 v192, v192
  v_mfma_f32_16x16x32_bf16 a[4:7], a[200:203], v[128:131], a[4:7]
  v_mfma_f32_16x16x32_bf16 a[4:7], a[204:207], v[160:163], a[4:7]
  v_exp_f32 v193, v193
  v_exp_f32 v194, v194
  v_mul_f32 v88, s47, v88
  v_mfma_f32_16x16x32_bf16 a[224:227], a[240:243], v[128:131], a[224:227]
  v_exp_f32 v195, v195
  v_mfma_f32_16x16x32_bf16 a[224:227], a[240:243], v[160:163], a[224:227]
  v_cvt_pk_bf16_f32 v192, v192, v193
  v_mul_f32 v89, s47, v89
  v_mfma_f32_16x16x32_bf16 a[36:39], a[200:203], v[136:139], a[36:39]
  ds_read_b64_tr_b16 a[220:221], v15 offset:24576
  ds_read_b64_tr_b16 a[222:223], v15 offset:28672
  v_mfma_f32_16x16x32_bf16 a[36:39], a[204:207], v[168:171], a[36:39]
  v_exp_f32 v196, v196
  v_mfma_f32_16x16x32_bf16 a[68:71], a[200:203], v[144:147], a[68:71]
  v_mfma_f32_16x16x32_bf16 a[68:71], a[204:207], v[176:179], a[68:71]
  v_exp_f32 v197, v197
  v_cvt_pk_bf16_f32 v193, v194, v195
  v_cvt_pk_bf16_f32 v88, v40, v88
  v_mfma_f32_16x16x32_bf16 a[100:103], a[200:203], v[152:155], a[100:103]
  v_mfma_f32_16x16x32_bf16 a[100:103], a[204:207], v[184:187], a[100:103]
  v_exp_f32 v198, v198
  v_exp_f32 v199, v199
  v_cvt_pk_bf16_f32 v89, v41, v89
  s_waitcnt lgkmcnt(0)
  v_mfma_f32_16x16x32_bf16 a[8:11], a[208:211], v[128:131], a[8:11]
  v_mfma_f32_16x16x32_bf16 a[8:11], a[212:215], v[160:163], a[8:11]
  ds_read_b64_tr_b16 a[192:193], v16 offset:16384
  ds_read_b64_tr_b16 a[194:195], v16 offset:20480
  v_cvt_pk_bf16_f32 v194, v196, v197
  v_lshlrev_b32 v40, 16, v90
  v_mfma_f32_16x16x32_bf16 a[40:43], a[208:211], v[136:139], a[40:43]
  v_mfma_f32_16x16x32_bf16 a[40:43], a[212:215], v[168:171], a[40:43]
  v_exp_f32 v224, v224
  v_exp_f32 v225, v225
  v_lshlrev_b32 v41, 16, v91
  v_mfma_f32_16x16x32_bf16 a[72:75], a[208:211], v[144:147], a[72:75]
  ds_read_b64_tr_b16 a[196:197], v16 offset:24576
  ds_read_b64_tr_b16 a[198:199], v16 offset:28672
  v_mfma_f32_16x16x32_bf16 a[72:75], a[212:215], v[176:179], a[72:75]
  v_cvt_pk_bf16_f32 v195, v198, v199
  v_and_b32 v90, 0xffff0000, v90
  v_mfma_f32_16x16x32_bf16 a[104:107], a[208:211], v[152:155], a[104:107]
  v_mfma_f32_16x16x32_bf16 a[104:107], a[212:215], v[184:187], a[104:107]
  ds_read_b64_tr_b16 a[200:201], v17 offset:16384
  ds_read_b64_tr_b16 a[202:203], v17 offset:20480
  v_exp_f32 v226, v226
  v_and_b32 v91, 0xffff0000, v91
  v_mfma_f32_16x16x32_bf16 a[12:15], a[216:219], v[128:131], a[12:15]
  v_mfma_f32_16x16x32_bf16 a[12:15], a[220:223], v[160:163], a[12:15]
  v_exp_f32 v227, v227
  v_cvt_pk_bf16_f32 v224, v224, v225
  v_mul_f32 v40, s47, v40
  v_mfma_f32_16x16x32_bf16 a[228:231], a[240:243], v[136:139], a[228:231]
  v_exp_f32 v228, v228
  v_mfma_f32_16x16x32_bf16 a[228:231], a[240:243], v[168:171], a[228:231]
  v_exp_f32 v229, v229
  v_mfma_f32_16x16x32_bf16 a[44:47], a[216:219], v[136:139], a[44:47]
  ds_read_b64_tr_b16 a[204:205], v17 offset:24576
  ds_read_b64_tr_b16 a[206:207], v17 offset:28672
  v_mfma_f32_16x16x32_bf16 a[44:47], a[220:223], v[168:171], a[44:47]
  v_cvt_pk_bf16_f32 v225, v226, v227
  v_mul_f32 v41, s47, v41
  v_mfma_f32_16x16x32_bf16 a[76:79], a[216:219], v[144:147], a[76:79]
  v_mfma_f32_16x16x32_bf16 a[76:79], a[220:223], v[176:179], a[76:79]
L_pad3:
  s_cbranch_execz L_pad7
  s_add_u32 m0, s55, 12288
  s_add_u32 s46, s45, 12288
  v_exp_f32 v230, v230
  v_mul_f32 v90, s47, v90
  v_mfma_f32_16x16x32_bf16 a[108:111], a[216:219], v[152:155], a[108:111]
  buffer_load_dwordx4 v1, s[28:31], s46 offen offset:0 nt lds
  v_mfma_f32_16x16x32_bf16 a[108:111], a[220:223], v[184:187], a[108:111]
  v_mul_f32 v91, s47, v91
  s_waitcnt lgkmcnt(0)
  v_mfma_f32_16x16x32_bf16 a[16:19], a[192:195], v[128:131], a[16:19]
  v_mfma_f32_16x16x32_bf16 a[16:19], a[196:199], v[160:163], a[16:19]
  ds_read_b64_tr_b16 a[208:209], v18 offset:16384
  ds_read_b64_tr_b16 a[210:211], v18 offset:20480
  v_exp_f32 v231, v231
  v_cvt_pk_bf16_f32 v90, v40, v90
  v_mfma_f32_16x16x32_bf16 a[48:51], a[192:195], v[136:139], a[48:51]
  v_mfma_f32_16x16x32_bf16 a[48:51], a[196:199], v[168:171], a[48:51]
  v_cvt_pk_bf16_f32 v226, v228, v229
  v_exp_f32 v200, v200
  v_cvt_pk_bf16_f32 v91, v41, v91
  v_mfma_f32_16x16x32_bf16 a[80:83], a[192:195], v[144:147], a[80:83]
  ds_read_b64_tr_b16 a[212:213], v18 offset:24576
  ds_read_b64_tr_b16 a[214:215], v18 offset:28672
  v_mfma_f32_16x16x32_bf16 a[80:83], a[196:199], v[176:179], a[80:83]
  v_exp_f32 v201, v201
  v_lshlrev_b32 v40, 16, v92
  v_mfma_f32_16x16x32_bf16 a[112:115], a[192:195], v[152:155], a[112:115]
  v_mfma_f32_16x16x32_bf16 a[112:115], a[196:199], v[184:187], a[112:115]
  ds_read_b64_tr_b16 a[216:217], v19 offset:16384
  ds_read_b64_tr_b16 a[218:219], v19 offset:20480
  v_cvt_pk_bf16_f32 v227, v230, v231
  v_lshlrev_b32 v41, 16, v93
  v_mfma_f32_16x16x32_bf16 a[20:23], a[200:203], v[128:131], a[20:23]
  v_mfma_f32_16x16x32_bf16 a[20:23], a[204:207], v[160:163], a[20:23]
  v_exp_f32 v202, v202
  v_exp_f32 v203, v203
  v_and_b32 v92, 0xffff0000, v92
  v_mfma_f32_16x16x32_bf16 a[232:235], a[240:243], v[144:147], a[232:235]
  v_cvt_pk_bf16_f32 v200, v200, v201
  v_exp_f32 v204, v204
  v_mfma_f32_16x16x32_bf16 a[232:235], a[240:243], v[176:179], a[232:235]
  v_exp_f32 v205, v205
  v_mfma_f32_16x16x32_bf16 a[52:55], a[200:203], v[136:139], a[52:55]
  ds_read_b64_tr_b16 a[220:221], v19 offset:24576
  ds_read_b64_tr_b16 a[222:223], v19 offset:28672
  v_mfma_f32_16x16x32_bf16 a[52:55], a[204:207], v[168:171], a[52:55]
  v_cvt_pk_bf16_f32 v201, v202, v203
  v_and_b32 v93, 0xffff0000, v93
  v_mfma_f32_16x16x32_bf16 a[84:87], a[200:203], v[144:147], a[84:87]
  s_waitcnt vmcnt(7)
  s_barrier
  v_mfma_f32_16x16x32_bf16 a[84:87], a[204:207], v[176:179], a[84:87]
  v_exp_f32 v206, v206
  v_mul_f32 v40, s47, v40
  v_mfma_f32_16x16x32_bf16 a[116:119], a[200:203], v[152:155], a[116:119]
  v_mfma_f32_16x16x32_bf16 a[116:119], a[204:207], v[184:187], a[116:119]
  v_exp_f32 v207, v207
  v_mul_f32 v41, s47, v41
  s_waitcnt lgkmcnt(0)
  v_mfma_f32_16x16x32_bf16 a[24:27], a[208:211], v[128:131], a[24:27]
  buffer_load_dwordx4 v2, s[28:31], s46 offen offset:1024 nt lds
  v_mfma_f32_16x16x32_bf16 a[24:27], a[212:215], v[160:163], a[24:27]
  ds_read_b128 a[192:195], v8 offset:0
  v_mul_f32 v92, s47, v92
  v_mfma_f32_16x16x32_bf16 a[56:59], a[208:211], v[136:139], a[56:59]
  s_add_u32 m0, s44, 16384
  v_mfma_f32_16x16x32_bf16 a[56:59], a[212:215], v[168:171], a[56:59]
  v_cvt_pk_bf16_f32 v202, v204, v205
  v_exp_f32 v232, v232
  v_mul_f32 v93, s47, v93
  v_mfma_f32_16x16x32_bf16 a[88:91], a[208:211], v[144:147], a[88:91]
  ds_read_b128 a[196:199], v9 offset:0
  v_mfma_f32_16x16x32_bf16 a[88:91], a[212:215], v[176:179], a[88:91]
  v_exp_f32 v233, v233
  v_cvt_pk_bf16_f32 v203, v206, v207
  v_cvt_pk_bf16_f32 v92, v40, v92
  v_mfma_f32_16x16x32_bf16 a[120:123], a[208:211], v[152:155], a[120:123]
  buffer_load_dwordx4 v1, s[8:11], s89 offen offset:0 nt lds
  v_mfma_f32_16x16x32_bf16 a[120:123], a[212:215], v[184:187], a[120:123]
  ds_read_b128 a[200:203], v10 offset:0
  v_cvt_pk_bf16_f32 v93, v41, v93
  v_mfma_f32_16x16x32_bf16 a[28:31], a[216:219], v[128:131], a[28:31]
  v_mfma_f32_16x16x32_bf16 a[28:31], a[220:223], v[160:163], a[28:31]
  v_exp_f32 v234, v234
  v_exp_f32 v235, v235
  v_lshlrev_b32 v40, 16, v94
  v_mfma_f32_16x16x32_bf16 a[236:239], a[240:243], v[152:155], a[236:239]
  v_cvt_pk_bf16_f32 v232, v232, v233
  v_lshlrev_b32 v41, 16, v95
  v_mfma_f32_16x16x32_bf16 a[236:239], a[240:243], v[184:187], a[236:239]
  v_exp_f32 v236, v236
  v_mfma_f32_16x16x32_bf16 a[60:63], a[216:219], v[136:139], a[60:63]
  ds_read_b128 a[204:207], v11 offset:0
  v_mfma_f32_16x16x32_bf16 a[60:63], a[220:223], v[168:171], a[60:63]
  v_exp_f32 v237, v237
  v_cvt_pk_bf16_f32 v233, v234, v235
  v_mfma_f32_16x16x32_bf16 a[92:95], a[216:219], v[144:147], a[92:95]
  buffer_load_dwordx4 v2, s[8:11], s89 offen offset:1024 nt lds
  v_mfma_f32_16x16x32_bf16 a[92:95], a[220:223], v[176:179], a[92:95]
  v_exp_f32 v238, v238
  v_and_b32 v94, 0xffff0000, v94
  v_mfma_f32_16x16x32_bf16 a[124:127], a[216:219], v[152:155], a[124:127]
  v_mfma_f32_16x16x32_bf16 a[124:127], a[220:223], v[184:187], a[124:127]
  v_exp_f32 v239, v239
  v_and_b32 v95, 0xffff0000, v95
  s_waitcnt lgkmcnt(0)
  v_mfma_f32_16x16x32_bf16 v[128:131], a[192:195], a[128:131], v[20:23]
  buffer_load_dwordx4 v3, s[8:11], s89 offen offset:2048 nt lds
  v_mfma_f32_16x16x32_bf16 v[128:131], a[196:199], a[132:135], v[128:131]
  ds_read_b128 a[208:211], v8 offset:4096
  v_mfma_f32_16x16x32_bf16 v[128:131], a[200:203], a[136:139], v[128:131]
  v_mfma_f32_16x16x32_bf16 v[128:131], a[204:207], a[140:143], v[128:131]
  v_cvt_pk_bf16_f32 v234, v236, v237
  v_exp_f32 v208, v208
  v_exp_f32 v209, v209
  v_mul_f32 v40, s47, v40
  v_mul_f32 v41, s47, v41
  v_mfma_f32_16x16x32_bf16 v[136:139], a[192:195], a[144:147], v[52:55]
  ds_read_b128 a[212:215], v9 offset:4096
  v_mfma_f32_16x16x32_bf16 v[136:139], a[196:199], a[148:151], v[136:139]
  v_mfma_f32_16x16x32_bf16 v[136:139], a[200:203], a[152:155], v[136:139]
  buffer_load_dwordx4 v4, s[8:11], s89 offen offset:3072 nt lds
  v_mfma_f32_16x16x32_bf16 v[136:139], a[204:207], a[156:159], v[136:139]
  ds_read_b128 a[216:219], v10 offset:4096
  v_cvt_pk_bf16_f32 v235, v238, v239
  v_exp_f32 v210, v210
  v_mul_f32 v94, s47, v94
  v_mul_f32 v95, s47, v95
  v_mfma_f32_16x16x32_bf16 v[144:147], a[192:195], a[160:163], v[56:59]
  v_mfma_f32_16x16x32_bf16 v[144:147], a[196:199], a[164:167], v[144:147]
  v_mfma_f32_16x16x32_bf16 v[144:147], a[200:203], a[168:171], v[144:147]
  ds_read_b128 a[220:223], v11 offset:4096
  v_mfma_f32_16x16x32_bf16 v[144:147], a[204:207], a[172:175], v[144:147]
  v_exp_f32 v211, v211
  v_cvt_pk_bf16_f32 v208, v208, v209
  v_exp_f32 v212, v212
  v_cvt_pk_bf16_f32 v94, v40, v94
  v_cvt_pk_bf16_f32 v95, v41, v95
  v_mfma_f32_16x16x32_bf16 v[152:155], a[192:195], a[176:179], v[60:63]
  s_waitcnt vmcnt(10)
  ds_read_b128 v[96:99], v36 offset:8192
  v_mfma_f32_16x16x32_bf16 v[152:155], a[196:199], a[180:183], v[152:155]
  ds_read_b128 v[100:103], v37 offset:8192
  v_mfma_f32_16x16x32_bf16 v[152:155], a[200:203], a[184:187], v[152:155]
  v_mfma_f32_16x16x32_bf16 v[152:155], a[204:207], a[188:191], v[152:155]
  ds_read_b128 v[104:107], v38 offset:8192
  v_exp_f32 v213, v213
  v_cvt_pk_bf16_f32 v209, v210, v211
  v_exp_f32 v214, v214
  v_exp_f32 v215, v215
  s_waitcnt lgkmcnt(3)
  v_mfma_f32_16x16x32_bf16 v[132:135], a[208:211], a[128:131], v[20:23]
  ds_read_b128 v[108:111], v39 offset:8192
  v_mfma_f32_16x16x32_bf16 v[132:135], a[212:215], a[132:135], v[132:135]
  ds_read_b128 a[192:195], v8 offset:8192
  v_mfma_f32_16x16x32_bf16 v[132:135], a[216:219], a[136:139], v[132:135]
  v_mfma_f32_16x16x32_bf16 v[132:135], a[220:223], a[140:143], v[132:135]
  v_cvt_pk_bf16_f32 v210, v212, v213
  v_exp_f32 v240, v240
  v_exp_f32 v241, v241
  v_cvt_pk_bf16_f32 v211, v214, v215
  v_mfma_f32_16x16x32_bf16 v[140:143], a[208:211], a[144:147], v[52:55]
  ds_read_b128 a[196:199], v9 offset:8192
  v_mfma_f32_16x16x32_bf16 v[140:143], a[212:215], a[148:151], v[140:143]
  v_mfma_f32_16x16x32_bf16 v[140:143], a[216:219], a[152:155], v[140:143]
  v_mfma_f32_16x16x32_bf16 v[140:143], a[220:223], a[156:159], v[140:143]
  ds_read_b128 a[200:203], v10 offset:8192
  v_exp_f32 v242, v242
  v_exp_f32 v243, v243
  v_cvt_pk_bf16_f32 v240, v240, v241
  v_mfma_f32_16x16x32_bf16 v[148:151], a[208:211], a[160:163], v[56:59]
  v_mfma_f32_16x16x32_bf16 v[148:151], a[212:215], a[164:167], v[148:151]
  v_mfma_f32_16x16x32_bf16 v[148:151], a[216:219], a[168:171], v[148:151]
  ds_read_b128 a[204:207], v11 offset:8192
  v_mfma_f32_16x16x32_bf16 v[148:151], a[220:223], a[172:175], v[148:151]
  v_exp_f32 v244, v244
  v_exp_f32 v245, v245
  v_cvt_pk_bf16_f32 v241, v242, v243
  v_exp_f32 v246, v246
  s_waitcnt lgkmcnt(7)
  v_lshlrev_b32 v40, 16, v96
  v_mfma_f32_16x16x32_bf16 v[156:159], a[208:211], a[176:179], v[60:63]
  v_mfma_f32_16x16x32_bf16 v[156:159], a[212:215], a[180:183], v[156:159]
  s_add_u32 m0, s55, 12288
  s_add_u32 s46, s45, 12288
  v_mfma_f32_16x16x32_bf16 v[156:159], a[216:219], a[184:187], v[156:159]
  buffer_load_dwordx4 v3, s[28:31], s46 offen offset:2048 nt lds
  v_mfma_f32_16x16x32_bf16 v[156:159], a[220:223], a[188:191], v[156:159]
  v_exp_f32 v247, v247
  v_lshlrev_b32 v41, 16, v97
  v_and_b32 v96, 0xffff0000, v96
  v_and_b32 v97, 0xffff0000, v97
  s_waitcnt lgkmcnt(0)
  v_mfma_f32_16x16x32_bf16 v[160:163], a[192:195], a[128:131], v[20:23]
  v_mfma_f32_16x16x32_bf16 v[160:163], a[196:199], a[132:135], v[160:163]
  ds_read_b128 a[208:211], v8 offset:12288
  v_mfma_f32_16x16x32_bf16 v[160:163], a[200:203], a[136:139], v[160:163]
  v_mfma_f32_16x16x32_bf16 v[160:163], a[204:207], a[140:143], v[160:163]
  v_cvt_pk_bf16_f32 v242, v244, v245
  v_exp_f32 v216, v216
  v_exp_f32 v217, v217
  v_mul_f32 v40, s47, v40
  v_mul_f32 v41, s47, v41
  v_mfma_f32_16x16x32_bf16 v[168:171], a[192:195], a[144:147], v[52:55]
  ds_read_b128 a[212:215], v9 offset:12288
  v_mfma_f32_16x16x32_bf16 v[168:171], a[196:199], a[148:151], v[168:171]
  v_mfma_f32_16x16x32_bf16 v[168:171], a[200:203], a[152:155], v[168:171]
  v_mfma_f32_16x16x32_bf16 v[168:171], a[204:207], a[156:159], v[168:171]
  ds_read_b128 a[216:219], v10 offset:12288
  v_cvt_pk_bf16_f32 v243, v246, v247
  v_exp_f32 v218, v218
  v_exp_f32 v219, v219
  v_mul_f32 v96, s47, v96
  v_mul_f32 v97, s47, v97
  v_cvt_pk_bf16_f32 v96, v40, v96
  v_mfma_f32_16x16x32_bf16 v[176:179], a[192:195], a[160:163], v[56:59]
  v_mfma_f32_16x16x32_bf16 v[176:179], a[196:199], a[164:167], v[176:179]
  v_mfma_f32_16x16x32_bf16 v[176:179], a[200:203], a[168:171], v[176:179]
  ds_read_b128 a[220:223], v11 offset:12288
  v_mfma_f32_16x16x32_bf16 v[176:179], a[204:207], a[172:175], v[176:179]
  v_cvt_pk_bf16_f32 v216, v216, v217
  v_exp_f32 v220, v220
  v_exp_f32 v221, v221
  v_cvt_pk_bf16_f32 v217, v218, v219
  v_cvt_pk_bf16_f32 v97, v41, v97
  v_lshlrev_b32 v40, 16, v98
  v_mfma_f32_16x16x32_bf16 v[184:187], a[192:195], a[176:179], v[60:63]
  s_waitcnt vmcnt(7)
  s_barrier
  v_mfma_f32_16x16x32_bf16 v[184:187], a[196:199], a[180:183], v[184:187]
  v_mfma_f32_16x16x32_bf16 v[184:187], a[200:203], a[184:187], v[184:187]
  v_mfma_f32_16x16x32_bf16 v[184:187], a[204:207], a[188:191], v[184:187]
  v_exp_f32 v222, v222
  v_exp_f32 v223, v223
  v_cvt_pk_bf16_f32 v218, v220, v221
  v_lshlrev_b32 v41, 16, v99
  v_and_b32 v98, 0xffff0000, v98
  s_waitcnt lgkmcnt(0)
  v_mfma_f32_16x16x32_bf16 v[164:167], a[208:211], a[128:131], v[20:23]
  buffer_load_dwordx4 v4, s[28:31], s46 offen offset:3072 nt lds
  v_mfma_f32_16x16x32_bf16 v[164:167], a[212:215], a[132:135], v[164:167]
  ds_read_b64_tr_b16 a[192:193], v12 offset:32768
  ds_read_b64_tr_b16 a[194:195], v12 offset:36864
  v_mfma_f32_16x16x32_bf16 v[164:167], a[216:219], a[136:139], v[164:167]
  s_add_u32 m0, s44, 49152
  v_mfma_f32_16x16x32_bf16 v[164:167], a[220:223], a[140:143], v[164:167]
  v_exp_f32 v248, v248
  v_and_b32 v99, 0xffff0000, v99
  v_mul_f32 v40, s47, v40
  v_mul_f32 v41, s47, v41
  v_mfma_f32_16x16x32_bf16 v[172:175], a[208:211], a[144:147], v[52:55]
  ds_read_b64_tr_b16 a[196:197], v12 offset:40960
  ds_read_b64_tr_b16 a[198:199], v12 offset:45056
  v_mfma_f32_16x16x32_bf16 v[172:175], a[212:215], a[148:151], v[172:175]
  v_mfma_f32_16x16x32_bf16 v[172:175], a[216:219], a[152:155], v[172:175]
  buffer_load_dwordx4 v5, s[12:15], s88 offen offset:0 nt lds
  v_mfma_f32_16x16x32_bf16 v[172:175], a[220:223], a[156:159], v[172:175]
  ds_read_b64_tr_b16 a[200:201], v13 offset:32768
  ds_read_b64_tr_b16 a[202:203], v13 offset:36864
  v_exp_f32 v249, v249
  v_mul_f32 v98, s47, v98
  v_mul_f32 v99, s47, v99
  v_mfma_f32_16x16x32_bf16 v[180:183], a[208:211], a[160:163], v[56:59]
  v_mfma_f32_16x16x32_bf16 v[180:183], a[212:215], a[164:167], v[180:183]
  v_mfma_f32_16x16x32_bf16 v[180:183], a[216:219], a[168:171], v[180:183]
  ds_read_b64_tr_b16 a[204:205], v13 offset:40960
  ds_read_b64_tr_b16 a[206:207], v13 offset:45056
  v_mfma_f32_16x16x32_bf16 v[180:183], a[220:223], a[172:175], v[180:183]
  v_cvt_pk_bf16_f32 v219, v222, v223
  v_exp_f32 v250, v250
  v_exp_f32 v251, v251
  v_cvt_pk_bf16_f32 v98, v40, v98
  v_cvt_pk_bf16_f32 v99, v41, v99
  v_lshlrev_b32 v40, 16, v100
  v_mfma_f32_16x16x32_bf16 v[188:191], a[208:211], a[176:179], v[60:63]
  buffer_load_dwordx4 v6, s[12:15], s88 offen offset:1024 nt lds
  v_mfma_f32_16x16x32_bf16 v[188:191], a[212:215], a[180:183], v[188:191]
  v_mfma_f32_16x16x32_bf16 v[188:191], a[216:219], a[184:187], v[188:191]
  v_mfma_f32_16x16x32_bf16 v[188:191], a[220:223], a[188:191], v[188:191]
  v_cvt_pk_bf16_f32 v248, v248, v249
  v_exp_f32 v252, v252
  v_lshlrev_b32 v41, 16, v101
  v_and_b32 v100, 0xffff0000, v100
  s_waitcnt lgkmcnt(0)
  v_mfma_f32_16x16x32_bf16 a[0:3], a[192:195], v[192:195], a[0:3]
  buffer_load_dwordx4 v5, s[12:15], s88 offen offset:2048 nt lds
  v_mfma_f32_16x16x32_bf16 a[0:3], a[196:199], v[224:227], a[0:3]
  ds_read_b64_tr_b16 a[208:209], v14 offset:32768
  ds_read_b64_tr_b16 a[210:211], v14 offset:36864
  v_and_b32 v101, 0xffff0000, v101
  v_mfma_f32_16x16x32_bf16 a[32:35], a[192:195], v[200:203], a[32:35]
  v_mfma_f32_16x16x32_bf16 a[32:35], a[196:199], v[232:235], a[32:35]
  v_exp_f32 v253, v253
  v_cvt_pk_bf16_f32 v249, v250, v251
  v_mul_f32 v40, s47, v40
  v_mfma_f32_16x16x32_bf16 a[64:67], a[192:195], v[208:211], a[64:67]
  ds_read_b64_tr_b16 a[212:213], v14 offset:40960
  ds_read_b64_tr_b16 a[214:215], v14 offset:45056
  v_mfma_f32_16x16x32_bf16 a[64:67], a[196:199], v[240:243], a[64:67]
  v_exp_f32 v254, v254
  v_mul_f32 v41, s47, v41
  v_mul_f32 v100, s47, v100
  v_mfma_f32_16x16x32_bf16 a[96:99], a[192:195], v[216:219], a[96:99]
  buffer_load_dwordx4 v6, s[12:15], s88 offen offset:3072 nt lds
  v_exp_f32 v255, v255
  v_cvt_pk_bf16_f32 v250, v252, v253
  v_cvt_pk_bf16_f32 v251, v254, v255
  s_nop 1
  v_mfma_f32_16x16x32_bf16 a[96:99], a[196:199], v[248:251], a[96:99]
  ds_read_b64_tr_b16 a[216:217], v15 offset:32768
  ds_read_b64_tr_b16 a[218:219], v15 offset:36864
  v_mul_f32 v101, s47, v101
  v_mfma_f32_16x16x32_bf16 a[4:7], a[200:203], v[192:195], a[4:7]
  v_mfma_f32_16x16x32_bf16 a[4:7], a[204:207], v[224:227], a[4:7]
  v_exp_f32 v128, v128
  v_exp_f32 v129, v129
  v_cvt_pk_bf16_f32 v100, v40, v100
  v_mfma_f32_16x16x32_bf16 a[224:227], a[240:243], v[192:195], a[224:227]
  v_exp_f32 v130, v130
  v_mfma_f32_16x16x32_bf16 a[224:227], a[240:243], v[224:227], a[224:227]
  v_cvt_pk_bf16_f32 v101, v41, v101
  v_lshlrev_b32 v40, 16, v102
  v_mfma_f32_16x16x32_bf16 a[36:39], a[200:203], v[200:203], a[36:39]
  ds_read_b64_tr_b16 a[220:221], v15 offset:40960
  ds_read_b64_tr_b16 a[222:223], v15 offset:45056
  v_mfma_f32_16x16x32_bf16 a[36:39], a[204:207], v[232:235], a[36:39]
  v_exp_f32 v131, v131
  v_mfma_f32_16x16x32_bf16 a[68:71], a[200:203], v[208:211], a[68:71]
  v_mfma_f32_16x16x32_bf16 a[68:71], a[204:207], v[240:243], a[68:71]
  v_cvt_pk_bf16_f32 v128, v128, v129
  v_exp_f32 v132, v132
  v_mfma_f32_16x16x32_bf16 a[100:103], a[200:203], v[216:219], a[100:103]
  v_mfma_f32_16x16x32_bf16 a[100:103], a[204:207], v[248:251], a[100:103]
  v_exp_f32 v133, v133
  v_cvt_pk_bf16_f32 v129, v130, v131
  v_lshlrev_b32 v41, 16, v103
  v_and_b32 v102, 0xffff0000, v102
  s_waitcnt lgkmcnt(0)
  v_mfma_f32_16x16x32_bf16 a[8:11], a[208:211], v[192:195], a[8:11]
  v_mfma_f32_16x16x32_bf16 a[8:11], a[212:215], v[224:227], a[8:11]
  ds_read_b64_tr_b16 a[192:193], v16 offset:32768
  ds_read_b64_tr_b16 a[194:195], v16 offset:36864
  v_exp_f32 v134, v134
  v_and_b32 v103, 0xffff0000, v103
  v_mfma_f32_16x16x32_bf16 a[40:43], a[208:211], v[200:203], a[40:43]
  v_mfma_f32_16x16x32_bf16 a[40:43], a[212:215], v[232:235], a[40:43]
  v_exp_f32 v135, v135
  v_cvt_pk_bf16_f32 v130, v132, v133
  v_mul_f32 v40, s47, v40
  v_mfma_f32_16x16x32_bf16 a[72:75], a[208:211], v[208:211], a[72:75]
  ds_read_b64_tr_b16 a[196:197], v16 offset:40960
  ds_read_b64_tr_b16 a[198:199], v16 offset:45056
  v_mfma_f32_16x16x32_bf16 a[72:75], a[212:215], v[240:243], a[72:75]
  v_exp_f32 v160, v160
  v_mul_f32 v41, s47, v41
  v_mfma_f32_16x16x32_bf16 a[104:107], a[208:211], v[216:219], a[104:107]
  v_mfma_f32_16x16x32_bf16 a[104:107], a[212:215], v[248:251], a[104:107]
  ds_read_b64_tr_b16 a[200:201], v17 offset:32768
  ds_read_b64_tr_b16 a[202:203], v17 offset:36864
  v_exp_f32 v161, v161
  v_mul_f32 v102, s47, v102
  v_mfma_f32_16x16x32_bf16 a[12:15], a[216:219], v[192:195], a[12:15]
  v_mfma_f32_16x16x32_bf16 a[12:15], a[220:223], v[224:227], a[12:15]
  v_cvt_pk_bf16_f32 v131, v134, v135
  v_exp_f32 v162, v162
  v_mul_f32 v103, s47, v103
  v_cvt_pk_bf16_f32 v102, v40, v102
  v_mfma_f32_16x16x32_bf16 a[228:231], a[240:243], v[200:203], a[228:231]
  v_exp_f32 v163, v163
  v_mfma_f32_16x16x32_bf16 a[228:231], a[240:243], v[232:235], a[228:231]
  v_cvt_pk_bf16_f32 v160, v160, v161
  v_cvt_pk_bf16_f32 v103, v41, v103
  v_mfma_f32_16x16x32_bf16 a[44:47], a[216:219], v[200:203], a[44:47]
  ds_read_b64_tr_b16 a[204:205], v17 offset:40960
  ds_read_b64_tr_b16 a[206:207], v17 offset:45056
  v_mfma_f32_16x16x32_bf16 a[44:47], a[220:223], v[232:235], a[44:47]
  v_exp_f32 v164, v164
  v_mfma_f32_16x16x32_bf16 a[76:79], a[216:219], v[208:211], a[76:79]
  v_mfma_f32_16x16x32_bf16 a[76:79], a[220:223], v[240:243], a[76:79]
  v_exp_f32 v165, v165
  v_cvt_pk_bf16_f32 v161, v162, v163
  v_exp_f32 v166, v166
  v_lshlrev_b32 v40, 16, v104
  v_mfma_f32_16x16x32_bf16 a[108:111], a[216:219], v[216:219], a[108:111]
  v_mfma_f32_16x16x32_bf16 a[108:111], a[220:223], v[248:251], a[108:111]
  v_exp_f32 v167, v167
  v_lshlrev_b32 v41, 16, v105
  s_waitcnt lgkmcnt(0)
  v_mfma_f32_16x16x32_bf16 a[16:19], a[192:195], v[192:195], a[16:19]
  v_mfma_f32_16x16x32_bf16 a[16:19], a[196:199], v[224:227], a[16:19]
  ds_read_b64_tr_b16 a[208:209], v18 offset:32768
  ds_read_b64_tr_b16 a[210:211], v18 offset:36864
  v_cvt_pk_bf16_f32 v162, v164, v165
  v_and_b32 v104, 0xffff0000, v104
  v_mfma_f32_16x16x32_bf16 a[48:51], a[192:195], v[200:203], a[48:51]
  v_mfma_f32_16x16x32_bf16 a[48:51], a[196:199], v[232:235], a[48:51]
  v_exp_f32 v136, v136
  v_exp_f32 v137, v137
  v_and_b32 v105, 0xffff0000, v105
  v_mul_f32 v40, s47, v40
  v_mfma_f32_16x16x32_bf16 a[80:83], a[192:195], v[208:211], a[80:83]
  ds_read_b64_tr_b16 a[212:213], v18 offset:40960
  ds_read_b64_tr_b16 a[214:215], v18 offset:45056
  v_mfma_f32_16x16x32_bf16 a[80:83], a[196:199], v[240:243], a[80:83]
  v_cvt_pk_bf16_f32 v163, v166, v167
  v_mul_f32 v41, s47, v41
  v_mfma_f32_16x16x32_bf16 a[112:115], a[192:195], v[216:219], a[112:115]
  v_mfma_f32_16x16x32_bf16 a[112:115], a[196:199], v[248:251], a[112:115]
  ds_read_b64_tr_b16 a[216:217], v19 offset:32768
  ds_read_b64_tr_b16 a[218:219], v19 offset:36864
  v_exp_f32 v138, v138
  v_mul_f32 v104, s47, v104
  v_mfma_f32_16x16x32_bf16 a[20:23], a[200:203], v[192:195], a[20:23]
  v_mfma_f32_16x16x32_bf16 a[20:23], a[204:207], v[224:227], a[20:23]
  v_exp_f32 v139, v139
  v_cvt_pk_bf16_f32 v136, v136, v137
  v_mul_f32 v105, s47, v105
  v_mfma_f32_16x16x32_bf16 a[232:235], a[240:243], v[208:211], a[232:235]
  v_exp_f32 v140, v140
  v_mfma_f32_16x16x32_bf16 a[232:235], a[240:243], v[240:243], a[232:235]
  v_exp_f32 v141, v141
  v_mfma_f32_16x16x32_bf16 a[52:55], a[200:203], v[200:203], a[52:55]
  ds_read_b64_tr_b16 a[220:221], v19 offset:40960
  ds_read_b64_tr_b16 a[222:223], v19 offset:45056
  v_mfma_f32_16x16x32_bf16 a[52:55], a[204:207], v[232:235], a[52:55]
  v_cvt_pk_bf16_f32 v137, v138, v139
  v_cvt_pk_bf16_f32 v104, v40, v104
  v_mfma_f32_16x16x32_bf16 a[84:87], a[200:203], v[208:211], a[84:87]
  s_waitcnt vmcnt(6)
  s_barrier
  v_mfma_f32_16x16x32_bf16 a[84:87], a[204:207], v[240:243], a[84:87]
  s_add_u32 m0, s44, 32768
  v_exp_f32 v142, v142
  v_cvt_pk_bf16_f32 v105, v41, v105
  v_lshlrev_b32 v40, 16, v106
  v_mfma_f32_16x16x32_bf16 a[116:119], a[200:203], v[216:219], a[116:119]
  v_mfma_f32_16x16x32_bf16 a[116:119], a[204:207], v[248:251], a[116:119]
  v_exp_f32 v143, v143
  v_lshlrev_b32 v41, 16, v107
  s_waitcnt lgkmcnt(0)
  v_mfma_f32_16x16x32_bf16 a[24:27], a[208:211], v[192:195], a[24:27]
  buffer_load_dwordx4 v1, s[16:19], s82 offen offset:0 nt lds
  v_mfma_f32_16x16x32_bf16 a[24:27], a[212:215], v[224:227], a[24:27]
  ds_read_b128 a[192:195], v8 offset:16384
  v_and_b32 v106, 0xffff0000, v106
  v_mfma_f32_16x16x32_bf16 a[56:59], a[208:211], v[200:203], a[56:59]
  v_mfma_f32_16x16x32_bf16 a[56:59], a[212:215], v[232:235], a[56:59]
  v_cvt_pk_bf16_f32 v138, v140, v141
  v_exp_f32 v168, v168
  v_exp_f32 v169, v169
  v_and_b32 v107, 0xffff0000, v107
  v_mfma_f32_16x16x32_bf16 a[88:91], a[208:211], v[208:211], a[88:91]
  ds_read_b128 a[196:199], v9 offset:16384
  v_mfma_f32_16x16x32_bf16 a[88:91], a[212:215], v[240:243], a[88:91]
  v_cvt_pk_bf16_f32 v139, v142, v143
  v_mul_f32 v40, s47, v40
  v_mfma_f32_16x16x32_bf16 a[120:123], a[208:211], v[216:219], a[120:123]
  buffer_load_dwordx4 v2, s[16:19], s82 offen offset:1024 nt lds
  v_mfma_f32_16x16x32_bf16 a[120:123], a[212:215], v[248:251], a[120:123]
  ds_read_b128 a[200:203], v10 offset:16384
  v_exp_f32 v170, v170
  v_mul_f32 v41, s47, v41
  v_mul_f32 v106, s47, v106
  v_mfma_f32_16x16x32_bf16 a[28:31], a[216:219], v[192:195], a[28:31]
  v_mfma_f32_16x16x32_bf16 a[28:31], a[220:223], v[224:227], a[28:31]
  v_exp_f32 v171, v171
  v_cvt_pk_bf16_f32 v168, v168, v169
  v_mul_f32 v107, s47, v107
  v_mfma_f32_16x16x32_bf16 a[236:239], a[240:243], v[216:219], a[236:239]
  v_exp_f32 v172, v172
  v_mfma_f32_16x16x32_bf16 a[236:239], a[240:243], v[248:251], a[236:239]
  v_exp_f32 v173, v173
  v_mfma_f32_16x16x32_bf16 a[60:63], a[216:219], v[200:203], a[60:63]
  ds_read_b128 a[204:207], v11 offset:16384
  v_mfma_f32_16x16x32_bf16 a[60:63], a[220:223], v[232:235], a[60:63]
  v_cvt_pk_bf16_f32 v169, v170, v171
  v_cvt_pk_bf16_f32 v106, v40, v106
  v_mfma_f32_16x16x32_bf16 a[92:95], a[216:219], v[208:211], a[92:95]
  buffer_load_dwordx4 v3, s[16:19], s82 offen offset:2048 nt lds
  v_mfma_f32_16x16x32_bf16 a[92:95], a[220:223], v[240:243], a[92:95]
  v_exp_f32 v174, v174
  v_cvt_pk_bf16_f32 v107, v41, v107
  v_mfma_f32_16x16x32_bf16 a[124:127], a[216:219], v[216:219], a[124:127]
  v_mfma_f32_16x16x32_bf16 a[124:127], a[220:223], v[248:251], a[124:127]
  v_exp_f32 v175, v175
  v_cvt_pk_bf16_f32 v170, v172, v173
  v_lshlrev_b32 v40, 16, v108
  s_waitcnt lgkmcnt(0)
  v_mfma_f32_16x16x32_bf16 v[192:195], a[192:195], a[128:131], v[20:23]
  buffer_load_dwordx4 v4, s[16:19], s82 offen offset:3072 nt lds
  v_mfma_f32_16x16x32_bf16 v[192:195], a[196:199], a[132:135], v[192:195]
  ds_read_b128 a[208:211], v8 offset:20480
  v_mfma_f32_16x16x32_bf16 v[192:195], a[200:203], a[136:139], v[192:195]
  v_mfma_f32_16x16x32_bf16 v[192:195], a[204:207], a[140:143], v[192:195]
  v_exp_f32 v144, v144
  v_exp_f32 v145, v145
  v_lshlrev_b32 v41, 16, v109
  v_and_b32 v108, 0xffff0000, v108
  v_and_b32 v109, 0xffff0000, v109
  v_mfma_f32_16x16x32_bf16 v[200:203], a[192:195], a[144:147], v[52:55]
  ds_read_b128 a[212:215], v9 offset:20480
  v_mfma_f32_16x16x32_bf16 v[200:203], a[196:199], a[148:151], v[200:203]
  v_mfma_f32_16x16x32_bf16 v[200:203], a[200:203], a[152:155], v[200:203]
  v_cvt_pk_bf16_f32 v171, v174, v175
  v_exp_f32 v146, v146
  v_mfma_f32_16x16x32_bf16 v[200:203], a[204:207], a[156:159], v[200:203]
  ds_read_b128 a[216:219], v10 offset:20480
  v_exp_f32 v147, v147
  v_mul_f32 v40, s47, v40
  v_mul_f32 v41, s47, v41
  v_mfma_f32_16x16x32_bf16 v[208:211], a[192:195], a[160:163], v[56:59]
  v_mfma_f32_16x16x32_bf16 v[208:211], a[196:199], a[164:167], v[208:211]
  v_mfma_f32_16x16x32_bf16 v[208:211], a[200:203], a[168:171], v[208:211]
  ds_read_b128 a[220:223], v11 offset:20480
  v_mfma_f32_16x16x32_bf16 v[208:211], a[204:207], a[172:175], v[208:211]
  v_cvt_pk_bf16_f32 v144, v144, v145
  v_exp_f32 v148, v148
  v_exp_f32 v149, v149
  v_cvt_pk_bf16_f32 v145, v146, v147
  v_mul_f32 v108, s47, v108
  v_mul_f32 v109, s47, v109
  v_cvt_pk_bf16_f32 v108, v40, v108
  v_mfma_f32_16x16x32_bf16 v[216:219], a[192:195], a[176:179], v[60:63]
  v_mfma_f32_16x16x32_bf16 v[216:219], a[196:199], a[180:183], v[216:219]
  v_exp_f32 v150, v150
  v_mfma_f32_16x16x32_bf16 v[216:219], a[200:203], a[184:187], v[216:219]
  v_mfma_f32_16x16x32_bf16 v[216:219], a[204:207], a[188:191], v[216:219]
  v_exp_f32 v151, v151
  v_cvt_pk_bf16_f32 v146, v148, v149
  v_exp_f32 v176, v176
  v_cvt_pk_bf16_f32 v109, v41, v109
  v_lshlrev_b32 v40, 16, v110
  s_waitcnt lgkmcnt(0)
  v_mfma_f32_16x16x32_bf16 v[196:199], a[208:211], a[128:131], v[20:23]
  v_mfma_f32_16x16x32_bf16 v[196:199], a[212:215], a[132:135], v[196:199]
  ds_read_b128 a[192:195], v8 offset:24576
  v_mfma_f32_16x16x32_bf16 v[196:199], a[216:219], a[136:139], v[196:199]
  v_mfma_f32_16x16x32_bf16 v[196:199], a[220:223], a[140:143], v[196:199]
  v_exp_f32 v177, v177
  v_cvt_pk_bf16_f32 v147, v150, v151
  v_exp_f32 v178, v178
  v_lshlrev_b32 v41, 16, v111
  v_and_b32 v110, 0xffff0000, v110
  v_mfma_f32_16x16x32_bf16 v[204:207], a[208:211], a[144:147], v[52:55]
  ds_read_b128 a[196:199], v9 offset:24576
  v_exp_f32 v179, v179
  v_mfma_f32_16x16x32_bf16 v[204:207], a[212:215], a[148:151], v[204:207]
  v_mfma_f32_16x16x32_bf16 v[204:207], a[216:219], a[152:155], v[204:207]
  v_mfma_f32_16x16x32_bf16 v[204:207], a[220:223], a[156:159], v[204:207]
  ds_read_b128 a[200:203], v10 offset:24576
  v_cvt_pk_bf16_f32 v176, v176, v177
  v_exp_f32 v180, v180
  v_and_b32 v111, 0xffff0000, v111
  v_mul_f32 v40, s47, v40
  v_mul_f32 v41, s47, v41
  v_mfma_f32_16x16x32_bf16 v[212:215], a[208:211], a[160:163], v[56:59]
  v_mfma_f32_16x16x32_bf16 v[212:215], a[212:215], a[164:167], v[212:215]
  v_mfma_f32_16x16x32_bf16 v[212:215], a[216:219], a[168:171], v[212:215]
  ds_read_b128 a[204:207], v11 offset:24576
  v_exp_f32 v181, v181
  v_mfma_f32_16x16x32_bf16 v[212:215], a[220:223], a[172:175], v[212:215]
  v_cvt_pk_bf16_f32 v177, v178, v179
  v_exp_f32 v182, v182
  v_exp_f32 v183, v183
  v_mul_f32 v110, s47, v110
  v_mul_f32 v111, s47, v111
  v_mfma_f32_16x16x32_bf16 v[220:223], a[208:211], a[176:179], v[60:63]
  v_mfma_f32_16x16x32_bf16 v[220:223], a[212:215], a[180:183], v[220:223]
  v_mfma_f32_16x16x32_bf16 v[220:223], a[216:219], a[184:187], v[220:223]
  v_mfma_f32_16x16x32_bf16 v[220:223], a[220:223], a[188:191], v[220:223]
  v_cvt_pk_bf16_f32 v178, v180, v181
  v_exp_f32 v152, v152
  v_exp_f32 v153, v153
  v_cvt_pk_bf16_f32 v179, v182, v183
  v_cvt_pk_bf16_f32 v110, v40, v110
  v_cvt_pk_bf16_f32 v111, v41, v111
  s_waitcnt lgkmcnt(0)
  v_mfma_f32_16x16x32_bf16 v[224:227], a[192:195], a[128:131], v[20:23]
  s_waitcnt vmcnt(8)
  ds_read_b128 v[112:115], v36 offset:12288
  ds_read_b128 v[116:119], v37 offset:12288
  v_mfma_f32_16x16x32_bf16 v[224:227], a[196:199], a[132:135], v[224:227]
  ds_read_b128 a[208:211], v8 offset:28672
  v_exp_f32 v154, v154
  v_mfma_f32_16x16x32_bf16 v[224:227], a[200:203], a[136:139], v[224:227]
  ds_read_b128 v[120:123], v38 offset:12288
  v_mfma_f32_16x16x32_bf16 v[224:227], a[204:207], a[140:143], v[224:227]
  ds_read_b128 v[124:127], v39 offset:12288
  v_exp_f32 v155, v155
  v_cvt_pk_bf16_f32 v152, v152, v153
  v_exp_f32 v156, v156
  v_mfma_f32_16x16x32_bf16 v[232:235], a[192:195], a[144:147], v[52:55]
  ds_read_b128 a[212:215], v9 offset:28672
  v_mfma_f32_16x16x32_bf16 v[232:235], a[196:199], a[148:151], v[232:235]
  v_mfma_f32_16x16x32_bf16 v[232:235], a[200:203], a[152:155], v[232:235]
  v_mfma_f32_16x16x32_bf16 v[232:235], a[204:207], a[156:159], v[232:235]
  ds_read_b128 a[216:219], v10 offset:28672
  v_exp_f32 v157, v157
  v_cvt_pk_bf16_f32 v153, v154, v155
  v_exp_f32 v158, v158
  v_mfma_f32_16x16x32_bf16 v[240:243], a[192:195], a[160:163], v[56:59]
  v_exp_f32 v159, v159
  v_mfma_f32_16x16x32_bf16 v[240:243], a[196:199], a[164:167], v[240:243]
  v_mfma_f32_16x16x32_bf16 v[240:243], a[200:203], a[168:171], v[240:243]
  ds_read_b128 a[220:223], v11 offset:28672
  v_mfma_f32_16x16x32_bf16 v[240:243], a[204:207], a[172:175], v[240:243]
  v_cvt_pk_bf16_f32 v154, v156, v157
L_pad4:
  s_cbranch_execz L_pad8
  v_exp_f32 v184, v184
  v_mfma_f32_16x16x32_bf16 v[248:251], a[192:195], a[176:179], v[60:63]
  s_waitcnt vmcnt(4)
  s_barrier
  v_mfma_f32_16x16x32_bf16 v[248:251], a[196:199], a[180:183], v[248:251]
  s_add_u32 m0, s44, 65536
  v_mfma_f32_16x16x32_bf16 v[248:251], a[200:203], a[184:187], v[248:251]
  v_exp_f32 v185, v185
  v_mfma_f32_16x16x32_bf16 v[248:251], a[204:207], a[188:191], v[248:251]
  v_cvt_pk_bf16_f32 v155, v158, v159
  s_waitcnt lgkmcnt(7)
  v_lshlrev_b32 v40, 16, v112
  v_lshlrev_b32 v41, 16, v113
  v_and_b32 v112, 0xffff0000, v112
  s_waitcnt lgkmcnt(0)
  v_mfma_f32_16x16x32_bf16 v[228:231], a[208:211], a[128:131], v[20:23]
  buffer_load_dwordx4 v5, s[12:15], s89 offen offset:0 nt lds
  v_mfma_f32_16x16x32_bf16 v[228:231], a[212:215], a[132:135], v[228:231]
  ds_read_b64_tr_b16 a[192:193], v12 offset:0
  ds_read_b64_tr_b16 a[194:195], v12 offset:4096
  v_mfma_f32_16x16x32_bf16 v[228:231], a[216:219], a[136:139], v[228:231]
  v_mfma_f32_16x16x32_bf16 v[228:231], a[220:223], a[140:143], v[228:231]
  v_exp_f32 v186, v186
  v_exp_f32 v187, v187
  v_and_b32 v113, 0xffff0000, v113
  v_mul_f32 v40, s47, v40
  v_mul_f32 v41, s47, v41
  v_mul_f32 v112, s47, v112
  v_mfma_f32_16x16x32_bf16 v[236:239], a[208:211], a[144:147], v[52:55]
  ds_read_b64_tr_b16 a[196:197], v12 offset:8192
  ds_read_b64_tr_b16 a[198:199], v12 offset:12288
  v_mfma_f32_16x16x32_bf16 v[236:239], a[212:215], a[148:151], v[236:239]
  v_cvt_pk_bf16_f32 v184, v184, v185
  v_mul_f32 v113, s47, v113
  v_mfma_f32_16x16x32_bf16 v[236:239], a[216:219], a[152:155], v[236:239]
  buffer_load_dwordx4 v6, s[12:15], s89 offen offset:1024 nt lds
  v_mfma_f32_16x16x32_bf16 v[236:239], a[220:223], a[156:159], v[236:239]
  ds_read_b64_tr_b16 a[200:201], v13 offset:0
  ds_read_b64_tr_b16 a[202:203], v13 offset:4096
  v_cvt_pk_bf16_f32 v112, v40, v112
  v_cvt_pk_bf16_f32 v113, v41, v113
  v_lshlrev_b32 v40, 16, v114
  v_mfma_f32_16x16x32_bf16 v[244:247], a[208:211], a[160:163], v[56:59]
  v_mfma_f32_16x16x32_bf16 v[244:247], a[212:215], a[164:167], v[244:247]
  v_mfma_f32_16x16x32_bf16 v[244:247], a[216:219], a[168:171], v[244:247]
  ds_read_b64_tr_b16 a[204:205], v13 offset:8192
  ds_read_b64_tr_b16 a[206:207], v13 offset:12288
  v_mfma_f32_16x16x32_bf16 v[244:247], a[220:223], a[172:175], v[244:247]
  v_exp_f32 v188, v188
  v_exp_f32 v189, v189
  v_cvt_pk_bf16_f32 v185, v186, v187
  v_lshlrev_b32 v41, 16, v115
  v_and_b32 v114, 0xffff0000, v114
  v_and_b32 v115, 0xffff0000, v115
  v_mul_f32 v40, s47, v40
  v_mfma_f32_16x16x32_bf16 v[252:255], a[208:211], a[176:179], v[60:63]
  buffer_load_dwordx4 v5, s[12:15], s89 offen offset:2048 nt lds
  v_mfma_f32_16x16x32_bf16 v[252:255], a[212:215], a[180:183], v[252:255]
  v_mfma_f32_16x16x32_bf16 v[252:255], a[216:219], a[184:187], v[252:255]
  v_mfma_f32_16x16x32_bf16 v[252:255], a[220:223], a[188:191], v[252:255]
  v_exp_f32 v190, v190
  v_exp_f32 v191, v191
  v_mul_f32 v41, s47, v41
  v_mul_f32 v114, s47, v114
  v_mul_f32 v115, s47, v115
  v_cvt_pk_bf16_f32 v114, v40, v114
  s_waitcnt lgkmcnt(0)
  v_mfma_f32_16x16x32_bf16 a[0:3], a[192:195], v[128:131], a[0:3]
  buffer_load_dwordx4 v6, s[12:15], s89 offen offset:3072 nt lds
  v_mfma_f32_16x16x32_bf16 a[0:3], a[196:199], v[160:163], a[0:3]
  ds_read_b64_tr_b16 a[208:209], v14 offset:0
  ds_read_b64_tr_b16 a[210:211], v14 offset:4096
  v_cvt_pk_bf16_f32 v115, v41, v115
  v_lshlrev_b32 v40, 16, v116
  v_mfma_f32_16x16x32_bf16 a[32:35], a[192:195], v[136:139], a[32:35]
  s_add_u32 m0, s44, 0
  v_cvt_pk_bf16_f32 v186, v188, v189
  v_mfma_f32_16x16x32_bf16 a[32:35], a[196:199], v[168:171], a[32:35]
  v_cvt_pk_bf16_f32 v187, v190, v191
  v_exp_f32 v192, v192
  v_lshlrev_b32 v41, 16, v117
  v_and_b32 v116, 0xffff0000, v116
  v_mfma_f32_16x16x32_bf16 a[64:67], a[192:195], v[144:147], a[64:67]
  ds_read_b64_tr_b16 a[212:213], v14 offset:8192
  ds_read_b64_tr_b16 a[214:215], v14 offset:12288
  v_mfma_f32_16x16x32_bf16 a[64:67], a[196:199], v[176:179], a[64:67]
  v_exp_f32 v193, v193
  v_and_b32 v117, 0xffff0000, v117
  v_mul_f32 v40, s47, v40
  v_mfma_f32_16x16x32_bf16 a[96:99], a[192:195], v[152:155], a[96:99]
  buffer_load_dwordx4 v1, s[16:19], s83 offen offset:0 nt lds
  v_mfma_f32_16x16x32_bf16 a[96:99], a[196:199], v[184:187], a[96:99]
  ds_read_b64_tr_b16 a[216:217], v15 offset:0
  ds_read_b64_tr_b16 a[218:219], v15 offset:4096
  v_mul_f32 v41, s47, v41
  v_mfma_f32_16x16x32_bf16 a[4:7], a[200:203], v[128:131], a[4:7]
  v_exp_f32 v194, v194
  v_mfma_f32_16x16x32_bf16 a[4:7], a[204:207], v[160:163], a[4:7]
  v_exp_f32 v195, v195
  v_mul_f32 v116, s47, v116
  v_mul_f32 v117, s47, v117
  v_mfma_f32_16x16x32_bf16 a[224:227], a[240:243], v[128:131], a[224:227]
  v_cvt_pk_bf16_f32 v192, v192, v193
  v_cvt_pk_bf16_f32 v116, v40, v116
  v_mfma_f32_16x16x32_bf16 a[224:227], a[240:243], v[160:163], a[224:227]
  v_exp_f32 v196, v196
  v_mfma_f32_16x16x32_bf16 a[36:39], a[200:203], v[136:139], a[36:39]
  ds_read_b64_tr_b16 a[220:221], v15 offset:8192
  ds_read_b64_tr_b16 a[222:223], v15 offset:12288
  v_mfma_f32_16x16x32_bf16 a[36:39], a[204:207], v[168:171], a[36:39]
  v_exp_f32 v197, v197
  v_cvt_pk_bf16_f32 v117, v41, v117
  v_mfma_f32_16x16x32_bf16 a[68:71], a[200:203], v[144:147], a[68:71]
  v_mfma_f32_16x16x32_bf16 a[68:71], a[204:207], v[176:179], a[68:71]
  v_cvt_pk_bf16_f32 v193, v194, v195
  v_exp_f32 v198, v198
  v_exp_f32 v199, v199
  v_lshlrev_b32 v40, 16, v118
  v_lshlrev_b32 v41, 16, v119
  v_mfma_f32_16x16x32_bf16 a[100:103], a[200:203], v[152:155], a[100:103]
  v_mfma_f32_16x16x32_bf16 a[100:103], a[204:207], v[184:187], a[100:103]
  v_cvt_pk_bf16_f32 v194, v196, v197
  v_exp_f32 v224, v224
  v_and_b32 v118, 0xffff0000, v118
  v_and_b32 v119, 0xffff0000, v119
  s_waitcnt lgkmcnt(0)
  v_mfma_f32_16x16x32_bf16 a[8:11], a[208:211], v[128:131], a[8:11]
  v_exp_f32 v225, v225
  v_mfma_f32_16x16x32_bf16 a[8:11], a[212:215], v[160:163], a[8:11]
  ds_read_b64_tr_b16 a[192:193], v16 offset:0
  ds_read_b64_tr_b16 a[194:195], v16 offset:4096
  v_mul_f32 v40, s47, v40
  v_mul_f32 v41, s47, v41
  v_mfma_f32_16x16x32_bf16 a[40:43], a[208:211], v[136:139], a[40:43]
  v_mfma_f32_16x16x32_bf16 a[40:43], a[212:215], v[168:171], a[40:43]
  v_cvt_pk_bf16_f32 v195, v198, v199
  v_exp_f32 v226, v226
  v_mul_f32 v118, s47, v118
  v_mul_f32 v119, s47, v119
  v_mfma_f32_16x16x32_bf16 a[72:75], a[208:211], v[144:147], a[72:75]
  ds_read_b64_tr_b16 a[196:197], v16 offset:8192
  ds_read_b64_tr_b16 a[198:199], v16 offset:12288
  v_mfma_f32_16x16x32_bf16 a[72:75], a[212:215], v[176:179], a[72:75]
  v_exp_f32 v227, v227
  v_cvt_pk_bf16_f32 v118, v40, v118
  v_cvt_pk_bf16_f32 v119, v41, v119
  v_mfma_f32_16x16x32_bf16 a[104:107], a[208:211], v[152:155], a[104:107]
  v_cvt_pk_bf16_f32 v224, v224, v225
  v_exp_f32 v228, v228
  v_mfma_f32_16x16x32_bf16 a[104:107], a[212:215], v[184:187], a[104:107]
  ds_read_b64_tr_b16 a[200:201], v17 offset:0
  ds_read_b64_tr_b16 a[202:203], v17 offset:4096
  v_lshlrev_b32 v40, 16, v120
  v_lshlrev_b32 v41, 16, v121
  v_mfma_f32_16x16x32_bf16 a[12:15], a[216:219], v[128:131], a[12:15]
  v_mfma_f32_16x16x32_bf16 a[12:15], a[220:223], v[160:163], a[12:15]
  v_exp_f32 v229, v229
  v_cvt_pk_bf16_f32 v225, v226, v227
  v_and_b32 v120, 0xffff0000, v120
  v_and_b32 v121, 0xffff0000, v121
  v_mfma_f32_16x16x32_bf16 a[228:231], a[240:243], v[136:139], a[228:231]
  v_exp_f32 v230, v230
  v_mfma_f32_16x16x32_bf16 a[228:231], a[240:243], v[168:171], a[228:231]
  v_exp_f32 v231, v231
  v_mfma_f32_16x16x32_bf16 a[44:47], a[216:219], v[136:139], a[44:47]
  ds_read_b64_tr_b16 a[204:205], v17 offset:8192
  ds_read_b64_tr_b16 a[206:207], v17 offset:12288
  v_mfma_f32_16x16x32_bf16 a[44:47], a[220:223], v[168:171], a[44:47]
  v_cvt_pk_bf16_f32 v226, v228, v229
  v_exp_f32 v200, v200
  v_mul_f32 v40, s47, v40
  v_mul_f32 v41, s47, v41
  v_mfma_f32_16x16x32_bf16 a[76:79], a[216:219], v[144:147], a[76:79]
  v_exp_f32 v201, v201
  v_mfma_f32_16x16x32_bf16 a[76:79], a[220:223], v[176:179], a[76:79]
  v_cvt_pk_bf16_f32 v227, v230, v231
  v_mul_f32 v120, s47, v120
  v_mul_f32 v121, s47, v121
  v_mfma_f32_16x16x32_bf16 a[108:111], a[216:219], v[152:155], a[108:111]
  v_mfma_f32_16x16x32_bf16 a[108:111], a[220:223], v[184:187], a[108:111]
  v_exp_f32 v202, v202
  v_exp_f32 v203, v203
  v_cvt_pk_bf16_f32 v120, v40, v120
  v_cvt_pk_bf16_f32 v121, v41, v121
  s_waitcnt lgkmcnt(0)
  v_mfma_f32_16x16x32_bf16 a[16:19], a[192:195], v[128:131], a[16:19]
  v_mfma_f32_16x16x32_bf16 a[16:19], a[196:199], v[160:163], a[16:19]
  ds_read_b64_tr_b16 a[208:209], v18 offset:0
  ds_read_b64_tr_b16 a[210:211], v18 offset:4096
  v_cvt_pk_bf16_f32 v200, v200, v201
  v_lshlrev_b32 v40, 16, v122
  v_lshlrev_b32 v41, 16, v123
  v_mfma_f32_16x16x32_bf16 a[48:51], a[192:195], v[136:139], a[48:51]
  v_mfma_f32_16x16x32_bf16 a[48:51], a[196:199], v[168:171], a[48:51]
  v_exp_f32 v204, v204
  v_exp_f32 v205, v205
  v_and_b32 v122, 0xffff0000, v122
  v_mfma_f32_16x16x32_bf16 a[80:83], a[192:195], v[144:147], a[80:83]
  ds_read_b64_tr_b16 a[212:213], v18 offset:8192
  ds_read_b64_tr_b16 a[214:215], v18 offset:12288
  v_mfma_f32_16x16x32_bf16 a[80:83], a[196:199], v[176:179], a[80:83]
  v_cvt_pk_bf16_f32 v201, v202, v203
  v_exp_f32 v206, v206
  v_and_b32 v123, 0xffff0000, v123
  v_mul_f32 v40, s47, v40
  v_mfma_f32_16x16x32_bf16 a[112:115], a[192:195], v[152:155], a[112:115]
  v_mfma_f32_16x16x32_bf16 a[112:115], a[196:199], v[184:187], a[112:115]
  ds_read_b64_tr_b16 a[216:217], v19 offset:0
  ds_read_b64_tr_b16 a[218:219], v19 offset:4096
  v_exp_f32 v207, v207
  v_mul_f32 v41, s47, v41
  v_mul_f32 v122, s47, v122
  v_mfma_f32_16x16x32_bf16 a[20:23], a[200:203], v[128:131], a[20:23]
  v_mfma_f32_16x16x32_bf16 a[20:23], a[204:207], v[160:163], a[20:23]
  v_cvt_pk_bf16_f32 v202, v204, v205
  v_exp_f32 v232, v232
  v_mul_f32 v123, s47, v123
  v_cvt_pk_bf16_f32 v122, v40, v122
  v_mfma_f32_16x16x32_bf16 a[232:235], a[240:243], v[144:147], a[232:235]
  v_exp_f32 v233, v233
  v_mfma_f32_16x16x32_bf16 a[232:235], a[240:243], v[176:179], a[232:235]
  v_cvt_pk_bf16_f32 v203, v206, v207
  v_exp_f32 v234, v234
  v_mfma_f32_16x16x32_bf16 a[52:55], a[200:203], v[136:139], a[52:55]
  ds_read_b64_tr_b16 a[220:221], v19 offset:8192
  ds_read_b64_tr_b16 a[222:223], v19 offset:12288
  v_mfma_f32_16x16x32_bf16 a[52:55], a[204:207], v[168:171], a[52:55]
  v_exp_f32 v235, v235
  v_cvt_pk_bf16_f32 v123, v41, v123
  v_lshlrev_b32 v40, 16, v124
  v_mfma_f32_16x16x32_bf16 a[84:87], a[200:203], v[144:147], a[84:87]
  s_waitcnt vmcnt(5)
  s_barrier
  v_mfma_f32_16x16x32_bf16 a[84:87], a[204:207], v[176:179], a[84:87]
  v_cvt_pk_bf16_f32 v232, v232, v233
  v_lshlrev_b32 v41, 16, v125
  v_and_b32 v124, 0xffff0000, v124
  v_mfma_f32_16x16x32_bf16 a[116:119], a[200:203], v[152:155], a[116:119]
  v_mfma_f32_16x16x32_bf16 a[116:119], a[204:207], v[184:187], a[116:119]
  v_exp_f32 v236, v236
  v_exp_f32 v237, v237
  v_and_b32 v125, 0xffff0000, v125
  v_mul_f32 v40, s47, v40
  s_waitcnt lgkmcnt(0)
  v_mfma_f32_16x16x32_bf16 a[24:27], a[208:211], v[128:131], a[24:27]
  buffer_load_dwordx4 v2, s[16:19], s83 offen offset:1024 nt lds
  v_mfma_f32_16x16x32_bf16 a[24:27], a[212:215], v[160:163], a[24:27]
  ds_read_b128 a[192:195], v8 offset:32768
  v_mul_f32 v41, s47, v41
  v_mul_f32 v124, s47, v124
  v_mfma_f32_16x16x32_bf16 a[56:59], a[208:211], v[136:139], a[56:59]
  v_mfma_f32_16x16x32_bf16 a[56:59], a[212:215], v[168:171], a[56:59]
  v_cvt_pk_bf16_f32 v233, v234, v235
  v_exp_f32 v238, v238
  v_exp_f32 v239, v239
  v_mul_f32 v125, s47, v125
  v_cvt_pk_bf16_f32 v124, v40, v124
  v_mfma_f32_16x16x32_bf16 a[88:91], a[208:211], v[144:147], a[88:91]
  ds_read_b128 a[196:199], v9 offset:32768
  v_mfma_f32_16x16x32_bf16 a[88:91], a[212:215], v[176:179], a[88:91]
  v_cvt_pk_bf16_f32 v234, v236, v237
  v_exp_f32 v208, v208
  v_cvt_pk_bf16_f32 v125, v41, v125
  v_lshlrev_b32 v40, 16, v126
  v_mfma_f32_16x16x32_bf16 a[120:123], a[208:211], v[152:155], a[120:123]
  buffer_load_dwordx4 v3, s[16:19], s83 offen offset:2048 nt lds
  v_mfma_f32_16x16x32_bf16 a[120:123], a[212:215], v[184:187], a[120:123]
  ds_read_b128 a[200:203], v10 offset:32768
  v_lshlrev_b32 v41, 16, v127
  v_and_b32 v126, 0xffff0000, v126
  v_mfma_f32_16x16x32_bf16 a[28:31], a[216:219], v[128:131], a[28:31]
  v_exp_f32 v209, v209
  v_mfma_f32_16x16x32_bf16 a[28:31], a[220:223], v[160:163], a[28:31]
  v_cvt_pk_bf16_f32 v235, v238, v239
  v_exp_f32 v210, v210
  v_and_b32 v127, 0xffff0000, v127
  v_mul_f32 v40, s47, v40
  v_mfma_f32_16x16x32_bf16 a[236:239], a[240:243], v[152:155], a[236:239]
  v_exp_f32 v211, v211
  v_mfma_f32_16x16x32_bf16 a[236:239], a[240:243], v[184:187], a[236:239]
  v_cvt_pk_bf16_f32 v208, v208, v209
  v_mul_f32 v41, s47, v41
  v_mfma_f32_16x16x32_bf16 a[60:63], a[216:219], v[136:139], a[60:63]
  ds_read_b128 a[204:207], v11 offset:32768
  v_mfma_f32_16x16x32_bf16 a[60:63], a[220:223], v[168:171], a[60:63]
  v_exp_f32 v212, v212
  v_exp_f32 v213, v213
  v_mul_f32 v126, s47, v126
  v_mfma_f32_16x16x32_bf16 a[92:95], a[216:219], v[144:147], a[92:95]
  buffer_load_dwordx4 v4, s[16:19], s83 offen offset:3072 nt lds
  v_mfma_f32_16x16x32_bf16 a[92:95], a[220:223], v[176:179], a[92:95]
  s_add_u32 m0, s44, 81920
  v_mul_f32 v127, s47, v127
  v_cvt_pk_bf16_f32 v126, v40, v126
  v_mfma_f32_16x16x32_bf16 a[124:127], a[216:219], v[152:155], a[124:127]
  v_cvt_pk_bf16_f32 v209, v210, v211
  v_exp_f32 v214, v214
  v_mfma_f32_16x16x32_bf16 a[124:127], a[220:223], v[184:187], a[124:127]
  v_cvt_pk_bf16_f32 v127, v41, v127
  s_waitcnt lgkmcnt(0)
  v_mfma_f32_16x16x32_bf16 v[128:131], a[192:195], v[64:67], 0
  buffer_load_dwordx4 v5, s[20:23], s82 offen offset:0 nt lds
  v_mfma_f32_16x16x32_bf16 v[128:131], a[196:199], v[68:71], v[128:131]
  ds_read_b128 a[208:211], v8 offset:36864
  v_mfma_f32_16x16x32_bf16 v[128:131], a[200:203], v[72:75], v[128:131]
  v_exp_f32 v215, v215
  v_mfma_f32_16x16x32_bf16 v[128:131], a[204:207], v[76:79], v[128:131]
  v_cvt_pk_bf16_f32 v210, v212, v213
  v_exp_f32 v240, v240
  v_exp_f32 v241, v241
  v_cvt_pk_bf16_f32 v211, v214, v215
  v_exp_f32 v242, v242
  v_mfma_f32_16x16x32_bf16 v[136:139], a[192:195], v[80:83], 0
  ds_read_b128 a[212:215], v9 offset:36864
  v_mfma_f32_16x16x32_bf16 v[136:139], a[196:199], v[84:87], v[136:139]
  v_exp_f32 v243, v243
  v_mfma_f32_16x16x32_bf16 v[136:139], a[200:203], v[88:91], v[136:139]
  buffer_load_dwordx4 v6, s[20:23], s82 offen offset:1024 nt lds
  v_mfma_f32_16x16x32_bf16 v[136:139], a[204:207], v[92:95], v[136:139]
  ds_read_b128 a[216:219], v10 offset:36864
  v_cvt_pk_bf16_f32 v240, v240, v241
  v_exp_f32 v244, v244
  v_exp_f32 v245, v245
  v_cvt_pk_bf16_f32 v241, v242, v243
  v_mfma_f32_16x16x32_bf16 v[144:147], a[192:195], v[96:99], 0
  v_mfma_f32_16x16x32_bf16 v[144:147], a[196:199], v[100:103], v[144:147]
  v_exp_f32 v246, v246
  v_mfma_f32_16x16x32_bf16 v[144:147], a[200:203], v[104:107], v[144:147]
  ds_read_b128 a[220:223], v11 offset:36864
  v_mfma_f32_16x16x32_bf16 v[144:147], a[204:207], v[108:111], v[144:147]
  v_exp_f32 v247, v247
  v_cvt_pk_bf16_f32 v242, v244, v245
  v_exp_f32 v216, v216
  v_exp_f32 v217, v217
  v_cvt_pk_bf16_f32 v243, v246, v247
  v_exp_f32 v218, v218
  v_mfma_f32_16x16x32_bf16 v[152:155], a[192:195], v[112:115], 0
  v_exp_f32 v219, v219
  v_mfma_f32_16x16x32_bf16 v[152:155], a[196:199], v[116:119], v[152:155]
  v_mfma_f32_16x16x32_bf16 v[152:155], a[200:203], v[120:123], v[152:155]
  v_mfma_f32_16x16x32_bf16 v[152:155], a[204:207], v[124:127], v[152:155]
  v_cvt_pk_bf16_f32 v216, v216, v217
  v_exp_f32 v220, v220
  v_exp_f32 v221, v221
  v_cvt_pk_bf16_f32 v217, v218, v219
  v_exp_f32 v222, v222
  s_waitcnt lgkmcnt(0)
  v_mfma_f32_16x16x32_bf16 v[132:135], a[208:211], v[64:67], 0
  v_exp_f32 v223, v223
  v_mfma_f32_16x16x32_bf16 v[132:135], a[212:215], v[68:71], v[132:135]
  ds_read_b128 a[192:195], v8 offset:40960
  v_mfma_f32_16x16x32_bf16 v[132:135], a[216:219], v[72:75], v[132:135]
  v_cvt_pk_bf16_f32 v218, v220, v221
  v_exp_f32 v248, v248
  v_mfma_f32_16x16x32_bf16 v[132:135], a[220:223], v[76:79], v[132:135]
  v_exp_f32 v249, v249
  v_max3_f32 v40, v128, v129, v130
  v_cvt_pk_bf16_f32 v219, v222, v223
  v_max3_f32 v41, v136, v137, v138
  v_exp_f32 v250, v250
  v_mfma_f32_16x16x32_bf16 v[140:143], a[208:211], v[80:83], 0
  ds_read_b128 a[196:199], v9 offset:40960
  v_mfma_f32_16x16x32_bf16 v[140:143], a[212:215], v[84:87], v[140:143]
  v_mfma_f32_16x16x32_bf16 v[140:143], a[216:219], v[88:91], v[140:143]
  v_max3_f32 v42, v144, v145, v146
  v_max3_f32 v43, v152, v153, v154
  v_mfma_f32_16x16x32_bf16 v[140:143], a[220:223], v[92:95], v[140:143]
  ds_read_b128 a[200:203], v10 offset:40960
  v_exp_f32 v251, v251
  v_max_f32 v40, v40, v131
  v_cvt_pk_bf16_f32 v248, v248, v249
  v_max_f32 v41, v41, v139
  v_exp_f32 v252, v252
  v_max_f32 v42, v42, v147
  v_mfma_f32_16x16x32_bf16 v[148:151], a[208:211], v[96:99], 0
  v_mfma_f32_16x16x32_bf16 v[148:151], a[212:215], v[100:103], v[148:151]
  v_exp_f32 v253, v253
  v_mfma_f32_16x16x32_bf16 v[148:151], a[216:219], v[104:107], v[148:151]
  ds_read_b128 a[204:207], v11 offset:40960
  v_mfma_f32_16x16x32_bf16 v[148:151], a[220:223], v[108:111], v[148:151]
  v_cvt_pk_bf16_f32 v249, v250, v251
  v_max_f32 v43, v43, v155
  v_exp_f32 v254, v254
  v_mov_b32 v36, v40
  v_exp_f32 v255, v255
  v_mov_b32 v37, v41
  v_cvt_pk_bf16_f32 v250, v252, v253
  v_mfma_f32_16x16x32_bf16 v[156:159], a[208:211], v[112:115], 0
  v_mfma_f32_16x16x32_bf16 v[156:159], a[212:215], v[116:119], v[156:159]
  v_cvt_pk_bf16_f32 v251, v254, v255
  v_mov_b32 v38, v42
  v_mfma_f32_16x16x32_bf16 v[156:159], a[216:219], v[120:123], v[156:159]
  v_mfma_f32_16x16x32_bf16 v[156:159], a[220:223], v[124:127], v[156:159]
  v_mov_b32 v39, v43
  v_permlane32_swap_b32 v40, v36
  v_permlane32_swap_b32 v41, v37
  v_permlane32_swap_b32 v42, v38
  s_waitcnt lgkmcnt(0)
  v_mfma_f32_16x16x32_bf16 v[160:163], a[192:195], v[64:67], 0
  v_permlane32_swap_b32 v43, v39
  v_mfma_f32_16x16x32_bf16 v[160:163], a[196:199], v[68:71], v[160:163]
  ds_read_b128 a[208:211], v8 offset:45056
  v_mfma_f32_16x16x32_bf16 v[160:163], a[200:203], v[72:75], v[160:163]
  v_mfma_f32_16x16x32_bf16 v[160:163], a[204:207], v[76:79], v[160:163]
  v_max_f32 v40, v40, v36
  v_max_f32 v41, v41, v37
  v_max_f32 v42, v42, v38
  v_max_f32 v43, v43, v39
  v_mov_b32 v36, v40
  v_mov_b32 v37, v41
  v_mov_b32 v38, v42
  v_mfma_f32_16x16x32_bf16 v[168:171], a[192:195], v[80:83], 0
  ds_read_b128 a[212:215], v9 offset:45056
  v_mov_b32 v39, v43
  v_mfma_f32_16x16x32_bf16 v[168:171], a[196:199], v[84:87], v[168:171]
  v_mfma_f32_16x16x32_bf16 v[168:171], a[200:203], v[88:91], v[168:171]
  v_permlane16_swap_b32 v40, v36
  v_mfma_f32_16x16x32_bf16 v[168:171], a[204:207], v[92:95], v[168:171]
  ds_read_b128 a[216:219], v10 offset:45056
  v_permlane16_swap_b32 v41, v37
  v_permlane16_swap_b32 v42, v38
  v_mfma_f32_16x16x32_bf16 v[176:179], a[192:195], v[96:99], 0
  v_mfma_f32_16x16x32_bf16 v[176:179], a[196:199], v[100:103], v[176:179]
  v_mfma_f32_16x16x32_bf16 v[176:179], a[200:203], v[104:107], v[176:179]
  ds_read_b128 a[220:223], v11 offset:45056
  v_permlane16_swap_b32 v43, v39
  v_mfma_f32_16x16x32_bf16 v[176:179], a[204:207], v[108:111], v[176:179]
  v_max_f32 v40, v40, v36
  v_max_f32 v41, v41, v37
  v_max_f32 v42, v42, v38
  v_max_f32 v43, v43, v39
  v_sub_f32 v20, 0, v40
  v_sub_f32 v52, 0, v41
  v_sub_f32 v56, 0, v42
  v_sub_f32 v60, 0, v43
  v_sub_f32 v21, 0, v40
  v_mfma_f32_16x16x32_bf16 v[184:187], a[192:195], v[112:115], 0
  s_waitcnt vmcnt(6)
  s_barrier
  v_mfma_f32_16x16x32_bf16 v[184:187], a[196:199], v[116:119], v[184:187]
  v_sub_f32 v53, 0, v41
  v_sub_f32 v57, 0, v42
  v_mfma_f32_16x16x32_bf16 v[184:187], a[200:203], v[120:123], v[184:187]
  v_mfma_f32_16x16x32_bf16 v[184:187], a[204:207], v[124:127], v[184:187]
  v_sub_f32 v61, 0, v43
  v_sub_f32 v22, 0, v40
  v_sub_f32 v54, 0, v41
  v_sub_f32 v58, 0, v42
  v_sub_f32 v62, 0, v43
  v_sub_f32 v23, 0, v40
  v_sub_f32 v55, 0, v41
  s_waitcnt lgkmcnt(0)
  v_mfma_f32_16x16x32_bf16 v[164:167], a[208:211], v[64:67], 0
  buffer_load_dwordx4 v5, s[20:23], s82 offen offset:2048 nt lds
  v_mfma_f32_16x16x32_bf16 v[164:167], a[212:215], v[68:71], v[164:167]
  ds_read_b64_tr_b16 a[192:193], v12 offset:16384
  ds_read_b64_tr_b16 a[194:195], v12 offset:20480
  v_mfma_f32_16x16x32_bf16 v[164:167], a[216:219], v[72:75], v[164:167]
  v_mfma_f32_16x16x32_bf16 v[164:167], a[220:223], v[76:79], v[164:167]
  v_sub_f32 v59, 0, v42
  v_sub_f32 v63, 0, v43
  v_add_f32 v128, v128, v20
  v_add_f32 v129, v129, v20
  v_add_f32 v130, v130, v20
  v_add_f32 v131, v131, v20
  v_add_f32 v136, v136, v52
  v_add_f32 v137, v137, v52
  v_mfma_f32_16x16x32_bf16 v[172:175], a[208:211], v[80:83], 0
  ds_read_b64_tr_b16 a[196:197], v12 offset:24576
  ds_read_b64_tr_b16 a[198:199], v12 offset:28672
  v_mfma_f32_16x16x32_bf16 v[172:175], a[212:215], v[84:87], v[172:175]
  v_mfma_f32_16x16x32_bf16 v[172:175], a[216:219], v[88:91], v[172:175]
  buffer_load_dwordx4 v6, s[20:23], s82 offen offset:3072 nt lds
  v_mfma_f32_16x16x32_bf16 v[172:175], a[220:223], v[92:95], v[172:175]
  ds_read_b64_tr_b16 a[200:201], v13 offset:16384
  ds_read_b64_tr_b16 a[202:203], v13 offset:20480
  v_add_f32 v138, v138, v52
  v_add_f32 v139, v139, v52
  v_add_f32 v144, v144, v56
  v_add_f32 v145, v145, v56
  v_add_f32 v146, v146, v56
  v_add_f32 v147, v147, v56
  v_mfma_f32_16x16x32_bf16 v[180:183], a[208:211], v[96:99], 0
  s_add_u32 m0, s44, 16384
  v_add_f32 v152, v152, v60
  v_mfma_f32_16x16x32_bf16 v[180:183], a[212:215], v[100:103], v[180:183]
  v_mfma_f32_16x16x32_bf16 v[180:183], a[216:219], v[104:107], v[180:183]
  ds_read_b64_tr_b16 a[204:205], v13 offset:24576
  ds_read_b64_tr_b16 a[206:207], v13 offset:28672
  v_mfma_f32_16x16x32_bf16 v[180:183], a[220:223], v[108:111], v[180:183]
  v_add_f32 v153, v153, v60
  v_add_f32 v154, v154, v60
  v_add_f32 v155, v155, v60
  v_add_f32 v132, v132, v20
  v_add_f32 v133, v133, v20
  v_add_f32 v134, v134, v20
  v_add_f32 v135, v135, v20
  v_add_f32 v140, v140, v52
  v_mfma_f32_16x16x32_bf16 v[188:191], a[208:211], v[112:115], 0
  buffer_load_dwordx4 v1, s[16:19], s84 offen offset:0 nt lds
  v_mfma_f32_16x16x32_bf16 v[188:191], a[212:215], v[116:119], v[188:191]
  v_mfma_f32_16x16x32_bf16 v[188:191], a[216:219], v[120:123], v[188:191]
  v_add_f32 v141, v141, v52
  v_add_f32 v142, v142, v52
  v_mfma_f32_16x16x32_bf16 v[188:191], a[220:223], v[124:127], v[188:191]
  v_add_f32 v143, v143, v52
  v_add_f32 v148, v148, v56
  v_add_f32 v149, v149, v56
  v_add_f32 v150, v150, v56
  v_add_f32 v151, v151, v56
  v_add_f32 v156, v156, v60
  v_add_f32 v157, v157, v60
  v_add_f32 v158, v158, v60
  s_waitcnt lgkmcnt(0)
  v_mfma_f32_16x16x32_bf16 a[0:3], a[192:195], v[192:195], a[0:3]
  buffer_load_dwordx4 v2, s[16:19], s84 offen offset:1024 nt lds
  v_mfma_f32_16x16x32_bf16 a[0:3], a[196:199], v[224:227], a[0:3]
  ds_read_b64_tr_b16 a[208:209], v14 offset:16384
  ds_read_b64_tr_b16 a[210:211], v14 offset:20480
  v_add_f32 v159, v159, v60
  v_mfma_f32_16x16x32_bf16 a[32:35], a[192:195], v[200:203], a[32:35]
  v_add_f32 v160, v160, v20
  v_add_f32 v161, v161, v20
  v_mfma_f32_16x16x32_bf16 a[32:35], a[196:199], v[232:235], a[32:35]
  v_add_f32 v162, v162, v20
  v_add_f32 v163, v163, v20
  v_add_f32 v168, v168, v52
  v_add_f32 v169, v169, v52
  v_mfma_f32_16x16x32_bf16 a[64:67], a[192:195], v[208:211], a[64:67]
  ds_read_b64_tr_b16 a[212:213], v14 offset:24576
  ds_read_b64_tr_b16 a[214:215], v14 offset:28672
  v_mfma_f32_16x16x32_bf16 a[64:67], a[196:199], v[240:243], a[64:67]
  v_add_f32 v170, v170, v52
  v_add_f32 v171, v171, v52
  v_add_f32 v176, v176, v56
  v_mfma_f32_16x16x32_bf16 a[96:99], a[192:195], v[216:219], a[96:99]
  buffer_load_dwordx4 v3, s[16:19], s84 offen offset:2048 nt lds
  v_mfma_f32_16x16x32_bf16 a[96:99], a[196:199], v[248:251], a[96:99]
  ds_read_b64_tr_b16 a[216:217], v15 offset:16384
  ds_read_b64_tr_b16 a[218:219], v15 offset:20480
  v_add_f32 v177, v177, v56
  v_add_f32 v178, v178, v56
  v_mfma_f32_16x16x32_bf16 a[4:7], a[200:203], v[192:195], a[4:7]
  v_add_f32 v179, v179, v56
  v_add_f32 v184, v184, v60
  v_mfma_f32_16x16x32_bf16 a[4:7], a[204:207], v[224:227], a[4:7]
  v_add_f32 v185, v185, v60
  v_add_f32 v186, v186, v60
  v_add_f32 v187, v187, v60
  v_mfma_f32_16x16x32_bf16 a[224:227], a[240:243], v[192:195], a[224:227]
  v_add_f32 v164, v164, v20
  v_add_f32 v165, v165, v20
  v_mfma_f32_16x16x32_bf16 a[224:227], a[240:243], v[224:227], a[224:227]
  v_add_f32 v166, v166, v20
  v_add_f32 v167, v167, v20
  v_add_f32 v172, v172, v52
  v_add_f32 v173, v173, v52
  v_mfma_f32_16x16x32_bf16 a[36:39], a[200:203], v[200:203], a[36:39]
  ds_read_b64_tr_b16 a[220:221], v15 offset:24576
  ds_read_b64_tr_b16 a[222:223], v15 offset:28672
  v_mfma_f32_16x16x32_bf16 a[36:39], a[204:207], v[232:235], a[36:39]
  v_add_f32 v174, v174, v52
  v_add_f32 v175, v175, v52
  v_add_f32 v180, v180, v56
  v_mfma_f32_16x16x32_bf16 a[68:71], a[200:203], v[208:211], a[68:71]
  v_add_f32 v181, v181, v56
  v_add_f32 v182, v182, v56
  v_mfma_f32_16x16x32_bf16 a[68:71], a[204:207], v[240:243], a[68:71]
  v_add_f32 v183, v183, v56
  v_add_f32 v188, v188, v60
  v_add_f32 v189, v189, v60
  v_add_f32 v190, v190, v60
  v_mfma_f32_16x16x32_bf16 a[100:103], a[200:203], v[216:219], a[100:103]
  v_mfma_f32_16x16x32_bf16 a[100:103], a[204:207], v[248:251], a[100:103]
  v_add_f32 v191, v191, v60
  v_exp_f32 v128, v128
  v_exp_f32 v129, v129
  s_waitcnt lgkmcnt(0)
  v_mfma_f32_16x16x32_bf16 a[8:11], a[208:211], v[192:195], a[8:11]
  v_mfma_f32_16x16x32_bf16 a[8:11], a[212:215], v[224:227], a[8:11]
  ds_read_b64_tr_b16 a[192:193], v16 offset:16384
  ds_read_b64_tr_b16 a[194:195], v16 offset:20480
  v_exp_f32 v130, v130
  v_mfma_f32_16x16x32_bf16 a[40:43], a[208:211], v[200:203], a[40:43]
  v_exp_f32 v131, v131
  v_mfma_f32_16x16x32_bf16 a[40:43], a[212:215], v[232:235], a[40:43]
  v_cvt_pk_bf16_f32 v128, v128, v129
  v_exp_f32 v132, v132
  v_exp_f32 v133, v133
  v_mfma_f32_16x16x32_bf16 a[72:75], a[208:211], v[208:211], a[72:75]
  ds_read_b64_tr_b16 a[196:197], v16 offset:24576
  ds_read_b64_tr_b16 a[198:199], v16 offset:28672
  v_mfma_f32_16x16x32_bf16 a[72:75], a[212:215], v[240:243], a[72:75]
  v_cvt_pk_bf16_f32 v129, v130, v131
  v_exp_f32 v134, v134
  v_mfma_f32_16x16x32_bf16 a[104:107], a[208:211], v[216:219], a[104:107]
  v_exp_f32 v135, v135
  v_mfma_f32_16x16x32_bf16 a[104:107], a[212:215], v[248:251], a[104:107]
  ds_read_b64_tr_b16 a[200:201], v17 offset:16384
  ds_read_b64_tr_b16 a[202:203], v17 offset:20480
  v_cvt_pk_bf16_f32 v130, v132, v133
  v_mfma_f32_16x16x32_bf16 a[12:15], a[216:219], v[192:195], a[12:15]
  v_mfma_f32_16x16x32_bf16 a[12:15], a[220:223], v[224:227], a[12:15]
  v_exp_f32 v160, v160
  v_exp_f32 v161, v161
  v_cvt_pk_bf16_f32 v131, v134, v135
  v_mfma_f32_16x16x32_bf16 a[228:231], a[240:243], v[200:203], a[228:231]
  v_exp_f32 v162, v162
  v_mfma_f32_16x16x32_bf16 a[228:231], a[240:243], v[232:235], a[228:231]
  v_exp_f32 v163, v163
  v_cvt_pk_bf16_f32 v160, v160, v161
  v_exp_f32 v164, v164
  v_mfma_f32_16x16x32_bf16 a[44:47], a[216:219], v[200:203], a[44:47]
  ds_read_b64_tr_b16 a[204:205], v17 offset:24576
  ds_read_b64_tr_b16 a[206:207], v17 offset:28672
  v_mfma_f32_16x16x32_bf16 a[44:47], a[220:223], v[232:235], a[44:47]
  v_exp_f32 v165, v165
  v_cvt_pk_bf16_f32 v161, v162, v163
  v_mfma_f32_16x16x32_bf16 a[76:79], a[216:219], v[208:211], a[76:79]
  v_exp_f32 v166, v166
  v_mfma_f32_16x16x32_bf16 a[76:79], a[220:223], v[240:243], a[76:79]
  v_exp_f32 v167, v167
  v_cvt_pk_bf16_f32 v162, v164, v165
  v_mfma_f32_16x16x32_bf16 a[108:111], a[216:219], v[216:219], a[108:111]
  v_mfma_f32_16x16x32_bf16 a[108:111], a[220:223], v[248:251], a[108:111]
  v_exp_f32 v136, v136
  v_exp_f32 v137, v137
  v_cvt_pk_bf16_f32 v163, v166, v167
  s_waitcnt lgkmcnt(0)
  v_mfma_f32_16x16x32_bf16 a[16:19], a[192:195], v[192:195], a[16:19]
  v_exp_f32 v138, v138
  v_mfma_f32_16x16x32_bf16 a[16:19], a[196:199], v[224:227], a[16:19]
  ds_read_b64_tr_b16 a[208:209], v18 offset:16384
  ds_read_b64_tr_b16 a[210:211], v18 offset:20480
  v_exp_f32 v139, v139
  v_mfma_f32_16x16x32_bf16 a[48:51], a[192:195], v[200:203], a[48:51]
  v_mfma_f32_16x16x32_bf16 a[48:51], a[196:199], v[232:235], a[48:51]
  v_cvt_pk_bf16_f32 v136, v136, v137
  v_exp_f32 v140, v140
  v_exp_f32 v141, v141
  v_mfma_f32_16x16x32_bf16 a[80:83], a[192:195], v[208:211], a[80:83]
  ds_read_b64_tr_b16 a[212:213], v18 offset:24576
  ds_read_b64_tr_b16 a[214:215], v18 offset:28672
  v_mfma_f32_16x16x32_bf16 a[80:83], a[196:199], v[240:243], a[80:83]
  v_cvt_pk_bf16_f32 v137, v138, v139
  v_exp_f32 v142, v142
  v_mfma_f32_16x16x32_bf16 a[112:115], a[192:195], v[216:219], a[112:115]
L_pad5:
  s_cbranch_execz L_pad9
  v_exp_f32 v143, v143
  v_mfma_f32_16x16x32_bf16 a[112:115], a[196:199], v[248:251], a[112:115]
  ds_read_b64_tr_b16 a[216:217], v19 offset:16384
  ds_read_b64_tr_b16 a[218:219], v19 offset:20480
  v_cvt_pk_bf16_f32 v138, v140, v141
  v_mfma_f32_16x16x32_bf16 a[20:23], a[200:203], v[192:195], a[20:23]
  v_mfma_f32_16x16x32_bf16 a[20:23], a[204:207], v[224:227], a[20:23]
  v_exp_f32 v168, v168
  v_exp_f32 v169, v169
  v_cvt_pk_bf16_f32 v139, v142, v143
  v_exp_f32 v170, v170
  v_mfma_f32_16x16x32_bf16 a[232:235], a[240:243], v[208:211], a[232:235]
  v_exp_f32 v171, v171
  v_mfma_f32_16x16x32_bf16 a[232:235], a[240:243], v[240:243], a[232:235]
  v_cvt_pk_bf16_f32 v168, v168, v169
  v_exp_f32 v172, v172
  v_mfma_f32_16x16x32_bf16 a[52:55], a[200:203], v[200:203], a[52:55]
  ds_read_b64_tr_b16 a[220:221], v19 offset:24576
  ds_read_b64_tr_b16 a[222:223], v19 offset:28672
  v_mfma_f32_16x16x32_bf16 a[52:55], a[204:207], v[232:235], a[52:55]
  v_exp_f32 v173, v173
  v_cvt_pk_bf16_f32 v169, v170, v171
  v_mfma_f32_16x16x32_bf16 a[84:87], a[200:203], v[208:211], a[84:87]
  s_waitcnt vmcnt(7)
  s_barrier
  v_mfma_f32_16x16x32_bf16 a[84:87], a[204:207], v[240:243], a[84:87]
  v_exp_f32 v174, v174
  v_exp_f32 v175, v175
  v_mfma_f32_16x16x32_bf16 a[116:119], a[200:203], v[216:219], a[116:119]
  v_mfma_f32_16x16x32_bf16 a[116:119], a[204:207], v[248:251], a[116:119]
  v_cvt_pk_bf16_f32 v170, v172, v173
  v_exp_f32 v144, v144
  v_exp_f32 v145, v145
  s_waitcnt lgkmcnt(0)
  v_mfma_f32_16x16x32_bf16 a[24:27], a[208:211], v[192:195], a[24:27]
  buffer_load_dwordx4 v4, s[16:19], s84 offen offset:3072 nt lds
  v_mfma_f32_16x16x32_bf16 a[24:27], a[212:215], v[224:227], a[24:27]
  ds_read_b128 a[192:195], v8 offset:0
  v_cvt_pk_bf16_f32 v171, v174, v175
  v_mfma_f32_16x16x32_bf16 a[56:59], a[208:211], v[200:203], a[56:59]
  s_add_u32 m0, s44, 49152
  v_mfma_f32_16x16x32_bf16 a[56:59], a[212:215], v[232:235], a[56:59]
  v_exp_f32 v146, v146
  v_exp_f32 v147, v147
  v_cvt_pk_bf16_f32 v144, v144, v145
  v_mfma_f32_16x16x32_bf16 a[88:91], a[208:211], v[208:211], a[88:91]
  ds_read_b128 a[196:199], v9 offset:0
  v_exp_f32 v148, v148
  v_mfma_f32_16x16x32_bf16 a[88:91], a[212:215], v[240:243], a[88:91]
  v_exp_f32 v149, v149
  v_cvt_pk_bf16_f32 v145, v146, v147
  v_mfma_f32_16x16x32_bf16 a[120:123], a[208:211], v[216:219], a[120:123]
  buffer_load_dwordx4 v5, s[20:23], s83 offen offset:0 nt lds
  v_mfma_f32_16x16x32_bf16 a[120:123], a[212:215], v[248:251], a[120:123]
  ds_read_b128 a[200:203], v10 offset:0
  v_exp_f32 v150, v150
  v_mfma_f32_16x16x32_bf16 a[28:31], a[216:219], v[192:195], a[28:31]
  v_mfma_f32_16x16x32_bf16 a[28:31], a[220:223], v[224:227], a[28:31]
  v_exp_f32 v151, v151
  v_cvt_pk_bf16_f32 v146, v148, v149
  v_exp_f32 v176, v176
  v_mfma_f32_16x16x32_bf16 a[236:239], a[240:243], v[216:219], a[236:239]
  v_exp_f32 v177, v177
  v_mfma_f32_16x16x32_bf16 a[236:239], a[240:243], v[248:251], a[236:239]
  v_cvt_pk_bf16_f32 v147, v150, v151
  v_exp_f32 v178, v178
  v_exp_f32 v179, v179
  v_mfma_f32_16x16x32_bf16 a[60:63], a[216:219], v[200:203], a[60:63]
  ds_read_b128 a[204:207], v11 offset:0
  v_cvt_pk_bf16_f32 v176, v176, v177
  v_mfma_f32_16x16x32_bf16 a[60:63], a[220:223], v[232:235], a[60:63]
  v_exp_f32 v180, v180
  v_mfma_f32_16x16x32_bf16 a[92:95], a[216:219], v[208:211], a[92:95]
  buffer_load_dwordx4 v6, s[20:23], s83 offen offset:1024 nt lds
  v_mfma_f32_16x16x32_bf16 a[92:95], a[220:223], v[240:243], a[92:95]
  v_exp_f32 v181, v181
  v_cvt_pk_bf16_f32 v177, v178, v179
  v_exp_f32 v182, v182
  v_mfma_f32_16x16x32_bf16 a[124:127], a[216:219], v[216:219], a[124:127]
  v_exp_f32 v183, v183
  v_mfma_f32_16x16x32_bf16 a[124:127], a[220:223], v[248:251], a[124:127]
  v_cvt_pk_bf16_f32 v178, v180, v181
  s_waitcnt lgkmcnt(0)
  v_mfma_f32_16x16x32_bf16 v[192:195], a[192:195], v[64:67], v[20:23]
  buffer_load_dwordx4 v5, s[20:23], s83 offen offset:2048 nt lds
  v_mfma_f32_16x16x32_bf16 v[192:195], a[196:199], v[68:71], v[192:195]
  ds_read_b128 a[208:211], v8 offset:4096
  v_exp_f32 v152, v152
  v_mfma_f32_16x16x32_bf16 v[192:195], a[200:203], v[72:75], v[192:195]
  v_mfma_f32_16x16x32_bf16 v[192:195], a[204:207], v[76:79], v[192:195]
  v_accvgpr_read_b32 v28, a224
  v_accvgpr_read_b32 v29, a228
  v_mfma_f32_16x16x32_bf16 v[200:203], a[192:195], v[80:83], v[52:55]
  ds_read_b128 a[212:215], v9 offset:4096
  v_accvgpr_read_b32 v30, a232
  v_mfma_f32_16x16x32_bf16 v[200:203], a[196:199], v[84:87], v[200:203]
  v_accvgpr_read_b32 v31, a236
  v_cmp_ngt_f32 vcc, s48, v28
  v_rcp_f32 v28, v28
  s_or_b64 s[50:51], s[50:51], vcc
  v_mfma_f32_16x16x32_bf16 v[200:203], a[200:203], v[88:91], v[200:203]
  buffer_load_dwordx4 v6, s[20:23], s83 offen offset:3072 nt lds
  v_mfma_f32_16x16x32_bf16 v[200:203], a[204:207], v[92:95], v[200:203]
  ds_read_b128 a[216:219], v10 offset:4096
  v_cmp_ngt_f32 vcc, s48, v29
  v_rcp_f32 v29, v29
  s_or_b64 s[50:51], s[50:51], vcc
  v_mfma_f32_16x16x32_bf16 v[208:211], a[192:195], v[96:99], v[56:59]
  v_cmp_ngt_f32 vcc, s48, v30
  v_rcp_f32 v30, v30
  s_or_b64 s[50:51], s[50:51], vcc
  v_mfma_f32_16x16x32_bf16 v[208:211], a[196:199], v[100:103], v[208:211]
  v_mfma_f32_16x16x32_bf16 v[208:211], a[200:203], v[104:107], v[208:211]
  ds_read_b128 a[220:223], v11 offset:4096
  v_cmp_ngt_f32 vcc, s48, v31
  v_rcp_f32 v31, v31
  s_or_b64 s[50:51], s[50:51], vcc
  v_mfma_f32_16x16x32_bf16 v[208:211], a[204:207], v[108:111], v[208:211]
  v_exp_f32 v153, v153
  v_accvgpr_read_b32 v36, a0
  v_accvgpr_read_b32 v37, a1
  v_accvgpr_read_b32 v38, a2
  v_accvgpr_read_b32 v39, a3
  v_mul_f32 v36, v36, v28
  v_mul_f32 v37, v37, v28
  v_mul_f32 v38, v38, v28
  v_mfma_f32_16x16x32_bf16 v[216:219], a[192:195], v[112:115], v[60:63]
  v_mul_f32 v39, v39, v28
  v_cvt_pk_bf16_f32 v36, v36, v37
  v_mfma_f32_16x16x32_bf16 v[216:219], a[196:199], v[116:119], v[216:219]
  v_mfma_f32_16x16x32_bf16 v[216:219], a[200:203], v[120:123], v[216:219]
  v_cvt_pk_bf16_f32 v179, v182, v183
  v_cvt_pk_bf16_f32 v37, v38, v39
  v_mfma_f32_16x16x32_bf16 v[216:219], a[204:207], v[124:127], v[216:219]
  v_accvgpr_read_b32 v40, a4
  v_accvgpr_read_b32 v41, a5
  v_accvgpr_read_b32 v42, a6
  v_accvgpr_read_b32 v43, a7
  s_waitcnt lgkmcnt(0)
  v_mfma_f32_16x16x32_bf16 v[196:199], a[208:211], v[64:67], v[20:23]
  ds_write_b64 v32, v[36:37] offset:0
  v_mfma_f32_16x16x32_bf16 v[196:199], a[212:215], v[68:71], v[196:199]
  ds_read_b128 a[192:195], v8 offset:8192
  v_exp_f32 v154, v154
  v_mfma_f32_16x16x32_bf16 v[196:199], a[216:219], v[72:75], v[196:199]
  v_mul_f32 v40, v40, v28
  v_mul_f32 v41, v41, v28
  v_mfma_f32_16x16x32_bf16 v[196:199], a[220:223], v[76:79], v[196:199]
  v_exp_f32 v155, v155
  v_mul_f32 v42, v42, v28
  v_mul_f32 v43, v43, v28
  v_cvt_pk_bf16_f32 v40, v40, v41
  v_cvt_pk_bf16_f32 v41, v42, v43
  v_accvgpr_read_b32 v36, a8
  v_accvgpr_read_b32 v37, a9
  v_accvgpr_read_b32 v38, a10
  v_accvgpr_read_b32 v39, a11
  v_mfma_f32_16x16x32_bf16 v[204:207], a[208:211], v[80:83], v[52:55]
  ds_read_b128 a[196:199], v9 offset:8192
  ds_write_b64 v33, v[40:41] offset:0
  v_mfma_f32_16x16x32_bf16 v[204:207], a[212:215], v[84:87], v[204:207]
  v_mul_f32 v36, v36, v28
  v_mul_f32 v37, v37, v28
  v_mfma_f32_16x16x32_bf16 v[204:207], a[216:219], v[88:91], v[204:207]
  v_mfma_f32_16x16x32_bf16 v[204:207], a[220:223], v[92:95], v[204:207]
  ds_read_b128 a[200:203], v10 offset:8192
  v_cvt_pk_bf16_f32 v152, v152, v153
  v_mul_f32 v38, v38, v28
  v_mul_f32 v39, v39, v28
  v_cvt_pk_bf16_f32 v36, v36, v37
  v_cvt_pk_bf16_f32 v37, v38, v39
  v_accvgpr_read_b32 v40, a12
  v_accvgpr_read_b32 v41, a13
  v_accvgpr_read_b32 v42, a14
  v_accvgpr_read_b32 v43, a15
  v_mfma_f32_16x16x32_bf16 v[212:215], a[208:211], v[96:99], v[56:59]
  ds_write_b64 v34, v[36:37] offset:0
  v_mfma_f32_16x16x32_bf16 v[212:215], a[212:215], v[100:103], v[212:215]
  v_exp_f32 v156, v156
  v_mfma_f32_16x16x32_bf16 v[212:215], a[216:219], v[104:107], v[212:215]
  ds_read_b128 a[204:207], v11 offset:8192
  v_mfma_f32_16x16x32_bf16 v[212:215], a[220:223], v[108:111], v[212:215]
  v_mul_f32 v40, v40, v28
  v_mul_f32 v41, v41, v28
  v_mul_f32 v42, v42, v28
  v_mul_f32 v43, v43, v28
  v_cvt_pk_bf16_f32 v40, v40, v41
  v_cvt_pk_bf16_f32 v41, v42, v43
  v_accvgpr_read_b32 v36, a16
  v_accvgpr_read_b32 v37, a17
  v_accvgpr_read_b32 v38, a18
  v_accvgpr_read_b32 v39, a19
  v_mfma_f32_16x16x32_bf16 v[220:223], a[208:211], v[112:115], v[60:63]
  ds_write_b64 v35, v[40:41] offset:0
  v_mfma_f32_16x16x32_bf16 v[220:223], a[212:215], v[116:119], v[220:223]
  v_mfma_f32_16x16x32_bf16 v[220:223], a[216:219], v[120:123], v[220:223]
  v_exp_f32 v157, v157
  v_mfma_f32_16x16x32_bf16 v[220:223], a[220:223], v[124:127], v[220:223]
  v_cvt_pk_bf16_f32 v153, v154, v155
  v_mul_f32 v36, v36, v28
  v_mul_f32 v37, v37, v28
  v_mul_f32 v38, v38, v28
  v_mul_f32 v39, v39, v28
  v_cvt_pk_bf16_f32 v36, v36, v37
  v_cvt_pk_bf16_f32 v37, v38, v39
  v_accvgpr_read_b32 v40, a20
  v_accvgpr_read_b32 v41, a21
  v_accvgpr_read_b32 v42, a22
  s_waitcnt lgkmcnt(1)
  v_mfma_f32_16x16x32_bf16 v[224:227], a[192:195], v[64:67], v[20:23]
  v_accvgpr_read_b32 v43, a23
  v_exp_f32 v158, v158
  v_mfma_f32_16x16x32_bf16 v[224:227], a[196:199], v[68:71], v[224:227]
  ds_read_b128 a[208:211], v8 offset:12288
  ds_write_b64 v32, v[36:37] offset:128
  v_mfma_f32_16x16x32_bf16 v[224:227], a[200:203], v[72:75], v[224:227]
  v_mul_f32 v40, v40, v28
  v_mul_f32 v41, v41, v28
  v_mfma_f32_16x16x32_bf16 v[224:227], a[204:207], v[76:79], v[224:227]
  v_mul_f32 v42, v42, v28
  v_mul_f32 v43, v43, v28
  v_cvt_pk_bf16_f32 v40, v40, v41
  v_cvt_pk_bf16_f32 v41, v42, v43
  v_accvgpr_read_b32 v36, a24
  v_accvgpr_read_b32 v37, a25
  v_mfma_f32_16x16x32_bf16 v[232:235], a[192:195], v[80:83], v[52:55]
  ds_read_b128 a[212:215], v9 offset:12288
  v_mfma_f32_16x16x32_bf16 v[232:235], a[196:199], v[84:87], v[232:235]
  v_accvgpr_read_b32 v38, a26
  v_accvgpr_read_b32 v39, a27
  v_mfma_f32_16x16x32_bf16 v[232:235], a[200:203], v[88:91], v[232:235]
  ds_write_b64 v33, v[40:41] offset:128
  v_mfma_f32_16x16x32_bf16 v[232:235], a[204:207], v[92:95], v[232:235]
  ds_read_b128 a[216:219], v10 offset:12288
  v_exp_f32 v159, v159
  v_mul_f32 v36, v36, v28
  v_mul_f32 v37, v37, v28
  v_mul_f32 v38, v38, v28
  v_mul_f32 v39, v39, v28
  v_cvt_pk_bf16_f32 v36, v36, v37
  v_cvt_pk_bf16_f32 v37, v38, v39
  v_mfma_f32_16x16x32_bf16 v[240:243], a[192:195], v[96:99], v[56:59]
  v_mfma_f32_16x16x32_bf16 v[240:243], a[196:199], v[100:103], v[240:243]
  v_cvt_pk_bf16_f32 v154, v156, v157
  v_accvgpr_read_b32 v40, a28
  v_mfma_f32_16x16x32_bf16 v[240:243], a[200:203], v[104:107], v[240:243]
  ds_read_b128 a[220:223], v11 offset:12288
  v_mfma_f32_16x16x32_bf16 v[240:243], a[204:207], v[108:111], v[240:243]
  v_exp_f32 v184, v184
  v_accvgpr_read_b32 v41, a29
  v_accvgpr_read_b32 v42, a30
  v_accvgpr_read_b32 v43, a31
  v_mfma_f32_16x16x32_bf16 v[248:251], a[192:195], v[112:115], v[60:63]
  s_waitcnt vmcnt(8)
  s_barrier
  ds_write_b64 v34, v[36:37] offset:128
  v_mfma_f32_16x16x32_bf16 v[248:251], a[196:199], v[116:119], v[248:251]
  s_add_u32 m0, s44, 32768
  v_mul_f32 v40, v40, v28
  v_mfma_f32_16x16x32_bf16 v[248:251], a[200:203], v[120:123], v[248:251]
  v_mfma_f32_16x16x32_bf16 v[248:251], a[204:207], v[124:127], v[248:251]
  v_mul_f32 v41, v41, v28
  v_mul_f32 v42, v42, v28
  v_mul_f32 v43, v43, v28
  v_cvt_pk_bf16_f32 v40, v40, v41
  v_cvt_pk_bf16_f32 v41, v42, v43
  v_accvgpr_read_b32 v36, a32
  v_accvgpr_read_b32 v37, a33
  v_accvgpr_read_b32 v38, a34
  v_accvgpr_read_b32 v39, a35
  s_waitcnt lgkmcnt(1)
  v_mfma_f32_16x16x32_bf16 v[228:231], a[208:211], v[64:67], v[20:23]
  buffer_load_dwordx4 v1, s[16:19], s85 offen offset:0 nt lds
  ds_write_b64 v35, v[40:41] offset:128
  v_mfma_f32_16x16x32_bf16 v[228:231], a[212:215], v[68:71], v[228:231]
  ds_read_b64_tr_b16 a[192:193], v12 offset:32768
  ds_read_b64_tr_b16 a[194:195], v12 offset:36864
  v_mfma_f32_16x16x32_bf16 v[228:231], a[216:219], v[72:75], v[228:231]
  v_mul_f32 v36, v36, v29
  v_mul_f32 v37, v37, v29
  v_mfma_f32_16x16x32_bf16 v[228:231], a[220:223], v[76:79], v[228:231]
  v_mul_f32 v38, v38, v29
  v_mul_f32 v39, v39, v29
  v_cvt_pk_bf16_f32 v36, v36, v37
  v_cvt_pk_bf16_f32 v37, v38, v39
  v_accvgpr_read_b32 v40, a36
  v_accvgpr_read_b32 v41, a37
  v_accvgpr_read_b32 v42, a38
  v_accvgpr_read_b32 v43, a39
  v_mfma_f32_16x16x32_bf16 v[236:239], a[208:211], v[80:83], v[52:55]
  ds_read_b64_tr_b16 a[196:197], v12 offset:40960
  ds_read_b64_tr_b16 a[198:199], v12 offset:45056
  ds_write_b64 v32, v[36:37] offset:4096
  v_mfma_f32_16x16x32_bf16 v[236:239], a[212:215], v[84:87], v[236:239]
  v_mfma_f32_16x16x32_bf16 v[236:239], a[216:219], v[88:91], v[236:239]
  buffer_load_dwordx4 v2, s[16:19], s85 offen offset:1024 nt lds
  v_mfma_f32_16x16x32_bf16 v[236:239], a[220:223], v[92:95], v[236:239]
  ds_read_b64_tr_b16 a[200:201], v13 offset:32768
  ds_read_b64_tr_b16 a[202:203], v13 offset:36864
  v_mul_f32 v40, v40, v29
  v_mul_f32 v41, v41, v29
  v_mul_f32 v42, v42, v29
  v_mul_f32 v43, v43, v29
  v_cvt_pk_bf16_f32 v40, v40, v41
  v_cvt_pk_bf16_f32 v41, v42, v43
  v_accvgpr_read_b32 v36, a40
  v_accvgpr_read_b32 v37, a41
  v_accvgpr_read_b32 v38, a42
  v_accvgpr_read_b32 v39, a43
  v_mfma_f32_16x16x32_bf16 v[244:247], a[208:211], v[96:99], v[56:59]
  ds_write_b64 v33, v[40:41] offset:4096
  v_mfma_f32_16x16x32_bf16 v[244:247], a[212:215], v[100:103], v[244:247]
  v_mul_f32 v36, v36, v29
  v_mul_f32 v37, v37, v29
  v_mfma_f32_16x16x32_bf16 v[244:247], a[216:219], v[104:107], v[244:247]
  ds_read_b64_tr_b16 a[204:205], v13 offset:40960
  ds_read_b64_tr_b16 a[206:207], v13 offset:45056
  v_mfma_f32_16x16x32_bf16 v[244:247], a[220:223], v[108:111], v[244:247]
  v_mul_f32 v38, v38, v29
  v_mul_f32 v39, v39, v29
  v_cvt_pk_bf16_f32 v36, v36, v37
  v_cvt_pk_bf16_f32 v37, v38, v39
  v_accvgpr_read_b32 v40, a44
  v_accvgpr_read_b32 v41, a45
  v_accvgpr_read_b32 v42, a46
  v_accvgpr_read_b32 v43, a47
  v_mfma_f32_16x16x32_bf16 v[252:255], a[208:211], v[112:115], v[60:63]
  buffer_load_dwordx4 v3, s[16:19], s85 offen offset:2048 nt lds
  ds_write_b64 v34, v[36:37] offset:4096
  v_mfma_f32_16x16x32_bf16 v[252:255], a[212:215], v[116:119], v[252:255]
  v_mul_f32 v40, v40, v29
  v_mul_f32 v41, v41, v29
  v_mfma_f32_16x16x32_bf16 v[252:255], a[216:219], v[120:123], v[252:255]
  v_mfma_f32_16x16x32_bf16 v[252:255], a[220:223], v[124:127], v[252:255]
  v_mul_f32 v42, v42, v29
  v_mul_f32 v43, v43, v29
  v_cvt_pk_bf16_f32 v40, v40, v41
  v_cvt_pk_bf16_f32 v41, v42, v43
  s_waitcnt lgkmcnt(1)
  ds_write_b64 v35, v[40:41] offset:4096
  v_mfma_f32_16x16x32_bf16 a[128:131], a[192:195], v[128:131], 0
  buffer_load_dwordx4 v4, s[16:19], s85 offen offset:3072 nt lds
  v_mfma_f32_16x16x32_bf16 a[128:131], a[196:199], v[160:163], a[128:131]
  ds_read_b64_tr_b16 a[208:209], v14 offset:32768
  ds_read_b64_tr_b16 a[210:211], v14 offset:36864
  v_mfma_f32_16x16x32_bf16 a[160:163], a[192:195], v[136:139], 0
  s_add_u32 m0, s44, 65536
  v_mfma_f32_16x16x32_bf16 a[160:163], a[196:199], v[168:171], a[160:163]
  v_exp_f32 v185, v185
  v_mfma_f32_16x16x32_bf16 a[244:247], a[192:195], v[144:147], 0
  ds_read_b64_tr_b16 a[212:213], v14 offset:40960
  ds_read_b64_tr_b16 a[214:215], v14 offset:45056
  v_mfma_f32_16x16x32_bf16 a[244:247], a[196:199], v[176:179], a[244:247]
  v_cvt_pk_bf16_f32 v155, v158, v159
  v_exp_f32 v186, v186
  s_nop 0
  v_mfma_f32_16x16x32_bf16 a[20:23], a[192:195], v[152:155], 0
  buffer_load_dwordx4 v5, s[20:23], s84 offen offset:0 nt lds
  v_exp_f32 v187, v187
  v_cvt_pk_bf16_f32 v184, v184, v185
  v_exp_f32 v188, v188
  v_exp_f32 v189, v189
  v_cvt_pk_bf16_f32 v185, v186, v187
  v_exp_f32 v190, v190
  v_exp_f32 v191, v191
  v_cvt_pk_bf16_f32 v186, v188, v189
  v_cvt_pk_bf16_f32 v187, v190, v191
  s_nop 1
  v_mfma_f32_16x16x32_bf16 a[20:23], a[196:199], v[184:187], a[20:23]
  ds_read_b64_tr_b16 a[216:217], v15 offset:32768
  ds_read_b64_tr_b16 a[218:219], v15 offset:36864
  v_mfma_f32_16x16x32_bf16 a[132:135], a[200:203], v[128:131], 0
  v_mfma_f32_16x16x32_bf16 a[132:135], a[204:207], v[160:163], a[132:135]
  v_exp_f32 v192, v192
  v_mfma_f32_16x16x32_bf16 a[224:227], a[240:243], v[128:131], 0
  v_exp_f32 v193, v193
  v_mfma_f32_16x16x32_bf16 a[224:227], a[240:243], v[160:163], a[224:227]
  v_exp_f32 v194, v194
  v_mfma_f32_16x16x32_bf16 a[164:167], a[200:203], v[136:139], 0
  ds_read_b64_tr_b16 a[220:221], v15 offset:40960
  ds_read_b64_tr_b16 a[222:223], v15 offset:45056
  v_mfma_f32_16x16x32_bf16 a[164:167], a[204:207], v[168:171], a[164:167]
  v_exp_f32 v195, v195
  v_mfma_f32_16x16x32_bf16 a[248:251], a[200:203], v[144:147], 0
  v_mfma_f32_16x16x32_bf16 a[248:251], a[204:207], v[176:179], a[248:251]
  v_cvt_pk_bf16_f32 v192, v192, v193
  v_exp_f32 v196, v196
  v_mfma_f32_16x16x32_bf16 a[24:27], a[200:203], v[152:155], 0
  v_mfma_f32_16x16x32_bf16 a[24:27], a[204:207], v[184:187], a[24:27]
  v_exp_f32 v197, v197
  v_cvt_pk_bf16_f32 v193, v194, v195
  s_waitcnt lgkmcnt(0)
  v_mfma_f32_16x16x32_bf16 a[136:139], a[208:211], v[128:131], 0
  v_mfma_f32_16x16x32_bf16 a[136:139], a[212:215], v[160:163], a[136:139]
  ds_read_b64_tr_b16 a[192:193], v16 offset:32768
  ds_read_b64_tr_b16 a[194:195], v16 offset:36864
  v_exp_f32 v198, v198
  v_mfma_f32_16x16x32_bf16 a[168:171], a[208:211], v[136:139], 0
  v_mfma_f32_16x16x32_bf16 a[168:171], a[212:215], v[168:171], a[168:171]
  v_exp_f32 v199, v199
  v_cvt_pk_bf16_f32 v194, v196, v197
  v_mfma_f32_16x16x32_bf16 a[252:255], a[208:211], v[144:147], 0
  ds_read_b64_tr_b16 a[196:197], v16 offset:40960
  ds_read_b64_tr_b16 a[198:199], v16 offset:45056
  v_mfma_f32_16x16x32_bf16 a[252:255], a[212:215], v[176:179], a[252:255]
  v_exp_f32 v224, v224
  v_mfma_f32_16x16x32_bf16 a[28:31], a[208:211], v[152:155], 0
  v_mfma_f32_16x16x32_bf16 a[28:31], a[212:215], v[184:187], a[28:31]
  ds_read_b64_tr_b16 a[200:201], v17 offset:32768
  ds_read_b64_tr_b16 a[202:203], v17 offset:36864
  v_exp_f32 v225, v225
  v_mfma_f32_16x16x32_bf16 a[140:143], a[216:219], v[128:131], 0
  v_mfma_f32_16x16x32_bf16 a[140:143], a[220:223], v[160:163], a[140:143]
  v_cvt_pk_bf16_f32 v195, v198, v199
  v_exp_f32 v226, v226
  v_exp_f32 v227, v227
  v_mfma_f32_16x16x32_bf16 a[228:231], a[240:243], v[136:139], 0
  v_cvt_pk_bf16_f32 v224, v224, v225
  v_exp_f32 v228, v228
  v_mfma_f32_16x16x32_bf16 a[228:231], a[240:243], v[168:171], a[228:231]
  v_exp_f32 v229, v229
  v_mfma_f32_16x16x32_bf16 a[172:175], a[216:219], v[136:139], 0
  ds_read_b64_tr_b16 a[204:205], v17 offset:40960
  ds_read_b64_tr_b16 a[206:207], v17 offset:45056
  v_mfma_f32_16x16x32_bf16 a[172:175], a[220:223], v[168:171], a[172:175]
  v_cvt_pk_bf16_f32 v225, v226, v227
  v_exp_f32 v230, v230
  v_mfma_f32_16x16x32_bf16 a[0:3], a[216:219], v[144:147], 0
  v_mfma_f32_16x16x32_bf16 a[0:3], a[220:223], v[176:179], a[0:3]
  v_exp_f32 v231, v231
  v_mfma_f32_16x16x32_bf16 a[32:35], a[216:219], v[152:155], 0
  v_cvt_pk_bf16_f32 v226, v228, v229
  v_exp_f32 v200, v200
  v_mfma_f32_16x16x32_bf16 a[32:35], a[220:223], v[184:187], a[32:35]
  v_exp_f32 v201, v201
  s_waitcnt lgkmcnt(0)
  v_mfma_f32_16x16x32_bf16 a[144:147], a[192:195], v[128:131], 0
  v_mfma_f32_16x16x32_bf16 a[144:147], a[196:199], v[160:163], a[144:147]
  ds_read_b64_tr_b16 a[208:209], v18 offset:32768
  ds_read_b64_tr_b16 a[210:211], v18 offset:36864
  v_mfma_f32_16x16x32_bf16 a[176:179], a[192:195], v[136:139], 0
  v_mfma_f32_16x16x32_bf16 a[176:179], a[196:199], v[168:171], a[176:179]
  v_cvt_pk_bf16_f32 v227, v230, v231
  v_exp_f32 v202, v202
  v_mfma_f32_16x16x32_bf16 a[4:7], a[192:195], v[144:147], 0
  ds_read_b64_tr_b16 a[212:213], v18 offset:40960
  ds_read_b64_tr_b16 a[214:215], v18 offset:45056
  v_mfma_f32_16x16x32_bf16 a[4:7], a[196:199], v[176:179], a[4:7]
  v_exp_f32 v203, v203
  v_mfma_f32_16x16x32_bf16 a[36:39], a[192:195], v[152:155], 0
  v_mfma_f32_16x16x32_bf16 a[36:39], a[196:199], v[184:187], a[36:39]
  ds_read_b64_tr_b16 a[216:217], v19 offset:32768
  ds_read_b64_tr_b16 a[218:219], v19 offset:36864
  v_cvt_pk_bf16_f32 v200, v200, v201
  v_mfma_f32_16x16x32_bf16 a[148:151], a[200:203], v[128:131], 0
  v_exp_f32 v204, v204
  v_mfma_f32_16x16x32_bf16 a[148:151], a[204:207], v[160:163], a[148:151]
  v_exp_f32 v205, v205
  v_mfma_f32_16x16x32_bf16 a[232:235], a[240:243], v[144:147], 0
  v_cvt_pk_bf16_f32 v201, v202, v203
  v_exp_f32 v206, v206
  v_mfma_f32_16x16x32_bf16 a[232:235], a[240:243], v[176:179], a[232:235]
  v_exp_f32 v207, v207
  v_mfma_f32_16x16x32_bf16 a[180:183], a[200:203], v[136:139], 0
  ds_read_b64_tr_b16 a[220:221], v19 offset:40960
  ds_read_b64_tr_b16 a[222:223], v19 offset:45056
  v_mfma_f32_16x16x32_bf16 a[180:183], a[204:207], v[168:171], a[180:183]
  v_cvt_pk_bf16_f32 v202, v204, v205
  v_exp_f32 v232, v232
  v_mfma_f32_16x16x32_bf16 a[8:11], a[200:203], v[144:147], 0
  s_waitcnt vmcnt(9)
  s_barrier
  v_mfma_f32_16x16x32_bf16 a[8:11], a[204:207], v[176:179], a[8:11]
  v_exp_f32 v233, v233
  v_mfma_f32_16x16x32_bf16 a[40:43], a[200:203], v[152:155], 0
  v_mfma_f32_16x16x32_bf16 a[40:43], a[204:207], v[184:187], a[40:43]
  v_cvt_pk_bf16_f32 v203, v206, v207
  s_waitcnt lgkmcnt(0)
  v_mfma_f32_16x16x32_bf16 a[152:155], a[208:211], v[128:131], 0
  buffer_load_dwordx4 v6, s[20:23], s84 offen offset:1024 nt lds
  v_mfma_f32_16x16x32_bf16 a[152:155], a[212:215], v[160:163], a[152:155]
  ds_read_b128 a[192:195], v8 offset:16384
  v_exp_f32 v234, v234
  v_mfma_f32_16x16x32_bf16 a[184:187], a[208:211], v[136:139], 0
  v_exp_f32 v235, v235
  v_mfma_f32_16x16x32_bf16 a[184:187], a[212:215], v[168:171], a[184:187]
  v_cvt_pk_bf16_f32 v232, v232, v233
  v_exp_f32 v236, v236
  v_mfma_f32_16x16x32_bf16 a[12:15], a[208:211], v[144:147], 0
  ds_read_b128 a[196:199], v9 offset:16384
  v_mfma_f32_16x16x32_bf16 a[12:15], a[212:215], v[176:179], a[12:15]
  v_accvgpr_read_b32 v36, a48
  v_exp_f32 v237, v237
  v_mfma_f32_16x16x32_bf16 a[44:47], a[208:211], v[152:155], 0
  buffer_load_dwordx4 v5, s[20:23], s84 offen offset:2048 nt lds
  v_mfma_f32_16x16x32_bf16 a[44:47], a[212:215], v[184:187], a[44:47]
  ds_read_b128 a[200:203], v10 offset:16384
  v_accvgpr_read_b32 v37, a49
  v_mfma_f32_16x16x32_bf16 a[156:159], a[216:219], v[128:131], 0
  v_mfma_f32_16x16x32_bf16 a[156:159], a[220:223], v[160:163], a[156:159]
  v_cvt_pk_bf16_f32 v233, v234, v235
  v_exp_f32 v238, v238
  v_mfma_f32_16x16x32_bf16 a[236:239], a[240:243], v[152:155], 0
  v_exp_f32 v239, v239
  v_mfma_f32_16x16x32_bf16 a[236:239], a[240:243], v[184:187], a[236:239]
  v_cvt_pk_bf16_f32 v234, v236, v237
  v_exp_f32 v208, v208
  v_mfma_f32_16x16x32_bf16 a[188:191], a[216:219], v[136:139], 0
  ds_read_b128 a[204:207], v11 offset:16384
  v_mfma_f32_16x16x32_bf16 a[188:191], a[220:223], v[168:171], a[188:191]
  v_exp_f32 v209, v209
  v_mfma_f32_16x16x32_bf16 a[16:19], a[216:219], v[144:147], 0
  buffer_load_dwordx4 v6, s[20:23], s84 offen offset:3072 nt lds
  v_mfma_f32_16x16x32_bf16 a[16:19], a[220:223], v[176:179], a[16:19]
  s_add_u32 m0, s44, 0
  v_cvt_pk_bf16_f32 v235, v238, v239
  v_mfma_f32_16x16x32_bf16 v[48:51], a[216:219], v[152:155], 0
  v_mfma_f32_16x16x32_bf16 v[48:51], a[220:223], v[184:187], v[48:51]
  v_exp_f32 v210, v210
  v_exp_f32 v211, v211
  s_waitcnt lgkmcnt(0)
  v_mfma_f32_16x16x32_bf16 v[128:131], a[192:195], v[64:67], v[20:23]
  buffer_load_dwordx4 v1, s[16:19], s86 offen offset:0 nt lds
  v_mfma_f32_16x16x32_bf16 v[128:131], a[196:199], v[68:71], v[128:131]
  v_mfma_f32_16x16x32_bf16 v[128:131], a[200:203], v[72:75], v[128:131]
  v_mfma_f32_16x16x32_bf16 v[128:131], a[204:207], v[76:79], v[128:131]
  ds_read_b128 a[208:211], v8 offset:20480
  ds_read_b128 a[212:215], v9 offset:20480
  v_cvt_pk_bf16_f32 v208, v208, v209
  v_exp_f32 v212, v212
  v_accvgpr_read_b32 v38, a50
  v_mfma_f32_16x16x32_bf16 v[136:139], a[192:195], v[80:83], v[52:55]
  v_mfma_f32_16x16x32_bf16 v[136:139], a[196:199], v[84:87], v[136:139]
  v_mfma_f32_16x16x32_bf16 v[136:139], a[200:203], v[88:91], v[136:139]
  buffer_load_dwordx4 v2, s[16:19], s86 offen offset:1024 nt lds
  v_mfma_f32_16x16x32_bf16 v[136:139], a[204:207], v[92:95], v[136:139]
  ds_read_b128 a[216:219], v10 offset:20480
  v_exp_f32 v213, v213
  v_cvt_pk_bf16_f32 v209, v210, v211
  v_accvgpr_read_b32 v39, a51
  v_mul_f32 v36, v36, v29
  v_mul_f32 v37, v37, v29
  v_mfma_f32_16x16x32_bf16 v[144:147], a[192:195], v[96:99], v[56:59]
  v_mfma_f32_16x16x32_bf16 v[144:147], a[196:199], v[100:103], v[144:147]
  v_mfma_f32_16x16x32_bf16 v[144:147], a[200:203], v[104:107], v[144:147]
  v_mfma_f32_16x16x32_bf16 v[144:147], a[204:207], v[108:111], v[144:147]
  ds_read_b128 a[220:223], v11 offset:20480
  v_exp_f32 v214, v214
  v_exp_f32 v215, v215
  v_cvt_pk_bf16_f32 v210, v212, v213
  v_exp_f32 v240, v240
  v_mul_f32 v38, v38, v29
  v_mul_f32 v39, v39, v29
  v_mfma_f32_16x16x32_bf16 v[152:155], a[192:195], v[112:115], v[60:63]
  v_mfma_f32_16x16x32_bf16 v[152:155], a[196:199], v[116:119], v[152:155]
  v_mfma_f32_16x16x32_bf16 v[152:155], a[200:203], v[120:123], v[152:155]
  v_mfma_f32_16x16x32_bf16 v[152:155], a[204:207], v[124:127], v[152:155]
  v_exp_f32 v241, v241
  v_cvt_pk_bf16_f32 v211, v214, v215
  v_exp_f32 v242, v242
  v_cvt_pk_bf16_f32 v36, v36, v37
  v_cvt_pk_bf16_f32 v37, v38, v39
  v_accvgpr_read_b32 v40, a52
  s_waitcnt lgkmcnt(0)
  v_mfma_f32_16x16x32_bf16 v[132:135], a[208:211], v[64:67], v[20:23]
  v_mfma_f32_16x16x32_bf16 v[132:135], a[212:215], v[68:71], v[132:135]
  v_mfma_f32_16x16x32_bf16 v[132:135], a[216:219], v[72:75], v[132:135]
  v_mfma_f32_16x16x32_bf16 v[132:135], a[220:223], v[76:79], v[132:135]
  ds_read_b128 a[192:195], v8 offset:24576
  ds_read_b128 a[196:199], v9 offset:24576
  v_exp_f32 v243, v243
  v_cvt_pk_bf16_f32 v240, v240, v241
  v_exp_f32 v244, v244
  v_accvgpr_read_b32 v41, a53
  v_accvgpr_read_b32 v42, a54
  v_mfma_f32_16x16x32_bf16 v[140:143], a[208:211], v[80:83], v[52:55]
  v_mfma_f32_16x16x32_bf16 v[140:143], a[212:215], v[84:87], v[140:143]
  v_mfma_f32_16x16x32_bf16 v[140:143], a[216:219], v[88:91], v[140:143]
  v_mfma_f32_16x16x32_bf16 v[140:143], a[220:223], v[92:95], v[140:143]
  ds_read_b128 a[200:203], v10 offset:24576
  v_exp_f32 v245, v245
  v_cvt_pk_bf16_f32 v241, v242, v243
  v_exp_f32 v246, v246
  v_exp_f32 v247, v247
  v_accvgpr_read_b32 v43, a55
  v_mfma_f32_16x16x32_bf16 v[148:151], a[208:211], v[96:99], v[56:59]
  ds_write_b64 v32, v[36:37] offset:4224
  v_mfma_f32_16x16x32_bf16 v[148:151], a[212:215], v[100:103], v[148:151]
  v_mfma_f32_16x16x32_bf16 v[148:151], a[216:219], v[104:107], v[148:151]
  v_mfma_f32_16x16x32_bf16 v[148:151], a[220:223], v[108:111], v[148:151]
  ds_read_b128 a[204:207], v11 offset:24576
  v_cvt_pk_bf16_f32 v242, v244, v245
  v_exp_f32 v216, v216
  v_exp_f32 v217, v217
  v_cvt_pk_bf16_f32 v243, v246, v247
  v_mul_f32 v40, v40, v29
  v_mfma_f32_16x16x32_bf16 v[156:159], a[208:211], v[112:115], v[60:63]
  v_mfma_f32_16x16x32_bf16 v[156:159], a[212:215], v[116:119], v[156:159]
  v_mfma_f32_16x16x32_bf16 v[156:159], a[216:219], v[120:123], v[156:159]
  v_mfma_f32_16x16x32_bf16 v[156:159], a[220:223], v[124:127], v[156:159]
L_pad6:
  s_cbranch_execz L_pad10
  v_exp_f32 v218, v218
  v_exp_f32 v219, v219
  v_cvt_pk_bf16_f32 v216, v216, v217
  v_exp_f32 v220, v220
  v_mul_f32 v41, v41, v29
  v_mul_f32 v42, v42, v29
  v_mul_f32 v43, v43, v29
  s_waitcnt lgkmcnt(0)
  v_mfma_f32_16x16x32_bf16 v[160:163], a[192:195], v[64:67], v[20:23]
  v_mfma_f32_16x16x32_bf16 v[160:163], a[196:199], v[68:71], v[160:163]
  v_mfma_f32_16x16x32_bf16 v[160:163], a[200:203], v[72:75], v[160:163]
  v_mfma_f32_16x16x32_bf16 v[160:163], a[204:207], v[76:79], v[160:163]
  ds_read_b128 a[208:211], v8 offset:28672
  ds_read_b128 a[212:215], v9 offset:28672
  v_exp_f32 v221, v221
  v_cvt_pk_bf16_f32 v217, v218, v219
  v_exp_f32 v222, v222
  v_cvt_pk_bf16_f32 v40, v40, v41
  v_cvt_pk_bf16_f32 v41, v42, v43
  v_mfma_f32_16x16x32_bf16 v[168:171], a[192:195], v[80:83], v[52:55]
  v_mfma_f32_16x16x32_bf16 v[168:171], a[196:199], v[84:87], v[168:171]
  v_mfma_f32_16x16x32_bf16 v[168:171], a[200:203], v[88:91], v[168:171]
  v_mfma_f32_16x16x32_bf16 v[168:171], a[204:207], v[92:95], v[168:171]
  ds_read_b128 a[216:219], v10 offset:28672
  v_exp_f32 v223, v223
  v_cvt_pk_bf16_f32 v218, v220, v221
  v_exp_f32 v248, v248
  v_accvgpr_read_b32 v36, a56
  v_accvgpr_read_b32 v37, a57
  v_mfma_f32_16x16x32_bf16 v[176:179], a[192:195], v[96:99], v[56:59]
  v_mfma_f32_16x16x32_bf16 v[176:179], a[196:199], v[100:103], v[176:179]
  v_mfma_f32_16x16x32_bf16 v[176:179], a[200:203], v[104:107], v[176:179]
  v_mfma_f32_16x16x32_bf16 v[176:179], a[204:207], v[108:111], v[176:179]
  ds_read_b128 a[220:223], v11 offset:28672
  v_exp_f32 v249, v249
  v_cvt_pk_bf16_f32 v219, v222, v223
  v_exp_f32 v250, v250
  v_exp_f32 v251, v251
  v_accvgpr_read_b32 v38, a58
  v_accvgpr_read_b32 v39, a59
  v_mfma_f32_16x16x32_bf16 v[184:187], a[192:195], v[112:115], v[60:63]
  s_waitcnt vmcnt(10)
  s_barrier
  v_mfma_f32_16x16x32_bf16 v[184:187], a[196:199], v[116:119], v[184:187]
  v_mfma_f32_16x16x32_bf16 v[184:187], a[200:203], v[120:123], v[184:187]
  ds_write_b64 v33, v[40:41] offset:4224
  v_mfma_f32_16x16x32_bf16 v[184:187], a[204:207], v[124:127], v[184:187]
  v_cvt_pk_bf16_f32 v248, v248, v249
  v_exp_f32 v252, v252
  s_waitcnt lgkmcnt(1)
  v_mfma_f32_16x16x32_bf16 v[164:167], a[208:211], v[64:67], v[20:23]
  buffer_load_dwordx4 v3, s[16:19], s86 offen offset:2048 nt lds
  v_mfma_f32_16x16x32_bf16 v[164:167], a[212:215], v[68:71], v[164:167]
  v_mfma_f32_16x16x32_bf16 v[164:167], a[216:219], v[72:75], v[164:167]
  v_mfma_f32_16x16x32_bf16 v[164:167], a[220:223], v[76:79], v[164:167]
  ds_read_b64_tr_b16 a[192:193], v12 offset:0
  ds_read_b64_tr_b16 a[194:195], v12 offset:4096
  ds_read_b64_tr_b16 a[196:197], v12 offset:8192
  ds_read_b64_tr_b16 a[198:199], v12 offset:12288
  v_exp_f32 v253, v253
  v_mul_f32 v36, v36, v29
  v_mfma_f32_16x16x32_bf16 v[172:175], a[208:211], v[80:83], v[52:55]
  v_mfma_f32_16x16x32_bf16 v[172:175], a[212:215], v[84:87], v[172:175]
  v_mfma_f32_16x16x32_bf16 v[172:175], a[216:219], v[88:91], v[172:175]
  buffer_load_dwordx4 v4, s[16:19], s86 offen offset:3072 nt lds
  v_mfma_f32_16x16x32_bf16 v[172:175], a[220:223], v[92:95], v[172:175]
  ds_read_b64_tr_b16 a[200:201], v13 offset:0
  ds_read_b64_tr_b16 a[202:203], v13 offset:4096
  v_cvt_pk_bf16_f32 v249, v250, v251
  v_exp_f32 v254, v254
  v_mul_f32 v37, v37, v29
  v_mul_f32 v38, v38, v29
  v_mfma_f32_16x16x32_bf16 v[180:183], a[208:211], v[96:99], v[56:59]
  s_add_u32 m0, s44, 81920
  v_mfma_f32_16x16x32_bf16 v[180:183], a[212:215], v[100:103], v[180:183]
  v_mfma_f32_16x16x32_bf16 v[180:183], a[216:219], v[104:107], v[180:183]
  v_mfma_f32_16x16x32_bf16 v[180:183], a[220:223], v[108:111], v[180:183]
  ds_read_b64_tr_b16 a[204:205], v13 offset:8192
  ds_read_b64_tr_b16 a[206:207], v13 offset:12288
  v_exp_f32 v255, v255
  v_cvt_pk_bf16_f32 v250, v252, v253
  v_cvt_pk_bf16_f32 v251, v254, v255
  v_mul_f32 v39, v39, v29
  v_cvt_pk_bf16_f32 v36, v36, v37
  v_mfma_f32_16x16x32_bf16 v[188:191], a[208:211], v[112:115], v[60:63]
  buffer_load_dwordx4 v5, s[20:23], s85 offen offset:0 nt lds
  v_mfma_f32_16x16x32_bf16 v[188:191], a[212:215], v[116:119], v[188:191]
  v_mfma_f32_16x16x32_bf16 v[188:191], a[216:219], v[120:123], v[188:191]
  v_mfma_f32_16x16x32_bf16 v[188:191], a[220:223], v[124:127], v[188:191]
  v_cvt_pk_bf16_f32 v37, v38, v39
  v_accvgpr_read_b32 v40, a60
  v_accvgpr_read_b32 v41, a61
  s_waitcnt lgkmcnt(0)
  v_mfma_f32_16x16x32_bf16 a[128:131], a[192:195], v[192:195], a[128:131]
  buffer_load_dwordx4 v6, s[20:23], s85 offen offset:1024 nt lds
  v_mfma_f32_16x16x32_bf16 a[128:131], a[196:199], v[224:227], a[128:131]
  ds_read_b64_tr_b16 a[208:209], v14 offset:0
  ds_read_b64_tr_b16 a[210:211], v14 offset:4096
  v_accvgpr_read_b32 v42, a62
  v_mfma_f32_16x16x32_bf16 a[160:163], a[192:195], v[200:203], a[160:163]
  v_mfma_f32_16x16x32_bf16 a[160:163], a[196:199], v[232:235], a[160:163]
  ds_read_b64_tr_b16 a[212:213], v14 offset:8192
  ds_read_b64_tr_b16 a[214:215], v14 offset:12288
  v_exp_f32 v128, v128
  v_exp_f32 v129, v129
  v_exp_f32 v130, v130
  v_accvgpr_read_b32 v43, a63
  v_mfma_f32_16x16x32_bf16 a[244:247], a[192:195], v[208:211], a[244:247]
  v_mfma_f32_16x16x32_bf16 a[244:247], a[196:199], v[240:243], a[244:247]
  ds_read_b64_tr_b16 a[216:217], v15 offset:0
  ds_read_b64_tr_b16 a[218:219], v15 offset:4096
  v_exp_f32 v131, v131
  v_mfma_f32_16x16x32_bf16 a[20:23], a[192:195], v[216:219], a[20:23]
  buffer_load_dwordx4 v5, s[20:23], s85 offen offset:2048 nt lds
  v_mfma_f32_16x16x32_bf16 a[20:23], a[196:199], v[248:251], a[20:23]
  ds_read_b64_tr_b16 a[220:221], v15 offset:8192
  ds_read_b64_tr_b16 a[222:223], v15 offset:12288
  v_mfma_f32_16x16x32_bf16 a[132:135], a[200:203], v[192:195], a[132:135]
  ds_write_b64 v34, v[36:37] offset:4224
  v_mfma_f32_16x16x32_bf16 a[132:135], a[204:207], v[224:227], a[132:135]
  v_cvt_pk_bf16_f32 v128, v128, v129
  v_exp_f32 v132, v132
  v_mfma_f32_16x16x32_bf16 a[224:227], a[240:243], v[192:195], a[224:227]
  v_exp_f32 v133, v133
  v_mfma_f32_16x16x32_bf16 a[224:227], a[240:243], v[224:227], a[224:227]
  v_cvt_pk_bf16_f32 v129, v130, v131
  v_mul_f32 v40, v40, v29
  v_mfma_f32_16x16x32_bf16 a[164:167], a[200:203], v[200:203], a[164:167]
  v_mfma_f32_16x16x32_bf16 a[164:167], a[204:207], v[232:235], a[164:167]
  v_exp_f32 v134, v134
  v_exp_f32 v135, v135
  v_mfma_f32_16x16x32_bf16 a[248:251], a[200:203], v[208:211], a[248:251]
  v_mfma_f32_16x16x32_bf16 a[248:251], a[204:207], v[240:243], a[248:251]
  v_cvt_pk_bf16_f32 v130, v132, v133
  v_exp_f32 v160, v160
  v_mfma_f32_16x16x32_bf16 a[24:27], a[200:203], v[216:219], a[24:27]
  v_mfma_f32_16x16x32_bf16 a[24:27], a[204:207], v[248:251], a[24:27]
  v_exp_f32 v161, v161
  v_cvt_pk_bf16_f32 v131, v134, v135
  v_mul_f32 v41, v41, v29
  s_waitcnt lgkmcnt(1)
  v_mfma_f32_16x16x32_bf16 a[136:139], a[208:211], v[192:195], a[136:139]
  v_mfma_f32_16x16x32_bf16 a[136:139], a[212:215], v[224:227], a[136:139]
  ds_read_b64_tr_b16 a[192:193], v16 offset:0
  ds_read_b64_tr_b16 a[194:195], v16 offset:4096
  v_exp_f32 v162, v162
  v_mul_f32 v42, v42, v29
  v_mfma_f32_16x16x32_bf16 a[168:171], a[208:211], v[200:203], a[168:171]
  v_mfma_f32_16x16x32_bf16 a[168:171], a[212:215], v[232:235], a[168:171]
  ds_read_b64_tr_b16 a[196:197], v16 offset:8192
  ds_read_b64_tr_b16 a[198:199], v16 offset:12288
  v_mul_f32 v43, v43, v29
  v_mfma_f32_16x16x32_bf16 a[252:255], a[208:211], v[208:211], a[252:255]
  v_mfma_f32_16x16x32_bf16 a[252:255], a[212:215], v[240:243], a[252:255]
  ds_read_b64_tr_b16 a[200:201], v17 offset:0
  ds_read_b64_tr_b16 a[202:203], v17 offset:4096
  v_exp_f32 v163, v163
  v_cvt_pk_bf16_f32 v40, v40, v41
  v_mfma_f32_16x16x32_bf16 a[28:31], a[208:211], v[216:219], a[28:31]
  v_mfma_f32_16x16x32_bf16 a[28:31], a[212:215], v[248:251], a[28:31]
  ds_read_b64_tr_b16 a[204:205], v17 offset:8192
  ds_read_b64_tr_b16 a[206:207], v17 offset:12288
  v_cvt_pk_bf16_f32 v160, v160, v161
  v_cvt_pk_bf16_f32 v41, v42, v43
  v_mfma_f32_16x16x32_bf16 a[140:143], a[216:219], v[192:195], a[140:143]
  v_mfma_f32_16x16x32_bf16 a[140:143], a[220:223], v[224:227], a[140:143]
  v_exp_f32 v164, v164
  v_exp_f32 v165, v165
  v_cvt_pk_bf16_f32 v161, v162, v163
  v_accvgpr_read_b32 v36, a64
  v_mfma_f32_16x16x32_bf16 a[228:231], a[240:243], v[200:203], a[228:231]
  v_exp_f32 v166, v166
  v_mfma_f32_16x16x32_bf16 a[228:231], a[240:243], v[232:235], a[228:231]
  v_exp_f32 v167, v167
  v_mfma_f32_16x16x32_bf16 a[172:175], a[216:219], v[200:203], a[172:175]
  v_mfma_f32_16x16x32_bf16 a[172:175], a[220:223], v[232:235], a[172:175]
  v_cvt_pk_bf16_f32 v162, v164, v165
  v_exp_f32 v136, v136
  v_accvgpr_read_b32 v37, a65
  v_mfma_f32_16x16x32_bf16 a[0:3], a[216:219], v[208:211], a[0:3]
  v_mfma_f32_16x16x32_bf16 a[0:3], a[220:223], v[240:243], a[0:3]
  v_exp_f32 v137, v137
  v_cvt_pk_bf16_f32 v163, v166, v167
  v_accvgpr_read_b32 v38, a66
  v_mfma_f32_16x16x32_bf16 a[32:35], a[216:219], v[216:219], a[32:35]
  v_mfma_f32_16x16x32_bf16 a[32:35], a[220:223], v[248:251], a[32:35]
  v_exp_f32 v138, v138
  v_accvgpr_read_b32 v39, a67
  s_waitcnt lgkmcnt(0)
  v_mfma_f32_16x16x32_bf16 a[144:147], a[192:195], v[192:195], a[144:147]
  v_mfma_f32_16x16x32_bf16 a[144:147], a[196:199], v[224:227], a[144:147]
  ds_read_b64_tr_b16 a[208:209], v18 offset:0
  ds_read_b64_tr_b16 a[210:211], v18 offset:4096
  v_exp_f32 v139, v139
  v_mfma_f32_16x16x32_bf16 a[176:179], a[192:195], v[200:203], a[176:179]
  v_mfma_f32_16x16x32_bf16 a[176:179], a[196:199], v[232:235], a[176:179]
  ds_read_b64_tr_b16 a[212:213], v18 offset:8192
  ds_read_b64_tr_b16 a[214:215], v18 offset:12288
  ds_write_b64 v35, v[40:41] offset:4224
  v_cvt_pk_bf16_f32 v136, v136, v137
  v_mfma_f32_16x16x32_bf16 a[4:7], a[192:195], v[208:211], a[4:7]
  v_mfma_f32_16x16x32_bf16 a[4:7], a[196:199], v[240:243], a[4:7]
  ds_read_b64_tr_b16 a[216:217], v19 offset:0
  ds_read_b64_tr_b16 a[218:219], v19 offset:4096
  v_exp_f32 v140, v140
  v_mfma_f32_16x16x32_bf16 a[36:39], a[192:195], v[216:219], a[36:39]
  v_mfma_f32_16x16x32_bf16 a[36:39], a[196:199], v[248:251], a[36:39]
  ds_read_b64_tr_b16 a[220:221], v19 offset:8192
  ds_read_b64_tr_b16 a[222:223], v19 offset:12288
  v_exp_f32 v141, v141
  v_mul_f32 v36, v36, v30
  v_mfma_f32_16x16x32_bf16 a[148:151], a[200:203], v[192:195], a[148:151]
  v_mfma_f32_16x16x32_bf16 a[148:151], a[204:207], v[224:227], a[148:151]
  v_cvt_pk_bf16_f32 v137, v138, v139
  v_exp_f32 v142, v142
  v_mul_f32 v37, v37, v30
  v_mfma_f32_16x16x32_bf16 a[232:235], a[240:243], v[208:211], a[232:235]
  v_exp_f32 v143, v143
  v_mfma_f32_16x16x32_bf16 a[232:235], a[240:243], v[240:243], a[232:235]
  v_cvt_pk_bf16_f32 v138, v140, v141
  v_exp_f32 v168, v168
  v_mfma_f32_16x16x32_bf16 a[180:183], a[200:203], v[200:203], a[180:183]
  v_mfma_f32_16x16x32_bf16 a[180:183], a[204:207], v[232:235], a[180:183]
  v_exp_f32 v169, v169
  v_cvt_pk_bf16_f32 v139, v142, v143
  v_mul_f32 v38, v38, v30
  v_mfma_f32_16x16x32_bf16 a[8:11], a[200:203], v[208:211], a[8:11]
  s_waitcnt vmcnt(11)
  s_barrier
  v_mfma_f32_16x16x32_bf16 a[8:11], a[204:207], v[240:243], a[8:11]
  v_exp_f32 v170, v170
  v_mul_f32 v39, v39, v30
  v_mfma_f32_16x16x32_bf16 a[40:43], a[200:203], v[216:219], a[40:43]
  v_mfma_f32_16x16x32_bf16 a[40:43], a[204:207], v[248:251], a[40:43]
  v_exp_f32 v171, v171
  s_waitcnt lgkmcnt(0)
  v_mfma_f32_16x16x32_bf16 a[152:155], a[208:211], v[192:195], a[152:155]
  buffer_load_dwordx4 v6, s[20:23], s85 offen offset:3072 nt lds
  v_mfma_f32_16x16x32_bf16 a[152:155], a[212:215], v[224:227], a[152:155]
  ds_read_b128 a[192:195], v8 offset:32768
  v_cvt_pk_bf16_f32 v168, v168, v169
  v_cvt_pk_bf16_f32 v36, v36, v37
  v_mfma_f32_16x16x32_bf16 a[184:187], a[208:211], v[200:203], a[184:187]
  s_add_u32 m0, s44, 16384
  v_mfma_f32_16x16x32_bf16 a[184:187], a[212:215], v[232:235], a[184:187]
  ds_read_b128 a[196:199], v9 offset:32768
  v_exp_f32 v172, v172
  v_cvt_pk_bf16_f32 v37, v38, v39
  v_mfma_f32_16x16x32_bf16 a[12:15], a[208:211], v[208:211], a[12:15]
  v_mfma_f32_16x16x32_bf16 a[12:15], a[212:215], v[240:243], a[12:15]
  ds_read_b128 a[200:203], v10 offset:32768
  v_exp_f32 v173, v173
  v_mfma_f32_16x16x32_bf16 a[44:47], a[208:211], v[216:219], a[44:47]
  buffer_load_dwordx4 v1, s[16:19], s87 offen offset:0 nt lds
  ds_write_b64 v32, v[36:37] offset:8192
  v_mfma_f32_16x16x32_bf16 a[44:47], a[212:215], v[248:251], a[44:47]
  ds_read_b128 a[204:207], v11 offset:32768
  v_cvt_pk_bf16_f32 v169, v170, v171
  v_mfma_f32_16x16x32_bf16 a[156:159], a[216:219], v[192:195], a[156:159]
  v_mfma_f32_16x16x32_bf16 a[156:159], a[220:223], v[224:227], a[156:159]
  s_waitcnt lgkmcnt(1)
  v_exp_f32 v174, v174
  v_mfma_f32_16x16x32_bf16 a[236:239], a[240:243], v[216:219], a[236:239]
  v_exp_f32 v175, v175
  v_mfma_f32_16x16x32_bf16 a[236:239], a[240:243], v[248:251], a[236:239]
  v_cvt_pk_bf16_f32 v170, v172, v173
  v_exp_f32 v144, v144
  v_mfma_f32_16x16x32_bf16 a[188:191], a[216:219], v[200:203], a[188:191]
  v_mfma_f32_16x16x32_bf16 a[188:191], a[220:223], v[232:235], a[188:191]
  ds_read_b128 a[48:51], v46 offset:0
  v_exp_f32 v145, v145
  v_cvt_pk_bf16_f32 v171, v174, v175
  v_mfma_f32_16x16x32_bf16 a[16:19], a[216:219], v[208:211], a[16:19]
  buffer_load_dwordx4 v2, s[16:19], s87 offen offset:1024 nt lds
  v_mfma_f32_16x16x32_bf16 a[16:19], a[220:223], v[240:243], a[16:19]
  ds_read_b128 a[56:59], v46 offset:2048
  v_exp_f32 v146, v146
  v_mfma_f32_16x16x32_bf16 v[48:51], a[216:219], v[216:219], v[48:51]
  v_mfma_f32_16x16x32_bf16 v[48:51], a[220:223], v[248:251], v[48:51]
  v_exp_f32 v147, v147
  s_waitcnt lgkmcnt(2)
  v_mfma_f32_16x16x32_bf16 v[192:195], a[192:195], v[64:67], v[20:23]
  buffer_load_dwordx4 v3, s[16:19], s87 offen offset:2048 nt lds
  v_mfma_f32_16x16x32_bf16 v[192:195], a[196:199], v[68:71], v[192:195]
  v_mfma_f32_16x16x32_bf16 v[192:195], a[200:203], v[72:75], v[192:195]
  v_mfma_f32_16x16x32_bf16 v[192:195], a[204:207], v[76:79], v[192:195]
  ds_read_b128 a[208:211], v8 offset:36864
  ds_read_b128 a[212:215], v9 offset:36864
  v_cvt_pk_bf16_f32 v144, v144, v145
  v_exp_f32 v148, v148
  v_xor_b32 v46, 64, v46
  v_mfma_f32_16x16x32_bf16 v[200:203], a[192:195], v[80:83], v[52:55]
  ds_read_b128 a[52:55], v46 offset:1024
  ds_read_b128 a[60:63], v46 offset:3072
  v_mfma_f32_16x16x32_bf16 v[200:203], a[196:199], v[84:87], v[200:203]
  v_mfma_f32_16x16x32_bf16 v[200:203], a[200:203], v[88:91], v[200:203]
  buffer_load_dwordx4 v4, s[16:19], s87 offen offset:3072 nt lds
  v_mfma_f32_16x16x32_bf16 v[200:203], a[204:207], v[92:95], v[200:203]
  ds_read_b128 a[216:219], v10 offset:36864
  v_exp_f32 v149, v149
  v_cvt_pk_bf16_f32 v145, v146, v147
  v_exp_f32 v150, v150
  v_mfma_f32_16x16x32_bf16 v[208:211], a[192:195], v[96:99], v[56:59]
  v_mfma_f32_16x16x32_bf16 v[208:211], a[196:199], v[100:103], v[208:211]
  v_mfma_f32_16x16x32_bf16 v[208:211], a[200:203], v[104:107], v[208:211]
  v_mfma_f32_16x16x32_bf16 v[208:211], a[204:207], v[108:111], v[208:211]
  ds_read_b128 a[220:223], v11 offset:36864
  v_exp_f32 v151, v151
  v_cvt_pk_bf16_f32 v146, v148, v149
  v_exp_f32 v176, v176
  v_accvgpr_read_b32 v40, a68
  v_accvgpr_read_b32 v41, a69
  v_mfma_f32_16x16x32_bf16 v[216:219], a[192:195], v[112:115], v[60:63]
  v_mfma_f32_16x16x32_bf16 v[216:219], a[196:199], v[116:119], v[216:219]
  v_mfma_f32_16x16x32_bf16 v[216:219], a[200:203], v[120:123], v[216:219]
  v_mfma_f32_16x16x32_bf16 v[216:219], a[204:207], v[124:127], v[216:219]
  v_exp_f32 v177, v177
  v_cvt_pk_bf16_f32 v147, v150, v151
  v_exp_f32 v178, v178
  v_exp_f32 v179, v179
  v_accvgpr_read_b32 v42, a70
  v_accvgpr_read_b32 v43, a71
  s_waitcnt lgkmcnt(0)
  v_mfma_f32_16x16x32_bf16 v[196:199], a[208:211], v[64:67], v[20:23]
  v_mfma_f32_16x16x32_bf16 v[196:199], a[212:215], v[68:71], v[196:199]
  v_mfma_f32_16x16x32_bf16 v[196:199], a[216:219], v[72:75], v[196:199]
  v_mfma_f32_16x16x32_bf16 v[196:199], a[220:223], v[76:79], v[196:199]
  ds_read_b128 a[192:195], v8 offset:40960
  ds_read_b128 a[196:199], v9 offset:40960
  v_cvt_pk_bf16_f32 v176, v176, v177
  v_exp_f32 v180, v180
  v_exp_f32 v181, v181
  v_mul_f32 v40, v40, v30
  v_mfma_f32_16x16x32_bf16 v[204:207], a[208:211], v[80:83], v[52:55]
  v_mfma_f32_16x16x32_bf16 v[204:207], a[212:215], v[84:87], v[204:207]
  v_mfma_f32_16x16x32_bf16 v[204:207], a[216:219], v[88:91], v[204:207]
  v_mfma_f32_16x16x32_bf16 v[204:207], a[220:223], v[92:95], v[204:207]
  ds_read_b128 a[200:203], v10 offset:40960
  v_cvt_pk_bf16_f32 v177, v178, v179
  v_exp_f32 v182, v182
  v_exp_f32 v183, v183
  v_cvt_pk_bf16_f32 v178, v180, v181
  v_mul_f32 v41, v41, v30
  v_mul_f32 v42, v42, v30
  v_mfma_f32_16x16x32_bf16 v[212:215], a[208:211], v[96:99], v[56:59]
  v_mfma_f32_16x16x32_bf16 v[212:215], a[212:215], v[100:103], v[212:215]
  v_mfma_f32_16x16x32_bf16 v[212:215], a[216:219], v[104:107], v[212:215]
  v_mfma_f32_16x16x32_bf16 v[212:215], a[220:223], v[108:111], v[212:215]
  ds_read_b128 a[204:207], v11 offset:40960
  v_exp_f32 v152, v152
  v_exp_f32 v153, v153
  v_cvt_pk_bf16_f32 v179, v182, v183
  v_exp_f32 v154, v154
  v_mul_f32 v43, v43, v30
  v_cvt_pk_bf16_f32 v40, v40, v41
  v_mfma_f32_16x16x32_bf16 v[220:223], a[208:211], v[112:115], v[60:63]
  v_mfma_f32_16x16x32_bf16 v[220:223], a[212:215], v[116:119], v[220:223]
  v_mfma_f32_16x16x32_bf16 v[220:223], a[216:219], v[120:123], v[220:223]
  v_mfma_f32_16x16x32_bf16 v[220:223], a[220:223], v[124:127], v[220:223]
  v_exp_f32 v155, v155
  v_cvt_pk_bf16_f32 v152, v152, v153
  v_exp_f32 v156, v156
  v_cvt_pk_bf16_f32 v41, v42, v43
  v_accvgpr_read_b32 v36, a72
  s_waitcnt lgkmcnt(0)
  v_mfma_f32_16x16x32_bf16 v[224:227], a[192:195], v[64:67], v[20:23]
  v_mfma_f32_16x16x32_bf16 v[224:227], a[196:199], v[68:71], v[224:227]
  v_mfma_f32_16x16x32_bf16 v[224:227], a[200:203], v[72:75], v[224:227]
  v_mfma_f32_16x16x32_bf16 v[224:227], a[204:207], v[76:79], v[224:227]
  ds_read_b128 a[208:211], v8 offset:45056
  ds_read_b128 a[212:215], v9 offset:45056
  v_exp_f32 v157, v157
  v_cvt_pk_bf16_f32 v153, v154, v155
  v_exp_f32 v158, v158
  v_accvgpr_read_b32 v37, a73
  v_mfma_f32_16x16x32_bf16 v[232:235], a[192:195], v[80:83], v[52:55]
  v_mfma_f32_16x16x32_bf16 v[232:235], a[196:199], v[84:87], v[232:235]
  v_mfma_f32_16x16x32_bf16 v[232:235], a[200:203], v[88:91], v[232:235]
  v_mfma_f32_16x16x32_bf16 v[232:235], a[204:207], v[92:95], v[232:235]
  ds_read_b128 a[216:219], v10 offset:45056
  v_exp_f32 v159, v159
  v_cvt_pk_bf16_f32 v154, v156, v157
  v_exp_f32 v184, v184
  v_exp_f32 v185, v185
  v_accvgpr_read_b32 v38, a74
  v_accvgpr_read_b32 v39, a75
  v_mfma_f32_16x16x32_bf16 v[240:243], a[192:195], v[96:99], v[56:59]
  v_mfma_f32_16x16x32_bf16 v[240:243], a[196:199], v[100:103], v[240:243]
  v_mfma_f32_16x16x32_bf16 v[240:243], a[200:203], v[104:107], v[240:243]
  v_mfma_f32_16x16x32_bf16 v[240:243], a[204:207], v[108:111], v[240:243]
  ds_read_b128 a[220:223], v11 offset:45056
  ds_write_b64 v33, v[40:41] offset:8192
  v_cvt_pk_bf16_f32 v155, v158, v159
  v_exp_f32 v186, v186
  v_exp_f32 v187, v187
  v_cvt_pk_bf16_f32 v184, v184, v185
  v_mfma_f32_16x16x32_bf16 v[248:251], a[192:195], v[112:115], v[60:63]
  s_waitcnt vmcnt(12)
  s_barrier
  v_mfma_f32_16x16x32_bf16 v[248:251], a[196:199], v[116:119], v[248:251]
  s_add_u32 m0, s44, 49152
  v_mfma_f32_16x16x32_bf16 v[248:251], a[200:203], v[120:123], v[248:251]
  v_mfma_f32_16x16x32_bf16 v[248:251], a[204:207], v[124:127], v[248:251]
  v_exp_f32 v188, v188
  v_mul_f32 v36, v36, v30
  s_waitcnt lgkmcnt(1)
  v_mfma_f32_16x16x32_bf16 v[228:231], a[208:211], v[64:67], v[20:23]
  buffer_load_dwordx4 v5, s[20:23], s86 offen offset:0 nt lds
  v_mfma_f32_16x16x32_bf16 v[228:231], a[212:215], v[68:71], v[228:231]
  v_mfma_f32_16x16x32_bf16 v[228:231], a[216:219], v[72:75], v[228:231]
  v_mfma_f32_16x16x32_bf16 v[228:231], a[220:223], v[76:79], v[228:231]
  ds_read_b64_tr_b16 a[192:193], v12 offset:16384
  ds_read_b64_tr_b16 a[194:195], v12 offset:20480
  ds_read_b64_tr_b16 a[196:197], v12 offset:24576
  ds_read_b64_tr_b16 a[198:199], v12 offset:28672
  v_exp_f32 v189, v189
  v_mul_f32 v37, v37, v30
  v_mfma_f32_16x16x32_bf16 v[236:239], a[208:211], v[80:83], v[52:55]
  v_mfma_f32_16x16x32_bf16 v[236:239], a[212:215], v[84:87], v[236:239]
  v_mfma_f32_16x16x32_bf16 v[236:239], a[216:219], v[88:91], v[236:239]
  buffer_load_dwordx4 v6, s[20:23], s86 offen offset:1024 nt lds
  v_mfma_f32_16x16x32_bf16 v[236:239], a[220:223], v[92:95], v[236:239]
  ds_read_b64_tr_b16 a[200:201], v13 offset:16384
  ds_read_b64_tr_b16 a[202:203], v13 offset:20480
  v_cvt_pk_bf16_f32 v185, v186, v187
  v_exp_f32 v190, v190
  v_mul_f32 v38, v38, v30
  v_mul_f32 v39, v39, v30
  v_mfma_f32_16x16x32_bf16 v[244:247], a[208:211], v[96:99], v[56:59]
  v_mfma_f32_16x16x32_bf16 v[244:247], a[212:215], v[100:103], v[244:247]
  v_mfma_f32_16x16x32_bf16 v[244:247], a[216:219], v[104:107], v[244:247]
  v_mfma_f32_16x16x32_bf16 v[244:247], a[220:223], v[108:111], v[244:247]
  ds_read_b64_tr_b16 a[204:205], v13 offset:24576
  ds_read_b64_tr_b16 a[206:207], v13 offset:28672
  v_exp_f32 v191, v191
  v_cvt_pk_bf16_f32 v186, v188, v189
  v_cvt_pk_bf16_f32 v187, v190, v191
  v_cvt_pk_bf16_f32 v36, v36, v37
  v_cvt_pk_bf16_f32 v37, v38, v39
  v_mfma_f32_16x16x32_bf16 v[252:255], a[208:211], v[112:115], v[60:63]
  buffer_load_dwordx4 v5, s[20:23], s86 offen offset:2048 nt lds
  v_mfma_f32_16x16x32_bf16 v[252:255], a[212:215], v[116:119], v[252:255]
  v_mfma_f32_16x16x32_bf16 v[252:255], a[216:219], v[120:123], v[252:255]
  v_mfma_f32_16x16x32_bf16 v[252:255], a[220:223], v[124:127], v[252:255]
  v_accvgpr_read_b32 v40, a76
  s_waitcnt lgkmcnt(0)
  v_mfma_f32_16x16x32_bf16 a[128:131], a[192:195], v[128:131], a[128:131]
  buffer_load_dwordx4 v6, s[20:23], s86 offen offset:3072 nt lds
  v_mfma_f32_16x16x32_bf16 a[128:131], a[196:199], v[160:163], a[128:131]
  ds_read_b64_tr_b16 a[208:209], v14 offset:16384
  ds_read_b64_tr_b16 a[210:211], v14 offset:20480
  v_accvgpr_read_b32 v41, a77
  v_mfma_f32_16x16x32_bf16 a[160:163], a[192:195], v[136:139], a[160:163]
  v_mfma_f32_16x16x32_bf16 a[160:163], a[196:199], v[168:171], a[160:163]
  ds_read_b64_tr_b16 a[212:213], v14 offset:24576
  ds_read_b64_tr_b16 a[214:215], v14 offset:28672
  v_exp_f32 v192, v192
  v_exp_f32 v193, v193
  v_exp_f32 v194, v194
  v_accvgpr_read_b32 v42, a78
  v_mfma_f32_16x16x32_bf16 a[244:247], a[192:195], v[144:147], a[244:247]
  v_mfma_f32_16x16x32_bf16 a[244:247], a[196:199], v[176:179], a[244:247]
  ds_read_b64_tr_b16 a[216:217], v15 offset:16384
  ds_read_b64_tr_b16 a[218:219], v15 offset:20480
  v_exp_f32 v195, v195
  v_accvgpr_read_b32 v43, a79
  v_mfma_f32_16x16x32_bf16 a[20:23], a[192:195], v[152:155], a[20:23]
  v_mfma_f32_16x16x32_bf16 a[20:23], a[196:199], v[184:187], a[20:23]
  ds_read_b64_tr_b16 a[220:221], v15 offset:24576
  ds_read_b64_tr_b16 a[222:223], v15 offset:28672
  v_cvt_pk_bf16_f32 v192, v192, v193
  v_mfma_f32_16x16x32_bf16 a[132:135], a[200:203], v[128:131], a[132:135]
  v_mfma_f32_16x16x32_bf16 a[132:135], a[204:207], v[160:163], a[132:135]
  v_exp_f32 v196, v196
  v_exp_f32 v197, v197
  v_mfma_f32_16x16x32_bf16 a[224:227], a[240:243], v[128:131], a[224:227]
  v_cvt_pk_bf16_f32 v193, v194, v195
  v_exp_f32 v198, v198
  v_mfma_f32_16x16x32_bf16 a[224:227], a[240:243], v[160:163], a[224:227]
  v_exp_f32 v199, v199
  v_mfma_f32_16x16x32_bf16 a[164:167], a[200:203], v[136:139], a[164:167]
  ds_write_b64 v34, v[36:37] offset:8192
  v_mfma_f32_16x16x32_bf16 a[164:167], a[204:207], v[168:171], a[164:167]
  v_cvt_pk_bf16_f32 v194, v196, v197
  v_exp_f32 v224, v224
  v_mfma_f32_16x16x32_bf16 a[248:251], a[200:203], v[144:147], a[248:251]
  v_mfma_f32_16x16x32_bf16 a[248:251], a[204:207], v[176:179], a[248:251]
  v_exp_f32 v225, v225
  v_cvt_pk_bf16_f32 v195, v198, v199
  v_mfma_f32_16x16x32_bf16 a[24:27], a[200:203], v[152:155], a[24:27]
  v_mfma_f32_16x16x32_bf16 a[24:27], a[204:207], v[184:187], a[24:27]
  v_exp_f32 v226, v226
  v_mul_f32 v40, v40, v30
  s_waitcnt lgkmcnt(1)
  v_mfma_f32_16x16x32_bf16 a[136:139], a[208:211], v[128:131], a[136:139]
  v_mfma_f32_16x16x32_bf16 a[136:139], a[212:215], v[160:163], a[136:139]
  ds_read_b64_tr_b16 a[192:193], v16 offset:16384
  ds_read_b64_tr_b16 a[194:195], v16 offset:20480
  v_exp_f32 v227, v227
  v_mul_f32 v41, v41, v30
  v_mfma_f32_16x16x32_bf16 a[168:171], a[208:211], v[136:139], a[168:171]
  v_mfma_f32_16x16x32_bf16 a[168:171], a[212:215], v[168:171], a[168:171]
  ds_read_b64_tr_b16 a[196:197], v16 offset:24576
  ds_read_b64_tr_b16 a[198:199], v16 offset:28672
  v_cvt_pk_bf16_f32 v224, v224, v225
  v_mul_f32 v42, v42, v30
  v_mfma_f32_16x16x32_bf16 a[252:255], a[208:211], v[144:147], a[252:255]
  v_mfma_f32_16x16x32_bf16 a[252:255], a[212:215], v[176:179], a[252:255]
  ds_read_b64_tr_b16 a[200:201], v17 offset:16384
  ds_read_b64_tr_b16 a[202:203], v17 offset:20480
  v_exp_f32 v228, v228
  v_mfma_f32_16x16x32_bf16 a[28:31], a[208:211], v[152:155], a[28:31]
  v_mfma_f32_16x16x32_bf16 a[28:31], a[212:215], v[184:187], a[28:31]
  ds_read_b64_tr_b16 a[204:205], v17 offset:24576
  ds_read_b64_tr_b16 a[206:207], v17 offset:28672
  v_exp_f32 v229, v229
  v_mul_f32 v43, v43, v30
  v_mfma_f32_16x16x32_bf16 a[140:143], a[216:219], v[128:131], a[140:143]
  v_mfma_f32_16x16x32_bf16 a[140:143], a[220:223], v[160:163], a[140:143]
  v_cvt_pk_bf16_f32 v225, v226, v227
  v_exp_f32 v230, v230
  v_cvt_pk_bf16_f32 v40, v40, v41
  v_mfma_f32_16x16x32_bf16 a[228:231], a[240:243], v[136:139], a[228:231]
  v_exp_f32 v231, v231
  v_mfma_f32_16x16x32_bf16 a[228:231], a[240:243], v[168:171], a[228:231]
  v_cvt_pk_bf16_f32 v226, v228, v229
  v_exp_f32 v200, v200
  v_mfma_f32_16x16x32_bf16 a[172:175], a[216:219], v[136:139], a[172:175]
  v_mfma_f32_16x16x32_bf16 a[172:175], a[220:223], v[168:171], a[172:175]
  v_exp_f32 v201, v201
  v_cvt_pk_bf16_f32 v227, v230, v231
  v_cvt_pk_bf16_f32 v41, v42, v43
  v_mfma_f32_16x16x32_bf16 a[0:3], a[216:219], v[144:147], a[0:3]
  v_mfma_f32_16x16x32_bf16 a[0:3], a[220:223], v[176:179], a[0:3]
  v_exp_f32 v202, v202
  v_exp_f32 v203, v203
  v_accvgpr_read_b32 v36, a80
  v_mfma_f32_16x16x32_bf16 a[32:35], a[216:219], v[152:155], a[32:35]
  v_mfma_f32_16x16x32_bf16 a[32:35], a[220:223], v[184:187], a[32:35]
  v_cvt_pk_bf16_f32 v200, v200, v201
  s_waitcnt lgkmcnt(0)
  v_mfma_f32_16x16x32_bf16 a[144:147], a[192:195], v[128:131], a[144:147]
  v_mfma_f32_16x16x32_bf16 a[144:147], a[196:199], v[160:163], a[144:147]
  ds_read_b64_tr_b16 a[208:209], v18 offset:16384
  ds_read_b64_tr_b16 a[210:211], v18 offset:20480
  v_exp_f32 v204, v204
  v_accvgpr_read_b32 v37, a81
  v_mfma_f32_16x16x32_bf16 a[176:179], a[192:195], v[136:139], a[176:179]
  v_mfma_f32_16x16x32_bf16 a[176:179], a[196:199], v[168:171], a[176:179]
  ds_read_b64_tr_b16 a[212:213], v18 offset:24576
  ds_read_b64_tr_b16 a[214:215], v18 offset:28672
  v_exp_f32 v205, v205
  v_accvgpr_read_b32 v38, a82
  v_mfma_f32_16x16x32_bf16 a[4:7], a[192:195], v[144:147], a[4:7]
  v_mfma_f32_16x16x32_bf16 a[4:7], a[196:199], v[176:179], a[4:7]
  ds_read_b64_tr_b16 a[216:217], v19 offset:16384
  ds_read_b64_tr_b16 a[218:219], v19 offset:20480
  v_cvt_pk_bf16_f32 v201, v202, v203
  v_accvgpr_read_b32 v39, a83
  v_mfma_f32_16x16x32_bf16 a[36:39], a[192:195], v[152:155], a[36:39]
  v_mfma_f32_16x16x32_bf16 a[36:39], a[196:199], v[184:187], a[36:39]
  ds_read_b64_tr_b16 a[220:221], v19 offset:24576
  ds_read_b64_tr_b16 a[222:223], v19 offset:28672
  v_exp_f32 v206, v206
  v_mfma_f32_16x16x32_bf16 a[148:151], a[200:203], v[128:131], a[148:151]
  v_mfma_f32_16x16x32_bf16 a[148:151], a[204:207], v[160:163], a[148:151]
  v_exp_f32 v207, v207
  v_cvt_pk_bf16_f32 v202, v204, v205
  v_mfma_f32_16x16x32_bf16 a[232:235], a[240:243], v[144:147], a[232:235]
  v_exp_f32 v232, v232
  v_mfma_f32_16x16x32_bf16 a[232:235], a[240:243], v[176:179], a[232:235]
  v_exp_f32 v233, v233
  v_mfma_f32_16x16x32_bf16 a[180:183], a[200:203], v[136:139], a[180:183]
  ds_write_b64 v35, v[40:41] offset:8192
  v_mfma_f32_16x16x32_bf16 a[180:183], a[204:207], v[168:171], a[180:183]
  v_cvt_pk_bf16_f32 v203, v206, v207
  v_exp_f32 v234, v234
  v_mfma_f32_16x16x32_bf16 a[8:11], a[200:203], v[144:147], a[8:11]
  s_waitcnt vmcnt(12)
  s_barrier
  v_mfma_f32_16x16x32_bf16 a[8:11], a[204:207], v[176:179], a[8:11]
  s_add_u32 m0, s44, 32768
  v_exp_f32 v235, v235
  v_mfma_f32_16x16x32_bf16 a[40:43], a[200:203], v[152:155], a[40:43]
  v_mfma_f32_16x16x32_bf16 a[40:43], a[204:207], v[184:187], a[40:43]
  v_cvt_pk_bf16_f32 v232, v232, v233
  v_exp_f32 v236, v236
  v_mul_f32 v36, v36, v30
  s_waitcnt lgkmcnt(1)
  v_mfma_f32_16x16x32_bf16 a[152:155], a[208:211], v[128:131], a[152:155]
  buffer_load_dwordx4 v1, s[16:19], s88 offen offset:0 nt lds
L_pad7:
  s_cbranch_execz L_padret
  v_mfma_f32_16x16x32_bf16 a[152:155], a[212:215], v[160:163], a[152:155]
  ds_read_b128 a[192:195], v8 offset:0
  v_mul_f32 v37, v37, v30
  v_mfma_f32_16x16x32_bf16 a[184:187], a[208:211], v[136:139], a[184:187]
  v_mfma_f32_16x16x32_bf16 a[184:187], a[212:215], v[168:171], a[184:187]
  ds_read_b128 a[196:199], v9 offset:0
  v_exp_f32 v237, v237
  v_mul_f32 v38, v38, v30
  v_mfma_f32_16x16x32_bf16 a[12:15], a[208:211], v[144:147], a[12:15]
  v_mfma_f32_16x16x32_bf16 a[12:15], a[212:215], v[176:179], a[12:15]
  ds_read_b128 a[200:203], v10 offset:0
  v_cvt_pk_bf16_f32 v233, v234, v235
  v_exp_f32 v238, v238
  v_mfma_f32_16x16x32_bf16 a[44:47], a[208:211], v[152:155], a[44:47]
  buffer_load_dwordx4 v2, s[16:19], s88 offen offset:1024 nt lds
  v_mfma_f32_16x16x32_bf16 a[44:47], a[212:215], v[184:187], a[44:47]
  ds_read_b128 a[204:207], v11 offset:0
  v_mul_f32 v39, v39, v30
  v_mfma_f32_16x16x32_bf16 a[156:159], a[216:219], v[128:131], a[156:159]
  v_mfma_f32_16x16x32_bf16 a[156:159], a[220:223], v[160:163], a[156:159]
  v_exp_f32 v239, v239
  v_cvt_pk_bf16_f32 v234, v236, v237
  v_cvt_pk_bf16_f32 v36, v36, v37
  v_mfma_f32_16x16x32_bf16 a[236:239], a[240:243], v[152:155], a[236:239]
  v_exp_f32 v208, v208
  v_mfma_f32_16x16x32_bf16 a[236:239], a[240:243], v[184:187], a[236:239]
  v_exp_f32 v209, v209
  v_cvt_pk_bf16_f32 v235, v238, v239
  v_mfma_f32_16x16x32_bf16 a[188:191], a[216:219], v[136:139], a[188:191]
  v_mfma_f32_16x16x32_bf16 a[188:191], a[220:223], v[168:171], a[188:191]
  v_exp_f32 v210, v210
  v_exp_f32 v211, v211
  v_cvt_pk_bf16_f32 v37, v38, v39
  v_mfma_f32_16x16x32_bf16 a[16:19], a[216:219], v[144:147], a[16:19]
  buffer_load_dwordx4 v3, s[16:19], s88 offen offset:2048 nt lds
  v_mfma_f32_16x16x32_bf16 a[16:19], a[220:223], v[176:179], a[16:19]
  v_cvt_pk_bf16_f32 v208, v208, v209
  v_exp_f32 v212, v212
  v_mfma_f32_16x16x32_bf16 v[48:51], a[216:219], v[152:155], v[48:51]
  v_mfma_f32_16x16x32_bf16 v[48:51], a[220:223], v[184:187], v[48:51]
  v_exp_f32 v213, v213
  s_waitcnt lgkmcnt(0)
  v_mfma_f32_16x16x32_bf16 v[128:131], a[192:195], v[64:67], v[20:23]
  buffer_load_dwordx4 v4, s[16:19], s88 offen offset:3072 nt lds
  ds_write_b64 v32, v[36:37] offset:8320
  v_mfma_f32_16x16x32_bf16 v[128:131], a[196:199], v[68:71], v[128:131]
  ds_read_b128 a[208:211], v8 offset:4096
  v_mfma_f32_16x16x32_bf16 v[128:131], a[200:203], v[72:75], v[128:131]
  v_mfma_f32_16x16x32_bf16 v[128:131], a[204:207], v[76:79], v[128:131]
  s_waitcnt lgkmcnt(1)
  v_cvt_pk_bf16_f32 v209, v210, v211
  v_exp_f32 v214, v214
  v_mfma_f32_16x16x32_bf16 v[136:139], a[192:195], v[80:83], v[52:55]
  ds_read_b128 a[212:215], v9 offset:4096
  v_mfma_f32_16x16x32_bf16 v[136:139], a[196:199], v[84:87], v[136:139]
  ds_read_b128 a[68:71], v46 offset:5120
  v_mfma_f32_16x16x32_bf16 v[136:139], a[200:203], v[88:91], v[136:139]
  v_mfma_f32_16x16x32_bf16 v[136:139], a[204:207], v[92:95], v[136:139]
  ds_read_b128 a[216:219], v10 offset:4096
  v_exp_f32 v215, v215
  v_cvt_pk_bf16_f32 v210, v212, v213
  v_exp_f32 v240, v240
  v_mfma_f32_16x16x32_bf16 v[144:147], a[192:195], v[96:99], v[56:59]
  ds_read_b128 a[76:79], v46 offset:7168
  v_mfma_f32_16x16x32_bf16 v[144:147], a[196:199], v[100:103], v[144:147]
  v_mfma_f32_16x16x32_bf16 v[144:147], a[200:203], v[104:107], v[144:147]
  ds_read_b128 a[220:223], v11 offset:4096
  v_mfma_f32_16x16x32_bf16 v[144:147], a[204:207], v[108:111], v[144:147]
  v_exp_f32 v241, v241
  v_cvt_pk_bf16_f32 v211, v214, v215
  v_exp_f32 v242, v242
  v_mfma_f32_16x16x32_bf16 v[152:155], a[192:195], v[112:115], v[60:63]
  v_mfma_f32_16x16x32_bf16 v[152:155], a[196:199], v[116:119], v[152:155]
  v_mfma_f32_16x16x32_bf16 v[152:155], a[200:203], v[120:123], v[152:155]
  v_mfma_f32_16x16x32_bf16 v[152:155], a[204:207], v[124:127], v[152:155]
  v_exp_f32 v243, v243
  v_cvt_pk_bf16_f32 v240, v240, v241
  v_exp_f32 v244, v244
  v_exp_f32 v245, v245
  v_xor_b32 v46, 64, v46
  s_waitcnt lgkmcnt(0)
  v_mfma_f32_16x16x32_bf16 v[132:135], a[208:211], v[64:67], v[20:23]
  ds_read_b128 a[64:67], v46 offset:4096
  ds_read_b128 a[72:75], v46 offset:6144
  v_mfma_f32_16x16x32_bf16 v[132:135], a[212:215], v[68:71], v[132:135]
  ds_read_b128 a[192:195], v8 offset:8192
  v_mfma_f32_16x16x32_bf16 v[132:135], a[216:219], v[72:75], v[132:135]
  v_mfma_f32_16x16x32_bf16 v[132:135], a[220:223], v[76:79], v[132:135]
  v_cvt_pk_bf16_f32 v241, v242, v243
  v_exp_f32 v246, v246
  v_exp_f32 v247, v247
  v_cvt_pk_bf16_f32 v242, v244, v245
  v_mfma_f32_16x16x32_bf16 v[140:143], a[208:211], v[80:83], v[52:55]
  ds_read_b128 a[196:199], v9 offset:8192
  v_mfma_f32_16x16x32_bf16 v[140:143], a[212:215], v[84:87], v[140:143]
  v_mfma_f32_16x16x32_bf16 v[140:143], a[216:219], v[88:91], v[140:143]
  v_mfma_f32_16x16x32_bf16 v[140:143], a[220:223], v[92:95], v[140:143]
  ds_read_b128 a[200:203], v10 offset:8192
  v_exp_f32 v216, v216
  v_exp_f32 v217, v217
  v_cvt_pk_bf16_f32 v243, v246, v247
  v_accvgpr_read_b32 v40, a84
  v_accvgpr_read_b32 v41, a85
  v_mfma_f32_16x16x32_bf16 v[148:151], a[208:211], v[96:99], v[56:59]
  v_mfma_f32_16x16x32_bf16 v[148:151], a[212:215], v[100:103], v[148:151]
  v_mfma_f32_16x16x32_bf16 v[148:151], a[216:219], v[104:107], v[148:151]
  ds_read_b128 a[204:207], v11 offset:8192
  v_mfma_f32_16x16x32_bf16 v[148:151], a[220:223], v[108:111], v[148:151]
  v_exp_f32 v218, v218
  v_exp_f32 v219, v219
  v_cvt_pk_bf16_f32 v216, v216, v217
  v_exp_f32 v220, v220
  v_accvgpr_read_b32 v42, a86
  v_mfma_f32_16x16x32_bf16 v[156:159], a[208:211], v[112:115], v[60:63]
  v_mfma_f32_16x16x32_bf16 v[156:159], a[212:215], v[116:119], v[156:159]
  v_mfma_f32_16x16x32_bf16 v[156:159], a[216:219], v[120:123], v[156:159]
  v_mfma_f32_16x16x32_bf16 v[156:159], a[220:223], v[124:127], v[156:159]
  v_exp_f32 v221, v221
  v_cvt_pk_bf16_f32 v217, v218, v219
  v_exp_f32 v222, v222
  v_accvgpr_read_b32 v43, a87
  v_mul_f32 v40, v40, v30
  s_waitcnt lgkmcnt(0)
  v_mfma_f32_16x16x32_bf16 v[160:163], a[192:195], v[64:67], v[20:23]
  v_mfma_f32_16x16x32_bf16 v[160:163], a[196:199], v[68:71], v[160:163]
  ds_read_b128 a[208:211], v8 offset:12288
  v_mfma_f32_16x16x32_bf16 v[160:163], a[200:203], v[72:75], v[160:163]
  v_mfma_f32_16x16x32_bf16 v[160:163], a[204:207], v[76:79], v[160:163]
  v_exp_f32 v223, v223
  v_cvt_pk_bf16_f32 v218, v220, v221
  v_exp_f32 v248, v248
  v_exp_f32 v249, v249
  v_mul_f32 v41, v41, v30
  v_mul_f32 v42, v42, v30
  v_mfma_f32_16x16x32_bf16 v[168:171], a[192:195], v[80:83], v[52:55]
  ds_read_b128 a[212:215], v9 offset:12288
  v_mfma_f32_16x16x32_bf16 v[168:171], a[196:199], v[84:87], v[168:171]
  v_mfma_f32_16x16x32_bf16 v[168:171], a[200:203], v[88:91], v[168:171]
  v_mfma_f32_16x16x32_bf16 v[168:171], a[204:207], v[92:95], v[168:171]
  ds_read_b128 a[216:219], v10 offset:12288
  v_cvt_pk_bf16_f32 v219, v222, v223
  v_exp_f32 v250, v250
  v_exp_f32 v251, v251
  v_mul_f32 v43, v43, v30
  v_mfma_f32_16x16x32_bf16 v[176:179], a[192:195], v[96:99], v[56:59]
  v_mfma_f32_16x16x32_bf16 v[176:179], a[196:199], v[100:103], v[176:179]
  v_mfma_f32_16x16x32_bf16 v[176:179], a[200:203], v[104:107], v[176:179]
  ds_read_b128 a[220:223], v11 offset:12288
  v_mfma_f32_16x16x32_bf16 v[176:179], a[204:207], v[108:111], v[176:179]
  v_cvt_pk_bf16_f32 v248, v248, v249
  v_exp_f32 v252, v252
  v_exp_f32 v253, v253
  v_cvt_pk_bf16_f32 v249, v250, v251
  v_cvt_pk_bf16_f32 v40, v40, v41
  v_cvt_pk_bf16_f32 v41, v42, v43
  v_mfma_f32_16x16x32_bf16 v[184:187], a[192:195], v[112:115], v[60:63]
  s_waitcnt vmcnt(12)
  s_barrier
  v_mfma_f32_16x16x32_bf16 v[184:187], a[196:199], v[116:119], v[184:187]
  s_add_u32 m0, s44, 65536
  v_mfma_f32_16x16x32_bf16 v[184:187], a[200:203], v[120:123], v[184:187]
  v_mfma_f32_16x16x32_bf16 v[184:187], a[204:207], v[124:127], v[184:187]
  v_exp_f32 v254, v254
  v_exp_f32 v255, v255
  v_accvgpr_read_b32 v36, a88
  s_waitcnt lgkmcnt(0)
  v_mfma_f32_16x16x32_bf16 v[164:167], a[208:211], v[64:67], v[20:23]
  buffer_load_dwordx4 v5, s[20:23], s87 offen offset:0 nt lds
  v_mfma_f32_16x16x32_bf16 v[164:167], a[212:215], v[68:71], v[164:167]
  ds_read_b64_tr_b16 a[192:193], v12 offset:32768
  ds_read_b64_tr_b16 a[194:195], v12 offset:36864
  v_mfma_f32_16x16x32_bf16 v[164:167], a[216:219], v[72:75], v[164:167]
  v_mfma_f32_16x16x32_bf16 v[164:167], a[220:223], v[76:79], v[164:167]
  v_cvt_pk_bf16_f32 v250, v252, v253
  v_cvt_pk_bf16_f32 v251, v254, v255
  v_accvgpr_read_b32 v37, a89
  v_accvgpr_read_b32 v38, a90
  v_mfma_f32_16x16x32_bf16 v[172:175], a[208:211], v[80:83], v[52:55]
  ds_read_b64_tr_b16 a[196:197], v12 offset:40960
  ds_read_b64_tr_b16 a[198:199], v12 offset:45056
  v_mfma_f32_16x16x32_bf16 v[172:175], a[212:215], v[84:87], v[172:175]
  v_mfma_f32_16x16x32_bf16 v[172:175], a[216:219], v[88:91], v[172:175]
  buffer_load_dwordx4 v6, s[20:23], s87 offen offset:1024 nt lds
  v_mfma_f32_16x16x32_bf16 v[172:175], a[220:223], v[92:95], v[172:175]
  ds_read_b64_tr_b16 a[200:201], v13 offset:32768
  ds_read_b64_tr_b16 a[202:203], v13 offset:36864
  v_accvgpr_read_b32 v39, a91
  v_mfma_f32_16x16x32_bf16 v[180:183], a[208:211], v[96:99], v[56:59]
  v_mfma_f32_16x16x32_bf16 v[180:183], a[212:215], v[100:103], v[180:183]
  v_mfma_f32_16x16x32_bf16 v[180:183], a[216:219], v[104:107], v[180:183]
  ds_read_b64_tr_b16 a[204:205], v13 offset:40960
  ds_read_b64_tr_b16 a[206:207], v13 offset:45056
  v_mfma_f32_16x16x32_bf16 v[180:183], a[220:223], v[108:111], v[180:183]
  ds_write_b64 v33, v[40:41] offset:8320
  v_mfma_f32_16x16x32_bf16 v[188:191], a[208:211], v[112:115], v[60:63]
  buffer_load_dwordx4 v5, s[20:23], s87 offen offset:2048 nt lds
  v_mfma_f32_16x16x32_bf16 v[188:191], a[212:215], v[116:119], v[188:191]
  v_mfma_f32_16x16x32_bf16 v[188:191], a[216:219], v[120:123], v[188:191]
  v_mfma_f32_16x16x32_bf16 v[188:191], a[220:223], v[124:127], v[188:191]
  v_mul_f32 v36, v36, v30
  s_waitcnt lgkmcnt(1)
  v_mfma_f32_16x16x32_bf16 a[128:131], a[192:195], v[192:195], a[128:131]
  buffer_load_dwordx4 v6, s[20:23], s87 offen offset:3072 nt lds
  v_mfma_f32_16x16x32_bf16 a[128:131], a[196:199], v[224:227], a[128:131]
  ds_read_b64_tr_b16 a[208:209], v14 offset:32768
  ds_read_b64_tr_b16 a[210:211], v14 offset:36864
  v_mfma_f32_16x16x32_bf16 a[160:163], a[192:195], v[200:203], a[160:163]
  v_mfma_f32_16x16x32_bf16 a[160:163], a[196:199], v[232:235], a[160:163]
  v_exp_f32 v128, v128
  v_exp_f32 v129, v129
  v_exp_f32 v130, v130
  v_exp_f32 v131, v131
  v_cvt_pk_bf16_f32 v128, v128, v129
  v_exp_f32 v132, v132
  v_mul_f32 v37, v37, v30
  v_mfma_f32_16x16x32_bf16 a[244:247], a[192:195], v[208:211], a[244:247]
  ds_read_b64_tr_b16 a[212:213], v14 offset:40960
  ds_read_b64_tr_b16 a[214:215], v14 offset:45056
  v_mfma_f32_16x16x32_bf16 a[244:247], a[196:199], v[240:243], a[244:247]
  v_exp_f32 v133, v133
  v_mul_f32 v38, v38, v30
  v_mfma_f32_16x16x32_bf16 a[20:23], a[192:195], v[216:219], a[20:23]
  v_mfma_f32_16x16x32_bf16 a[20:23], a[196:199], v[248:251], a[20:23]
  ds_read_b64_tr_b16 a[216:217], v15 offset:32768
  ds_read_b64_tr_b16 a[218:219], v15 offset:36864
  v_cvt_pk_bf16_f32 v129, v130, v131
  v_mfma_f32_16x16x32_bf16 a[132:135], a[200:203], v[192:195], a[132:135]
  v_mfma_f32_16x16x32_bf16 a[132:135], a[204:207], v[224:227], a[132:135]
  v_exp_f32 v134, v134
  v_exp_f32 v135, v135
  v_mul_f32 v39, v39, v30
  v_mfma_f32_16x16x32_bf16 a[224:227], a[240:243], v[192:195], a[224:227]
  v_cvt_pk_bf16_f32 v130, v132, v133
  v_cvt_pk_bf16_f32 v36, v36, v37
  v_mfma_f32_16x16x32_bf16 a[224:227], a[240:243], v[224:227], a[224:227]
  v_exp_f32 v160, v160
  v_mfma_f32_16x16x32_bf16 a[164:167], a[200:203], v[200:203], a[164:167]
  ds_read_b64_tr_b16 a[220:221], v15 offset:40960
  ds_read_b64_tr_b16 a[222:223], v15 offset:45056
  v_mfma_f32_16x16x32_bf16 a[164:167], a[204:207], v[232:235], a[164:167]
  v_exp_f32 v161, v161
  v_mfma_f32_16x16x32_bf16 a[248:251], a[200:203], v[208:211], a[248:251]
  v_mfma_f32_16x16x32_bf16 a[248:251], a[204:207], v[240:243], a[248:251]
  v_cvt_pk_bf16_f32 v131, v134, v135
  v_exp_f32 v162, v162
  v_cvt_pk_bf16_f32 v37, v38, v39
  v_mfma_f32_16x16x32_bf16 a[24:27], a[200:203], v[216:219], a[24:27]
  v_mfma_f32_16x16x32_bf16 a[24:27], a[204:207], v[248:251], a[24:27]
  v_exp_f32 v163, v163
  v_cvt_pk_bf16_f32 v160, v160, v161
  s_waitcnt lgkmcnt(0)
  v_mfma_f32_16x16x32_bf16 a[136:139], a[208:211], v[192:195], a[136:139]
  v_mfma_f32_16x16x32_bf16 a[136:139], a[212:215], v[224:227], a[136:139]
  ds_read_b64_tr_b16 a[192:193], v16 offset:32768
  ds_read_b64_tr_b16 a[194:195], v16 offset:36864
  v_exp_f32 v164, v164
  v_accvgpr_read_b32 v40, a92
  v_mfma_f32_16x16x32_bf16 a[168:171], a[208:211], v[200:203], a[168:171]
  v_mfma_f32_16x16x32_bf16 a[168:171], a[212:215], v[232:235], a[168:171]
  v_exp_f32 v165, v165
  v_cvt_pk_bf16_f32 v161, v162, v163
  v_accvgpr_read_b32 v41, a93
  v_mfma_f32_16x16x32_bf16 a[252:255], a[208:211], v[208:211], a[252:255]
  ds_read_b64_tr_b16 a[196:197], v16 offset:40960
  ds_read_b64_tr_b16 a[198:199], v16 offset:45056
  v_mfma_f32_16x16x32_bf16 a[252:255], a[212:215], v[240:243], a[252:255]
  v_exp_f32 v166, v166
  v_accvgpr_read_b32 v42, a94
  v_mfma_f32_16x16x32_bf16 a[28:31], a[208:211], v[216:219], a[28:31]
  v_mfma_f32_16x16x32_bf16 a[28:31], a[212:215], v[248:251], a[28:31]
  ds_read_b64_tr_b16 a[200:201], v17 offset:32768
  ds_read_b64_tr_b16 a[202:203], v17 offset:36864
  v_exp_f32 v167, v167
  v_mfma_f32_16x16x32_bf16 a[140:143], a[216:219], v[192:195], a[140:143]
  v_mfma_f32_16x16x32_bf16 a[140:143], a[220:223], v[224:227], a[140:143]
  v_cvt_pk_bf16_f32 v162, v164, v165
  v_exp_f32 v136, v136
  v_accvgpr_read_b32 v43, a95
  v_mfma_f32_16x16x32_bf16 a[228:231], a[240:243], v[200:203], a[228:231]
  v_exp_f32 v137, v137
  v_mfma_f32_16x16x32_bf16 a[228:231], a[240:243], v[232:235], a[228:231]
  v_cvt_pk_bf16_f32 v163, v166, v167
  v_exp_f32 v138, v138
  v_mfma_f32_16x16x32_bf16 a[172:175], a[216:219], v[200:203], a[172:175]
  ds_read_b64_tr_b16 a[204:205], v17 offset:40960
  ds_read_b64_tr_b16 a[206:207], v17 offset:45056
  v_mfma_f32_16x16x32_bf16 a[172:175], a[220:223], v[232:235], a[172:175]
  v_exp_f32 v139, v139
  v_mfma_f32_16x16x32_bf16 a[0:3], a[216:219], v[208:211], a[0:3]
  v_mfma_f32_16x16x32_bf16 a[0:3], a[220:223], v[240:243], a[0:3]
  ds_write_b64 v34, v[36:37] offset:8320
  v_cvt_pk_bf16_f32 v136, v136, v137
  v_mfma_f32_16x16x32_bf16 a[32:35], a[216:219], v[216:219], a[32:35]
  v_mfma_f32_16x16x32_bf16 a[32:35], a[220:223], v[248:251], a[32:35]
  v_exp_f32 v140, v140
  v_exp_f32 v141, v141
  s_waitcnt lgkmcnt(1)
  v_mfma_f32_16x16x32_bf16 a[144:147], a[192:195], v[192:195], a[144:147]
  v_mfma_f32_16x16x32_bf16 a[144:147], a[196:199], v[224:227], a[144:147]
  ds_read_b64_tr_b16 a[208:209], v18 offset:32768
  ds_read_b64_tr_b16 a[210:211], v18 offset:36864
  v_cvt_pk_bf16_f32 v137, v138, v139
  v_mfma_f32_16x16x32_bf16 a[176:179], a[192:195], v[200:203], a[176:179]
  v_mfma_f32_16x16x32_bf16 a[176:179], a[196:199], v[232:235], a[176:179]
  v_exp_f32 v142, v142
  v_exp_f32 v143, v143
  v_mul_f32 v40, v40, v30
  v_mfma_f32_16x16x32_bf16 a[4:7], a[192:195], v[208:211], a[4:7]
  ds_read_b64_tr_b16 a[212:213], v18 offset:40960
  ds_read_b64_tr_b16 a[214:215], v18 offset:45056
  v_mfma_f32_16x16x32_bf16 a[4:7], a[196:199], v[240:243], a[4:7]
  v_cvt_pk_bf16_f32 v138, v140, v141
  v_mul_f32 v41, v41, v30
  v_mfma_f32_16x16x32_bf16 a[36:39], a[192:195], v[216:219], a[36:39]
  v_mfma_f32_16x16x32_bf16 a[36:39], a[196:199], v[248:251], a[36:39]
  ds_read_b64_tr_b16 a[216:217], v19 offset:32768
  ds_read_b64_tr_b16 a[218:219], v19 offset:36864
  v_exp_f32 v168, v168
  v_mul_f32 v42, v42, v30
  v_mfma_f32_16x16x32_bf16 a[148:151], a[200:203], v[192:195], a[148:151]
  v_mfma_f32_16x16x32_bf16 a[148:151], a[204:207], v[224:227], a[148:151]
  v_exp_f32 v169, v169
  v_cvt_pk_bf16_f32 v139, v142, v143
  v_mfma_f32_16x16x32_bf16 a[232:235], a[240:243], v[208:211], a[232:235]
  v_exp_f32 v170, v170
  v_mfma_f32_16x16x32_bf16 a[232:235], a[240:243], v[240:243], a[232:235]
  v_exp_f32 v171, v171
  v_mfma_f32_16x16x32_bf16 a[180:183], a[200:203], v[200:203], a[180:183]
  ds_read_b64_tr_b16 a[220:221], v19 offset:40960
  ds_read_b64_tr_b16 a[222:223], v19 offset:45056
  v_mfma_f32_16x16x32_bf16 a[180:183], a[204:207], v[232:235], a[180:183]
  v_cvt_pk_bf16_f32 v168, v168, v169
  v_mul_f32 v43, v43, v30
  v_mfma_f32_16x16x32_bf16 a[8:11], a[200:203], v[208:211], a[8:11]
  s_waitcnt vmcnt(12)
  s_barrier
  v_mfma_f32_16x16x32_bf16 a[8:11], a[204:207], v[240:243], a[8:11]
  s_add_u32 m0, s44, 0
  v_cvt_pk_bf16_f32 v40, v40, v41
  v_mfma_f32_16x16x32_bf16 a[40:43], a[200:203], v[216:219], a[40:43]
  v_mfma_f32_16x16x32_bf16 a[40:43], a[204:207], v[248:251], a[40:43]
  v_exp_f32 v172, v172
  v_exp_f32 v173, v173
  v_cvt_pk_bf16_f32 v41, v42, v43
  s_waitcnt lgkmcnt(0)
  v_mfma_f32_16x16x32_bf16 a[152:155], a[208:211], v[192:195], a[152:155]
  buffer_load_dwordx4 v1, s[16:19], s89 offen offset:0 nt lds
  v_mfma_f32_16x16x32_bf16 a[152:155], a[212:215], v[224:227], a[152:155]
  ds_read_b128 a[192:195], v8 offset:16384
  v_accvgpr_read_b32 v36, a96
  v_mfma_f32_16x16x32_bf16 a[184:187], a[208:211], v[200:203], a[184:187]
  v_mfma_f32_16x16x32_bf16 a[184:187], a[212:215], v[232:235], a[184:187]
  v_cvt_pk_bf16_f32 v169, v170, v171
  v_exp_f32 v174, v174
  v_mfma_f32_16x16x32_bf16 a[12:15], a[208:211], v[208:211], a[12:15]
  ds_read_b128 a[196:199], v9 offset:16384
  v_mfma_f32_16x16x32_bf16 a[12:15], a[212:215], v[240:243], a[12:15]
  v_exp_f32 v175, v175
  v_cvt_pk_bf16_f32 v170, v172, v173
  v_accvgpr_read_b32 v37, a97
  v_mfma_f32_16x16x32_bf16 a[44:47], a[208:211], v[216:219], a[44:47]
  buffer_load_dwordx4 v2, s[16:19], s89 offen offset:1024 nt lds
  v_mfma_f32_16x16x32_bf16 a[44:47], a[212:215], v[248:251], a[44:47]
  ds_read_b128 a[200:203], v10 offset:16384
  v_accvgpr_read_b32 v38, a98
  v_mfma_f32_16x16x32_bf16 a[156:159], a[216:219], v[192:195], a[156:159]
  v_mfma_f32_16x16x32_bf16 a[156:159], a[220:223], v[224:227], a[156:159]
  v_exp_f32 v144, v144
  v_exp_f32 v145, v145
  v_mfma_f32_16x16x32_bf16 a[236:239], a[240:243], v[216:219], a[236:239]
  v_cvt_pk_bf16_f32 v171, v174, v175
  v_exp_f32 v146, v146
  v_mfma_f32_16x16x32_bf16 a[236:239], a[240:243], v[248:251], a[236:239]
  v_accvgpr_read_b32 v39, a99
  v_exp_f32 v147, v147
  v_mfma_f32_16x16x32_bf16 a[188:191], a[216:219], v[200:203], a[188:191]
  ds_read_b128 a[204:207], v11 offset:16384
  v_mfma_f32_16x16x32_bf16 a[188:191], a[220:223], v[232:235], a[188:191]
  v_cvt_pk_bf16_f32 v144, v144, v145
  v_exp_f32 v148, v148
  v_mfma_f32_16x16x32_bf16 a[16:19], a[216:219], v[208:211], a[16:19]
  buffer_load_dwordx4 v3, s[16:19], s89 offen offset:2048 nt lds
  v_mfma_f32_16x16x32_bf16 a[16:19], a[220:223], v[240:243], a[16:19]
  v_exp_f32 v149, v149
  v_mfma_f32_16x16x32_bf16 v[48:51], a[216:219], v[216:219], v[48:51]
  v_mfma_f32_16x16x32_bf16 v[48:51], a[220:223], v[248:251], v[48:51]
  v_cvt_pk_bf16_f32 v145, v146, v147
  s_waitcnt lgkmcnt(0)
  v_mfma_f32_16x16x32_bf16 v[192:195], a[192:195], v[64:67], v[20:23]
  buffer_load_dwordx4 v4, s[16:19], s89 offen offset:3072 nt lds
  ds_write_b64 v35, v[40:41] offset:8320
  v_mfma_f32_16x16x32_bf16 v[192:195], a[196:199], v[68:71], v[192:195]
  ds_read_b128 a[208:211], v8 offset:20480
  v_mfma_f32_16x16x32_bf16 v[192:195], a[200:203], v[72:75], v[192:195]
  v_mfma_f32_16x16x32_bf16 v[192:195], a[204:207], v[76:79], v[192:195]
  v_exp_f32 v150, v150
  v_exp_f32 v151, v151
  v_mfma_f32_16x16x32_bf16 v[200:203], a[192:195], v[80:83], v[52:55]
  ds_read_b128 a[212:215], v9 offset:20480
  v_mfma_f32_16x16x32_bf16 v[200:203], a[196:199], v[84:87], v[200:203]
  v_mfma_f32_16x16x32_bf16 v[200:203], a[200:203], v[88:91], v[200:203]
  v_mfma_f32_16x16x32_bf16 v[200:203], a[204:207], v[92:95], v[200:203]
  ds_read_b128 a[216:219], v10 offset:20480
  v_cvt_pk_bf16_f32 v146, v148, v149
  v_exp_f32 v176, v176
  v_exp_f32 v177, v177
  v_mul_f32 v36, v36, v31
  v_mfma_f32_16x16x32_bf16 v[208:211], a[192:195], v[96:99], v[56:59]
  v_mfma_f32_16x16x32_bf16 v[208:211], a[196:199], v[100:103], v[208:211]
  v_mfma_f32_16x16x32_bf16 v[208:211], a[200:203], v[104:107], v[208:211]
  ds_read_b128 a[220:223], v11 offset:20480
  v_mfma_f32_16x16x32_bf16 v[208:211], a[204:207], v[108:111], v[208:211]
  v_cvt_pk_bf16_f32 v147, v150, v151
  v_exp_f32 v178, v178
  v_exp_f32 v179, v179
  v_cvt_pk_bf16_f32 v176, v176, v177
  v_mul_f32 v37, v37, v31
  v_mul_f32 v38, v38, v31
  v_mfma_f32_16x16x32_bf16 v[216:219], a[192:195], v[112:115], v[60:63]
  v_mfma_f32_16x16x32_bf16 v[216:219], a[196:199], v[116:119], v[216:219]
  v_mfma_f32_16x16x32_bf16 v[216:219], a[200:203], v[120:123], v[216:219]
  v_mfma_f32_16x16x32_bf16 v[216:219], a[204:207], v[124:127], v[216:219]
  v_exp_f32 v180, v180
  v_exp_f32 v181, v181
  v_cvt_pk_bf16_f32 v177, v178, v179
  v_exp_f32 v182, v182
  v_mul_f32 v39, v39, v31
  s_waitcnt lgkmcnt(0)
  v_mfma_f32_16x16x32_bf16 v[196:199], a[208:211], v[64:67], v[20:23]
  v_mfma_f32_16x16x32_bf16 v[196:199], a[212:215], v[68:71], v[196:199]
  ds_read_b128 a[192:195], v8 offset:24576
  v_mfma_f32_16x16x32_bf16 v[196:199], a[216:219], v[72:75], v[196:199]
  v_mfma_f32_16x16x32_bf16 v[196:199], a[220:223], v[76:79], v[196:199]
  v_exp_f32 v183, v183
  v_cvt_pk_bf16_f32 v178, v180, v181
  v_exp_f32 v152, v152
  v_cvt_pk_bf16_f32 v36, v36, v37
  v_cvt_pk_bf16_f32 v37, v38, v39
  v_mfma_f32_16x16x32_bf16 v[204:207], a[208:211], v[80:83], v[52:55]
  ds_read_b128 a[196:199], v9 offset:24576
  v_mfma_f32_16x16x32_bf16 v[204:207], a[212:215], v[84:87], v[204:207]
  v_mfma_f32_16x16x32_bf16 v[204:207], a[216:219], v[88:91], v[204:207]
  v_mfma_f32_16x16x32_bf16 v[204:207], a[220:223], v[92:95], v[204:207]
  ds_read_b128 a[200:203], v10 offset:24576
  v_exp_f32 v153, v153
  v_cvt_pk_bf16_f32 v179, v182, v183
  v_exp_f32 v154, v154
  v_accvgpr_read_b32 v40, a100
  v_mfma_f32_16x16x32_bf16 v[212:215], a[208:211], v[96:99], v[56:59]
  v_mfma_f32_16x16x32_bf16 v[212:215], a[212:215], v[100:103], v[212:215]
  v_mfma_f32_16x16x32_bf16 v[212:215], a[216:219], v[104:107], v[212:215]
  ds_read_b128 a[204:207], v11 offset:24576
  v_mfma_f32_16x16x32_bf16 v[212:215], a[220:223], v[108:111], v[212:215]
  v_exp_f32 v155, v155
  v_cvt_pk_bf16_f32 v152, v152, v153
  v_exp_f32 v156, v156
  v_exp_f32 v157, v157
  v_accvgpr_read_b32 v41, a101
  v_accvgpr_read_b32 v42, a102
  v_mfma_f32_16x16x32_bf16 v[220:223], a[208:211], v[112:115], v[60:63]
  v_mfma_f32_16x16x32_bf16 v[220:223], a[212:215], v[116:119], v[220:223]
  v_mfma_f32_16x16x32_bf16 v[220:223], a[216:219], v[120:123], v[220:223]
  v_mfma_f32_16x16x32_bf16 v[220:223], a[220:223], v[124:127], v[220:223]
  v_cvt_pk_bf16_f32 v153, v154, v155
  v_exp_f32 v158, v158
  v_exp_f32 v159, v159
  v_cvt_pk_bf16_f32 v154, v156, v157
  v_accvgpr_read_b32 v43, a103
  s_waitcnt lgkmcnt(0)
  v_mfma_f32_16x16x32_bf16 v[224:227], a[192:195], v[64:67], v[20:23]
  v_mfma_f32_16x16x32_bf16 v[224:227], a[196:199], v[68:71], v[224:227]
  ds_read_b128 a[208:211], v8 offset:28672
  v_mfma_f32_16x16x32_bf16 v[224:227], a[200:203], v[72:75], v[224:227]
  v_mfma_f32_16x16x32_bf16 v[224:227], a[204:207], v[76:79], v[224:227]
  ds_write_b64 v32, v[36:37] offset:12288
  v_exp_f32 v184, v184
  v_exp_f32 v185, v185
  v_cvt_pk_bf16_f32 v155, v158, v159
  v_mfma_f32_16x16x32_bf16 v[232:235], a[192:195], v[80:83], v[52:55]
  ds_read_b128 a[212:215], v9 offset:28672
  v_mfma_f32_16x16x32_bf16 v[232:235], a[196:199], v[84:87], v[232:235]
  v_mfma_f32_16x16x32_bf16 v[232:235], a[200:203], v[88:91], v[232:235]
  v_mfma_f32_16x16x32_bf16 v[232:235], a[204:207], v[92:95], v[232:235]
  ds_read_b128 a[216:219], v10 offset:28672
  v_exp_f32 v186, v186
  v_exp_f32 v187, v187
  v_cvt_pk_bf16_f32 v184, v184, v185
  v_exp_f32 v188, v188
  v_mfma_f32_16x16x32_bf16 v[240:243], a[192:195], v[96:99], v[56:59]
  v_mfma_f32_16x16x32_bf16 v[240:243], a[196:199], v[100:103], v[240:243]
  v_mfma_f32_16x16x32_bf16 v[240:243], a[200:203], v[104:107], v[240:243]
  ds_read_b128 a[220:223], v11 offset:28672
  v_mfma_f32_16x16x32_bf16 v[240:243], a[204:207], v[108:111], v[240:243]
  v_exp_f32 v189, v189
  v_cvt_pk_bf16_f32 v185, v186, v187
  v_exp_f32 v190, v190
  v_mul_f32 v40, v40, v31
  v_mul_f32 v41, v41, v31
  v_mfma_f32_16x16x32_bf16 v[248:251], a[192:195], v[112:115], v[60:63]
  s_waitcnt vmcnt(12)
  s_barrier
  v_mfma_f32_16x16x32_bf16 v[248:251], a[196:199], v[116:119], v[248:251]
  s_add_u32 m0, s44, 81920
  v_mfma_f32_16x16x32_bf16 v[248:251], a[200:203], v[120:123], v[248:251]
  v_mfma_f32_16x16x32_bf16 v[248:251], a[204:207], v[124:127], v[248:251]
  v_exp_f32 v191, v191
  v_cvt_pk_bf16_f32 v186, v188, v189
  v_mul_f32 v42, v42, v31
  s_waitcnt lgkmcnt(0)
  v_mfma_f32_16x16x32_bf16 v[228:231], a[208:211], v[64:67], v[20:23]
  buffer_load_dwordx4 v5, s[20:23], s88 offen offset:0 nt lds
  v_mfma_f32_16x16x32_bf16 v[228:231], a[212:215], v[68:71], v[228:231]
  ds_read_b64_tr_b16 a[192:193], v12 offset:0
  ds_read_b64_tr_b16 a[194:195], v12 offset:4096
  v_mfma_f32_16x16x32_bf16 v[228:231], a[216:219], v[72:75], v[228:231]
  v_mfma_f32_16x16x32_bf16 v[228:231], a[220:223], v[76:79], v[228:231]
  v_cvt_pk_bf16_f32 v187, v190, v191
  v_mul_f32 v43, v43, v31
  v_cvt_pk_bf16_f32 v40, v40, v41
  v_mfma_f32_16x16x32_bf16 v[236:239], a[208:211], v[80:83], v[52:55]
  ds_read_b64_tr_b16 a[196:197], v12 offset:8192
  ds_read_b64_tr_b16 a[198:199], v12 offset:12288
  v_mfma_f32_16x16x32_bf16 v[236:239], a[212:215], v[84:87], v[236:239]
  v_mfma_f32_16x16x32_bf16 v[236:239], a[216:219], v[88:91], v[236:239]
  buffer_load_dwordx4 v6, s[20:23], s88 offen offset:1024 nt lds
  v_mfma_f32_16x16x32_bf16 v[236:239], a[220:223], v[92:95], v[236:239]
  ds_read_b64_tr_b16 a[200:201], v13 offset:0
  ds_read_b64_tr_b16 a[202:203], v13 offset:4096
  v_cvt_pk_bf16_f32 v41, v42, v43
  v_mfma_f32_16x16x32_bf16 v[244:247], a[208:211], v[96:99], v[56:59]
  v_mfma_f32_16x16x32_bf16 v[244:247], a[212:215], v[100:103], v[244:247]
  v_mfma_f32_16x16x32_bf16 v[244:247], a[216:219], v[104:107], v[244:247]
  ds_read_b64_tr_b16 a[204:205], v13 offset:8192
  ds_read_b64_tr_b16 a[206:207], v13 offset:12288
  v_mfma_f32_16x16x32_bf16 v[244:247], a[220:223], v[108:111], v[244:247]
  v_accvgpr_read_b32 v36, a104
  v_accvgpr_read_b32 v37, a105
  v_mfma_f32_16x16x32_bf16 v[252:255], a[208:211], v[112:115], v[60:63]
  buffer_load_dwordx4 v5, s[20:23], s88 offen offset:2048 nt lds
  v_mfma_f32_16x16x32_bf16 v[252:255], a[212:215], v[116:119], v[252:255]
  v_mfma_f32_16x16x32_bf16 v[252:255], a[216:219], v[120:123], v[252:255]
  v_mfma_f32_16x16x32_bf16 v[252:255], a[220:223], v[124:127], v[252:255]
  v_accvgpr_read_b32 v38, a106
  s_waitcnt lgkmcnt(0)
  v_mfma_f32_16x16x32_bf16 a[128:131], a[192:195], v[128:131], a[128:131]
  buffer_load_dwordx4 v6, s[20:23], s88 offen offset:3072 nt lds
  v_mfma_f32_16x16x32_bf16 a[128:131], a[196:199], v[160:163], a[128:131]
  ds_read_b64_tr_b16 a[208:209], v14 offset:0
  ds_read_b64_tr_b16 a[210:211], v14 offset:4096
  v_accvgpr_read_b32 v39, a107
  v_mfma_f32_16x16x32_bf16 a[160:163], a[192:195], v[136:139], a[160:163]
  v_mfma_f32_16x16x32_bf16 a[160:163], a[196:199], v[168:171], a[160:163]
  v_exp_f32 v192, v192
  v_exp_f32 v193, v193
  v_exp_f32 v194, v194
  v_exp_f32 v195, v195
  v_cvt_pk_bf16_f32 v192, v192, v193
  v_exp_f32 v196, v196
  v_mfma_f32_16x16x32_bf16 a[244:247], a[192:195], v[144:147], a[244:247]
  ds_read_b64_tr_b16 a[212:213], v14 offset:8192
  ds_read_b64_tr_b16 a[214:215], v14 offset:12288
  v_mfma_f32_16x16x32_bf16 a[244:247], a[196:199], v[176:179], a[244:247]
  v_exp_f32 v197, v197
  v_mfma_f32_16x16x32_bf16 a[20:23], a[192:195], v[152:155], a[20:23]
  v_mfma_f32_16x16x32_bf16 a[20:23], a[196:199], v[184:187], a[20:23]
  ds_read_b64_tr_b16 a[216:217], v15 offset:0
  ds_read_b64_tr_b16 a[218:219], v15 offset:4096
  ds_write_b64 v33, v[40:41] offset:12288
  v_cvt_pk_bf16_f32 v193, v194, v195
  v_mfma_f32_16x16x32_bf16 a[132:135], a[200:203], v[128:131], a[132:135]
  v_mfma_f32_16x16x32_bf16 a[132:135], a[204:207], v[160:163], a[132:135]
  v_exp_f32 v198, v198
  v_exp_f32 v199, v199
  v_mfma_f32_16x16x32_bf16 a[224:227], a[240:243], v[128:131], a[224:227]
  v_cvt_pk_bf16_f32 v194, v196, v197
  v_mul_f32 v36, v36, v31
  v_mfma_f32_16x16x32_bf16 a[224:227], a[240:243], v[160:163], a[224:227]
  v_exp_f32 v224, v224
  v_mfma_f32_16x16x32_bf16 a[164:167], a[200:203], v[136:139], a[164:167]
  ds_read_b64_tr_b16 a[220:221], v15 offset:8192
  ds_read_b64_tr_b16 a[222:223], v15 offset:12288
  v_mfma_f32_16x16x32_bf16 a[164:167], a[204:207], v[168:171], a[164:167]
  v_exp_f32 v225, v225
  v_mfma_f32_16x16x32_bf16 a[248:251], a[200:203], v[144:147], a[248:251]
  v_mfma_f32_16x16x32_bf16 a[248:251], a[204:207], v[176:179], a[248:251]
  v_cvt_pk_bf16_f32 v195, v198, v199
  v_exp_f32 v226, v226
  v_mfma_f32_16x16x32_bf16 a[24:27], a[200:203], v[152:155], a[24:27]
  v_mfma_f32_16x16x32_bf16 a[24:27], a[204:207], v[184:187], a[24:27]
L_pad8:
  s_cbranch_execz L_padret
  v_exp_f32 v227, v227
  v_cvt_pk_bf16_f32 v224, v224, v225
  v_mul_f32 v37, v37, v31
  s_waitcnt lgkmcnt(0)
  v_mfma_f32_16x16x32_bf16 a[136:139], a[208:211], v[128:131], a[136:139]
  v_mfma_f32_16x16x32_bf16 a[136:139], a[212:215], v[160:163], a[136:139]
  ds_read_b64_tr_b16 a[192:193], v16 offset:0
  ds_read_b64_tr_b16 a[194:195], v16 offset:4096
  v_exp_f32 v228, v228
  v_mul_f32 v38, v38, v31
  v_mfma_f32_16x16x32_bf16 a[168:171], a[208:211], v[136:139], a[168:171]
  v_mfma_f32_16x16x32_bf16 a[168:171], a[212:215], v[168:171], a[168:171]
  v_exp_f32 v229, v229
  v_cvt_pk_bf16_f32 v225, v226, v227
  v_mfma_f32_16x16x32_bf16 a[252:255], a[208:211], v[144:147], a[252:255]
  ds_read_b64_tr_b16 a[196:197], v16 offset:8192
  ds_read_b64_tr_b16 a[198:199], v16 offset:12288
  v_mfma_f32_16x16x32_bf16 a[252:255], a[212:215], v[176:179], a[252:255]
  v_exp_f32 v230, v230
  v_mul_f32 v39, v39, v31
  v_mfma_f32_16x16x32_bf16 a[28:31], a[208:211], v[152:155], a[28:31]
  v_mfma_f32_16x16x32_bf16 a[28:31], a[212:215], v[184:187], a[28:31]
  ds_read_b64_tr_b16 a[200:201], v17 offset:0
  ds_read_b64_tr_b16 a[202:203], v17 offset:4096
  v_exp_f32 v231, v231
  v_cvt_pk_bf16_f32 v36, v36, v37
  v_mfma_f32_16x16x32_bf16 a[140:143], a[216:219], v[128:131], a[140:143]
  v_mfma_f32_16x16x32_bf16 a[140:143], a[220:223], v[160:163], a[140:143]
  v_cvt_pk_bf16_f32 v226, v228, v229
  v_exp_f32 v200, v200
  v_mfma_f32_16x16x32_bf16 a[228:231], a[240:243], v[136:139], a[228:231]
  v_exp_f32 v201, v201
  v_mfma_f32_16x16x32_bf16 a[228:231], a[240:243], v[168:171], a[228:231]
  v_cvt_pk_bf16_f32 v227, v230, v231
  v_cvt_pk_bf16_f32 v37, v38, v39
  v_mfma_f32_16x16x32_bf16 a[172:175], a[216:219], v[136:139], a[172:175]
  ds_read_b64_tr_b16 a[204:205], v17 offset:8192
  ds_read_b64_tr_b16 a[206:207], v17 offset:12288
  v_mfma_f32_16x16x32_bf16 a[172:175], a[220:223], v[168:171], a[172:175]
  v_exp_f32 v202, v202
  v_mfma_f32_16x16x32_bf16 a[0:3], a[216:219], v[144:147], a[0:3]
  v_mfma_f32_16x16x32_bf16 a[0:3], a[220:223], v[176:179], a[0:3]
  v_exp_f32 v203, v203
  v_cvt_pk_bf16_f32 v200, v200, v201
  v_mfma_f32_16x16x32_bf16 a[32:35], a[216:219], v[152:155], a[32:35]
  v_mfma_f32_16x16x32_bf16 a[32:35], a[220:223], v[184:187], a[32:35]
  v_exp_f32 v204, v204
  v_exp_f32 v205, v205
  s_waitcnt lgkmcnt(0)
  v_mfma_f32_16x16x32_bf16 a[144:147], a[192:195], v[128:131], a[144:147]
  ds_write_b64 v34, v[36:37] offset:12288
  v_mfma_f32_16x16x32_bf16 a[144:147], a[196:199], v[160:163], a[144:147]
  ds_read_b64_tr_b16 a[208:209], v18 offset:0
  ds_read_b64_tr_b16 a[210:211], v18 offset:4096
  v_cvt_pk_bf16_f32 v201, v202, v203
  v_mfma_f32_16x16x32_bf16 a[176:179], a[192:195], v[136:139], a[176:179]
  v_mfma_f32_16x16x32_bf16 a[176:179], a[196:199], v[168:171], a[176:179]
  s_waitcnt lgkmcnt(2)
  v_exp_f32 v206, v206
  v_exp_f32 v207, v207
  v_mfma_f32_16x16x32_bf16 a[4:7], a[192:195], v[144:147], a[4:7]
  ds_read_b64_tr_b16 a[212:213], v18 offset:8192
  ds_read_b64_tr_b16 a[214:215], v18 offset:12288
  v_mfma_f32_16x16x32_bf16 a[4:7], a[196:199], v[176:179], a[4:7]
  v_cvt_pk_bf16_f32 v202, v204, v205
  v_exp_f32 v232, v232
  v_mfma_f32_16x16x32_bf16 a[36:39], a[192:195], v[152:155], a[36:39]
  ds_read_b128 a[80:83], v46 offset:8192
  v_mfma_f32_16x16x32_bf16 a[36:39], a[196:199], v[184:187], a[36:39]
  ds_read_b64_tr_b16 a[216:217], v19 offset:0
  ds_read_b64_tr_b16 a[218:219], v19 offset:4096
  v_mfma_f32_16x16x32_bf16 a[148:151], a[200:203], v[128:131], a[148:151]
  v_mfma_f32_16x16x32_bf16 a[148:151], a[204:207], v[160:163], a[148:151]
  ds_read_b128 a[88:91], v46 offset:10240
  v_exp_f32 v233, v233
  v_cvt_pk_bf16_f32 v203, v206, v207
  v_mfma_f32_16x16x32_bf16 a[232:235], a[240:243], v[144:147], a[232:235]
  v_exp_f32 v234, v234
  v_mfma_f32_16x16x32_bf16 a[232:235], a[240:243], v[176:179], a[232:235]
  v_exp_f32 v235, v235
  v_mfma_f32_16x16x32_bf16 a[180:183], a[200:203], v[136:139], a[180:183]
  ds_read_b64_tr_b16 a[220:221], v19 offset:8192
  ds_read_b64_tr_b16 a[222:223], v19 offset:12288
  v_mfma_f32_16x16x32_bf16 a[180:183], a[204:207], v[168:171], a[180:183]
  v_cvt_pk_bf16_f32 v232, v232, v233
  v_xor_b32 v46, 64, v46
  v_mfma_f32_16x16x32_bf16 a[8:11], a[200:203], v[144:147], a[8:11]
  s_waitcnt vmcnt(12)
  s_barrier
  v_mfma_f32_16x16x32_bf16 a[8:11], a[204:207], v[176:179], a[8:11]
  s_add_u32 m0, s44, 16384
  v_exp_f32 v236, v236
  v_mfma_f32_16x16x32_bf16 a[40:43], a[200:203], v[152:155], a[40:43]
  ds_read_b128 a[84:87], v46 offset:9216
  v_mfma_f32_16x16x32_bf16 a[40:43], a[204:207], v[184:187], a[40:43]
  v_exp_f32 v237, v237
  s_waitcnt lgkmcnt(1)
  v_mfma_f32_16x16x32_bf16 a[152:155], a[208:211], v[128:131], a[152:155]
  buffer_load_dwordx4 v5, s[20:23], s89 offen offset:0 nt lds
  v_mfma_f32_16x16x32_bf16 a[152:155], a[212:215], v[160:163], a[152:155]
  ds_read_b128 a[192:195], v8 offset:32768
  ds_read_b128 a[92:95], v46 offset:11264
  v_mfma_f32_16x16x32_bf16 a[184:187], a[208:211], v[136:139], a[184:187]
  v_mfma_f32_16x16x32_bf16 a[184:187], a[212:215], v[168:171], a[184:187]
  v_cvt_pk_bf16_f32 v233, v234, v235
  v_exp_f32 v238, v238
  v_mfma_f32_16x16x32_bf16 a[12:15], a[208:211], v[144:147], a[12:15]
  ds_read_b128 a[196:199], v9 offset:32768
  v_mfma_f32_16x16x32_bf16 a[12:15], a[212:215], v[176:179], a[12:15]
  v_exp_f32 v239, v239
  v_cvt_pk_bf16_f32 v234, v236, v237
  v_mfma_f32_16x16x32_bf16 a[44:47], a[208:211], v[152:155], a[44:47]
  buffer_load_dwordx4 v6, s[20:23], s89 offen offset:1024 nt lds
  v_mfma_f32_16x16x32_bf16 a[44:47], a[212:215], v[184:187], a[44:47]
  ds_read_b128 a[200:203], v10 offset:32768
  v_accvgpr_read_b32 v40, a108
  v_mfma_f32_16x16x32_bf16 a[156:159], a[216:219], v[128:131], a[156:159]
  v_mfma_f32_16x16x32_bf16 a[156:159], a[220:223], v[160:163], a[156:159]
  v_exp_f32 v208, v208
  v_exp_f32 v209, v209
  v_accvgpr_read_b32 v41, a109
  v_mfma_f32_16x16x32_bf16 a[236:239], a[240:243], v[152:155], a[236:239]
  v_cvt_pk_bf16_f32 v235, v238, v239
  v_exp_f32 v210, v210
  v_mfma_f32_16x16x32_bf16 a[236:239], a[240:243], v[184:187], a[236:239]
  v_accvgpr_read_b32 v42, a110
  v_accvgpr_read_b32 v43, a111
  v_mfma_f32_16x16x32_bf16 a[188:191], a[216:219], v[136:139], a[188:191]
  ds_read_b128 a[204:207], v11 offset:32768
  v_mfma_f32_16x16x32_bf16 a[188:191], a[220:223], v[168:171], a[188:191]
  v_exp_f32 v211, v211
  v_cvt_pk_bf16_f32 v208, v208, v209
  v_mfma_f32_16x16x32_bf16 a[16:19], a[216:219], v[144:147], a[16:19]
  buffer_load_dwordx4 v5, s[20:23], s89 offen offset:2048 nt lds
  v_mfma_f32_16x16x32_bf16 a[16:19], a[220:223], v[176:179], a[16:19]
  v_exp_f32 v212, v212
  v_mfma_f32_16x16x32_bf16 v[48:51], a[216:219], v[152:155], v[48:51]
  v_mfma_f32_16x16x32_bf16 v[48:51], a[220:223], v[184:187], v[48:51]
  v_exp_f32 v213, v213
  v_cvt_pk_bf16_f32 v209, v210, v211
  s_waitcnt lgkmcnt(0)
  v_mfma_f32_16x16x32_bf16 v[128:131], a[192:195], v[64:67], v[20:23]
  buffer_load_dwordx4 v6, s[20:23], s89 offen offset:3072 nt lds
  v_mfma_f32_16x16x32_bf16 v[128:131], a[196:199], v[68:71], v[128:131]
  ds_read_b128 a[208:211], v8 offset:36864
  v_mfma_f32_16x16x32_bf16 v[128:131], a[200:203], v[72:75], v[128:131]
  v_mfma_f32_16x16x32_bf16 v[128:131], a[204:207], v[76:79], v[128:131]
  v_exp_f32 v214, v214
  v_exp_f32 v215, v215
  v_mul_f32 v40, v40, v31
  v_mfma_f32_16x16x32_bf16 v[136:139], a[192:195], v[80:83], v[52:55]
  ds_read_b128 a[212:215], v9 offset:36864
  v_mfma_f32_16x16x32_bf16 v[136:139], a[196:199], v[84:87], v[136:139]
  v_mfma_f32_16x16x32_bf16 v[136:139], a[200:203], v[88:91], v[136:139]
  v_mfma_f32_16x16x32_bf16 v[136:139], a[204:207], v[92:95], v[136:139]
  ds_read_b128 a[216:219], v10 offset:36864
  v_cvt_pk_bf16_f32 v210, v212, v213
  v_exp_f32 v240, v240
  v_exp_f32 v241, v241
  v_mul_f32 v41, v41, v31
  v_mul_f32 v42, v42, v31
  v_mfma_f32_16x16x32_bf16 v[144:147], a[192:195], v[96:99], v[56:59]
  v_mfma_f32_16x16x32_bf16 v[144:147], a[196:199], v[100:103], v[144:147]
  v_mfma_f32_16x16x32_bf16 v[144:147], a[200:203], v[104:107], v[144:147]
  ds_read_b128 a[220:223], v11 offset:36864
  v_mfma_f32_16x16x32_bf16 v[144:147], a[204:207], v[108:111], v[144:147]
  v_cvt_pk_bf16_f32 v211, v214, v215
  v_exp_f32 v242, v242
  v_exp_f32 v243, v243
  v_cvt_pk_bf16_f32 v240, v240, v241
  v_mul_f32 v43, v43, v31
  v_mfma_f32_16x16x32_bf16 v[152:155], a[192:195], v[112:115], v[60:63]
  v_mfma_f32_16x16x32_bf16 v[152:155], a[196:199], v[116:119], v[152:155]
  v_mfma_f32_16x16x32_bf16 v[152:155], a[200:203], v[120:123], v[152:155]
  v_mfma_f32_16x16x32_bf16 v[152:155], a[204:207], v[124:127], v[152:155]
  v_exp_f32 v244, v244
  v_exp_f32 v245, v245
  v_cvt_pk_bf16_f32 v241, v242, v243
  v_exp_f32 v246, v246
  v_cvt_pk_bf16_f32 v40, v40, v41
  v_cvt_pk_bf16_f32 v41, v42, v43
  s_waitcnt lgkmcnt(0)
  v_mfma_f32_16x16x32_bf16 v[132:135], a[208:211], v[64:67], v[20:23]
  v_mfma_f32_16x16x32_bf16 v[132:135], a[212:215], v[68:71], v[132:135]
  ds_read_b128 a[192:195], v8 offset:40960
  v_mfma_f32_16x16x32_bf16 v[132:135], a[216:219], v[72:75], v[132:135]
  v_mfma_f32_16x16x32_bf16 v[132:135], a[220:223], v[76:79], v[132:135]
  v_exp_f32 v247, v247
  v_cvt_pk_bf16_f32 v242, v244, v245
  v_exp_f32 v216, v216
  v_accvgpr_read_b32 v36, a112
  v_mfma_f32_16x16x32_bf16 v[140:143], a[208:211], v[80:83], v[52:55]
  ds_read_b128 a[196:199], v9 offset:40960
  v_mfma_f32_16x16x32_bf16 v[140:143], a[212:215], v[84:87], v[140:143]
  v_mfma_f32_16x16x32_bf16 v[140:143], a[216:219], v[88:91], v[140:143]
  v_mfma_f32_16x16x32_bf16 v[140:143], a[220:223], v[92:95], v[140:143]
  ds_read_b128 a[200:203], v10 offset:40960
  v_exp_f32 v217, v217
  v_cvt_pk_bf16_f32 v243, v246, v247
  v_exp_f32 v218, v218
  v_accvgpr_read_b32 v37, a113
  v_mfma_f32_16x16x32_bf16 v[148:151], a[208:211], v[96:99], v[56:59]
  v_mfma_f32_16x16x32_bf16 v[148:151], a[212:215], v[100:103], v[148:151]
  v_mfma_f32_16x16x32_bf16 v[148:151], a[216:219], v[104:107], v[148:151]
  ds_read_b128 a[204:207], v11 offset:40960
  v_mfma_f32_16x16x32_bf16 v[148:151], a[220:223], v[108:111], v[148:151]
  v_exp_f32 v219, v219
  v_cvt_pk_bf16_f32 v216, v216, v217
  v_exp_f32 v220, v220
  v_exp_f32 v221, v221
  v_accvgpr_read_b32 v38, a114
  v_accvgpr_read_b32 v39, a115
  v_mfma_f32_16x16x32_bf16 v[156:159], a[208:211], v[112:115], v[60:63]
  v_mfma_f32_16x16x32_bf16 v[156:159], a[212:215], v[116:119], v[156:159]
  v_mfma_f32_16x16x32_bf16 v[156:159], a[216:219], v[120:123], v[156:159]
  v_mfma_f32_16x16x32_bf16 v[156:159], a[220:223], v[124:127], v[156:159]
  v_cvt_pk_bf16_f32 v217, v218, v219
  v_exp_f32 v222, v222
  v_exp_f32 v223, v223
  v_cvt_pk_bf16_f32 v218, v220, v221
  s_waitcnt lgkmcnt(0)
  v_mfma_f32_16x16x32_bf16 v[160:163], a[192:195], v[64:67], v[20:23]
  v_mfma_f32_16x16x32_bf16 v[160:163], a[196:199], v[68:71], v[160:163]
  ds_read_b128 a[208:211], v8 offset:45056
  ds_write_b64 v35, v[40:41] offset:12288
  v_mfma_f32_16x16x32_bf16 v[160:163], a[200:203], v[72:75], v[160:163]
  v_mfma_f32_16x16x32_bf16 v[160:163], a[204:207], v[76:79], v[160:163]
  v_exp_f32 v248, v248
  v_exp_f32 v249, v249
  v_cvt_pk_bf16_f32 v219, v222, v223
  v_mfma_f32_16x16x32_bf16 v[168:171], a[192:195], v[80:83], v[52:55]
  ds_read_b128 a[212:215], v9 offset:45056
  v_mfma_f32_16x16x32_bf16 v[168:171], a[196:199], v[84:87], v[168:171]
  v_mfma_f32_16x16x32_bf16 v[168:171], a[200:203], v[88:91], v[168:171]
  v_mfma_f32_16x16x32_bf16 v[168:171], a[204:207], v[92:95], v[168:171]
  ds_read_b128 a[216:219], v10 offset:45056
  v_exp_f32 v250, v250
  v_exp_f32 v251, v251
  v_cvt_pk_bf16_f32 v248, v248, v249
  v_exp_f32 v252, v252
  v_mul_f32 v36, v36, v31
  v_mfma_f32_16x16x32_bf16 v[176:179], a[192:195], v[96:99], v[56:59]
  v_mfma_f32_16x16x32_bf16 v[176:179], a[196:199], v[100:103], v[176:179]
  v_mfma_f32_16x16x32_bf16 v[176:179], a[200:203], v[104:107], v[176:179]
  ds_read_b128 a[220:223], v11 offset:45056
  v_mfma_f32_16x16x32_bf16 v[176:179], a[204:207], v[108:111], v[176:179]
  v_exp_f32 v253, v253
  v_cvt_pk_bf16_f32 v249, v250, v251
  v_exp_f32 v254, v254
  v_mul_f32 v37, v37, v31
  v_mfma_f32_16x16x32_bf16 v[184:187], a[192:195], v[112:115], v[60:63]
  s_waitcnt vmcnt(12)
  s_barrier
  v_mfma_f32_16x16x32_bf16 v[184:187], a[196:199], v[116:119], v[184:187]
  v_mfma_f32_16x16x32_bf16 v[184:187], a[200:203], v[120:123], v[184:187]
  v_mfma_f32_16x16x32_bf16 v[184:187], a[204:207], v[124:127], v[184:187]
  v_exp_f32 v255, v255
  v_cvt_pk_bf16_f32 v250, v252, v253
  v_cvt_pk_bf16_f32 v251, v254, v255
  v_mul_f32 v38, v38, v31
  v_mul_f32 v39, v39, v31
  s_waitcnt lgkmcnt(0)
  v_mfma_f32_16x16x32_bf16 v[164:167], a[208:211], v[64:67], v[20:23]
  v_mfma_f32_16x16x32_bf16 v[164:167], a[212:215], v[68:71], v[164:167]
  ds_read_b64_tr_b16 a[192:193], v12 offset:16384
  ds_read_b64_tr_b16 a[194:195], v12 offset:20480
  v_mfma_f32_16x16x32_bf16 v[164:167], a[216:219], v[72:75], v[164:167]
  v_mfma_f32_16x16x32_bf16 v[164:167], a[220:223], v[76:79], v[164:167]
  v_cvt_pk_bf16_f32 v36, v36, v37
  v_cvt_pk_bf16_f32 v37, v38, v39
  v_mfma_f32_16x16x32_bf16 v[172:175], a[208:211], v[80:83], v[52:55]
  ds_read_b64_tr_b16 a[196:197], v12 offset:24576
  ds_read_b64_tr_b16 a[198:199], v12 offset:28672
  v_mfma_f32_16x16x32_bf16 v[172:175], a[212:215], v[84:87], v[172:175]
  v_mfma_f32_16x16x32_bf16 v[172:175], a[216:219], v[88:91], v[172:175]
  v_mfma_f32_16x16x32_bf16 v[172:175], a[220:223], v[92:95], v[172:175]
  ds_read_b64_tr_b16 a[200:201], v13 offset:16384
  ds_read_b64_tr_b16 a[202:203], v13 offset:20480
  v_accvgpr_read_b32 v40, a116
  v_mfma_f32_16x16x32_bf16 v[180:183], a[208:211], v[96:99], v[56:59]
  v_mfma_f32_16x16x32_bf16 v[180:183], a[212:215], v[100:103], v[180:183]
  v_mfma_f32_16x16x32_bf16 v[180:183], a[216:219], v[104:107], v[180:183]
  ds_read_b64_tr_b16 a[204:205], v13 offset:24576
  ds_read_b64_tr_b16 a[206:207], v13 offset:28672
  v_mfma_f32_16x16x32_bf16 v[180:183], a[220:223], v[108:111], v[180:183]
  v_accvgpr_read_b32 v41, a117
  v_accvgpr_read_b32 v42, a118
  v_mfma_f32_16x16x32_bf16 v[188:191], a[208:211], v[112:115], v[60:63]
  v_mfma_f32_16x16x32_bf16 v[188:191], a[212:215], v[116:119], v[188:191]
  v_mfma_f32_16x16x32_bf16 v[188:191], a[216:219], v[120:123], v[188:191]
  v_mfma_f32_16x16x32_bf16 v[188:191], a[220:223], v[124:127], v[188:191]
  v_accvgpr_read_b32 v43, a119
  s_waitcnt lgkmcnt(0)
  v_mfma_f32_16x16x32_bf16 a[128:131], a[192:195], v[192:195], a[128:131]
  v_mfma_f32_16x16x32_bf16 a[128:131], a[196:199], v[224:227], a[128:131]
  ds_read_b64_tr_b16 a[208:209], v14 offset:16384
  ds_read_b64_tr_b16 a[210:211], v14 offset:20480
  v_mfma_f32_16x16x32_bf16 a[160:163], a[192:195], v[200:203], a[160:163]
  v_mfma_f32_16x16x32_bf16 a[160:163], a[196:199], v[232:235], a[160:163]
  v_exp_f32 v128, v128
  v_exp_f32 v129, v129
  v_exp_f32 v130, v130
  v_exp_f32 v131, v131
  v_cvt_pk_bf16_f32 v128, v128, v129
  v_exp_f32 v132, v132
  v_mfma_f32_16x16x32_bf16 a[244:247], a[192:195], v[208:211], a[244:247]
  ds_read_b64_tr_b16 a[212:213], v14 offset:24576
  ds_read_b64_tr_b16 a[214:215], v14 offset:28672
  v_mfma_f32_16x16x32_bf16 a[244:247], a[196:199], v[240:243], a[244:247]
  v_exp_f32 v133, v133
  v_mfma_f32_16x16x32_bf16 a[20:23], a[192:195], v[216:219], a[20:23]
  ds_write_b64 v32, v[36:37] offset:12416
  v_mfma_f32_16x16x32_bf16 a[20:23], a[196:199], v[248:251], a[20:23]
  ds_read_b64_tr_b16 a[216:217], v15 offset:16384
  ds_read_b64_tr_b16 a[218:219], v15 offset:20480
  v_cvt_pk_bf16_f32 v129, v130, v131
  v_mfma_f32_16x16x32_bf16 a[132:135], a[200:203], v[192:195], a[132:135]
  v_mfma_f32_16x16x32_bf16 a[132:135], a[204:207], v[224:227], a[132:135]
  v_exp_f32 v134, v134
  v_exp_f32 v135, v135
  v_mfma_f32_16x16x32_bf16 a[224:227], a[240:243], v[192:195], a[224:227]
  v_cvt_pk_bf16_f32 v130, v132, v133
  v_mul_f32 v40, v40, v31
  v_mfma_f32_16x16x32_bf16 a[224:227], a[240:243], v[224:227], a[224:227]
  v_exp_f32 v160, v160
  v_mfma_f32_16x16x32_bf16 a[164:167], a[200:203], v[200:203], a[164:167]
  ds_read_b64_tr_b16 a[220:221], v15 offset:24576
  ds_read_b64_tr_b16 a[222:223], v15 offset:28672
  v_mfma_f32_16x16x32_bf16 a[164:167], a[204:207], v[232:235], a[164:167]
  v_exp_f32 v161, v161
  v_mfma_f32_16x16x32_bf16 a[248:251], a[200:203], v[208:211], a[248:251]
  v_mfma_f32_16x16x32_bf16 a[248:251], a[204:207], v[240:243], a[248:251]
  v_cvt_pk_bf16_f32 v131, v134, v135
  v_exp_f32 v162, v162
  v_mfma_f32_16x16x32_bf16 a[24:27], a[200:203], v[216:219], a[24:27]
  v_mfma_f32_16x16x32_bf16 a[24:27], a[204:207], v[248:251], a[24:27]
  v_exp_f32 v163, v163
  v_cvt_pk_bf16_f32 v160, v160, v161
  v_mul_f32 v41, v41, v31
  s_waitcnt lgkmcnt(0)
  v_mfma_f32_16x16x32_bf16 a[136:139], a[208:211], v[192:195], a[136:139]
  v_mfma_f32_16x16x32_bf16 a[136:139], a[212:215], v[224:227], a[136:139]
  ds_read_b64_tr_b16 a[192:193], v16 offset:16384
  ds_read_b64_tr_b16 a[194:195], v16 offset:20480
  v_exp_f32 v164, v164
  v_mul_f32 v42, v42, v31
  v_mfma_f32_16x16x32_bf16 a[168:171], a[208:211], v[200:203], a[168:171]
  v_mfma_f32_16x16x32_bf16 a[168:171], a[212:215], v[232:235], a[168:171]
  s_add_u32 s56, s45, 0
  v_exp_f32 v165, v165
  v_cvt_pk_bf16_f32 v161, v162, v163
  v_mfma_f32_16x16x32_bf16 a[252:255], a[208:211], v[208:211], a[252:255]
  ds_read_b64_tr_b16 a[196:197], v16 offset:24576
  ds_read_b64_tr_b16 a[198:199], v16 offset:28672
  v_mfma_f32_16x16x32_bf16 a[252:255], a[212:215], v[240:243], a[252:255]
  v_exp_f32 v166, v166
  v_mul_f32 v43, v43, v31
  v_mfma_f32_16x16x32_bf16 a[28:31], a[208:211], v[216:219], a[28:31]
  v_mfma_f32_16x16x32_bf16 a[28:31], a[212:215], v[248:251], a[28:31]
  ds_read_b64_tr_b16 a[200:201], v17 offset:16384
  ds_read_b64_tr_b16 a[202:203], v17 offset:20480
  v_exp_f32 v167, v167
  v_cvt_pk_bf16_f32 v40, v40, v41
  v_mfma_f32_16x16x32_bf16 a[140:143], a[216:219], v[192:195], a[140:143]
  v_mfma_f32_16x16x32_bf16 a[140:143], a[220:223], v[224:227], a[140:143]
  v_cvt_pk_bf16_f32 v162, v164, v165
  v_exp_f32 v136, v136
  v_mfma_f32_16x16x32_bf16 a[228:231], a[240:243], v[200:203], a[228:231]
  v_exp_f32 v137, v137
  v_mfma_f32_16x16x32_bf16 a[228:231], a[240:243], v[232:235], a[228:231]
  v_cvt_pk_bf16_f32 v163, v166, v167
  v_cvt_pk_bf16_f32 v41, v42, v43
  v_mfma_f32_16x16x32_bf16 a[172:175], a[216:219], v[200:203], a[172:175]
  ds_read_b64_tr_b16 a[204:205], v17 offset:24576
  ds_read_b64_tr_b16 a[206:207], v17 offset:28672
  v_mfma_f32_16x16x32_bf16 a[172:175], a[220:223], v[232:235], a[172:175]
  v_exp_f32 v138, v138
  v_mfma_f32_16x16x32_bf16 a[0:3], a[216:219], v[208:211], a[0:3]
  v_mfma_f32_16x16x32_bf16 a[0:3], a[220:223], v[240:243], a[0:3]
  v_exp_f32 v139, v139
  v_cvt_pk_bf16_f32 v136, v136, v137
  v_accvgpr_read_b32 v36, a120
  v_mfma_f32_16x16x32_bf16 a[32:35], a[216:219], v[216:219], a[32:35]
  v_mfma_f32_16x16x32_bf16 a[32:35], a[220:223], v[248:251], a[32:35]
  v_exp_f32 v140, v140
  v_exp_f32 v141, v141
  s_waitcnt lgkmcnt(0)
  v_mfma_f32_16x16x32_bf16 a[144:147], a[192:195], v[192:195], a[144:147]
  buffer_store_dwordx4 a[48:51], v47, s[32:35], s56 offen offset:0 sc0 sc1
  v_mfma_f32_16x16x32_bf16 a[144:147], a[196:199], v[224:227], a[144:147]
  ds_read_b64_tr_b16 a[208:209], v18 offset:16384
  ds_read_b64_tr_b16 a[210:211], v18 offset:20480
  v_cvt_pk_bf16_f32 v137, v138, v139
  v_accvgpr_read_b32 v37, a121
  v_mfma_f32_16x16x32_bf16 a[176:179], a[192:195], v[200:203], a[176:179]
  v_mfma_f32_16x16x32_bf16 a[176:179], a[196:199], v[232:235], a[176:179]
  v_exp_f32 v142, v142
  v_exp_f32 v143, v143
  v_accvgpr_read_b32 v38, a122
  v_mfma_f32_16x16x32_bf16 a[4:7], a[192:195], v[208:211], a[4:7]
  ds_read_b64_tr_b16 a[212:213], v18 offset:24576
  ds_read_b64_tr_b16 a[214:215], v18 offset:28672
  v_mfma_f32_16x16x32_bf16 a[4:7], a[196:199], v[240:243], a[4:7]
  v_cvt_pk_bf16_f32 v138, v140, v141
  v_accvgpr_read_b32 v39, a123
  v_mfma_f32_16x16x32_bf16 a[36:39], a[192:195], v[216:219], a[36:39]
  v_mfma_f32_16x16x32_bf16 a[36:39], a[196:199], v[248:251], a[36:39]
  ds_read_b64_tr_b16 a[216:217], v19 offset:16384
  ds_read_b64_tr_b16 a[218:219], v19 offset:20480
  v_exp_f32 v168, v168
  v_mfma_f32_16x16x32_bf16 a[148:151], a[200:203], v[192:195], a[148:151]
  v_mfma_f32_16x16x32_bf16 a[148:151], a[204:207], v[224:227], a[148:151]
  v_exp_f32 v169, v169
  v_cvt_pk_bf16_f32 v139, v142, v143
  v_mfma_f32_16x16x32_bf16 a[232:235], a[240:243], v[208:211], a[232:235]
  v_exp_f32 v170, v170
  v_mfma_f32_16x16x32_bf16 a[232:235], a[240:243], v[240:243], a[232:235]
  v_exp_f32 v171, v171
  v_mfma_f32_16x16x32_bf16 a[180:183], a[200:203], v[200:203], a[180:183]
  ds_read_b64_tr_b16 a[220:221], v19 offset:24576
  ds_read_b64_tr_b16 a[222:223], v19 offset:28672
  v_mfma_f32_16x16x32_bf16 a[180:183], a[204:207], v[232:235], a[180:183]
  buffer_store_dwordx4 a[52:55], v47, s[32:35], s56 offen offset:1024 sc0 sc1
  v_cvt_pk_bf16_f32 v168, v168, v169
  v_mfma_f32_16x16x32_bf16 a[8:11], a[200:203], v[208:211], a[8:11]
  s_waitcnt vmcnt(10)
  s_barrier
  ds_write_b64 v33, v[40:41] offset:12416
  v_mfma_f32_16x16x32_bf16 a[8:11], a[204:207], v[240:243], a[8:11]
  v_exp_f32 v172, v172
  v_mfma_f32_16x16x32_bf16 a[40:43], a[200:203], v[216:219], a[40:43]
  v_mfma_f32_16x16x32_bf16 a[40:43], a[204:207], v[248:251], a[40:43]
  v_exp_f32 v173, v173
  s_waitcnt lgkmcnt(1)
  v_mfma_f32_16x16x32_bf16 a[152:155], a[208:211], v[192:195], a[152:155]
  v_mfma_f32_16x16x32_bf16 a[152:155], a[212:215], v[224:227], a[152:155]
  ds_read_b128 a[192:195], v8 offset:0
  v_cvt_pk_bf16_f32 v169, v170, v171
  v_exp_f32 v174, v174
  v_mul_f32 v36, v36, v31
  v_mfma_f32_16x16x32_bf16 a[184:187], a[208:211], v[200:203], a[184:187]
  v_mfma_f32_16x16x32_bf16 a[184:187], a[212:215], v[232:235], a[184:187]
  v_exp_f32 v175, v175
  v_cvt_pk_bf16_f32 v170, v172, v173
  v_mfma_f32_16x16x32_bf16 a[12:15], a[208:211], v[208:211], a[12:15]
  ds_read_b128 a[196:199], v9 offset:0
  v_mfma_f32_16x16x32_bf16 a[12:15], a[212:215], v[240:243], a[12:15]
  v_exp_f32 v144, v144
  v_exp_f32 v145, v145
  v_mul_f32 v37, v37, v31
  v_mfma_f32_16x16x32_bf16 a[44:47], a[208:211], v[216:219], a[44:47]
  v_mfma_f32_16x16x32_bf16 a[44:47], a[212:215], v[248:251], a[44:47]
  ds_read_b128 a[200:203], v10 offset:0
  v_cvt_pk_bf16_f32 v171, v174, v175
  v_mul_f32 v38, v38, v31
  v_mfma_f32_16x16x32_bf16 a[156:159], a[216:219], v[192:195], a[156:159]
  buffer_store_dwordx4 a[56:59], v47, s[32:35], s56 offen offset:2048 sc0 sc1
  v_mfma_f32_16x16x32_bf16 a[156:159], a[220:223], v[224:227], a[156:159]
  v_exp_f32 v146, v146
  v_exp_f32 v147, v147
  v_mfma_f32_16x16x32_bf16 a[236:239], a[240:243], v[216:219], a[236:239]
  v_cvt_pk_bf16_f32 v144, v144, v145
  v_exp_f32 v148, v148
  v_mfma_f32_16x16x32_bf16 a[236:239], a[240:243], v[248:251], a[236:239]
  v_mul_f32 v39, v39, v31
  v_cvt_pk_bf16_f32 v36, v36, v37
  v_mfma_f32_16x16x32_bf16 a[188:191], a[216:219], v[200:203], a[188:191]
  ds_read_b128 a[204:207], v11 offset:0
  v_mfma_f32_16x16x32_bf16 a[188:191], a[220:223], v[232:235], a[188:191]
  v_exp_f32 v149, v149
  v_cvt_pk_bf16_f32 v145, v146, v147
  v_mfma_f32_16x16x32_bf16 a[16:19], a[216:219], v[208:211], a[16:19]
  v_mfma_f32_16x16x32_bf16 a[16:19], a[220:223], v[240:243], a[16:19]
  v_exp_f32 v150, v150
  v_exp_f32 v151, v151
  v_mfma_f32_16x16x32_bf16 v[48:51], a[216:219], v[216:219], v[48:51]
  v_mfma_f32_16x16x32_bf16 v[48:51], a[220:223], v[248:251], v[48:51]
  v_cvt_pk_bf16_f32 v146, v148, v149
  v_exp_f32 v176, v176
  s_waitcnt lgkmcnt(0)
  v_mfma_f32_16x16x32_bf16 v[192:195], a[192:195], v[64:67], v[20:23]
  v_mfma_f32_16x16x32_bf16 v[192:195], a[196:199], v[68:71], v[192:195]
  ds_read_b128 a[208:211], v8 offset:4096
  v_mfma_f32_16x16x32_bf16 v[192:195], a[200:203], v[72:75], v[192:195]
  v_mfma_f32_16x16x32_bf16 v[192:195], a[204:207], v[76:79], v[192:195]
  buffer_store_dwordx4 a[60:63], v47, s[32:35], s56 offen offset:3072 sc0 sc1
  v_exp_f32 v177, v177
  v_cvt_pk_bf16_f32 v147, v150, v151
  v_exp_f32 v178, v178
  v_cvt_pk_bf16_f32 v37, v38, v39
  v_accvgpr_read_b32 v40, a124
  v_mfma_f32_16x16x32_bf16 v[200:203], a[192:195], v[80:83], v[52:55]
  ds_read_b128 a[212:215], v9 offset:4096
  v_mfma_f32_16x16x32_bf16 v[200:203], a[196:199], v[84:87], v[200:203]
  v_mfma_f32_16x16x32_bf16 v[200:203], a[200:203], v[88:91], v[200:203]
  v_mfma_f32_16x16x32_bf16 v[200:203], a[204:207], v[92:95], v[200:203]
  ds_read_b128 a[216:219], v10 offset:4096
  v_exp_f32 v179, v179
  v_cvt_pk_bf16_f32 v176, v176, v177
  v_exp_f32 v180, v180
  v_accvgpr_read_b32 v41, a125
  v_mfma_f32_16x16x32_bf16 v[208:211], a[192:195], v[96:99], v[56:59]
  v_mfma_f32_16x16x32_bf16 v[208:211], a[196:199], v[100:103], v[208:211]
  s_add_u32 s56, s45, 4096
  v_mfma_f32_16x16x32_bf16 v[208:211], a[200:203], v[104:107], v[208:211]
  ds_read_b128 a[220:223], v11 offset:4096
  v_mfma_f32_16x16x32_bf16 v[208:211], a[204:207], v[108:111], v[208:211]
  v_exp_f32 v181, v181
  v_cvt_pk_bf16_f32 v177, v178, v179
  v_exp_f32 v182, v182
  v_exp_f32 v183, v183
  v_accvgpr_read_b32 v42, a126
  v_accvgpr_read_b32 v43, a127
  v_mfma_f32_16x16x32_bf16 v[216:219], a[192:195], v[112:115], v[60:63]
  v_mfma_f32_16x16x32_bf16 v[216:219], a[196:199], v[116:119], v[216:219]
  v_mfma_f32_16x16x32_bf16 v[216:219], a[200:203], v[120:123], v[216:219]
  v_mfma_f32_16x16x32_bf16 v[216:219], a[204:207], v[124:127], v[216:219]
  v_cvt_pk_bf16_f32 v178, v180, v181
  v_exp_f32 v152, v152
  v_exp_f32 v153, v153
  v_cvt_pk_bf16_f32 v179, v182, v183
  s_waitcnt lgkmcnt(0)
  v_mfma_f32_16x16x32_bf16 v[196:199], a[208:211], v[64:67], v[20:23]
  v_mfma_f32_16x16x32_bf16 v[196:199], a[212:215], v[68:71], v[196:199]
  ds_read_b128 a[192:195], v8 offset:8192
  v_mfma_f32_16x16x32_bf16 v[196:199], a[216:219], v[72:75], v[196:199]
  ds_write_b64 v34, v[36:37] offset:12416
  v_mfma_f32_16x16x32_bf16 v[196:199], a[220:223], v[76:79], v[196:199]
  v_exp_f32 v154, v154
  v_exp_f32 v155, v155
  v_cvt_pk_bf16_f32 v152, v152, v153
  v_exp_f32 v156, v156
  v_mfma_f32_16x16x32_bf16 v[204:207], a[208:211], v[80:83], v[52:55]
  ds_read_b128 a[196:199], v9 offset:8192
  v_mfma_f32_16x16x32_bf16 v[204:207], a[212:215], v[84:87], v[204:207]
  buffer_store_dwordx4 a[64:67], v47, s[32:35], s56 offen offset:0 sc0 sc1
  v_mfma_f32_16x16x32_bf16 v[204:207], a[216:219], v[88:91], v[204:207]
  v_mfma_f32_16x16x32_bf16 v[204:207], a[220:223], v[92:95], v[204:207]
  ds_read_b128 a[200:203], v10 offset:8192
  v_exp_f32 v157, v157
  v_cvt_pk_bf16_f32 v153, v154, v155
  v_exp_f32 v158, v158
  v_mul_f32 v40, v40, v31
  v_mfma_f32_16x16x32_bf16 v[212:215], a[208:211], v[96:99], v[56:59]
  v_mfma_f32_16x16x32_bf16 v[212:215], a[212:215], v[100:103], v[212:215]
  v_mfma_f32_16x16x32_bf16 v[212:215], a[216:219], v[104:107], v[212:215]
  ds_read_b128 a[204:207], v11 offset:8192
  v_mfma_f32_16x16x32_bf16 v[212:215], a[220:223], v[108:111], v[212:215]
  v_exp_f32 v159, v159
  v_cvt_pk_bf16_f32 v154, v156, v157
  v_exp_f32 v184, v184
  v_mul_f32 v41, v41, v31
  v_mfma_f32_16x16x32_bf16 v[220:223], a[208:211], v[112:115], v[60:63]
  v_mfma_f32_16x16x32_bf16 v[220:223], a[212:215], v[116:119], v[220:223]
  v_mfma_f32_16x16x32_bf16 v[220:223], a[216:219], v[120:123], v[220:223]
  v_mfma_f32_16x16x32_bf16 v[220:223], a[220:223], v[124:127], v[220:223]
  v_exp_f32 v185, v185
  v_cvt_pk_bf16_f32 v155, v158, v159
  v_exp_f32 v186, v186
  v_exp_f32 v187, v187
  v_mul_f32 v42, v42, v31
  s_waitcnt lgkmcnt(0)
  v_mfma_f32_16x16x32_bf16 v[224:227], a[192:195], v[64:67], v[20:23]
  v_mfma_f32_16x16x32_bf16 v[224:227], a[196:199], v[68:71], v[224:227]
  ds_read_b128 a[208:211], v8 offset:12288
  v_mfma_f32_16x16x32_bf16 v[224:227], a[200:203], v[72:75], v[224:227]
  buffer_store_dwordx4 a[68:71], v47, s[32:35], s56 offen offset:1024 sc0 sc1
  v_mfma_f32_16x16x32_bf16 v[224:227], a[204:207], v[76:79], v[224:227]
  v_cvt_pk_bf16_f32 v184, v184, v185
  v_exp_f32 v188, v188
  v_exp_f32 v189, v189
  v_cvt_pk_bf16_f32 v185, v186, v187
  v_mul_f32 v43, v43, v31
  v_cvt_pk_bf16_f32 v40, v40, v41
  v_mfma_f32_16x16x32_bf16 v[232:235], a[192:195], v[80:83], v[52:55]
  ds_read_b128 a[212:215], v9 offset:12288
  v_mfma_f32_16x16x32_bf16 v[232:235], a[196:199], v[84:87], v[232:235]
  v_mfma_f32_16x16x32_bf16 v[232:235], a[200:203], v[88:91], v[232:235]
  v_mfma_f32_16x16x32_bf16 v[232:235], a[204:207], v[92:95], v[232:235]
  ds_read_b128 a[216:219], v10 offset:12288
  v_exp_f32 v190, v190
  v_exp_f32 v191, v191
  v_cvt_pk_bf16_f32 v186, v188, v189
  v_cvt_pk_bf16_f32 v41, v42, v43
  v_mfma_f32_16x16x32_bf16 v[240:243], a[192:195], v[96:99], v[56:59]
  v_mfma_f32_16x16x32_bf16 v[240:243], a[196:199], v[100:103], v[240:243]
  v_mfma_f32_16x16x32_bf16 v[240:243], a[200:203], v[104:107], v[240:243]
  ds_read_b128 a[220:223], v11 offset:12288
  v_mfma_f32_16x16x32_bf16 v[240:243], a[204:207], v[108:111], v[240:243]
  v_cvt_pk_bf16_f32 v187, v190, v191
  v_mfma_f32_16x16x32_bf16 v[248:251], a[192:195], v[112:115], v[60:63]
  s_waitcnt vmcnt(10)
  s_barrier
  v_mfma_f32_16x16x32_bf16 v[248:251], a[196:199], v[116:119], v[248:251]
L_pad9:
  s_cbranch_execz L_padret
  buffer_store_dwordx4 a[72:75], v47, s[32:35], s56 offen offset:2048 sc0 sc1
  ds_write_b64 v35, v[40:41] offset:12416
  v_mfma_f32_16x16x32_bf16 v[248:251], a[200:203], v[120:123], v[248:251]
  v_mfma_f32_16x16x32_bf16 v[248:251], a[204:207], v[124:127], v[248:251]
  s_waitcnt lgkmcnt(1)
  v_mfma_f32_16x16x32_bf16 v[228:231], a[208:211], v[64:67], v[20:23]
  s_waitcnt lgkmcnt(0)
  v_mfma_f32_16x16x32_bf16 v[228:231], a[212:215], v[68:71], v[228:231]
  ds_read_b64_tr_b16 a[192:193], v12 offset:32768
  ds_read_b64_tr_b16 a[194:195], v12 offset:36864
  v_mfma_f32_16x16x32_bf16 v[228:231], a[216:219], v[72:75], v[228:231]
  v_mfma_f32_16x16x32_bf16 v[228:231], a[220:223], v[76:79], v[228:231]
  ds_read_b128 a[100:103], v46 offset:13312
  v_mfma_f32_16x16x32_bf16 v[236:239], a[208:211], v[80:83], v[52:55]
  ds_read_b64_tr_b16 a[196:197], v12 offset:40960
  ds_read_b64_tr_b16 a[198:199], v12 offset:45056
  v_mfma_f32_16x16x32_bf16 v[236:239], a[212:215], v[84:87], v[236:239]
  v_mfma_f32_16x16x32_bf16 v[236:239], a[216:219], v[88:91], v[236:239]
  ds_read_b128 a[108:111], v46 offset:15360
  v_mfma_f32_16x16x32_bf16 v[236:239], a[220:223], v[92:95], v[236:239]
  ds_read_b64_tr_b16 a[200:201], v13 offset:32768
  ds_read_b64_tr_b16 a[202:203], v13 offset:36864
  v_mfma_f32_16x16x32_bf16 v[244:247], a[208:211], v[96:99], v[56:59]
  v_mfma_f32_16x16x32_bf16 v[244:247], a[212:215], v[100:103], v[244:247]
  buffer_store_dwordx4 a[76:79], v47, s[32:35], s56 offen offset:3072 sc0 sc1
  v_mfma_f32_16x16x32_bf16 v[244:247], a[216:219], v[104:107], v[244:247]
  ds_read_b64_tr_b16 a[204:205], v13 offset:40960
  ds_read_b64_tr_b16 a[206:207], v13 offset:45056
  v_mfma_f32_16x16x32_bf16 v[244:247], a[220:223], v[108:111], v[244:247]
  v_xor_b32 v46, 64, v46
  v_mfma_f32_16x16x32_bf16 v[252:255], a[208:211], v[112:115], v[60:63]
  ds_read_b128 a[96:99], v46 offset:12288
  v_mfma_f32_16x16x32_bf16 v[252:255], a[212:215], v[116:119], v[252:255]
  v_mfma_f32_16x16x32_bf16 v[252:255], a[216:219], v[120:123], v[252:255]
  ds_read_b128 a[104:107], v46 offset:14336
  v_mfma_f32_16x16x32_bf16 v[252:255], a[220:223], v[124:127], v[252:255]
  s_waitcnt lgkmcnt(2)
  v_mfma_f32_16x16x32_bf16 a[128:131], a[192:195], v[128:131], a[128:131]
  s_add_u32 s56, s45, 8192
  v_mfma_f32_16x16x32_bf16 a[128:131], a[196:199], v[160:163], a[128:131]
  ds_read_b64_tr_b16 a[208:209], v14 offset:32768
  ds_read_b64_tr_b16 a[210:211], v14 offset:36864
  v_mfma_f32_16x16x32_bf16 a[160:163], a[192:195], v[136:139], a[160:163]
  v_mfma_f32_16x16x32_bf16 a[160:163], a[196:199], v[168:171], a[160:163]
  v_exp_f32 v192, v192
  v_exp_f32 v193, v193
  v_exp_f32 v194, v194
  v_exp_f32 v195, v195
  v_cvt_pk_bf16_f32 v192, v192, v193
  v_exp_f32 v196, v196
  v_mfma_f32_16x16x32_bf16 a[244:247], a[192:195], v[144:147], a[244:247]
  ds_read_b64_tr_b16 a[212:213], v14 offset:40960
  ds_read_b64_tr_b16 a[214:215], v14 offset:45056
  v_mfma_f32_16x16x32_bf16 a[244:247], a[196:199], v[176:179], a[244:247]
  v_exp_f32 v197, v197
  v_mfma_f32_16x16x32_bf16 a[20:23], a[192:195], v[152:155], a[20:23]
  v_mfma_f32_16x16x32_bf16 a[20:23], a[196:199], v[184:187], a[20:23]
  ds_read_b64_tr_b16 a[216:217], v15 offset:32768
  ds_read_b64_tr_b16 a[218:219], v15 offset:36864
  v_cvt_pk_bf16_f32 v193, v194, v195
  v_mfma_f32_16x16x32_bf16 a[132:135], a[200:203], v[128:131], a[132:135]
  v_mfma_f32_16x16x32_bf16 a[132:135], a[204:207], v[160:163], a[132:135]
  v_exp_f32 v198, v198
  v_exp_f32 v199, v199
  v_mfma_f32_16x16x32_bf16 a[224:227], a[240:243], v[128:131], a[224:227]
  v_cvt_pk_bf16_f32 v194, v196, v197
  v_exp_f32 v224, v224
  v_mfma_f32_16x16x32_bf16 a[224:227], a[240:243], v[160:163], a[224:227]
  v_exp_f32 v225, v225
  v_mfma_f32_16x16x32_bf16 a[164:167], a[200:203], v[136:139], a[164:167]
  ds_read_b64_tr_b16 a[220:221], v15 offset:40960
  ds_read_b64_tr_b16 a[222:223], v15 offset:45056
  v_mfma_f32_16x16x32_bf16 a[164:167], a[204:207], v[168:171], a[164:167]
  v_cvt_pk_bf16_f32 v195, v198, v199
  v_exp_f32 v226, v226
  v_mfma_f32_16x16x32_bf16 a[248:251], a[200:203], v[144:147], a[248:251]
  buffer_store_dwordx4 a[80:83], v47, s[32:35], s56 offen offset:0 sc0 sc1
  v_mfma_f32_16x16x32_bf16 a[248:251], a[204:207], v[176:179], a[248:251]
  v_exp_f32 v227, v227
  v_mfma_f32_16x16x32_bf16 a[24:27], a[200:203], v[152:155], a[24:27]
  v_mfma_f32_16x16x32_bf16 a[24:27], a[204:207], v[184:187], a[24:27]
  v_cvt_pk_bf16_f32 v224, v224, v225
  s_waitcnt lgkmcnt(0)
  v_mfma_f32_16x16x32_bf16 a[136:139], a[208:211], v[128:131], a[136:139]
  v_mfma_f32_16x16x32_bf16 a[136:139], a[212:215], v[160:163], a[136:139]
  ds_read_b64_tr_b16 a[192:193], v16 offset:32768
  ds_read_b64_tr_b16 a[194:195], v16 offset:36864
  v_exp_f32 v228, v228
  v_mfma_f32_16x16x32_bf16 a[168:171], a[208:211], v[136:139], a[168:171]
  v_mfma_f32_16x16x32_bf16 a[168:171], a[212:215], v[168:171], a[168:171]
  v_exp_f32 v229, v229
  v_cvt_pk_bf16_f32 v225, v226, v227
  v_mfma_f32_16x16x32_bf16 a[252:255], a[208:211], v[144:147], a[252:255]
  ds_read_b64_tr_b16 a[196:197], v16 offset:40960
  ds_read_b64_tr_b16 a[198:199], v16 offset:45056
  v_mfma_f32_16x16x32_bf16 a[252:255], a[212:215], v[176:179], a[252:255]
  v_exp_f32 v230, v230
  v_mfma_f32_16x16x32_bf16 a[28:31], a[208:211], v[152:155], a[28:31]
  v_mfma_f32_16x16x32_bf16 a[28:31], a[212:215], v[184:187], a[28:31]
  ds_read_b64_tr_b16 a[200:201], v17 offset:32768
  ds_read_b64_tr_b16 a[202:203], v17 offset:36864
  v_exp_f32 v231, v231
  v_mfma_f32_16x16x32_bf16 a[140:143], a[216:219], v[128:131], a[140:143]
  buffer_store_dwordx4 a[84:87], v47, s[32:35], s56 offen offset:1024 sc0 sc1
  v_mfma_f32_16x16x32_bf16 a[140:143], a[220:223], v[160:163], a[140:143]
  v_cvt_pk_bf16_f32 v226, v228, v229
  v_exp_f32 v200, v200
  v_mfma_f32_16x16x32_bf16 a[228:231], a[240:243], v[136:139], a[228:231]
  v_exp_f32 v201, v201
  v_mfma_f32_16x16x32_bf16 a[228:231], a[240:243], v[168:171], a[228:231]
  v_cvt_pk_bf16_f32 v227, v230, v231
  v_exp_f32 v202, v202
  v_mfma_f32_16x16x32_bf16 a[172:175], a[216:219], v[136:139], a[172:175]
  ds_read_b64_tr_b16 a[204:205], v17 offset:40960
  ds_read_b64_tr_b16 a[206:207], v17 offset:45056
  v_mfma_f32_16x16x32_bf16 a[172:175], a[220:223], v[168:171], a[172:175]
  v_exp_f32 v203, v203
  v_mfma_f32_16x16x32_bf16 a[0:3], a[216:219], v[144:147], a[0:3]
  v_mfma_f32_16x16x32_bf16 a[0:3], a[220:223], v[176:179], a[0:3]
  v_cvt_pk_bf16_f32 v200, v200, v201
  v_exp_f32 v204, v204
  v_mfma_f32_16x16x32_bf16 a[32:35], a[216:219], v[152:155], a[32:35]
  v_mfma_f32_16x16x32_bf16 a[32:35], a[220:223], v[184:187], a[32:35]
  v_exp_f32 v205, v205
  s_waitcnt lgkmcnt(0)
  v_mfma_f32_16x16x32_bf16 a[144:147], a[192:195], v[128:131], a[144:147]
  v_mfma_f32_16x16x32_bf16 a[144:147], a[196:199], v[160:163], a[144:147]
  ds_read_b64_tr_b16 a[208:209], v18 offset:32768
  ds_read_b64_tr_b16 a[210:211], v18 offset:36864
  v_cvt_pk_bf16_f32 v201, v202, v203
  v_mfma_f32_16x16x32_bf16 a[176:179], a[192:195], v[136:139], a[176:179]
  v_mfma_f32_16x16x32_bf16 a[176:179], a[196:199], v[168:171], a[176:179]
  v_exp_f32 v206, v206
  v_exp_f32 v207, v207
  v_mfma_f32_16x16x32_bf16 a[4:7], a[192:195], v[144:147], a[4:7]
  ds_read_b64_tr_b16 a[212:213], v18 offset:40960
  ds_read_b64_tr_b16 a[214:215], v18 offset:45056
  v_mfma_f32_16x16x32_bf16 a[4:7], a[196:199], v[176:179], a[4:7]
  buffer_store_dwordx4 a[88:91], v47, s[32:35], s56 offen offset:2048 sc0 sc1
  v_cvt_pk_bf16_f32 v202, v204, v205
  v_mfma_f32_16x16x32_bf16 a[36:39], a[192:195], v[152:155], a[36:39]
  v_mfma_f32_16x16x32_bf16 a[36:39], a[196:199], v[184:187], a[36:39]
  ds_read_b64_tr_b16 a[216:217], v19 offset:32768
  ds_read_b64_tr_b16 a[218:219], v19 offset:36864
  v_exp_f32 v232, v232
  v_mfma_f32_16x16x32_bf16 a[148:151], a[200:203], v[128:131], a[148:151]
  v_mfma_f32_16x16x32_bf16 a[148:151], a[204:207], v[160:163], a[148:151]
  v_exp_f32 v233, v233
  v_cvt_pk_bf16_f32 v203, v206, v207
  v_mfma_f32_16x16x32_bf16 a[232:235], a[240:243], v[144:147], a[232:235]
  v_exp_f32 v234, v234
  v_mfma_f32_16x16x32_bf16 a[232:235], a[240:243], v[176:179], a[232:235]
  v_exp_f32 v235, v235
  v_mfma_f32_16x16x32_bf16 a[180:183], a[200:203], v[136:139], a[180:183]
  ds_read_b64_tr_b16 a[220:221], v19 offset:40960
  ds_read_b64_tr_b16 a[222:223], v19 offset:45056
  v_mfma_f32_16x16x32_bf16 a[180:183], a[204:207], v[168:171], a[180:183]
  v_cvt_pk_bf16_f32 v232, v232, v233
  v_exp_f32 v236, v236
  v_mfma_f32_16x16x32_bf16 a[8:11], a[200:203], v[144:147], a[8:11]
  s_waitcnt vmcnt(11)
  s_barrier
  v_mfma_f32_16x16x32_bf16 a[8:11], a[204:207], v[176:179], a[8:11]
  v_exp_f32 v237, v237
  v_mfma_f32_16x16x32_bf16 a[40:43], a[200:203], v[152:155], a[40:43]
  v_mfma_f32_16x16x32_bf16 a[40:43], a[204:207], v[184:187], a[40:43]
  v_cvt_pk_bf16_f32 v233, v234, v235
  s_waitcnt lgkmcnt(0)
  v_mfma_f32_16x16x32_bf16 a[152:155], a[208:211], v[128:131], a[152:155]
  v_subrev_u32 v12, 49152, v12
  v_subrev_u32 v13, 49152, v13
  v_subrev_u32 v14, 49152, v14
  v_subrev_u32 v15, 49152, v15
  v_subrev_u32 v16, 49152, v16
  v_subrev_u32 v17, 49152, v17
  v_subrev_u32 v18, 49152, v18
  v_subrev_u32 v19, 49152, v19
  v_mfma_f32_16x16x32_bf16 a[152:155], a[212:215], v[160:163], a[152:155]
  buffer_store_dwordx4 a[92:95], v47, s[32:35], s56 offen offset:3072 sc0 sc1
  v_mfma_f32_16x16x32_bf16 a[184:187], a[208:211], v[136:139], a[184:187]
  v_mfma_f32_16x16x32_bf16 a[184:187], a[212:215], v[168:171], a[184:187]
  ds_read_b64_tr_b16 v[64:65], v12 offset:16384
  v_exp_f32 v238, v238
  v_mfma_f32_16x16x32_bf16 a[12:15], a[208:211], v[144:147], a[12:15]
  ds_read_b64_tr_b16 v[66:67], v12 offset:20480
  v_mfma_f32_16x16x32_bf16 a[12:15], a[212:215], v[176:179], a[12:15]
  ds_read_b64_tr_b16 v[96:97], v12 offset:24576
  ds_read_b64_tr_b16 v[98:99], v12 offset:28672
  v_mfma_f32_16x16x32_bf16 a[44:47], a[208:211], v[152:155], a[44:47]
  ds_read_b64_tr_b16 v[68:69], v13 offset:16384
  v_mfma_f32_16x16x32_bf16 a[44:47], a[212:215], v[184:187], a[44:47]
  ds_read_b64_tr_b16 v[70:71], v13 offset:20480
  v_exp_f32 v239, v239
  v_cvt_pk_bf16_f32 v234, v236, v237
  v_mfma_f32_16x16x32_bf16 a[156:159], a[216:219], v[128:131], a[156:159]
  ds_read_b64_tr_b16 v[100:101], v13 offset:24576
  ds_read_b64_tr_b16 v[102:103], v13 offset:28672
  v_mfma_f32_16x16x32_bf16 a[156:159], a[220:223], v[160:163], a[156:159]
  ds_read_b64_tr_b16 v[72:73], v14 offset:16384
  v_exp_f32 v208, v208
  v_exp_f32 v209, v209
  v_mfma_f32_16x16x32_bf16 a[236:239], a[240:243], v[152:155], a[236:239]
  s_add_u32 s56, s45, 12288
  v_cvt_pk_bf16_f32 v235, v238, v239
  v_mfma_f32_16x16x32_bf16 a[236:239], a[240:243], v[184:187], a[236:239]
  v_exp_f32 v210, v210
  v_mfma_f32_16x16x32_bf16 a[188:191], a[216:219], v[136:139], a[188:191]
  ds_read_b64_tr_b16 v[74:75], v14 offset:20480
  v_mfma_f32_16x16x32_bf16 a[188:191], a[220:223], v[168:171], a[188:191]
  ds_read_b64_tr_b16 v[104:105], v14 offset:24576
  ds_read_b64_tr_b16 v[106:107], v14 offset:28672
  v_exp_f32 v211, v211
  v_cvt_pk_bf16_f32 v208, v208, v209
  v_exp_f32 v212, v212
  v_mfma_f32_16x16x32_bf16 a[16:19], a[216:219], v[144:147], a[16:19]
  ds_read_b64_tr_b16 v[76:77], v15 offset:16384
  v_mfma_f32_16x16x32_bf16 a[16:19], a[220:223], v[176:179], a[16:19]
  ds_read_b64_tr_b16 v[78:79], v15 offset:20480
  v_exp_f32 v213, v213
  v_cvt_pk_bf16_f32 v209, v210, v211
  v_mfma_f32_16x16x32_bf16 v[48:51], a[216:219], v[152:155], v[48:51]
  ds_read_b64_tr_b16 v[108:109], v15 offset:24576
  ds_read_b64_tr_b16 v[110:111], v15 offset:28672
  v_mfma_f32_16x16x32_bf16 v[48:51], a[220:223], v[184:187], v[48:51]
  v_exp_f32 v214, v214
  s_waitcnt lgkmcnt(14)
  v_mfma_f32_16x16x32_bf16 a[128:131], v[64:67], v[192:195], a[128:131]
  ds_read_b64_tr_b16 v[80:81], v16 offset:16384
  ds_read_b64_tr_b16 v[82:83], v16 offset:20480
  s_waitcnt lgkmcnt(14)
  v_mfma_f32_16x16x32_bf16 a[128:131], v[96:99], v[224:227], a[128:131]
  ds_read_b64_tr_b16 v[112:113], v16 offset:24576
  ds_read_b64_tr_b16 v[114:115], v16 offset:28672
  ds_read_b64_tr_b16 v[84:85], v17 offset:16384
  v_exp_f32 v215, v215
  v_cvt_pk_bf16_f32 v210, v212, v213
  v_exp_f32 v240, v240
  v_mfma_f32_16x16x32_bf16 a[224:227], a[240:243], v[192:195], a[224:227]
  v_exp_f32 v241, v241
  v_mfma_f32_16x16x32_bf16 a[224:227], a[240:243], v[224:227], a[224:227]
  v_cvt_pk_bf16_f32 v211, v214, v215
  v_exp_f32 v242, v242
  s_waitcnt lgkmcnt(15)
  v_mfma_f32_16x16x32_bf16 a[132:135], v[68:71], v[192:195], a[132:135]
  ds_read_b64_tr_b16 v[86:87], v17 offset:20480
  ds_read_b64_tr_b16 v[116:117], v17 offset:24576
  ds_read_b64_tr_b16 v[118:119], v17 offset:28672
  s_waitcnt lgkmcnt(15)
  v_mfma_f32_16x16x32_bf16 a[132:135], v[100:103], v[224:227], a[132:135]
  ds_read_b64_tr_b16 v[88:89], v18 offset:16384
  ds_read_b64_tr_b16 v[90:91], v18 offset:20480
  v_exp_f32 v243, v243
  s_waitcnt lgkmcnt(15)
  v_mfma_f32_16x16x32_bf16 a[136:139], v[72:75], v[192:195], a[136:139]
  ds_read_b64_tr_b16 v[120:121], v18 offset:24576
  ds_read_b64_tr_b16 v[122:123], v18 offset:28672
  ds_read_b64_tr_b16 v[92:93], v19 offset:16384
  s_waitcnt lgkmcnt(15)
  v_mfma_f32_16x16x32_bf16 a[136:139], v[104:107], v[224:227], a[136:139]
  ds_read_b64_tr_b16 v[94:95], v19 offset:20480
  ds_read_b64_tr_b16 v[124:125], v19 offset:24576
  ds_read_b64_tr_b16 v[126:127], v19 offset:28672
  v_cvt_pk_bf16_f32 v240, v240, v241
  v_exp_f32 v244, v244
  v_mfma_f32_16x16x32_bf16 a[140:143], v[76:79], v[192:195], a[140:143]
  buffer_store_dwordx4 a[96:99], v47, s[32:35], s56 offen offset:0 sc0 sc1
  s_waitcnt lgkmcnt(15)
  v_mfma_f32_16x16x32_bf16 a[140:143], v[108:111], v[224:227], a[140:143]
  v_exp_f32 v245, v245
  v_cvt_pk_bf16_f32 v241, v242, v243
  s_waitcnt lgkmcnt(14)
  v_mfma_f32_16x16x32_bf16 a[144:147], v[80:83], v[192:195], a[144:147]
  v_exp_f32 v246, v246
  s_waitcnt lgkmcnt(12)
  v_mfma_f32_16x16x32_bf16 a[144:147], v[112:115], v[224:227], a[144:147]
  v_exp_f32 v247, v247
  s_waitcnt lgkmcnt(10)
  v_mfma_f32_16x16x32_bf16 a[148:151], v[84:87], v[192:195], a[148:151]
  v_cvt_pk_bf16_f32 v242, v244, v245
  v_accvgpr_read_b32 v28, a224
  s_waitcnt lgkmcnt(8)
  v_mfma_f32_16x16x32_bf16 a[148:151], v[116:119], v[224:227], a[148:151]
  v_exp_f32 v216, v216
  v_cmp_ngt_f32 vcc, s48, v28
  v_rcp_f32 v28, v28
  s_or_b64 s[50:51], s[50:51], vcc
  v_accvgpr_read_b32 v36, a128
  v_accvgpr_read_b32 v37, a129
  v_accvgpr_read_b32 v38, a130
  s_waitcnt lgkmcnt(6)
  v_mfma_f32_16x16x32_bf16 a[152:155], v[88:91], v[192:195], a[152:155]
  v_exp_f32 v217, v217
  s_waitcnt lgkmcnt(4)
  v_mfma_f32_16x16x32_bf16 a[152:155], v[120:123], v[224:227], a[152:155]
  v_cvt_pk_bf16_f32 v243, v246, v247
  v_accvgpr_read_b32 v39, a131
  v_mul_f32 v36, v36, v28
  v_mul_f32 v37, v37, v28
  v_mul_f32 v38, v38, v28
  v_mul_f32 v39, v39, v28
  v_cvt_pk_bf16_f32 v36, v36, v37
  v_cvt_pk_bf16_f32 v37, v38, v39
  v_accvgpr_read_b32 v40, a132
  v_accvgpr_read_b32 v41, a133
  v_accvgpr_read_b32 v42, a134
  v_accvgpr_read_b32 v43, a135
  s_waitcnt lgkmcnt(2)
  v_mfma_f32_16x16x32_bf16 a[156:159], v[92:95], v[192:195], a[156:159]
  buffer_store_dwordx4 a[100:103], v47, s[32:35], s56 offen offset:1024 sc0 sc1
  ds_write_b64 v32, v[36:37] offset:0
  s_waitcnt lgkmcnt(1)
  v_mfma_f32_16x16x32_bf16 a[156:159], v[124:127], v[224:227], a[156:159]
  v_exp_f32 v218, v218
  v_exp_f32 v219, v219
  v_mul_f32 v40, v40, v28
  v_mul_f32 v41, v41, v28
  v_mul_f32 v42, v42, v28
  v_mul_f32 v43, v43, v28
  v_cvt_pk_bf16_f32 v40, v40, v41
  v_cvt_pk_bf16_f32 v41, v42, v43
  v_accvgpr_read_b32 v36, a136
  v_accvgpr_read_b32 v37, a137
  v_accvgpr_read_b32 v38, a138
  v_accvgpr_read_b32 v39, a139
  v_mfma_f32_16x16x32_bf16 a[160:163], v[64:67], v[200:203], a[160:163]
  ds_write_b64 v33, v[40:41] offset:0
  v_mfma_f32_16x16x32_bf16 a[160:163], v[96:99], v[232:235], a[160:163]
  v_cvt_pk_bf16_f32 v216, v216, v217
  v_exp_f32 v220, v220
  v_mul_f32 v36, v36, v28
  v_mul_f32 v37, v37, v28
  v_mul_f32 v38, v38, v28
  v_mul_f32 v39, v39, v28
  v_cvt_pk_bf16_f32 v36, v36, v37
  v_cvt_pk_bf16_f32 v37, v38, v39
  v_accvgpr_read_b32 v40, a140
  v_accvgpr_read_b32 v41, a141
  v_accvgpr_read_b32 v42, a142
  v_accvgpr_read_b32 v43, a143
  v_mfma_f32_16x16x32_bf16 a[228:231], a[240:243], v[200:203], a[228:231]
  ds_write_b64 v34, v[36:37] offset:0
  v_mfma_f32_16x16x32_bf16 a[228:231], a[240:243], v[232:235], a[228:231]
  v_exp_f32 v221, v221
  v_cvt_pk_bf16_f32 v217, v218, v219
  v_exp_f32 v222, v222
  v_mul_f32 v40, v40, v28
  v_mul_f32 v41, v41, v28
  v_mul_f32 v42, v42, v28
  v_mul_f32 v43, v43, v28
  v_cvt_pk_bf16_f32 v40, v40, v41
  v_cvt_pk_bf16_f32 v41, v42, v43
  v_mfma_f32_16x16x32_bf16 a[164:167], v[68:71], v[200:203], a[164:167]
  v_accvgpr_read_b32 v36, a144
  v_accvgpr_read_b32 v37, a145
  v_mfma_f32_16x16x32_bf16 a[164:167], v[100:103], v[232:235], a[164:167]
  v_exp_f32 v223, v223
  v_cvt_pk_bf16_f32 v218, v220, v221
  v_accvgpr_read_b32 v38, a146
  v_accvgpr_read_b32 v39, a147
  v_mfma_f32_16x16x32_bf16 a[168:171], v[72:75], v[200:203], a[168:171]
  ds_write_b64 v35, v[40:41] offset:0
  v_mfma_f32_16x16x32_bf16 a[168:171], v[104:107], v[232:235], a[168:171]
  v_exp_f32 v248, v248
  v_exp_f32 v249, v249
  v_mul_f32 v36, v36, v28
  v_mul_f32 v37, v37, v28
  v_mul_f32 v38, v38, v28
  v_mul_f32 v39, v39, v28
  v_cvt_pk_bf16_f32 v36, v36, v37
  v_cvt_pk_bf16_f32 v37, v38, v39
  v_accvgpr_read_b32 v40, a148
  v_accvgpr_read_b32 v41, a149
  v_accvgpr_read_b32 v42, a150
  v_accvgpr_read_b32 v43, a151
  v_mfma_f32_16x16x32_bf16 a[172:175], v[76:79], v[200:203], a[172:175]
  ds_write_b64 v32, v[36:37] offset:128
  v_mfma_f32_16x16x32_bf16 a[172:175], v[108:111], v[232:235], a[172:175]
  v_cvt_pk_bf16_f32 v219, v222, v223
  v_exp_f32 v250, v250
  v_mul_f32 v40, v40, v28
  v_mul_f32 v41, v41, v28
  v_mul_f32 v42, v42, v28
  v_mul_f32 v43, v43, v28
  v_cvt_pk_bf16_f32 v40, v40, v41
  v_cvt_pk_bf16_f32 v41, v42, v43
  v_accvgpr_read_b32 v36, a152
  v_accvgpr_read_b32 v37, a153
  v_accvgpr_read_b32 v38, a154
  v_accvgpr_read_b32 v39, a155
  v_mfma_f32_16x16x32_bf16 a[176:179], v[80:83], v[200:203], a[176:179]
  ds_write_b64 v33, v[40:41] offset:128
  v_mfma_f32_16x16x32_bf16 a[176:179], v[112:115], v[232:235], a[176:179]
  v_exp_f32 v251, v251
  v_cvt_pk_bf16_f32 v248, v248, v249
  v_mul_f32 v36, v36, v28
  v_mul_f32 v37, v37, v28
  v_mul_f32 v38, v38, v28
  v_mul_f32 v39, v39, v28
  v_cvt_pk_bf16_f32 v36, v36, v37
  v_cvt_pk_bf16_f32 v37, v38, v39
  v_accvgpr_read_b32 v40, a156
  v_accvgpr_read_b32 v41, a157
  v_accvgpr_read_b32 v42, a158
  v_accvgpr_read_b32 v43, a159
  v_mfma_f32_16x16x32_bf16 a[180:183], v[84:87], v[200:203], a[180:183]
  buffer_store_dwordx4 a[104:107], v47, s[32:35], s56 offen offset:2048 sc0 sc1
  ds_write_b64 v34, v[36:37] offset:128
  v_mfma_f32_16x16x32_bf16 a[180:183], v[116:119], v[232:235], a[180:183]
  v_exp_f32 v252, v252
  v_exp_f32 v253, v253
  v_mul_f32 v40, v40, v28
  v_mul_f32 v41, v41, v28
  v_mul_f32 v42, v42, v28
  v_mul_f32 v43, v43, v28
  v_cvt_pk_bf16_f32 v40, v40, v41
  v_cvt_pk_bf16_f32 v41, v42, v43
  v_accvgpr_read_b32 v29, a228
  v_mfma_f32_16x16x32_bf16 a[184:187], v[88:91], v[200:203], a[184:187]
  ds_write_b64 v35, v[40:41] offset:128
  v_mfma_f32_16x16x32_bf16 a[184:187], v[120:123], v[232:235], a[184:187]
  v_cvt_pk_bf16_f32 v249, v250, v251
  v_exp_f32 v254, v254
  v_cmp_ngt_f32 vcc, s48, v29
  v_rcp_f32 v29, v29
  s_or_b64 s[50:51], s[50:51], vcc
  v_accvgpr_read_b32 v36, a160
  v_accvgpr_read_b32 v37, a161
  v_accvgpr_read_b32 v38, a162
  v_accvgpr_read_b32 v39, a163
  v_mul_f32 v36, v36, v29
  v_mul_f32 v37, v37, v29
  v_mul_f32 v38, v38, v29
  v_mul_f32 v39, v39, v29
  v_cvt_pk_bf16_f32 v36, v36, v37
  v_cvt_pk_bf16_f32 v37, v38, v39
  v_mfma_f32_16x16x32_bf16 a[188:191], v[92:95], v[200:203], a[188:191]
  ds_write_b64 v32, v[36:37] offset:4096
  s_waitcnt lgkmcnt(0)
  ds_read_b128 v[128:131], v46 offset:0
  ds_read_b128 v[136:139], v46 offset:2048
  v_mfma_f32_16x16x32_bf16 a[188:191], v[124:127], v[232:235], a[188:191]
  v_exp_f32 v255, v255
  v_cvt_pk_bf16_f32 v250, v252, v253
  v_cvt_pk_bf16_f32 v251, v254, v255
  v_xor_b32 v46, 64, v46
  v_mfma_f32_16x16x32_bf16 a[244:247], v[64:67], v[208:211], a[244:247]
  ds_read_b128 v[132:135], v46 offset:1024
  ds_read_b128 v[140:143], v46 offset:3072
  v_mfma_f32_16x16x32_bf16 a[244:247], v[96:99], v[240:243], a[244:247]
  v_accvgpr_read_b32 v40, a164
  v_accvgpr_read_b32 v41, a165
  v_accvgpr_read_b32 v42, a166
  v_accvgpr_read_b32 v43, a167
  v_mul_f32 v40, v40, v29
  v_mul_f32 v41, v41, v29
  v_mul_f32 v42, v42, v29
  v_mul_f32 v43, v43, v29
  v_cvt_pk_bf16_f32 v40, v40, v41
  v_cvt_pk_bf16_f32 v41, v42, v43
  v_accvgpr_read_b32 v36, a168
  v_accvgpr_read_b32 v37, a169
  v_accvgpr_read_b32 v38, a170
  v_accvgpr_read_b32 v39, a171
  v_mfma_f32_16x16x32_bf16 a[232:235], a[240:243], v[208:211], a[232:235]
  ds_write_b64 v33, v[40:41] offset:4096
  v_mfma_f32_16x16x32_bf16 a[232:235], a[240:243], v[240:243], a[232:235]
  v_mul_f32 v36, v36, v29
  v_mul_f32 v37, v37, v29
  v_mul_f32 v38, v38, v29
  v_mul_f32 v39, v39, v29
  v_cvt_pk_bf16_f32 v36, v36, v37
  v_cvt_pk_bf16_f32 v37, v38, v39
  v_mfma_f32_16x16x32_bf16 a[248:251], v[68:71], v[208:211], a[248:251]
  ds_write_b64 v34, v[36:37] offset:4096
  s_add_u32 s54, s45, 0
  s_waitcnt lgkmcnt(5)
  buffer_store_dwordx4 v[128:131], v47, s[36:39], s54 offen offset:0 sc0 sc1
  s_waitcnt lgkmcnt(3)
  buffer_store_dwordx4 v[132:135], v47, s[36:39], s54 offen offset:1024 sc0 sc1
  buffer_store_dwordx4 v[136:139], v47, s[36:39], s54 offen offset:2048 sc0 sc1
  s_waitcnt lgkmcnt(2)
  buffer_store_dwordx4 v[140:143], v47, s[36:39], s54 offen offset:3072 sc0 sc1
  v_mfma_f32_16x16x32_bf16 a[248:251], v[100:103], v[240:243], a[248:251]
  v_accvgpr_read_b32 v40, a172
  v_accvgpr_read_b32 v41, a173
  v_accvgpr_read_b32 v42, a174
  v_accvgpr_read_b32 v43, a175
  v_mul_f32 v40, v40, v29
  v_mul_f32 v41, v41, v29
  v_mul_f32 v42, v42, v29
  v_mul_f32 v43, v43, v29
  v_cvt_pk_bf16_f32 v40, v40, v41
  v_cvt_pk_bf16_f32 v41, v42, v43
  v_accvgpr_read_b32 v36, a176
  v_accvgpr_read_b32 v37, a177
  v_accvgpr_read_b32 v38, a178
  v_accvgpr_read_b32 v39, a179
  v_mfma_f32_16x16x32_bf16 a[252:255], v[72:75], v[208:211], a[252:255]
  ds_write_b64 v35, v[40:41] offset:4096
  v_mfma_f32_16x16x32_bf16 a[252:255], v[104:107], v[240:243], a[252:255]
  v_mul_f32 v36, v36, v29
  v_mul_f32 v37, v37, v29
  v_mul_f32 v38, v38, v29
  v_mul_f32 v39, v39, v29
  v_cvt_pk_bf16_f32 v36, v36, v37
  v_cvt_pk_bf16_f32 v37, v38, v39
  v_accvgpr_read_b32 v40, a180
  v_accvgpr_read_b32 v41, a181
  v_accvgpr_read_b32 v42, a182
  v_accvgpr_read_b32 v43, a183
  v_mfma_f32_16x16x32_bf16 a[0:3], v[76:79], v[208:211], a[0:3]
  buffer_store_dwordx4 a[108:111], v47, s[32:35], s56 offen offset:3072 sc0 sc1
  ds_write_b64 v32, v[36:37] offset:4224
  v_mfma_f32_16x16x32_bf16 a[0:3], v[108:111], v[240:243], a[0:3]
  v_mul_f32 v40, v40, v29
  v_mul_f32 v41, v41, v29
  v_mul_f32 v42, v42, v29
  v_mul_f32 v43, v43, v29
  v_cvt_pk_bf16_f32 v40, v40, v41
  v_cvt_pk_bf16_f32 v41, v42, v43
  v_accvgpr_read_b32 v36, a184
  v_accvgpr_read_b32 v37, a185
  v_accvgpr_read_b32 v38, a186
  v_accvgpr_read_b32 v39, a187
  v_mfma_f32_16x16x32_bf16 a[4:7], v[80:83], v[208:211], a[4:7]
  ds_write_b64 v33, v[40:41] offset:4224
  v_mfma_f32_16x16x32_bf16 a[4:7], v[112:115], v[240:243], a[4:7]
  v_mul_f32 v36, v36, v29
  v_mul_f32 v37, v37, v29
  v_mul_f32 v38, v38, v29
  v_mul_f32 v39, v39, v29
  v_cvt_pk_bf16_f32 v36, v36, v37
  v_cvt_pk_bf16_f32 v37, v38, v39
  v_accvgpr_read_b32 v40, a188
  v_accvgpr_read_b32 v41, a189
  v_accvgpr_read_b32 v42, a190
  v_accvgpr_read_b32 v43, a191
  v_mfma_f32_16x16x32_bf16 a[8:11], v[84:87], v[208:211], a[8:11]
  ds_write_b64 v34, v[36:37] offset:4224
  v_mfma_f32_16x16x32_bf16 a[8:11], v[116:119], v[240:243], a[8:11]
  v_mul_f32 v40, v40, v29
  v_mul_f32 v41, v41, v29
  v_mul_f32 v42, v42, v29
  v_mul_f32 v43, v43, v29
  v_cvt_pk_bf16_f32 v40, v40, v41
  v_cvt_pk_bf16_f32 v41, v42, v43
  v_accvgpr_read_b32 v30, a232
  v_mfma_f32_16x16x32_bf16 a[12:15], v[88:91], v[208:211], a[12:15]
  ds_write_b64 v35, v[40:41] offset:4224
  v_mfma_f32_16x16x32_bf16 a[12:15], v[120:123], v[240:243], a[12:15]
  v_cmp_ngt_f32 vcc, s48, v30
  v_rcp_f32 v30, v30
  s_or_b64 s[50:51], s[50:51], vcc
  v_accvgpr_read_b32 v36, a244
  v_accvgpr_read_b32 v37, a245
  v_accvgpr_read_b32 v38, a246
  v_accvgpr_read_b32 v39, a247
  v_mul_f32 v36, v36, v30
  v_mul_f32 v37, v37, v30
  v_mul_f32 v38, v38, v30
  v_mul_f32 v39, v39, v30
  v_cvt_pk_bf16_f32 v36, v36, v37
  v_cvt_pk_bf16_f32 v37, v38, v39
  v_mfma_f32_16x16x32_bf16 a[16:19], v[92:95], v[208:211], a[16:19]
  ds_write_b64 v32, v[36:37] offset:8192
  s_waitcnt lgkmcnt(0)
  ds_read_b128 v[148:151], v46 offset:5120
  ds_read_b128 v[156:159], v46 offset:7168
  v_mfma_f32_16x16x32_bf16 a[16:19], v[124:127], v[240:243], a[16:19]
  v_xor_b32 v46, 64, v46
  v_mfma_f32_16x16x32_bf16 a[20:23], v[64:67], v[216:219], a[20:23]
  ds_read_b128 v[144:147], v46 offset:4096
  ds_read_b128 v[152:155], v46 offset:6144
  v_mfma_f32_16x16x32_bf16 a[20:23], v[96:99], v[248:251], a[20:23]
  v_accvgpr_read_b32 v40, a248
  v_accvgpr_read_b32 v41, a249
  v_accvgpr_read_b32 v42, a250
  v_accvgpr_read_b32 v43, a251
  v_mul_f32 v40, v40, v30
  v_mul_f32 v41, v41, v30
  v_mul_f32 v42, v42, v30
  v_mul_f32 v43, v43, v30
  v_cvt_pk_bf16_f32 v40, v40, v41
  v_cvt_pk_bf16_f32 v41, v42, v43
  v_accvgpr_read_b32 v36, a252
  v_accvgpr_read_b32 v37, a253
  v_accvgpr_read_b32 v38, a254
  v_accvgpr_read_b32 v39, a255
  v_mfma_f32_16x16x32_bf16 a[236:239], a[240:243], v[216:219], a[236:239]
  ds_write_b64 v33, v[40:41] offset:8192
  v_mfma_f32_16x16x32_bf16 a[236:239], a[240:243], v[248:251], a[236:239]
  v_mul_f32 v36, v36, v30
  v_mul_f32 v37, v37, v30
  v_mul_f32 v38, v38, v30
  v_mul_f32 v39, v39, v30
  v_cvt_pk_bf16_f32 v36, v36, v37
  v_cvt_pk_bf16_f32 v37, v38, v39
  v_mfma_f32_16x16x32_bf16 a[24:27], v[68:71], v[216:219], a[24:27]
  ds_write_b64 v34, v[36:37] offset:8192
  s_add_u32 s54, s45, 4096
  s_waitcnt lgkmcnt(3)
  buffer_store_dwordx4 v[144:147], v47, s[36:39], s54 offen offset:0 sc0 sc1
  buffer_store_dwordx4 v[148:151], v47, s[36:39], s54 offen offset:1024 sc0 sc1
L_pad10:
  s_cbranch_execz L_padret
  s_waitcnt lgkmcnt(2)
  buffer_store_dwordx4 v[152:155], v47, s[36:39], s54 offen offset:2048 sc0 sc1
  buffer_store_dwordx4 v[156:159], v47, s[36:39], s54 offen offset:3072 sc0 sc1
  v_mfma_f32_16x16x32_bf16 a[24:27], v[100:103], v[248:251], a[24:27]
  v_accvgpr_read_b32 v40, a0
  v_accvgpr_read_b32 v41, a1
  v_accvgpr_read_b32 v42, a2
  v_accvgpr_read_b32 v43, a3
  v_mul_f32 v40, v40, v30
  v_mul_f32 v41, v41, v30
  v_mul_f32 v42, v42, v30
  v_mul_f32 v43, v43, v30
  v_cvt_pk_bf16_f32 v40, v40, v41
  v_cvt_pk_bf16_f32 v41, v42, v43
  v_accvgpr_read_b32 v36, a4
  v_accvgpr_read_b32 v37, a5
  v_accvgpr_read_b32 v38, a6
  v_accvgpr_read_b32 v39, a7
  v_mfma_f32_16x16x32_bf16 a[28:31], v[72:75], v[216:219], a[28:31]
  ds_write_b64 v35, v[40:41] offset:8192
  v_mfma_f32_16x16x32_bf16 a[28:31], v[104:107], v[248:251], a[28:31]
  v_mul_f32 v36, v36, v30
  v_mul_f32 v37, v37, v30
  v_mul_f32 v38, v38, v30
  v_mul_f32 v39, v39, v30
  v_cvt_pk_bf16_f32 v36, v36, v37
  v_cvt_pk_bf16_f32 v37, v38, v39
  v_accvgpr_read_b32 v40, a8
  v_accvgpr_read_b32 v41, a9
  v_accvgpr_read_b32 v42, a10
  v_accvgpr_read_b32 v43, a11
  v_mfma_f32_16x16x32_bf16 a[32:35], v[76:79], v[216:219], a[32:35]
  ds_write_b64 v32, v[36:37] offset:8320
  v_mfma_f32_16x16x32_bf16 a[32:35], v[108:111], v[248:251], a[32:35]
  v_mul_f32 v40, v40, v30
  v_mul_f32 v41, v41, v30
  v_mul_f32 v42, v42, v30
  v_mul_f32 v43, v43, v30
  v_cvt_pk_bf16_f32 v40, v40, v41
  v_cvt_pk_bf16_f32 v41, v42, v43
  v_accvgpr_read_b32 v36, a12
  v_accvgpr_read_b32 v37, a13
  v_accvgpr_read_b32 v38, a14
  v_accvgpr_read_b32 v39, a15
  v_mfma_f32_16x16x32_bf16 a[36:39], v[80:83], v[216:219], a[36:39]
  ds_write_b64 v33, v[40:41] offset:8320
  v_mfma_f32_16x16x32_bf16 a[36:39], v[112:115], v[248:251], a[36:39]
  v_mul_f32 v36, v36, v30
  v_mul_f32 v37, v37, v30
  v_mul_f32 v38, v38, v30
  v_mul_f32 v39, v39, v30
  v_cvt_pk_bf16_f32 v36, v36, v37
  v_cvt_pk_bf16_f32 v37, v38, v39
  v_accvgpr_read_b32 v40, a16
  v_accvgpr_read_b32 v41, a17
  v_accvgpr_read_b32 v42, a18
  v_accvgpr_read_b32 v43, a19
  v_mfma_f32_16x16x32_bf16 a[40:43], v[84:87], v[216:219], a[40:43]
  ds_write_b64 v34, v[36:37] offset:8320
  v_mfma_f32_16x16x32_bf16 a[40:43], v[116:119], v[248:251], a[40:43]
  v_mul_f32 v40, v40, v30
  v_mul_f32 v41, v41, v30
  v_mul_f32 v42, v42, v30
  v_mul_f32 v43, v43, v30
  v_cvt_pk_bf16_f32 v40, v40, v41
  v_cvt_pk_bf16_f32 v41, v42, v43
  v_accvgpr_read_b32 v31, a236
  v_mfma_f32_16x16x32_bf16 a[44:47], v[88:91], v[216:219], a[44:47]
  ds_write_b64 v35, v[40:41] offset:8320
  v_mfma_f32_16x16x32_bf16 a[44:47], v[120:123], v[248:251], a[44:47]
  v_cmp_ngt_f32 vcc, s48, v31
  v_rcp_f32 v31, v31
  s_or_b64 s[50:51], s[50:51], vcc
  v_accvgpr_read_b32 v36, a20
  v_accvgpr_read_b32 v37, a21
  v_accvgpr_read_b32 v38, a22
  v_accvgpr_read_b32 v39, a23
  v_mul_f32 v36, v36, v31
  v_mul_f32 v37, v37, v31
  v_mul_f32 v38, v38, v31
  v_mul_f32 v39, v39, v31
  v_cvt_pk_bf16_f32 v36, v36, v37
  v_cvt_pk_bf16_f32 v37, v38, v39
  v_mfma_f32_16x16x32_bf16 v[48:51], v[92:95], v[216:219], v[48:51]
  ds_write_b64 v32, v[36:37] offset:12288
  s_waitcnt lgkmcnt(0)
  ds_read_b128 v[160:163], v46 offset:8192
  ds_read_b128 v[168:171], v46 offset:10240
  v_mfma_f32_16x16x32_bf16 v[48:51], v[124:127], v[248:251], v[48:51]
  v_xor_b32 v46, 64, v46
  ds_read_b128 v[164:167], v46 offset:9216
  ds_read_b128 v[172:175], v46 offset:11264
  v_accvgpr_read_b32 v40, a24
  v_accvgpr_read_b32 v41, a25
  v_accvgpr_read_b32 v42, a26
  v_accvgpr_read_b32 v43, a27
  v_mul_f32 v40, v40, v31
  v_mul_f32 v41, v41, v31
  v_mul_f32 v42, v42, v31
  v_mul_f32 v43, v43, v31
  v_cvt_pk_bf16_f32 v40, v40, v41
  v_cvt_pk_bf16_f32 v41, v42, v43
  v_accvgpr_read_b32 v36, a28
  v_accvgpr_read_b32 v37, a29
  v_accvgpr_read_b32 v38, a30
  v_accvgpr_read_b32 v39, a31
  ds_write_b64 v33, v[40:41] offset:12288
  v_mul_f32 v36, v36, v31
  v_mul_f32 v37, v37, v31
  v_mul_f32 v38, v38, v31
  v_mul_f32 v39, v39, v31
  v_cvt_pk_bf16_f32 v36, v36, v37
  v_cvt_pk_bf16_f32 v37, v38, v39
  ds_write_b64 v34, v[36:37] offset:12288
  s_add_u32 s54, s45, 8192
  s_waitcnt lgkmcnt(5)
  buffer_store_dwordx4 v[160:163], v47, s[36:39], s54 offen offset:0 sc0 sc1
  s_waitcnt lgkmcnt(3)
  buffer_store_dwordx4 v[164:167], v47, s[36:39], s54 offen offset:1024 sc0 sc1
  buffer_store_dwordx4 v[168:171], v47, s[36:39], s54 offen offset:2048 sc0 sc1
  s_waitcnt lgkmcnt(2)
  buffer_store_dwordx4 v[172:175], v47, s[36:39], s54 offen offset:3072 sc0 sc1
  v_accvgpr_read_b32 v40, a32
  v_accvgpr_read_b32 v41, a33
  v_accvgpr_read_b32 v42, a34
  v_accvgpr_read_b32 v43, a35
  v_mul_f32 v40, v40, v31
  v_mul_f32 v41, v41, v31
  v_mul_f32 v42, v42, v31
  v_mul_f32 v43, v43, v31
  v_cvt_pk_bf16_f32 v40, v40, v41
  v_cvt_pk_bf16_f32 v41, v42, v43
  v_accvgpr_read_b32 v36, a36
  v_accvgpr_read_b32 v37, a37
  v_accvgpr_read_b32 v38, a38
  v_accvgpr_read_b32 v39, a39
  ds_write_b64 v35, v[40:41] offset:12288
  v_mul_f32 v36, v36, v31
  v_mul_f32 v37, v37, v31
  v_mul_f32 v38, v38, v31
  v_mul_f32 v39, v39, v31
  v_cvt_pk_bf16_f32 v36, v36, v37
  v_cvt_pk_bf16_f32 v37, v38, v39
  v_accvgpr_read_b32 v40, a40
  v_accvgpr_read_b32 v41, a41
  v_accvgpr_read_b32 v42, a42
  v_accvgpr_read_b32 v43, a43
  ds_write_b64 v32, v[36:37] offset:12416
  v_mul_f32 v40, v40, v31
  v_mul_f32 v41, v41, v31
  v_mul_f32 v42, v42, v31
  v_mul_f32 v43, v43, v31
  v_cvt_pk_bf16_f32 v40, v40, v41
  v_cvt_pk_bf16_f32 v41, v42, v43
  v_accvgpr_read_b32 v36, a44
  v_accvgpr_read_b32 v37, a45
  v_accvgpr_read_b32 v38, a46
  v_accvgpr_read_b32 v39, a47
  ds_write_b64 v33, v[40:41] offset:12416
  v_mul_f32 v36, v36, v31
  v_mul_f32 v37, v37, v31
  v_mul_f32 v38, v38, v31
  v_mul_f32 v39, v39, v31
  v_cvt_pk_bf16_f32 v36, v36, v37
  v_cvt_pk_bf16_f32 v37, v38, v39
  v_mul_f32 v40, v48, v31
  v_mul_f32 v41, v49, v31
  v_mul_f32 v42, v50, v31
  v_mul_f32 v43, v51, v31
  ds_write_b64 v34, v[36:37] offset:12416
  v_cvt_pk_bf16_f32 v40, v40, v41
  v_cvt_pk_bf16_f32 v41, v42, v43
  ds_write_b64 v35, v[40:41] offset:12416
  s_waitcnt lgkmcnt(0)
  ds_read_b128 v[180:183], v46 offset:13312
  ds_read_b128 v[188:191], v46 offset:15360
  v_xor_b32 v46, 64, v46
  ds_read_b128 v[176:179], v46 offset:12288
  ds_read_b128 v[184:187], v46 offset:14336
  s_add_u32 s54, s45, 12288
  s_waitcnt lgkmcnt(1)
  buffer_store_dwordx4 v[176:179], v47, s[36:39], s54 offen offset:0 sc0 sc1
  buffer_store_dwordx4 v[180:183], v47, s[36:39], s54 offen offset:1024 sc0 sc1
  s_waitcnt lgkmcnt(0)
  buffer_store_dwordx4 v[184:187], v47, s[36:39], s54 offen offset:2048 sc0 sc1
  buffer_store_dwordx4 v[188:191], v47, s[36:39], s54 offen offset:3072 sc0 sc1
  s_cmp_lg_u64 s[50:51], 0
  s_cselect_b32 s46, 1, 0
  s_lshl_b32 s56, s3, 2
  s_add_u32 s56, s56, 32768
  v_mov_b32 v8, s46
  v_mov_b32 v9, s56
  v_mov_b32 v10, 32768
  ds_write_b32 v9, v8
  s_waitcnt lgkmcnt(0)
  s_barrier
  ds_read_b128 v[12:15], v10
  s_waitcnt lgkmcnt(0)
  v_or3_b32 v12, v12, v13, v14
  v_or_b32 v12, v12, v15
  s_nop 0
  v_readfirstlane_b32 s46, v12
  s_nop 0
  s_cmp_lg_u32 s46, 0
  s_cbranch_scc1 LS_entry
L_end:
  s_endpgm
LS_entry:
  s_waitcnt vmcnt(0) lgkmcnt(0)
  s_lshl_b32 s46, s3, 6
  v_or_b32 v0, s46, v0
  s_cmp_ge_u32 s2, 256
  s_cbranch_scc1 LS_end
  s_load_dwordx4 s[92:95], s[0:1], 0
  s_load_dwordx4 s[96:99], s[0:1], 16
  v_lshrrev_b32 v25, 6, v0
  v_and_b32 v0, 63, v0
  v_readfirstlane_b32 s3, v25
  v_lshrrev_b32 v23, 4, v0
  v_and_b32 v24, 15, v0
  v_xor_b32 v22, v24, v23
  v_lshlrev_b32 v22, 4, v22
  v_lshl_add_u32 v1, v23, 8, v22
  v_xor_b32 v2, 64, v1
  v_xor_b32 v3, 128, v1
  v_xor_b32 v4, 192, v1
  s_lshl_b32 s44, s3, 12
  s_lshl_b32 s45, s3, 14
  s_add_u32 s55, s45, 98304
  s_lshl_b32 s54, s2, 16
  s_lshl_b32 s56, s2, 17
  s_mov_b32 s82, s44
  s_mov_b32 s11, 0x20000
  s_mov_b32 s27, 0x20000
  s_mov_b32 s10, 131072
  s_mov_b32 s26, 65536
  s_waitcnt lgkmcnt(0)
  s_add_u32 s8, s94, s56
  s_addc_u32 s9, s95, 0
  s_and_b32 s9, s9, 0xffff
  s_add_u32 m0, s44, 0
  s_nop 0
  buffer_load_dwordx4 v1, s[8:11], s82 offen offset:0 nt lds
  buffer_load_dwordx4 v2, s[8:11], s82 offen offset:1024 nt lds
  buffer_load_dwordx4 v3, s[8:11], s82 offen offset:2048 nt lds
  buffer_load_dwordx4 v4, s[8:11], s82 offen offset:3072 nt lds
  s_add_u32 s24, s92, s54
  s_addc_u32 s25, s93, 0
  s_and_b32 s25, s25, 0xffff
  s_add_u32 m0, s55, 0
  s_add_u32 s46, s45, 0
  buffer_load_dwordx4 v1, s[24:27], s46 offen offset:0 nt lds
  buffer_load_dwordx4 v2, s[24:27], s46 offen offset:1024 nt lds
  buffer_load_dwordx4 v3, s[24:27], s46 offen offset:2048 nt lds
  buffer_load_dwordx4 v4, s[24:27], s46 offen offset:3072 nt lds
  s_add_u32 m0, s55, 4096
  s_add_u32 s46, s45, 4096
  buffer_load_dwordx4 v1, s[24:27], s46 offen offset:0 nt lds
  buffer_load_dwordx4 v2, s[24:27], s46 offen offset:1024 nt lds
  buffer_load_dwordx4 v3, s[24:27], s46 offen offset:2048 nt lds
  buffer_load_dwordx4 v4, s[24:27], s46 offen offset:3072 nt lds
  s_add_u32 s12, s96, s56
  s_addc_u32 s13, s97, 0
  s_and_b32 s13, s13, 0xffff
  s_mov_b32 s14, 131072
  s_mov_b32 s15, 0x20000
  s_add_u32 s83, s82, 16384
  s_add_u32 s84, s82, 32768
  s_add_u32 s85, s82, 49152
  s_add_u32 s86, s82, 65536
  s_add_u32 s87, s82, 81920
  s_add_u32 s88, s82, 98304
  s_add_u32 s89, s82, 114688
  v_lshl_add_u32 v8, v24, 8, v22
  v_xor_b32 v9, 64, v8
  v_xor_b32 v10, 128, v8
  v_xor_b32 v11, 192, v8
  v_lshlrev_b32 v22, 1, v23
  v_xor_b32 v22, v24, v22
  v_lshlrev_b32 v22, 4, v22
  v_lshl_add_u32 v5, v23, 8, v22
  v_xor_b32 v6, 128, v5
  v_lshrrev_b32 v20, 2, v0
  v_and_b32 v21, 7, v20
  v_lshlrev_b32 v20, 8, v20
  v_lshl_add_u32 v20, v21, 5, v20
  v_and_b32 v21, 3, v0
  v_lshl_add_u32 v20, v21, 3, v20
  v_add_u32 v12, 49152, v20
  v_xor_b32 v13, 32, v12
  v_xor_b32 v14, 64, v12
  v_xor_b32 v15, 96, v12
  v_xor_b32 v16, 128, v12
  v_xor_b32 v17, 160, v12
  v_xor_b32 v18, 192, v12
  v_xor_b32 v19, 224, v12
  v_lshrrev_b32 v20, 5, v0
  v_and_b32 v21, 7, v0
  v_xor_b32 v20, v20, v21
  v_lshlrev_b32 v20, 4, v20
  v_lshl_add_u32 v20, v24, 8, v20
  v_and_b32 v21, 1, v23
  v_lshl_add_u32 v20, v21, 3, v20
  v_add_u32 v32, s55, v20
  v_xor_b32 v33, 32, v32
  v_xor_b32 v34, 64, v32
  v_xor_b32 v35, 96, v32
  v_lshlrev_b32 v47, 4, v0
  v_add_u32 v46, s55, v1
  v_and_b32 v22, 3, v0
  v_cmp_eq_u32 vcc, 0, v22
  v_mov_b32 v21, 0x3f803f80
  s_nop 0
  v_cndmask_b32 v22, 0, v21, vcc
  v_accvgpr_write_b32 a240, v22
  v_accvgpr_write_b32 a241, v22
  v_accvgpr_write_b32 a242, v22
  v_accvgpr_write_b32 a243, v22
  s_mov_b32 s47, 0x3e0293ee
  s_mov_b32 s48, 0x41800000
  s_add_u32 s28, s92, s54
  s_addc_u32 s29, s93, 0
  s_add_u32 s28, s28, 16777216
  s_addc_u32 s29, s29, 0
  s_and_b32 s29, s29, 0xffff
  s_mov_b32 s30, 65536
  s_mov_b32 s31, 0x20000
  s_add_u32 s16, s94, s56
  s_addc_u32 s17, s95, 0
  s_add_u32 s16, s16, 33554432
  s_addc_u32 s17, s17, 0
  s_and_b32 s17, s17, 0xffff
  s_mov_b32 s18, 131072
  s_mov_b32 s19, 0x20000
  s_add_u32 s20, s96, s56
  s_addc_u32 s21, s97, 0
  s_add_u32 s20, s20, 33554432
  s_addc_u32 s21, s21, 0
  s_and_b32 s21, s21, 0xffff
  s_mov_b32 s22, 131072
  s_mov_b32 s23, 0x20000
  s_lshl_b32 s54, s2, 16
  s_add_u32 s32, s98, s54
  s_addc_u32 s33, s99, 0
  s_and_b32 s33, s33, 0xffff
  s_mov_b32 s34, 65536
  s_mov_b32 s35, 0x20000
  s_add_u32 s36, s98, s54
  s_addc_u32 s37, s99, 0
  s_add_u32 s36, s36, 16777216
  s_addc_u32 s37, s37, 0
  s_and_b32 s37, s37, 0xffff
  s_mov_b32 s38, 65536
  s_mov_b32 s39, 0x20000
  v_add_u32 v28, s55, v8
  v_add_u32 v29, s55, v9
  v_add_u32 v30, s55, v10
  v_add_u32 v31, s55, v11
  s_waitcnt vmcnt(8)
  s_barrier
  s_add_u32 m0, s55, 8192
  s_add_u32 s46, s45, 8192
  buffer_load_dwordx4 v1, s[24:27], s46 offen offset:0 nt lds
  buffer_load_dwordx4 v2, s[24:27], s46 offen offset:1024 nt lds
  buffer_load_dwordx4 v3, s[24:27], s46 offen offset:2048 nt lds
  buffer_load_dwordx4 v4, s[24:27], s46 offen offset:3072 nt lds
  ds_read_b128 a[0:3], v8 offset:0
  ds_read_b128 a[4:7], v9 offset:0
  ds_read_b128 a[8:11], v10 offset:0
  ds_read_b128 a[12:15], v11 offset:0
  ds_read_b128 a[16:19], v8 offset:4096
  ds_read_b128 a[20:23], v9 offset:4096
  ds_read_b128 a[24:27], v10 offset:4096
  ds_read_b128 a[28:31], v11 offset:4096
  ds_read_b128 a[32:35], v8 offset:8192
  ds_read_b128 a[36:39], v9 offset:8192
  ds_read_b128 a[40:43], v10 offset:8192
  ds_read_b128 a[44:47], v11 offset:8192
  ds_read_b128 a[48:51], v8 offset:12288
  ds_read_b128 a[52:55], v9 offset:12288
  ds_read_b128 a[56:59], v10 offset:12288
  ds_read_b128 a[60:63], v11 offset:12288
  s_waitcnt vmcnt(8)
  ds_read_b128 v[192:195], v28 offset:0
  ds_read_b128 v[196:199], v29 offset:0
  ds_read_b128 v[200:203], v30 offset:0
  ds_read_b128 v[204:207], v31 offset:0
  s_add_u32 m0, s55, 12288
  s_add_u32 s46, s45, 12288
  buffer_load_dwordx4 v1, s[24:27], s46 offen offset:0 nt lds
  buffer_load_dwordx4 v2, s[24:27], s46 offen offset:1024 nt lds
  buffer_load_dwordx4 v3, s[24:27], s46 offen offset:2048 nt lds
  buffer_load_dwordx4 v4, s[24:27], s46 offen offset:3072 nt lds
  s_waitcnt lgkmcnt(3)
  v_lshlrev_b32 v40, 16, v192
  v_lshlrev_b32 v41, 16, v193
  v_lshlrev_b32 v42, 16, v194
  v_lshlrev_b32 v43, 16, v195
  v_and_b32 v192, 0xffff0000, v192
  v_and_b32 v193, 0xffff0000, v193
  v_and_b32 v194, 0xffff0000, v194
  v_and_b32 v195, 0xffff0000, v195
  v_mul_f32 v40, s47, v40
  v_mul_f32 v41, s47, v41
  v_mul_f32 v42, s47, v42
  v_mul_f32 v43, s47, v43
  v_mul_f32 v192, s47, v192
  v_mul_f32 v193, s47, v193
  v_mul_f32 v194, s47, v194
  v_mul_f32 v195, s47, v195
  v_cvt_pk_bf16_f32 v192, v40, v192
  v_cvt_pk_bf16_f32 v193, v41, v193
  v_cvt_pk_bf16_f32 v194, v42, v194
  v_cvt_pk_bf16_f32 v195, v43, v195
  s_waitcnt lgkmcnt(2)
  v_lshlrev_b32 v40, 16, v196
  v_lshlrev_b32 v41, 16, v197
  v_lshlrev_b32 v42, 16, v198
  v_lshlrev_b32 v43, 16, v199
  v_and_b32 v196, 0xffff0000, v196
  v_and_b32 v197, 0xffff0000, v197
  v_and_b32 v198, 0xffff0000, v198
  v_and_b32 v199, 0xffff0000, v199
  v_mul_f32 v40, s47, v40
  v_mul_f32 v41, s47, v41
  v_mul_f32 v42, s47, v42
  v_mul_f32 v43, s47, v43
  v_mul_f32 v196, s47, v196
  v_mul_f32 v197, s47, v197
  v_mul_f32 v198, s47, v198
  v_mul_f32 v199, s47, v199
  v_cvt_pk_bf16_f32 v196, v40, v196
  v_cvt_pk_bf16_f32 v197, v41, v197
  v_cvt_pk_bf16_f32 v198, v42, v198
  v_cvt_pk_bf16_f32 v199, v43, v199
  s_waitcnt lgkmcnt(1)
  v_lshlrev_b32 v40, 16, v200
  v_lshlrev_b32 v41, 16, v201
  v_lshlrev_b32 v42, 16, v202
  v_lshlrev_b32 v43, 16, v203
  v_and_b32 v200, 0xffff0000, v200
  v_and_b32 v201, 0xffff0000, v201
  v_and_b32 v202, 0xffff0000, v202
  v_and_b32 v203, 0xffff0000, v203
  v_mul_f32 v40, s47, v40
  v_mul_f32 v41, s47, v41
  v_mul_f32 v42, s47, v42
  v_mul_f32 v43, s47, v43
  v_mul_f32 v200, s47, v200
  v_mul_f32 v201, s47, v201
  v_mul_f32 v202, s47, v202
  v_mul_f32 v203, s47, v203
  v_cvt_pk_bf16_f32 v200, v40, v200
  v_cvt_pk_bf16_f32 v201, v41, v201
  v_cvt_pk_bf16_f32 v202, v42, v202
  v_cvt_pk_bf16_f32 v203, v43, v203
  s_waitcnt lgkmcnt(0)
  v_lshlrev_b32 v40, 16, v204
  v_lshlrev_b32 v41, 16, v205
  v_lshlrev_b32 v42, 16, v206
  v_lshlrev_b32 v43, 16, v207
  v_and_b32 v204, 0xffff0000, v204
  v_and_b32 v205, 0xffff0000, v205
  v_and_b32 v206, 0xffff0000, v206
  v_and_b32 v207, 0xffff0000, v207
  v_mul_f32 v40, s47, v40
  v_mul_f32 v41, s47, v41
  v_mul_f32 v42, s47, v42
  v_mul_f32 v43, s47, v43
  v_mul_f32 v204, s47, v204
  v_mul_f32 v205, s47, v205
  v_mul_f32 v206, s47, v206
  v_mul_f32 v207, s47, v207
  v_cvt_pk_bf16_f32 v204, v40, v204
  v_cvt_pk_bf16_f32 v205, v41, v205
  v_cvt_pk_bf16_f32 v206, v42, v206
  v_cvt_pk_bf16_f32 v207, v43, v207
  v_mfma_f32_16x16x32_bf16 v[128:131], a[0:3], v[192:195], 0
  v_accvgpr_write_b32 a128, v192
  v_mfma_f32_16x16x32_bf16 v[128:131], a[4:7], v[196:199], v[128:131]
  v_accvgpr_write_b32 a129, v193
  v_mfma_f32_16x16x32_bf16 v[128:131], a[8:11], v[200:203], v[128:131]
  v_accvgpr_write_b32 a130, v194
  v_mfma_f32_16x16x32_bf16 v[128:131], a[12:15], v[204:207], v[128:131]
  v_accvgpr_write_b32 a131, v195
  v_mfma_f32_16x16x32_bf16 v[132:135], a[16:19], v[192:195], 0
  v_accvgpr_write_b32 a132, v196
  v_mfma_f32_16x16x32_bf16 v[132:135], a[20:23], v[196:199], v[132:135]
  v_accvgpr_write_b32 a133, v197
  v_mfma_f32_16x16x32_bf16 v[132:135], a[24:27], v[200:203], v[132:135]
  v_accvgpr_write_b32 a134, v198
  v_mfma_f32_16x16x32_bf16 v[132:135], a[28:31], v[204:207], v[132:135]
  v_accvgpr_write_b32 a135, v199
  v_mfma_f32_16x16x32_bf16 v[160:163], a[32:35], v[192:195], 0
  v_accvgpr_write_b32 a136, v200
  v_mfma_f32_16x16x32_bf16 v[160:163], a[36:39], v[196:199], v[160:163]
  v_accvgpr_write_b32 a137, v201
  v_mfma_f32_16x16x32_bf16 v[160:163], a[40:43], v[200:203], v[160:163]
  v_accvgpr_write_b32 a138, v202
  v_mfma_f32_16x16x32_bf16 v[160:163], a[44:47], v[204:207], v[160:163]
  v_accvgpr_write_b32 a139, v203
  v_mfma_f32_16x16x32_bf16 v[164:167], a[48:51], v[192:195], 0
  v_accvgpr_write_b32 a140, v204
  v_mfma_f32_16x16x32_bf16 v[164:167], a[52:55], v[196:199], v[164:167]
  v_accvgpr_write_b32 a141, v205
  v_mfma_f32_16x16x32_bf16 v[164:167], a[56:59], v[200:203], v[164:167]
  v_accvgpr_write_b32 a142, v206
  v_mfma_f32_16x16x32_bf16 v[164:167], a[60:63], v[204:207], v[164:167]
  v_accvgpr_write_b32 a143, v207
  v_max3_f32 v44, v128, v129, v130
  v_max3_f32 v45, v131, v132, v133
  v_max3_f32 v44, v44, v134, v135
  v_max3_f32 v45, v45, v160, v161
  v_max3_f32 v44, v44, v162, v163
  s_nop 1
  v_max3_f32 v45, v45, v164, v165
  v_max3_f32 v44, v44, v166, v167
  v_max_f32 v44, v44, v45
  v_mov_b32 v24, v44
  s_nop 1
  v_permlane32_swap_b32 v44, v24
  v_max_f32 v44, v44, v24
  v_mov_b32 v24, v44
  s_nop 1
  v_permlane16_swap_b32 v44, v24
  v_max_f32 v44, v44, v24
  v_sub_f32 v20, 0, v44
  v_sub_f32 v21, 0, v44
  v_sub_f32 v22, 0, v44
  v_sub_f32 v23, 0, v44
  v_add_f32 v128, v128, v20
  v_add_f32 v129, v129, v20
  v_exp_f32 v128, v128
  v_add_f32 v130, v130, v20
  v_exp_f32 v129, v129
  v_add_f32 v131, v131, v20
  v_exp_f32 v130, v130
  v_add_f32 v132, v132, v20
  v_exp_f32 v131, v131
  v_cvt_pk_bf16_f32 v128, v128, v129
  v_add_f32 v133, v133, v20
  v_exp_f32 v132, v132
  v_add_f32 v134, v134, v20
  v_exp_f32 v133, v133
  v_cvt_pk_bf16_f32 v129, v130, v131
  v_add_f32 v135, v135, v20
  v_exp_f32 v134, v134
  v_exp_f32 v135, v135
  v_cvt_pk_bf16_f32 v130, v132, v133
  v_cvt_pk_bf16_f32 v131, v134, v135
  s_waitcnt vmcnt(8)
  ds_read_b128 v[208:211], v28 offset:4096
  ds_read_b128 v[212:215], v29 offset:4096
  ds_read_b128 v[216:219], v30 offset:4096
  ds_read_b128 v[220:223], v31 offset:4096
  s_add_u32 m0, s44, 16384
  s_nop 0
  buffer_load_dwordx4 v1, s[8:11], s83 offen offset:0 nt lds
  buffer_load_dwordx4 v2, s[8:11], s83 offen offset:1024 nt lds
  buffer_load_dwordx4 v3, s[8:11], s83 offen offset:2048 nt lds
  buffer_load_dwordx4 v4, s[8:11], s83 offen offset:3072 nt lds
  s_waitcnt lgkmcnt(3)
  v_lshlrev_b32 v40, 16, v208
  v_lshlrev_b32 v41, 16, v209
  v_lshlrev_b32 v42, 16, v210
  v_lshlrev_b32 v43, 16, v211
  v_and_b32 v208, 0xffff0000, v208
  v_and_b32 v209, 0xffff0000, v209
  v_and_b32 v210, 0xffff0000, v210
  v_and_b32 v211, 0xffff0000, v211
  v_mul_f32 v40, s47, v40
  v_mul_f32 v41, s47, v41
  v_mul_f32 v42, s47, v42
  v_mul_f32 v43, s47, v43
  v_mul_f32 v208, s47, v208
  v_mul_f32 v209, s47, v209
  v_mul_f32 v210, s47, v210
  v_mul_f32 v211, s47, v211
  v_cvt_pk_bf16_f32 v208, v40, v208
  v_cvt_pk_bf16_f32 v209, v41, v209
  v_cvt_pk_bf16_f32 v210, v42, v210
  v_cvt_pk_bf16_f32 v211, v43, v211
  s_waitcnt lgkmcnt(2)
  v_lshlrev_b32 v40, 16, v212
  v_lshlrev_b32 v41, 16, v213
  v_lshlrev_b32 v42, 16, v214
  v_lshlrev_b32 v43, 16, v215
  v_and_b32 v212, 0xffff0000, v212
  v_and_b32 v213, 0xffff0000, v213
  v_and_b32 v214, 0xffff0000, v214
  v_and_b32 v215, 0xffff0000, v215
  v_mul_f32 v40, s47, v40
  v_mul_f32 v41, s47, v41
  v_mul_f32 v42, s47, v42
  v_mul_f32 v43, s47, v43
  v_mul_f32 v212, s47, v212
  v_mul_f32 v213, s47, v213
  v_mul_f32 v214, s47, v214
  v_mul_f32 v215, s47, v215
  v_cvt_pk_bf16_f32 v212, v40, v212
  v_cvt_pk_bf16_f32 v213, v41, v213
  v_cvt_pk_bf16_f32 v214, v42, v214
  v_cvt_pk_bf16_f32 v215, v43, v215
  s_waitcnt lgkmcnt(1)
  v_lshlrev_b32 v40, 16, v216
  v_lshlrev_b32 v41, 16, v217
  v_lshlrev_b32 v42, 16, v218
  v_lshlrev_b32 v43, 16, v219
  v_and_b32 v216, 0xffff0000, v216
  v_and_b32 v217, 0xffff0000, v217
  v_and_b32 v218, 0xffff0000, v218
  v_and_b32 v219, 0xffff0000, v219
  v_mul_f32 v40, s47, v40
  v_mul_f32 v41, s47, v41
  v_mul_f32 v42, s47, v42
  v_mul_f32 v43, s47, v43
  v_mul_f32 v216, s47, v216
  v_mul_f32 v217, s47, v217
  v_mul_f32 v218, s47, v218
  v_mul_f32 v219, s47, v219
  v_cvt_pk_bf16_f32 v216, v40, v216
  v_cvt_pk_bf16_f32 v217, v41, v217
  v_cvt_pk_bf16_f32 v218, v42, v218
  v_cvt_pk_bf16_f32 v219, v43, v219
  s_waitcnt lgkmcnt(0)
  v_lshlrev_b32 v40, 16, v220
  v_lshlrev_b32 v41, 16, v221
  v_lshlrev_b32 v42, 16, v222
  v_lshlrev_b32 v43, 16, v223
  v_and_b32 v220, 0xffff0000, v220
  v_and_b32 v221, 0xffff0000, v221
  v_and_b32 v222, 0xffff0000, v222
  v_and_b32 v223, 0xffff0000, v223
  v_mul_f32 v40, s47, v40
  v_mul_f32 v41, s47, v41
  v_mul_f32 v42, s47, v42
  v_mul_f32 v43, s47, v43
  v_mul_f32 v220, s47, v220
  v_mul_f32 v221, s47, v221
  v_mul_f32 v222, s47, v222
  v_mul_f32 v223, s47, v223
  v_cvt_pk_bf16_f32 v220, v40, v220
  v_cvt_pk_bf16_f32 v221, v41, v221
  v_cvt_pk_bf16_f32 v222, v42, v222
  v_cvt_pk_bf16_f32 v223, v43, v223
  v_mfma_f32_16x16x32_bf16 v[136:139], a[0:3], v[208:211], 0
  v_accvgpr_write_b32 a144, v208
  v_mfma_f32_16x16x32_bf16 v[136:139], a[4:7], v[212:215], v[136:139]
  v_accvgpr_write_b32 a145, v209
  v_mfma_f32_16x16x32_bf16 v[136:139], a[8:11], v[216:219], v[136:139]
  v_accvgpr_write_b32 a146, v210
  v_mfma_f32_16x16x32_bf16 v[136:139], a[12:15], v[220:223], v[136:139]
  v_accvgpr_write_b32 a147, v211
  v_mfma_f32_16x16x32_bf16 v[140:143], a[16:19], v[208:211], 0
  v_accvgpr_write_b32 a148, v212
  v_mfma_f32_16x16x32_bf16 v[140:143], a[20:23], v[212:215], v[140:143]
  v_accvgpr_write_b32 a149, v213
  v_mfma_f32_16x16x32_bf16 v[140:143], a[24:27], v[216:219], v[140:143]
  v_accvgpr_write_b32 a150, v214
  v_mfma_f32_16x16x32_bf16 v[140:143], a[28:31], v[220:223], v[140:143]
  v_accvgpr_write_b32 a151, v215
  v_mfma_f32_16x16x32_bf16 v[168:171], a[32:35], v[208:211], 0
  v_accvgpr_write_b32 a152, v216
  v_mfma_f32_16x16x32_bf16 v[168:171], a[36:39], v[212:215], v[168:171]
  v_accvgpr_write_b32 a153, v217
  v_mfma_f32_16x16x32_bf16 v[168:171], a[40:43], v[216:219], v[168:171]
  v_accvgpr_write_b32 a154, v218
  v_mfma_f32_16x16x32_bf16 v[168:171], a[44:47], v[220:223], v[168:171]
  v_accvgpr_write_b32 a155, v219
  v_mfma_f32_16x16x32_bf16 v[172:175], a[48:51], v[208:211], 0
  v_accvgpr_write_b32 a156, v220
  v_mfma_f32_16x16x32_bf16 v[172:175], a[52:55], v[212:215], v[172:175]
  v_accvgpr_write_b32 a157, v221
  v_mfma_f32_16x16x32_bf16 v[172:175], a[56:59], v[216:219], v[172:175]
  v_accvgpr_write_b32 a158, v222
  v_mfma_f32_16x16x32_bf16 v[172:175], a[60:63], v[220:223], v[172:175]
  v_accvgpr_write_b32 a159, v223
  v_max3_f32 v44, v136, v137, v138
  v_max3_f32 v45, v139, v140, v141
  v_max3_f32 v44, v44, v142, v143
  v_max3_f32 v45, v45, v168, v169
  v_max3_f32 v44, v44, v170, v171
  s_nop 1
  v_max3_f32 v45, v45, v172, v173
  v_max3_f32 v44, v44, v174, v175
  v_max_f32 v44, v44, v45
  v_mov_b32 v24, v44
  s_nop 1
  v_permlane32_swap_b32 v44, v24
  v_max_f32 v44, v44, v24
  v_mov_b32 v24, v44
  s_nop 1
  v_permlane16_swap_b32 v44, v24
  v_max_f32 v44, v44, v24
  v_sub_f32 v52, 0, v44
  v_sub_f32 v53, 0, v44
  v_sub_f32 v54, 0, v44
  v_sub_f32 v55, 0, v44
  v_add_f32 v136, v136, v52
  v_add_f32 v137, v137, v52
  v_exp_f32 v136, v136
  v_add_f32 v138, v138, v52
  v_exp_f32 v137, v137
  v_add_f32 v139, v139, v52
  v_exp_f32 v138, v138
  v_add_f32 v140, v140, v52
  v_exp_f32 v139, v139
  v_cvt_pk_bf16_f32 v136, v136, v137
  v_add_f32 v141, v141, v52
  v_exp_f32 v140, v140
  v_add_f32 v142, v142, v52
  v_exp_f32 v141, v141
  v_cvt_pk_bf16_f32 v137, v138, v139
  v_add_f32 v143, v143, v52
  v_exp_f32 v142, v142
  v_exp_f32 v143, v143
  v_cvt_pk_bf16_f32 v138, v140, v141
  v_cvt_pk_bf16_f32 v139, v142, v143
  s_waitcnt vmcnt(8)
  ds_read_b128 v[224:227], v28 offset:8192
  ds_read_b128 v[228:231], v29 offset:8192
  ds_read_b128 v[232:235], v30 offset:8192
  ds_read_b128 v[236:239], v31 offset:8192
  s_add_u32 m0, s44, 49152
  s_nop 0
  buffer_load_dwordx4 v5, s[12:15], s82 offen offset:0 nt lds
  buffer_load_dwordx4 v6, s[12:15], s82 offen offset:1024 nt lds
  buffer_load_dwordx4 v5, s[12:15], s82 offen offset:2048 nt lds
  buffer_load_dwordx4 v6, s[12:15], s82 offen offset:3072 nt lds
  s_waitcnt lgkmcnt(3)
  v_lshlrev_b32 v40, 16, v224
  v_lshlrev_b32 v41, 16, v225
  v_lshlrev_b32 v42, 16, v226
  v_lshlrev_b32 v43, 16, v227
  v_and_b32 v224, 0xffff0000, v224
  v_and_b32 v225, 0xffff0000, v225
  v_and_b32 v226, 0xffff0000, v226
  v_and_b32 v227, 0xffff0000, v227
  v_mul_f32 v40, s47, v40
  v_mul_f32 v41, s47, v41
  v_mul_f32 v42, s47, v42
  v_mul_f32 v43, s47, v43
  v_mul_f32 v224, s47, v224
  v_mul_f32 v225, s47, v225
  v_mul_f32 v226, s47, v226
  v_mul_f32 v227, s47, v227
  v_cvt_pk_bf16_f32 v224, v40, v224
  v_cvt_pk_bf16_f32 v225, v41, v225
  v_cvt_pk_bf16_f32 v226, v42, v226
  v_cvt_pk_bf16_f32 v227, v43, v227
  s_waitcnt lgkmcnt(2)
  v_lshlrev_b32 v40, 16, v228
  v_lshlrev_b32 v41, 16, v229
  v_lshlrev_b32 v42, 16, v230
  v_lshlrev_b32 v43, 16, v231
  v_and_b32 v228, 0xffff0000, v228
  v_and_b32 v229, 0xffff0000, v229
  v_and_b32 v230, 0xffff0000, v230
  v_and_b32 v231, 0xffff0000, v231
  v_mul_f32 v40, s47, v40
  v_mul_f32 v41, s47, v41
  v_mul_f32 v42, s47, v42
  v_mul_f32 v43, s47, v43
  v_mul_f32 v228, s47, v228
  v_mul_f32 v229, s47, v229
  v_mul_f32 v230, s47, v230
  v_mul_f32 v231, s47, v231
  v_cvt_pk_bf16_f32 v228, v40, v228
  v_cvt_pk_bf16_f32 v229, v41, v229
  v_cvt_pk_bf16_f32 v230, v42, v230
  v_cvt_pk_bf16_f32 v231, v43, v231
  s_waitcnt lgkmcnt(1)
  v_lshlrev_b32 v40, 16, v232
  v_lshlrev_b32 v41, 16, v233
  v_lshlrev_b32 v42, 16, v234
  v_lshlrev_b32 v43, 16, v235
  v_and_b32 v232, 0xffff0000, v232
  v_and_b32 v233, 0xffff0000, v233
  v_and_b32 v234, 0xffff0000, v234
  v_and_b32 v235, 0xffff0000, v235
  v_mul_f32 v40, s47, v40
  v_mul_f32 v41, s47, v41
  v_mul_f32 v42, s47, v42
  v_mul_f32 v43, s47, v43
  v_mul_f32 v232, s47, v232
  v_mul_f32 v233, s47, v233
  v_mul_f32 v234, s47, v234
  v_mul_f32 v235, s47, v235
  v_cvt_pk_bf16_f32 v232, v40, v232
  v_cvt_pk_bf16_f32 v233, v41, v233
  v_cvt_pk_bf16_f32 v234, v42, v234
  v_cvt_pk_bf16_f32 v235, v43, v235
  s_waitcnt lgkmcnt(0)
  v_lshlrev_b32 v40, 16, v236
  v_lshlrev_b32 v41, 16, v237
  v_lshlrev_b32 v42, 16, v238
  v_lshlrev_b32 v43, 16, v239
  v_and_b32 v236, 0xffff0000, v236
  v_and_b32 v237, 0xffff0000, v237
  v_and_b32 v238, 0xffff0000, v238
  v_and_b32 v239, 0xffff0000, v239
  v_mul_f32 v40, s47, v40
  v_mul_f32 v41, s47, v41
  v_mul_f32 v42, s47, v42
  v_mul_f32 v43, s47, v43
  v_mul_f32 v236, s47, v236
  v_mul_f32 v237, s47, v237
  v_mul_f32 v238, s47, v238
  v_mul_f32 v239, s47, v239
  v_cvt_pk_bf16_f32 v236, v40, v236
  v_cvt_pk_bf16_f32 v237, v41, v237
  v_cvt_pk_bf16_f32 v238, v42, v238
  v_cvt_pk_bf16_f32 v239, v43, v239
  v_mfma_f32_16x16x32_bf16 v[144:147], a[0:3], v[224:227], 0
  v_accvgpr_write_b32 a160, v224
  v_mfma_f32_16x16x32_bf16 v[144:147], a[4:7], v[228:231], v[144:147]
  v_accvgpr_write_b32 a161, v225
  v_mfma_f32_16x16x32_bf16 v[144:147], a[8:11], v[232:235], v[144:147]
  v_accvgpr_write_b32 a162, v226
  v_mfma_f32_16x16x32_bf16 v[144:147], a[12:15], v[236:239], v[144:147]
  v_accvgpr_write_b32 a163, v227
  v_mfma_f32_16x16x32_bf16 v[148:151], a[16:19], v[224:227], 0
  v_accvgpr_write_b32 a164, v228
  v_mfma_f32_16x16x32_bf16 v[148:151], a[20:23], v[228:231], v[148:151]
  v_accvgpr_write_b32 a165, v229
  v_mfma_f32_16x16x32_bf16 v[148:151], a[24:27], v[232:235], v[148:151]
  v_accvgpr_write_b32 a166, v230
  v_mfma_f32_16x16x32_bf16 v[148:151], a[28:31], v[236:239], v[148:151]
  v_accvgpr_write_b32 a167, v231
  v_mfma_f32_16x16x32_bf16 v[176:179], a[32:35], v[224:227], 0
  v_accvgpr_write_b32 a168, v232
  v_mfma_f32_16x16x32_bf16 v[176:179], a[36:39], v[228:231], v[176:179]
  v_accvgpr_write_b32 a169, v233
  v_mfma_f32_16x16x32_bf16 v[176:179], a[40:43], v[232:235], v[176:179]
  v_accvgpr_write_b32 a170, v234
  v_mfma_f32_16x16x32_bf16 v[176:179], a[44:47], v[236:239], v[176:179]
  v_accvgpr_write_b32 a171, v235
  v_mfma_f32_16x16x32_bf16 v[180:183], a[48:51], v[224:227], 0
  v_accvgpr_write_b32 a172, v236
  v_mfma_f32_16x16x32_bf16 v[180:183], a[52:55], v[228:231], v[180:183]
  v_accvgpr_write_b32 a173, v237
  v_mfma_f32_16x16x32_bf16 v[180:183], a[56:59], v[232:235], v[180:183]
  v_accvgpr_write_b32 a174, v238
  v_mfma_f32_16x16x32_bf16 v[180:183], a[60:63], v[236:239], v[180:183]
  v_accvgpr_write_b32 a175, v239
  v_max3_f32 v44, v144, v145, v146
  v_max3_f32 v45, v147, v148, v149
  v_max3_f32 v44, v44, v150, v151
  v_max3_f32 v45, v45, v176, v177
  v_max3_f32 v44, v44, v178, v179
  s_nop 1
  v_max3_f32 v45, v45, v180, v181
  v_max3_f32 v44, v44, v182, v183
  v_max_f32 v44, v44, v45
  v_mov_b32 v24, v44
  s_nop 1
  v_permlane32_swap_b32 v44, v24
  v_max_f32 v44, v44, v24
  v_mov_b32 v24, v44
  s_nop 1
  v_permlane16_swap_b32 v44, v24
  v_max_f32 v44, v44, v24
  v_sub_f32 v56, 0, v44
  v_sub_f32 v57, 0, v44
  v_sub_f32 v58, 0, v44
  v_sub_f32 v59, 0, v44
  v_add_f32 v144, v144, v56
  v_add_f32 v145, v145, v56
  v_exp_f32 v144, v144
  v_add_f32 v146, v146, v56
  v_exp_f32 v145, v145
  v_add_f32 v147, v147, v56
  v_exp_f32 v146, v146
  v_add_f32 v148, v148, v56
  v_exp_f32 v147, v147
  v_cvt_pk_bf16_f32 v144, v144, v145
  v_add_f32 v149, v149, v56
  v_exp_f32 v148, v148
  v_add_f32 v150, v150, v56
  v_exp_f32 v149, v149
  v_cvt_pk_bf16_f32 v145, v146, v147
  v_add_f32 v151, v151, v56
  v_exp_f32 v150, v150
  v_exp_f32 v151, v151
  v_cvt_pk_bf16_f32 v146, v148, v149
  v_cvt_pk_bf16_f32 v147, v150, v151
  s_waitcnt vmcnt(8)
  ds_read_b128 v[240:243], v28 offset:12288
  ds_read_b128 v[244:247], v29 offset:12288
  ds_read_b128 v[248:251], v30 offset:12288
  ds_read_b128 v[252:255], v31 offset:12288
  s_add_u32 m0, s44, 32768
  s_nop 0
  buffer_load_dwordx4 v1, s[8:11], s84 offen offset:0 nt lds
  buffer_load_dwordx4 v2, s[8:11], s84 offen offset:1024 nt lds
  buffer_load_dwordx4 v3, s[8:11], s84 offen offset:2048 nt lds
  buffer_load_dwordx4 v4, s[8:11], s84 offen offset:3072 nt lds
  s_waitcnt lgkmcnt(3)
  v_lshlrev_b32 v40, 16, v240
  v_lshlrev_b32 v41, 16, v241
  v_lshlrev_b32 v42, 16, v242
  v_lshlrev_b32 v43, 16, v243
  v_and_b32 v240, 0xffff0000, v240
  v_and_b32 v241, 0xffff0000, v241
  v_and_b32 v242, 0xffff0000, v242
  v_and_b32 v243, 0xffff0000, v243
  v_mul_f32 v40, s47, v40
  v_mul_f32 v41, s47, v41
  v_mul_f32 v42, s47, v42
  v_mul_f32 v43, s47, v43
  v_mul_f32 v240, s47, v240
  v_mul_f32 v241, s47, v241
  v_mul_f32 v242, s47, v242
  v_mul_f32 v243, s47, v243
  v_cvt_pk_bf16_f32 v240, v40, v240
  v_cvt_pk_bf16_f32 v241, v41, v241
  v_cvt_pk_bf16_f32 v242, v42, v242
  v_cvt_pk_bf16_f32 v243, v43, v243
  s_waitcnt lgkmcnt(2)
  v_lshlrev_b32 v40, 16, v244
  v_lshlrev_b32 v41, 16, v245
  v_lshlrev_b32 v42, 16, v246
  v_lshlrev_b32 v43, 16, v247
  v_and_b32 v244, 0xffff0000, v244
  v_and_b32 v245, 0xffff0000, v245
  v_and_b32 v246, 0xffff0000, v246
  v_and_b32 v247, 0xffff0000, v247
  v_mul_f32 v40, s47, v40
  v_mul_f32 v41, s47, v41
  v_mul_f32 v42, s47, v42
  v_mul_f32 v43, s47, v43
  v_mul_f32 v244, s47, v244
  v_mul_f32 v245, s47, v245
  v_mul_f32 v246, s47, v246
  v_mul_f32 v247, s47, v247
  v_cvt_pk_bf16_f32 v244, v40, v244
  v_cvt_pk_bf16_f32 v245, v41, v245
  v_cvt_pk_bf16_f32 v246, v42, v246
  v_cvt_pk_bf16_f32 v247, v43, v247
  s_waitcnt lgkmcnt(1)
  v_lshlrev_b32 v40, 16, v248
  v_lshlrev_b32 v41, 16, v249
  v_lshlrev_b32 v42, 16, v250
  v_lshlrev_b32 v43, 16, v251
  v_and_b32 v248, 0xffff0000, v248
  v_and_b32 v249, 0xffff0000, v249
  v_and_b32 v250, 0xffff0000, v250
  v_and_b32 v251, 0xffff0000, v251
  v_mul_f32 v40, s47, v40
  v_mul_f32 v41, s47, v41
  v_mul_f32 v42, s47, v42
  v_mul_f32 v43, s47, v43
  v_mul_f32 v248, s47, v248
  v_mul_f32 v249, s47, v249
  v_mul_f32 v250, s47, v250
  v_mul_f32 v251, s47, v251
  v_cvt_pk_bf16_f32 v248, v40, v248
  v_cvt_pk_bf16_f32 v249, v41, v249
  v_cvt_pk_bf16_f32 v250, v42, v250
  v_cvt_pk_bf16_f32 v251, v43, v251
  s_waitcnt lgkmcnt(0)
  v_lshlrev_b32 v40, 16, v252
  v_lshlrev_b32 v41, 16, v253
  v_lshlrev_b32 v42, 16, v254
  v_lshlrev_b32 v43, 16, v255
  v_and_b32 v252, 0xffff0000, v252
  v_and_b32 v253, 0xffff0000, v253
  v_and_b32 v254, 0xffff0000, v254
  v_and_b32 v255, 0xffff0000, v255
  v_mul_f32 v40, s47, v40
  v_mul_f32 v41, s47, v41
  v_mul_f32 v42, s47, v42
  v_mul_f32 v43, s47, v43
  v_mul_f32 v252, s47, v252
  v_mul_f32 v253, s47, v253
  v_mul_f32 v254, s47, v254
  v_mul_f32 v255, s47, v255
  v_cvt_pk_bf16_f32 v252, v40, v252
  v_cvt_pk_bf16_f32 v253, v41, v253
  v_cvt_pk_bf16_f32 v254, v42, v254
  v_cvt_pk_bf16_f32 v255, v43, v255
  v_mfma_f32_16x16x32_bf16 v[152:155], a[0:3], v[240:243], 0
  v_accvgpr_write_b32 a176, v240
  v_mfma_f32_16x16x32_bf16 v[152:155], a[4:7], v[244:247], v[152:155]
  v_accvgpr_write_b32 a177, v241
  v_mfma_f32_16x16x32_bf16 v[152:155], a[8:11], v[248:251], v[152:155]
  v_accvgpr_write_b32 a178, v242
  v_mfma_f32_16x16x32_bf16 v[152:155], a[12:15], v[252:255], v[152:155]
  v_accvgpr_write_b32 a179, v243
  v_mfma_f32_16x16x32_bf16 v[156:159], a[16:19], v[240:243], 0
  v_accvgpr_write_b32 a180, v244
  v_mfma_f32_16x16x32_bf16 v[156:159], a[20:23], v[244:247], v[156:159]
  v_accvgpr_write_b32 a181, v245
  v_mfma_f32_16x16x32_bf16 v[156:159], a[24:27], v[248:251], v[156:159]
  v_accvgpr_write_b32 a182, v246
  v_mfma_f32_16x16x32_bf16 v[156:159], a[28:31], v[252:255], v[156:159]
  v_accvgpr_write_b32 a183, v247
  v_mfma_f32_16x16x32_bf16 v[184:187], a[32:35], v[240:243], 0
  v_accvgpr_write_b32 a184, v248
  v_mfma_f32_16x16x32_bf16 v[184:187], a[36:39], v[244:247], v[184:187]
  v_accvgpr_write_b32 a185, v249
  v_mfma_f32_16x16x32_bf16 v[184:187], a[40:43], v[248:251], v[184:187]
  v_accvgpr_write_b32 a186, v250
  v_mfma_f32_16x16x32_bf16 v[184:187], a[44:47], v[252:255], v[184:187]
  v_accvgpr_write_b32 a187, v251
  v_mfma_f32_16x16x32_bf16 v[188:191], a[48:51], v[240:243], 0
  v_accvgpr_write_b32 a188, v252
  v_mfma_f32_16x16x32_bf16 v[188:191], a[52:55], v[244:247], v[188:191]
  v_accvgpr_write_b32 a189, v253
  v_mfma_f32_16x16x32_bf16 v[188:191], a[56:59], v[248:251], v[188:191]
  v_accvgpr_write_b32 a190, v254
  v_mfma_f32_16x16x32_bf16 v[188:191], a[60:63], v[252:255], v[188:191]
  v_accvgpr_write_b32 a191, v255
  v_max3_f32 v44, v152, v153, v154
  v_max3_f32 v45, v155, v156, v157
  v_max3_f32 v44, v44, v158, v159
  v_max3_f32 v45, v45, v184, v185
  v_max3_f32 v44, v44, v186, v187
  s_nop 1
  v_max3_f32 v45, v45, v188, v189
  v_max3_f32 v44, v44, v190, v191
  v_max_f32 v44, v44, v45
  v_mov_b32 v24, v44
  s_nop 1
  v_permlane32_swap_b32 v44, v24
  v_max_f32 v44, v44, v24
  v_mov_b32 v24, v44
  s_nop 1
  v_permlane16_swap_b32 v44, v24
  v_max_f32 v44, v44, v24
  v_sub_f32 v60, 0, v44
  v_sub_f32 v61, 0, v44
  v_sub_f32 v62, 0, v44
  v_sub_f32 v63, 0, v44
  v_add_f32 v152, v152, v60
  v_add_f32 v153, v153, v60
  v_exp_f32 v152, v152
  v_add_f32 v154, v154, v60
  v_exp_f32 v153, v153
  v_add_f32 v155, v155, v60
  v_exp_f32 v154, v154
  v_add_f32 v156, v156, v60
  v_exp_f32 v155, v155
  v_cvt_pk_bf16_f32 v152, v152, v153
  v_add_f32 v157, v157, v60
  v_exp_f32 v156, v156
  v_add_f32 v158, v158, v60
  v_exp_f32 v157, v157
  v_cvt_pk_bf16_f32 v153, v154, v155
  v_add_f32 v159, v159, v60
  v_exp_f32 v158, v158
  v_exp_f32 v159, v159
  v_cvt_pk_bf16_f32 v154, v156, v157
  v_cvt_pk_bf16_f32 v155, v158, v159
  s_waitcnt vmcnt(8)
  s_barrier
  ds_read_b128 a[192:195], v8 offset:16384
  ds_read_b128 a[196:199], v9 offset:16384
  ds_read_b128 a[200:203], v10 offset:16384
  ds_read_b128 a[204:207], v11 offset:16384
  s_waitcnt lgkmcnt(3)
  v_mfma_f32_16x16x32_bf16 v[192:195], a[192:195], a[128:131], v[20:23]
  s_waitcnt lgkmcnt(2)
  v_mfma_f32_16x16x32_bf16 v[192:195], a[196:199], a[132:135], v[192:195]
  s_waitcnt lgkmcnt(1)
  v_mfma_f32_16x16x32_bf16 v[192:195], a[200:203], a[136:139], v[192:195]
  s_waitcnt lgkmcnt(0)
  v_mfma_f32_16x16x32_bf16 v[192:195], a[204:207], a[140:143], v[192:195]
  v_add_f32 v160, v160, v20
  v_add_f32 v161, v161, v20
  v_exp_f32 v160, v160
  v_add_f32 v162, v162, v20
  v_exp_f32 v161, v161
  v_add_f32 v163, v163, v20
  v_exp_f32 v162, v162
  v_add_f32 v164, v164, v20
  ds_read_b128 a[208:211], v8 offset:20480
  ds_read_b128 a[212:215], v9 offset:20480
  v_mfma_f32_16x16x32_bf16 v[200:203], a[192:195], a[144:147], v[52:55]
  v_mfma_f32_16x16x32_bf16 v[200:203], a[196:199], a[148:151], v[200:203]
  v_mfma_f32_16x16x32_bf16 v[200:203], a[200:203], a[152:155], v[200:203]
  v_mfma_f32_16x16x32_bf16 v[200:203], a[204:207], a[156:159], v[200:203]
  v_exp_f32 v163, v163
  v_max_f32 v44, v192, v193
  v_cvt_pk_bf16_f32 v160, v160, v161
  v_max_f32 v45, v194, v195
  v_add_f32 v165, v165, v20
  v_exp_f32 v164, v164
  v_add_f32 v166, v166, v20
  ds_read_b128 a[216:219], v10 offset:20480
  v_mfma_f32_16x16x32_bf16 v[208:211], a[192:195], a[160:163], v[56:59]
  v_mfma_f32_16x16x32_bf16 v[208:211], a[196:199], a[164:167], v[208:211]
  v_mfma_f32_16x16x32_bf16 v[208:211], a[200:203], a[168:171], v[208:211]
  v_mfma_f32_16x16x32_bf16 v[208:211], a[204:207], a[172:175], v[208:211]
  v_exp_f32 v165, v165
  v_max3_f32 v44, v44, v200, v201
  v_cvt_pk_bf16_f32 v161, v162, v163
  v_max3_f32 v45, v45, v202, v203
  v_add_f32 v167, v167, v20
  v_exp_f32 v166, v166
  v_add_f32 v168, v168, v52
  v_exp_f32 v167, v167
  ds_read_b128 a[220:223], v11 offset:20480
  v_mfma_f32_16x16x32_bf16 v[216:219], a[192:195], a[176:179], v[60:63]
  v_mfma_f32_16x16x32_bf16 v[216:219], a[196:199], a[180:183], v[216:219]
  v_mfma_f32_16x16x32_bf16 v[216:219], a[200:203], a[184:187], v[216:219]
  v_mfma_f32_16x16x32_bf16 v[216:219], a[204:207], a[188:191], v[216:219]
  v_cvt_pk_bf16_f32 v162, v164, v165
  v_max3_f32 v44, v44, v208, v209
  v_add_f32 v169, v169, v52
  v_max3_f32 v45, v45, v210, v211
  v_exp_f32 v168, v168
  v_add_f32 v170, v170, v52
  v_exp_f32 v169, v169
  s_waitcnt lgkmcnt(0)
  v_mfma_f32_16x16x32_bf16 v[196:199], a[208:211], a[128:131], v[20:23]
  v_mfma_f32_16x16x32_bf16 v[196:199], a[212:215], a[132:135], v[196:199]
  v_mfma_f32_16x16x32_bf16 v[196:199], a[216:219], a[136:139], v[196:199]
  v_mfma_f32_16x16x32_bf16 v[196:199], a[220:223], a[140:143], v[196:199]
  v_cvt_pk_bf16_f32 v163, v166, v167
  v_max3_f32 v44, v44, v216, v217
  v_add_f32 v171, v171, v52
  v_max3_f32 v45, v45, v218, v219
  v_exp_f32 v170, v170
  v_add_f32 v172, v172, v52
  v_exp_f32 v171, v171
  v_cvt_pk_bf16_f32 v168, v168, v169
  ds_read_b128 a[192:195], v8 offset:24576
  ds_read_b128 a[196:199], v9 offset:24576
  v_mfma_f32_16x16x32_bf16 v[204:207], a[208:211], a[144:147], v[52:55]
  v_mfma_f32_16x16x32_bf16 v[204:207], a[212:215], a[148:151], v[204:207]
  v_mfma_f32_16x16x32_bf16 v[204:207], a[216:219], a[152:155], v[204:207]
  v_mfma_f32_16x16x32_bf16 v[204:207], a[220:223], a[156:159], v[204:207]
  v_add_f32 v173, v173, v52
  v_max3_f32 v44, v44, v196, v197
  v_exp_f32 v172, v172
  v_max3_f32 v45, v45, v198, v199
  v_add_f32 v174, v174, v52
  v_exp_f32 v173, v173
  v_cvt_pk_bf16_f32 v169, v170, v171
  ds_read_b128 a[200:203], v10 offset:24576
  v_mfma_f32_16x16x32_bf16 v[212:215], a[208:211], a[160:163], v[56:59]
  v_mfma_f32_16x16x32_bf16 v[212:215], a[212:215], a[164:167], v[212:215]
  v_mfma_f32_16x16x32_bf16 v[212:215], a[216:219], a[168:171], v[212:215]
  v_mfma_f32_16x16x32_bf16 v[212:215], a[220:223], a[172:175], v[212:215]
  v_add_f32 v175, v175, v52
  v_max3_f32 v44, v44, v204, v205
  v_exp_f32 v174, v174
  v_max3_f32 v45, v45, v206, v207
  v_add_f32 v176, v176, v56
  v_exp_f32 v175, v175
  v_cvt_pk_bf16_f32 v170, v172, v173
  v_add_f32 v177, v177, v56
  ds_read_b128 a[204:207], v11 offset:24576
  v_mfma_f32_16x16x32_bf16 v[220:223], a[208:211], a[176:179], v[60:63]
  v_mfma_f32_16x16x32_bf16 v[220:223], a[212:215], a[180:183], v[220:223]
  v_mfma_f32_16x16x32_bf16 v[220:223], a[216:219], a[184:187], v[220:223]
  v_mfma_f32_16x16x32_bf16 v[220:223], a[220:223], a[188:191], v[220:223]
  v_exp_f32 v176, v176
  v_max3_f32 v44, v44, v212, v213
  v_add_f32 v178, v178, v56
  v_max3_f32 v45, v45, v214, v215
  v_exp_f32 v177, v177
  v_cvt_pk_bf16_f32 v171, v174, v175
  v_add_f32 v179, v179, v56
  s_waitcnt lgkmcnt(0)
  v_mfma_f32_16x16x32_bf16 v[224:227], a[192:195], a[128:131], v[20:23]
  v_mfma_f32_16x16x32_bf16 v[224:227], a[196:199], a[132:135], v[224:227]
  v_mfma_f32_16x16x32_bf16 v[224:227], a[200:203], a[136:139], v[224:227]
  v_mfma_f32_16x16x32_bf16 v[224:227], a[204:207], a[140:143], v[224:227]
  v_exp_f32 v178, v178
  v_max3_f32 v44, v44, v220, v221
  v_add_f32 v180, v180, v56
  v_max3_f32 v45, v45, v222, v223
  v_exp_f32 v179, v179
  v_cvt_pk_bf16_f32 v176, v176, v177
  v_add_f32 v181, v181, v56
  v_exp_f32 v180, v180
  ds_read_b128 a[208:211], v8 offset:28672
  ds_read_b128 a[212:215], v9 offset:28672
  v_mfma_f32_16x16x32_bf16 v[232:235], a[192:195], a[144:147], v[52:55]
  v_mfma_f32_16x16x32_bf16 v[232:235], a[196:199], a[148:151], v[232:235]
  v_mfma_f32_16x16x32_bf16 v[232:235], a[200:203], a[152:155], v[232:235]
  v_mfma_f32_16x16x32_bf16 v[232:235], a[204:207], a[156:159], v[232:235]
  v_add_f32 v182, v182, v56
  v_max3_f32 v44, v44, v224, v225
  v_exp_f32 v181, v181
  v_max3_f32 v45, v45, v226, v227
  v_cvt_pk_bf16_f32 v177, v178, v179
  v_add_f32 v183, v183, v56
  v_exp_f32 v182, v182
  ds_read_b128 a[216:219], v10 offset:28672
  v_mfma_f32_16x16x32_bf16 v[240:243], a[192:195], a[160:163], v[56:59]
  v_mfma_f32_16x16x32_bf16 v[240:243], a[196:199], a[164:167], v[240:243]
  v_mfma_f32_16x16x32_bf16 v[240:243], a[200:203], a[168:171], v[240:243]
  v_mfma_f32_16x16x32_bf16 v[240:243], a[204:207], a[172:175], v[240:243]
  v_add_f32 v184, v184, v60
  v_max3_f32 v44, v44, v232, v233
  v_exp_f32 v183, v183
  v_max3_f32 v45, v45, v234, v235
  v_cvt_pk_bf16_f32 v178, v180, v181
  v_add_f32 v185, v185, v60
  v_exp_f32 v184, v184
  v_add_f32 v186, v186, v60
  ds_read_b128 a[220:223], v11 offset:28672
  v_mfma_f32_16x16x32_bf16 v[248:251], a[192:195], a[176:179], v[60:63]
  s_waitcnt vmcnt(4)
  s_barrier
  v_mfma_f32_16x16x32_bf16 v[248:251], a[196:199], a[180:183], v[248:251]
  s_add_u32 m0, s44, 65536
  v_mfma_f32_16x16x32_bf16 v[248:251], a[200:203], a[184:187], v[248:251]
  v_mfma_f32_16x16x32_bf16 v[248:251], a[204:207], a[188:191], v[248:251]
  v_exp_f32 v185, v185
  v_max3_f32 v44, v44, v240, v241
  v_cvt_pk_bf16_f32 v179, v182, v183
  v_max3_f32 v45, v45, v242, v243
  v_add_f32 v187, v187, v60
  s_waitcnt lgkmcnt(0)
  v_mfma_f32_16x16x32_bf16 v[228:231], a[208:211], a[128:131], v[20:23]
  buffer_load_dwordx4 v5, s[12:15], s83 offen offset:0 nt lds
  v_mfma_f32_16x16x32_bf16 v[228:231], a[212:215], a[132:135], v[228:231]
  v_mfma_f32_16x16x32_bf16 v[228:231], a[216:219], a[136:139], v[228:231]
  v_mfma_f32_16x16x32_bf16 v[228:231], a[220:223], a[140:143], v[228:231]
  v_exp_f32 v186, v186
  v_max3_f32 v44, v44, v248, v249
  v_add_f32 v188, v188, v60
  v_max3_f32 v45, v45, v250, v251
  v_exp_f32 v187, v187
  v_cvt_pk_bf16_f32 v184, v184, v185
  v_add_f32 v189, v189, v60
  ds_read_b64_tr_b16 a[192:193], v12 offset:0
  ds_read_b64_tr_b16 a[194:195], v12 offset:4096
  ds_read_b64_tr_b16 a[196:197], v12 offset:8192
  ds_read_b64_tr_b16 a[198:199], v12 offset:12288
  v_mfma_f32_16x16x32_bf16 v[236:239], a[208:211], a[144:147], v[52:55]
  v_mfma_f32_16x16x32_bf16 v[236:239], a[212:215], a[148:151], v[236:239]
  v_mfma_f32_16x16x32_bf16 v[236:239], a[216:219], a[152:155], v[236:239]
  buffer_load_dwordx4 v6, s[12:15], s83 offen offset:1024 nt lds
  v_mfma_f32_16x16x32_bf16 v[236:239], a[220:223], a[156:159], v[236:239]
  v_exp_f32 v188, v188
  v_max3_f32 v44, v44, v228, v229
  v_add_f32 v190, v190, v60
  v_max3_f32 v45, v45, v230, v231
  ds_read_b64_tr_b16 a[200:201], v13 offset:0
  ds_read_b64_tr_b16 a[202:203], v13 offset:4096
  v_mfma_f32_16x16x32_bf16 v[244:247], a[208:211], a[160:163], v[56:59]
  v_mfma_f32_16x16x32_bf16 v[244:247], a[212:215], a[164:167], v[244:247]
  v_mfma_f32_16x16x32_bf16 v[244:247], a[216:219], a[168:171], v[244:247]
  v_mfma_f32_16x16x32_bf16 v[244:247], a[220:223], a[172:175], v[244:247]
  v_exp_f32 v189, v189
  v_max3_f32 v44, v44, v236, v237
  v_cvt_pk_bf16_f32 v185, v186, v187
  v_max3_f32 v45, v45, v238, v239
  v_add_f32 v191, v191, v60
  v_exp_f32 v190, v190
  v_exp_f32 v191, v191
  ds_read_b64_tr_b16 a[204:205], v13 offset:8192
  ds_read_b64_tr_b16 a[206:207], v13 offset:12288
  v_mfma_f32_16x16x32_bf16 v[252:255], a[208:211], a[176:179], v[60:63]
  buffer_load_dwordx4 v5, s[12:15], s83 offen offset:2048 nt lds
  v_mfma_f32_16x16x32_bf16 v[252:255], a[212:215], a[180:183], v[252:255]
  v_mfma_f32_16x16x32_bf16 v[252:255], a[216:219], a[184:187], v[252:255]
  v_mfma_f32_16x16x32_bf16 v[252:255], a[220:223], a[188:191], v[252:255]
  v_cvt_pk_bf16_f32 v186, v188, v189
  v_max3_f32 v44, v44, v244, v245
  v_cvt_pk_bf16_f32 v187, v190, v191
  v_max3_f32 v45, v45, v246, v247
  s_waitcnt lgkmcnt(0)
  v_mfma_f32_16x16x32_bf16 a[0:3], a[192:195], v[128:131], 0
  buffer_load_dwordx4 v6, s[12:15], s83 offen offset:3072 nt lds
  v_mfma_f32_16x16x32_bf16 a[0:3], a[196:199], v[160:163], a[0:3]
  ds_read_b64_tr_b16 a[208:209], v14 offset:0
  ds_read_b64_tr_b16 a[210:211], v14 offset:4096
  v_mfma_f32_16x16x32_bf16 a[32:35], a[192:195], v[136:139], 0
  v_mfma_f32_16x16x32_bf16 a[32:35], a[196:199], v[168:171], a[32:35]
  v_max3_f32 v44, v44, v252, v253
  v_max3_f32 v45, v45, v254, v255
  v_max_f32 v44, v44, v45
  v_cmp_lt_f32 vcc, s48, v44
  ds_read_b64_tr_b16 a[212:213], v14 offset:8192
  ds_read_b64_tr_b16 a[214:215], v14 offset:12288
  v_mfma_f32_16x16x32_bf16 a[64:67], a[192:195], v[144:147], 0
  v_mfma_f32_16x16x32_bf16 a[64:67], a[196:199], v[176:179], a[64:67]
  s_cbranch_vccnz LS_t0
LS_b0:
  v_exp_f32 v192, v192
  ds_read_b64_tr_b16 a[216:217], v15 offset:0
  ds_read_b64_tr_b16 a[218:219], v15 offset:4096
  v_mfma_f32_16x16x32_bf16 a[96:99], a[192:195], v[152:155], 0
  v_mfma_f32_16x16x32_bf16 a[96:99], a[196:199], v[184:187], a[96:99]
  v_exp_f32 v193, v193
  ds_read_b64_tr_b16 a[220:221], v15 offset:8192
  ds_read_b64_tr_b16 a[222:223], v15 offset:12288
  v_mfma_f32_16x16x32_bf16 a[4:7], a[200:203], v[128:131], 0
  v_mfma_f32_16x16x32_bf16 a[4:7], a[204:207], v[160:163], a[4:7]
  v_exp_f32 v194, v194
  v_mfma_f32_16x16x32_bf16 a[224:227], a[240:243], v[128:131], 0
  v_exp_f32 v195, v195
  v_mfma_f32_16x16x32_bf16 a[224:227], a[240:243], v[160:163], a[224:227]
  v_cvt_pk_bf16_f32 v192, v192, v193
  v_exp_f32 v196, v196
  v_mfma_f32_16x16x32_bf16 a[36:39], a[200:203], v[136:139], 0
  v_mfma_f32_16x16x32_bf16 a[36:39], a[204:207], v[168:171], a[36:39]
  v_exp_f32 v197, v197
  v_cvt_pk_bf16_f32 v193, v194, v195
  v_mfma_f32_16x16x32_bf16 a[68:71], a[200:203], v[144:147], 0
  v_mfma_f32_16x16x32_bf16 a[68:71], a[204:207], v[176:179], a[68:71]
  v_exp_f32 v198, v198
  v_exp_f32 v199, v199
  v_cvt_pk_bf16_f32 v194, v196, v197
  v_mfma_f32_16x16x32_bf16 a[100:103], a[200:203], v[152:155], 0
  v_mfma_f32_16x16x32_bf16 a[100:103], a[204:207], v[184:187], a[100:103]
  v_exp_f32 v224, v224
  s_waitcnt lgkmcnt(0)
  v_mfma_f32_16x16x32_bf16 a[8:11], a[208:211], v[128:131], 0
  v_mfma_f32_16x16x32_bf16 a[8:11], a[212:215], v[160:163], a[8:11]
  v_exp_f32 v225, v225
  v_cvt_pk_bf16_f32 v195, v198, v199
  v_exp_f32 v226, v226
  ds_read_b64_tr_b16 a[192:193], v16 offset:0
  ds_read_b64_tr_b16 a[194:195], v16 offset:4096
  v_mfma_f32_16x16x32_bf16 a[40:43], a[208:211], v[136:139], 0
  v_mfma_f32_16x16x32_bf16 a[40:43], a[212:215], v[168:171], a[40:43]
  v_exp_f32 v227, v227
  ds_read_b64_tr_b16 a[196:197], v16 offset:8192
  ds_read_b64_tr_b16 a[198:199], v16 offset:12288
  v_mfma_f32_16x16x32_bf16 a[72:75], a[208:211], v[144:147], 0
  v_mfma_f32_16x16x32_bf16 a[72:75], a[212:215], v[176:179], a[72:75]
  v_cvt_pk_bf16_f32 v224, v224, v225
  v_exp_f32 v228, v228
  ds_read_b64_tr_b16 a[200:201], v17 offset:0
  ds_read_b64_tr_b16 a[202:203], v17 offset:4096
  v_mfma_f32_16x16x32_bf16 a[104:107], a[208:211], v[152:155], 0
  v_mfma_f32_16x16x32_bf16 a[104:107], a[212:215], v[184:187], a[104:107]
  v_exp_f32 v229, v229
  ds_read_b64_tr_b16 a[204:205], v17 offset:8192
  ds_read_b64_tr_b16 a[206:207], v17 offset:12288
  v_mfma_f32_16x16x32_bf16 a[12:15], a[216:219], v[128:131], 0
  v_mfma_f32_16x16x32_bf16 a[12:15], a[220:223], v[160:163], a[12:15]
  v_cvt_pk_bf16_f32 v225, v226, v227
  v_exp_f32 v230, v230
  v_mfma_f32_16x16x32_bf16 a[228:231], a[240:243], v[136:139], 0
  v_exp_f32 v231, v231
  v_mfma_f32_16x16x32_bf16 a[228:231], a[240:243], v[168:171], a[228:231]
  v_cvt_pk_bf16_f32 v226, v228, v229
  v_exp_f32 v200, v200
  v_mfma_f32_16x16x32_bf16 a[44:47], a[216:219], v[136:139], 0
  v_mfma_f32_16x16x32_bf16 a[44:47], a[220:223], v[168:171], a[44:47]
  v_exp_f32 v201, v201
  v_mfma_f32_16x16x32_bf16 a[76:79], a[216:219], v[144:147], 0
  v_mfma_f32_16x16x32_bf16 a[76:79], a[220:223], v[176:179], a[76:79]
  v_cvt_pk_bf16_f32 v227, v230, v231
  v_exp_f32 v202, v202
  s_add_u32 m0, s55, 0
  s_add_u32 s46, s45, 0
  v_mfma_f32_16x16x32_bf16 a[108:111], a[216:219], v[152:155], 0
  buffer_load_dwordx4 v1, s[28:31], s46 offen offset:0 nt lds
  v_mfma_f32_16x16x32_bf16 a[108:111], a[220:223], v[184:187], a[108:111]
  s_waitcnt lgkmcnt(0)
  v_mfma_f32_16x16x32_bf16 a[16:19], a[192:195], v[128:131], 0
  v_mfma_f32_16x16x32_bf16 a[16:19], a[196:199], v[160:163], a[16:19]
  v_exp_f32 v203, v203
  v_cvt_pk_bf16_f32 v200, v200, v201
  ds_read_b64_tr_b16 a[208:209], v18 offset:0
  ds_read_b64_tr_b16 a[210:211], v18 offset:4096
  v_mfma_f32_16x16x32_bf16 a[48:51], a[192:195], v[136:139], 0
  v_mfma_f32_16x16x32_bf16 a[48:51], a[196:199], v[168:171], a[48:51]
  v_exp_f32 v204, v204
  ds_read_b64_tr_b16 a[212:213], v18 offset:8192
  ds_read_b64_tr_b16 a[214:215], v18 offset:12288
  v_mfma_f32_16x16x32_bf16 a[80:83], a[192:195], v[144:147], 0
  buffer_load_dwordx4 v2, s[28:31], s46 offen offset:1024 nt lds
  v_mfma_f32_16x16x32_bf16 a[80:83], a[196:199], v[176:179], a[80:83]
  ds_read_b64_tr_b16 a[216:217], v19 offset:0
  ds_read_b64_tr_b16 a[218:219], v19 offset:4096
  v_mfma_f32_16x16x32_bf16 a[112:115], a[192:195], v[152:155], 0
  v_mfma_f32_16x16x32_bf16 a[112:115], a[196:199], v[184:187], a[112:115]
  v_exp_f32 v205, v205
  v_cvt_pk_bf16_f32 v201, v202, v203
  ds_read_b64_tr_b16 a[220:221], v19 offset:8192
  ds_read_b64_tr_b16 a[222:223], v19 offset:12288
  v_mfma_f32_16x16x32_bf16 a[20:23], a[200:203], v[128:131], 0
  v_mfma_f32_16x16x32_bf16 a[20:23], a[204:207], v[160:163], a[20:23]
  v_exp_f32 v206, v206
  v_mfma_f32_16x16x32_bf16 a[232:235], a[240:243], v[144:147], 0
  v_exp_f32 v207, v207
  v_mfma_f32_16x16x32_bf16 a[232:235], a[240:243], v[176:179], a[232:235]
  v_cvt_pk_bf16_f32 v202, v204, v205
  v_exp_f32 v232, v232
  v_mfma_f32_16x16x32_bf16 a[52:55], a[200:203], v[136:139], 0
  v_mfma_f32_16x16x32_bf16 a[52:55], a[204:207], v[168:171], a[52:55]
  v_exp_f32 v233, v233
  v_cvt_pk_bf16_f32 v203, v206, v207
  v_mfma_f32_16x16x32_bf16 a[84:87], a[200:203], v[144:147], 0
  s_waitcnt vmcnt(6)
  s_barrier
  v_mfma_f32_16x16x32_bf16 a[84:87], a[204:207], v[176:179], a[84:87]
  v_exp_f32 v234, v234
  s_add_u32 m0, s44, 0
  v_mfma_f32_16x16x32_bf16 a[116:119], a[200:203], v[152:155], 0
  v_mfma_f32_16x16x32_bf16 a[116:119], a[204:207], v[184:187], a[116:119]
  v_exp_f32 v235, v235
  s_waitcnt lgkmcnt(0)
  v_mfma_f32_16x16x32_bf16 a[24:27], a[208:211], v[128:131], 0
  buffer_load_dwordx4 v1, s[8:11], s85 offen offset:0 nt lds
  v_mfma_f32_16x16x32_bf16 a[24:27], a[212:215], v[160:163], a[24:27]
  v_cvt_pk_bf16_f32 v232, v232, v233
  v_exp_f32 v236, v236
  ds_read_b128 a[192:195], v8 offset:32768
  v_mfma_f32_16x16x32_bf16 a[56:59], a[208:211], v[136:139], 0
  v_mfma_f32_16x16x32_bf16 a[56:59], a[212:215], v[168:171], a[56:59]
  v_exp_f32 v237, v237
  ds_read_b128 a[196:199], v9 offset:32768
  v_mfma_f32_16x16x32_bf16 a[88:91], a[208:211], v[144:147], 0
  v_mfma_f32_16x16x32_bf16 a[88:91], a[212:215], v[176:179], a[88:91]
  v_cvt_pk_bf16_f32 v233, v234, v235
  v_exp_f32 v238, v238
  ds_read_b128 a[200:203], v10 offset:32768
  v_mfma_f32_16x16x32_bf16 a[120:123], a[208:211], v[152:155], 0
  buffer_load_dwordx4 v2, s[8:11], s85 offen offset:1024 nt lds
  v_mfma_f32_16x16x32_bf16 a[120:123], a[212:215], v[184:187], a[120:123]
  v_exp_f32 v239, v239
  ds_read_b128 a[204:207], v11 offset:32768
  v_mfma_f32_16x16x32_bf16 a[28:31], a[216:219], v[128:131], 0
  v_mfma_f32_16x16x32_bf16 a[28:31], a[220:223], v[160:163], a[28:31]
  v_cvt_pk_bf16_f32 v234, v236, v237
  v_exp_f32 v208, v208
  v_mfma_f32_16x16x32_bf16 a[236:239], a[240:243], v[152:155], 0
  v_exp_f32 v209, v209
  v_mfma_f32_16x16x32_bf16 a[236:239], a[240:243], v[184:187], a[236:239]
  v_cvt_pk_bf16_f32 v235, v238, v239
  v_exp_f32 v210, v210
  v_mfma_f32_16x16x32_bf16 a[60:63], a[216:219], v[136:139], 0
  v_mfma_f32_16x16x32_bf16 a[60:63], a[220:223], v[168:171], a[60:63]
  v_exp_f32 v211, v211
  v_cvt_pk_bf16_f32 v208, v208, v209
  v_mfma_f32_16x16x32_bf16 a[92:95], a[216:219], v[144:147], 0
  buffer_load_dwordx4 v3, s[8:11], s85 offen offset:2048 nt lds
  v_mfma_f32_16x16x32_bf16 a[92:95], a[220:223], v[176:179], a[92:95]
  v_exp_f32 v212, v212
  v_mfma_f32_16x16x32_bf16 a[124:127], a[216:219], v[152:155], 0
  v_mfma_f32_16x16x32_bf16 a[124:127], a[220:223], v[184:187], a[124:127]
  v_exp_f32 v213, v213
  v_cvt_pk_bf16_f32 v209, v210, v211
  s_waitcnt lgkmcnt(0)
  s_cbranch_vccnz LS_t15
LS_b15:
  v_mfma_f32_16x16x32_bf16 v[128:131], a[192:195], a[128:131], v[20:23]
  buffer_load_dwordx4 v4, s[8:11], s85 offen offset:3072 nt lds
  v_mfma_f32_16x16x32_bf16 v[128:131], a[196:199], a[132:135], v[128:131]
  v_mfma_f32_16x16x32_bf16 v[128:131], a[200:203], a[136:139], v[128:131]
  v_mfma_f32_16x16x32_bf16 v[128:131], a[204:207], a[140:143], v[128:131]
  v_exp_f32 v214, v214
  v_exp_f32 v215, v215
  v_cvt_pk_bf16_f32 v210, v212, v213
  v_mfma_f32_16x16x32_bf16 v[136:139], a[192:195], a[144:147], v[52:55]
  v_mfma_f32_16x16x32_bf16 v[136:139], a[196:199], a[148:151], v[136:139]
  v_mfma_f32_16x16x32_bf16 v[136:139], a[200:203], a[152:155], v[136:139]
  v_mfma_f32_16x16x32_bf16 v[136:139], a[204:207], a[156:159], v[136:139]
  v_exp_f32 v240, v240
  v_max_f32 v44, v128, v129
  v_exp_f32 v241, v241
  v_max_f32 v45, v130, v131
  v_cvt_pk_bf16_f32 v211, v214, v215
  v_exp_f32 v242, v242
  ds_read_b128 a[208:211], v8 offset:36864
  v_mfma_f32_16x16x32_bf16 v[144:147], a[192:195], a[160:163], v[56:59]
  v_mfma_f32_16x16x32_bf16 v[144:147], a[196:199], a[164:167], v[144:147]
  v_mfma_f32_16x16x32_bf16 v[144:147], a[200:203], a[168:171], v[144:147]
  v_mfma_f32_16x16x32_bf16 v[144:147], a[204:207], a[172:175], v[144:147]
  v_exp_f32 v243, v243
  v_max3_f32 v44, v44, v136, v137
  v_cvt_pk_bf16_f32 v240, v240, v241
  v_max3_f32 v45, v45, v138, v139
  v_exp_f32 v244, v244
  ds_read_b128 a[212:215], v9 offset:36864
  ds_read_b128 a[216:219], v10 offset:36864
  v_mfma_f32_16x16x32_bf16 v[152:155], a[192:195], a[176:179], v[60:63]
  v_mfma_f32_16x16x32_bf16 v[152:155], a[196:199], a[180:183], v[152:155]
  v_mfma_f32_16x16x32_bf16 v[152:155], a[200:203], a[184:187], v[152:155]
  v_mfma_f32_16x16x32_bf16 v[152:155], a[204:207], a[188:191], v[152:155]
  v_exp_f32 v245, v245
  v_max3_f32 v44, v44, v144, v145
  v_cvt_pk_bf16_f32 v241, v242, v243
  v_max3_f32 v45, v45, v146, v147
  ds_read_b128 a[220:223], v11 offset:36864
  s_waitcnt lgkmcnt(0)
  v_mfma_f32_16x16x32_bf16 v[132:135], a[208:211], a[128:131], v[20:23]
  v_mfma_f32_16x16x32_bf16 v[132:135], a[212:215], a[132:135], v[132:135]
  v_mfma_f32_16x16x32_bf16 v[132:135], a[216:219], a[136:139], v[132:135]
  v_mfma_f32_16x16x32_bf16 v[132:135], a[220:223], a[140:143], v[132:135]
  v_exp_f32 v246, v246
  v_max3_f32 v44, v44, v152, v153
  v_exp_f32 v247, v247
  v_max3_f32 v45, v45, v154, v155
  v_cvt_pk_bf16_f32 v242, v244, v245
  v_mfma_f32_16x16x32_bf16 v[140:143], a[208:211], a[144:147], v[52:55]
  v_mfma_f32_16x16x32_bf16 v[140:143], a[212:215], a[148:151], v[140:143]
  v_mfma_f32_16x16x32_bf16 v[140:143], a[216:219], a[152:155], v[140:143]
  v_mfma_f32_16x16x32_bf16 v[140:143], a[220:223], a[156:159], v[140:143]
  v_exp_f32 v216, v216
  v_max3_f32 v44, v44, v132, v133
  v_exp_f32 v217, v217
  v_max3_f32 v45, v45, v134, v135
  v_cvt_pk_bf16_f32 v243, v246, v247
  v_exp_f32 v218, v218
  ds_read_b128 a[192:195], v8 offset:40960
  v_mfma_f32_16x16x32_bf16 v[148:151], a[208:211], a[160:163], v[56:59]
  v_mfma_f32_16x16x32_bf16 v[148:151], a[212:215], a[164:167], v[148:151]
  v_mfma_f32_16x16x32_bf16 v[148:151], a[216:219], a[168:171], v[148:151]
  v_mfma_f32_16x16x32_bf16 v[148:151], a[220:223], a[172:175], v[148:151]
  v_exp_f32 v219, v219
  v_max3_f32 v44, v44, v140, v141
  v_cvt_pk_bf16_f32 v216, v216, v217
  v_max3_f32 v45, v45, v142, v143
  v_exp_f32 v220, v220
  ds_read_b128 a[196:199], v9 offset:40960
  ds_read_b128 a[200:203], v10 offset:40960
  v_mfma_f32_16x16x32_bf16 v[156:159], a[208:211], a[176:179], v[60:63]
  v_mfma_f32_16x16x32_bf16 v[156:159], a[212:215], a[180:183], v[156:159]
  v_mfma_f32_16x16x32_bf16 v[156:159], a[216:219], a[184:187], v[156:159]
  v_mfma_f32_16x16x32_bf16 v[156:159], a[220:223], a[188:191], v[156:159]
  v_exp_f32 v221, v221
  v_max3_f32 v44, v44, v148, v149
  v_cvt_pk_bf16_f32 v217, v218, v219
  v_max3_f32 v45, v45, v150, v151
  ds_read_b128 a[204:207], v11 offset:40960
  s_waitcnt lgkmcnt(0)
  v_mfma_f32_16x16x32_bf16 v[160:163], a[192:195], a[128:131], v[20:23]
  v_mfma_f32_16x16x32_bf16 v[160:163], a[196:199], a[132:135], v[160:163]
  v_mfma_f32_16x16x32_bf16 v[160:163], a[200:203], a[136:139], v[160:163]
  v_mfma_f32_16x16x32_bf16 v[160:163], a[204:207], a[140:143], v[160:163]
  v_exp_f32 v222, v222
  v_max3_f32 v44, v44, v156, v157
  v_exp_f32 v223, v223
  v_max3_f32 v45, v45, v158, v159
  v_cvt_pk_bf16_f32 v218, v220, v221
  v_mfma_f32_16x16x32_bf16 v[168:171], a[192:195], a[144:147], v[52:55]
  v_mfma_f32_16x16x32_bf16 v[168:171], a[196:199], a[148:151], v[168:171]
  v_mfma_f32_16x16x32_bf16 v[168:171], a[200:203], a[152:155], v[168:171]
  v_mfma_f32_16x16x32_bf16 v[168:171], a[204:207], a[156:159], v[168:171]
  v_exp_f32 v248, v248
  v_max3_f32 v44, v44, v160, v161
  v_exp_f32 v249, v249
  v_max3_f32 v45, v45, v162, v163
  v_cvt_pk_bf16_f32 v219, v222, v223
  v_exp_f32 v250, v250
  ds_read_b128 a[208:211], v8 offset:45056
  v_mfma_f32_16x16x32_bf16 v[176:179], a[192:195], a[160:163], v[56:59]
  v_mfma_f32_16x16x32_bf16 v[176:179], a[196:199], a[164:167], v[176:179]
  v_mfma_f32_16x16x32_bf16 v[176:179], a[200:203], a[168:171], v[176:179]
  v_mfma_f32_16x16x32_bf16 v[176:179], a[204:207], a[172:175], v[176:179]
  v_exp_f32 v251, v251
  v_max3_f32 v44, v44, v168, v169
  v_cvt_pk_bf16_f32 v248, v248, v249
  v_max3_f32 v45, v45, v170, v171
  v_exp_f32 v252, v252
  ds_read_b128 a[212:215], v9 offset:45056
  ds_read_b128 a[216:219], v10 offset:45056
  v_mfma_f32_16x16x32_bf16 v[184:187], a[192:195], a[176:179], v[60:63]
  s_waitcnt vmcnt(6)
  s_barrier
  v_mfma_f32_16x16x32_bf16 v[184:187], a[196:199], a[180:183], v[184:187]
  s_add_u32 m0, s44, 81920
  v_mfma_f32_16x16x32_bf16 v[184:187], a[200:203], a[184:187], v[184:187]
  v_mfma_f32_16x16x32_bf16 v[184:187], a[204:207], a[188:191], v[184:187]
  v_exp_f32 v253, v253
  ds_read_b128 a[220:223], v11 offset:45056
  s_waitcnt lgkmcnt(0)
  v_mfma_f32_16x16x32_bf16 v[164:167], a[208:211], a[128:131], v[20:23]
  buffer_load_dwordx4 v5, s[12:15], s84 offen offset:0 nt lds
  v_mfma_f32_16x16x32_bf16 v[164:167], a[212:215], a[132:135], v[164:167]
  v_mfma_f32_16x16x32_bf16 v[164:167], a[216:219], a[136:139], v[164:167]
  v_mfma_f32_16x16x32_bf16 v[164:167], a[220:223], a[140:143], v[164:167]
  v_cvt_pk_bf16_f32 v249, v250, v251
  v_max3_f32 v44, v44, v176, v177
  v_exp_f32 v254, v254
  v_max3_f32 v45, v45, v178, v179
  v_mfma_f32_16x16x32_bf16 v[172:175], a[208:211], a[144:147], v[52:55]
  v_mfma_f32_16x16x32_bf16 v[172:175], a[212:215], a[148:151], v[172:175]
  v_mfma_f32_16x16x32_bf16 v[172:175], a[216:219], a[152:155], v[172:175]
  buffer_load_dwordx4 v6, s[12:15], s84 offen offset:1024 nt lds
  v_mfma_f32_16x16x32_bf16 v[172:175], a[220:223], a[156:159], v[172:175]
  v_exp_f32 v255, v255
  v_max3_f32 v44, v44, v184, v185
  v_cvt_pk_bf16_f32 v250, v252, v253
  v_max3_f32 v45, v45, v186, v187
  v_cvt_pk_bf16_f32 v251, v254, v255
  ds_read_b64_tr_b16 a[192:193], v12 offset:16384
  ds_read_b64_tr_b16 a[194:195], v12 offset:20480
  v_mfma_f32_16x16x32_bf16 v[180:183], a[208:211], a[160:163], v[56:59]
  v_mfma_f32_16x16x32_bf16 v[180:183], a[212:215], a[164:167], v[180:183]
  v_mfma_f32_16x16x32_bf16 v[180:183], a[216:219], a[168:171], v[180:183]
  v_mfma_f32_16x16x32_bf16 v[180:183], a[220:223], a[172:175], v[180:183]
  v_max3_f32 v44, v44, v164, v165
  v_max3_f32 v45, v45, v166, v167
  v_max3_f32 v44, v44, v172, v173
  v_max3_f32 v45, v45, v174, v175
  ds_read_b64_tr_b16 a[196:197], v12 offset:24576
  ds_read_b64_tr_b16 a[198:199], v12 offset:28672
  ds_read_b64_tr_b16 a[200:201], v13 offset:16384
  ds_read_b64_tr_b16 a[202:203], v13 offset:20480
  v_mfma_f32_16x16x32_bf16 v[188:191], a[208:211], a[176:179], v[60:63]
  buffer_load_dwordx4 v5, s[12:15], s84 offen offset:2048 nt lds
  v_mfma_f32_16x16x32_bf16 v[188:191], a[212:215], a[180:183], v[188:191]
  v_mfma_f32_16x16x32_bf16 v[188:191], a[216:219], a[184:187], v[188:191]
  v_mfma_f32_16x16x32_bf16 v[188:191], a[220:223], a[188:191], v[188:191]
  v_max3_f32 v44, v44, v180, v181
  v_max3_f32 v45, v45, v182, v183
  ds_read_b64_tr_b16 a[204:205], v13 offset:24576
  ds_read_b64_tr_b16 a[206:207], v13 offset:28672
  s_waitcnt lgkmcnt(0)
  v_mfma_f32_16x16x32_bf16 a[0:3], a[192:195], v[192:195], a[0:3]
  buffer_load_dwordx4 v6, s[12:15], s84 offen offset:3072 nt lds
  v_mfma_f32_16x16x32_bf16 a[0:3], a[196:199], v[224:227], a[0:3]
  ds_read_b64_tr_b16 a[208:209], v14 offset:16384
  ds_read_b64_tr_b16 a[210:211], v14 offset:20480
  v_mfma_f32_16x16x32_bf16 a[32:35], a[192:195], v[200:203], a[32:35]
  v_mfma_f32_16x16x32_bf16 a[32:35], a[196:199], v[232:235], a[32:35]
  v_max3_f32 v44, v44, v188, v189
  v_max3_f32 v45, v45, v190, v191
  v_max_f32 v44, v44, v45
  ds_read_b64_tr_b16 a[212:213], v14 offset:24576
  ds_read_b64_tr_b16 a[214:215], v14 offset:28672
  v_mfma_f32_16x16x32_bf16 a[64:67], a[192:195], v[208:211], a[64:67]
  v_mfma_f32_16x16x32_bf16 a[64:67], a[196:199], v[240:243], a[64:67]
  v_cmp_lt_f32 vcc, s48, v44
  ds_read_b64_tr_b16 a[216:217], v15 offset:16384
  ds_read_b64_tr_b16 a[218:219], v15 offset:20480
  v_mfma_f32_16x16x32_bf16 a[96:99], a[192:195], v[216:219], a[96:99]
  v_mfma_f32_16x16x32_bf16 a[96:99], a[196:199], v[248:251], a[96:99]
  s_cbranch_vccnz LS_t1
LS_b1:
  v_exp_f32 v128, v128
  ds_read_b64_tr_b16 a[220:221], v15 offset:24576
  ds_read_b64_tr_b16 a[222:223], v15 offset:28672
  v_mfma_f32_16x16x32_bf16 a[4:7], a[200:203], v[192:195], a[4:7]
  s_add_u32 m0, s55, 0
  s_add_u32 s46, s45, 0
  v_mfma_f32_16x16x32_bf16 a[4:7], a[204:207], v[224:227], a[4:7]
  v_mfma_f32_16x16x32_bf16 a[224:227], a[240:243], v[192:195], a[224:227]
  v_exp_f32 v129, v129
  v_mfma_f32_16x16x32_bf16 a[224:227], a[240:243], v[224:227], a[224:227]
  v_exp_f32 v130, v130
  v_mfma_f32_16x16x32_bf16 a[36:39], a[200:203], v[200:203], a[36:39]
  v_mfma_f32_16x16x32_bf16 a[36:39], a[204:207], v[232:235], a[36:39]
  v_exp_f32 v131, v131
  v_cvt_pk_bf16_f32 v128, v128, v129
  v_exp_f32 v132, v132
  v_mfma_f32_16x16x32_bf16 a[68:71], a[200:203], v[208:211], a[68:71]
  buffer_load_dwordx4 v3, s[28:31], s46 offen offset:2048 nt lds
  v_mfma_f32_16x16x32_bf16 a[68:71], a[204:207], v[240:243], a[68:71]
  v_exp_f32 v133, v133
  v_mfma_f32_16x16x32_bf16 a[100:103], a[200:203], v[216:219], a[100:103]
  v_mfma_f32_16x16x32_bf16 a[100:103], a[204:207], v[248:251], a[100:103]
  v_cvt_pk_bf16_f32 v129, v130, v131
  v_exp_f32 v134, v134
  s_waitcnt lgkmcnt(0)
  v_mfma_f32_16x16x32_bf16 a[8:11], a[208:211], v[192:195], a[8:11]
  v_mfma_f32_16x16x32_bf16 a[8:11], a[212:215], v[224:227], a[8:11]
  v_exp_f32 v135, v135
  v_cvt_pk_bf16_f32 v130, v132, v133
  ds_read_b64_tr_b16 a[192:193], v16 offset:16384
  ds_read_b64_tr_b16 a[194:195], v16 offset:20480
  v_mfma_f32_16x16x32_bf16 a[40:43], a[208:211], v[200:203], a[40:43]
  buffer_load_dwordx4 v4, s[28:31], s46 offen offset:3072 nt lds
  v_mfma_f32_16x16x32_bf16 a[40:43], a[212:215], v[232:235], a[40:43]
  ds_read_b64_tr_b16 a[196:197], v16 offset:24576
  ds_read_b64_tr_b16 a[198:199], v16 offset:28672
  v_mfma_f32_16x16x32_bf16 a[72:75], a[208:211], v[208:211], a[72:75]
  v_mfma_f32_16x16x32_bf16 a[72:75], a[212:215], v[240:243], a[72:75]
  v_exp_f32 v160, v160
  v_exp_f32 v161, v161
  ds_read_b64_tr_b16 a[200:201], v17 offset:16384
  ds_read_b64_tr_b16 a[202:203], v17 offset:20480
  v_mfma_f32_16x16x32_bf16 a[104:107], a[208:211], v[216:219], a[104:107]
  v_mfma_f32_16x16x32_bf16 a[104:107], a[212:215], v[248:251], a[104:107]
  v_cvt_pk_bf16_f32 v131, v134, v135
  v_exp_f32 v162, v162
  ds_read_b64_tr_b16 a[204:205], v17 offset:24576
  ds_read_b64_tr_b16 a[206:207], v17 offset:28672
  v_mfma_f32_16x16x32_bf16 a[12:15], a[216:219], v[192:195], a[12:15]
  v_mfma_f32_16x16x32_bf16 a[12:15], a[220:223], v[224:227], a[12:15]
  v_exp_f32 v163, v163
  v_mfma_f32_16x16x32_bf16 a[228:231], a[240:243], v[200:203], a[228:231]
  v_cvt_pk_bf16_f32 v160, v160, v161
  v_exp_f32 v164, v164
  v_mfma_f32_16x16x32_bf16 a[228:231], a[240:243], v[232:235], a[228:231]
  v_exp_f32 v165, v165
  v_mfma_f32_16x16x32_bf16 a[44:47], a[216:219], v[200:203], a[44:47]
  v_mfma_f32_16x16x32_bf16 a[44:47], a[220:223], v[232:235], a[44:47]
  v_cvt_pk_bf16_f32 v161, v162, v163
  v_exp_f32 v166, v166
  v_mfma_f32_16x16x32_bf16 a[76:79], a[216:219], v[208:211], a[76:79]
  v_mfma_f32_16x16x32_bf16 a[76:79], a[220:223], v[240:243], a[76:79]
  v_exp_f32 v167, v167
  v_mfma_f32_16x16x32_bf16 a[108:111], a[216:219], v[216:219], a[108:111]
  v_mfma_f32_16x16x32_bf16 a[108:111], a[220:223], v[248:251], a[108:111]
  v_cvt_pk_bf16_f32 v162, v164, v165
  v_exp_f32 v136, v136
  s_waitcnt lgkmcnt(0)
  v_mfma_f32_16x16x32_bf16 a[16:19], a[192:195], v[192:195], a[16:19]
  v_mfma_f32_16x16x32_bf16 a[16:19], a[196:199], v[224:227], a[16:19]
  v_exp_f32 v137, v137
  v_cvt_pk_bf16_f32 v163, v166, v167
  v_exp_f32 v138, v138
  ds_read_b64_tr_b16 a[208:209], v18 offset:16384
  ds_read_b64_tr_b16 a[210:211], v18 offset:20480
  v_mfma_f32_16x16x32_bf16 a[48:51], a[192:195], v[200:203], a[48:51]
  v_mfma_f32_16x16x32_bf16 a[48:51], a[196:199], v[232:235], a[48:51]
  v_exp_f32 v139, v139
  ds_read_b64_tr_b16 a[212:213], v18 offset:24576
  ds_read_b64_tr_b16 a[214:215], v18 offset:28672
  v_mfma_f32_16x16x32_bf16 a[80:83], a[192:195], v[208:211], a[80:83]
  v_mfma_f32_16x16x32_bf16 a[80:83], a[196:199], v[240:243], a[80:83]
  v_cvt_pk_bf16_f32 v136, v136, v137
  v_exp_f32 v140, v140
  ds_read_b64_tr_b16 a[216:217], v19 offset:16384
  ds_read_b64_tr_b16 a[218:219], v19 offset:20480
  v_mfma_f32_16x16x32_bf16 a[112:115], a[192:195], v[216:219], a[112:115]
  v_mfma_f32_16x16x32_bf16 a[112:115], a[196:199], v[248:251], a[112:115]
  v_exp_f32 v141, v141
  ds_read_b64_tr_b16 a[220:221], v19 offset:24576
  ds_read_b64_tr_b16 a[222:223], v19 offset:28672
  v_mfma_f32_16x16x32_bf16 a[20:23], a[200:203], v[192:195], a[20:23]
  v_mfma_f32_16x16x32_bf16 a[20:23], a[204:207], v[224:227], a[20:23]
  v_cvt_pk_bf16_f32 v137, v138, v139
  v_exp_f32 v142, v142
  v_mfma_f32_16x16x32_bf16 a[232:235], a[240:243], v[208:211], a[232:235]
  v_exp_f32 v143, v143
  v_mfma_f32_16x16x32_bf16 a[232:235], a[240:243], v[240:243], a[232:235]
  v_cvt_pk_bf16_f32 v138, v140, v141
  v_exp_f32 v168, v168
  v_mfma_f32_16x16x32_bf16 a[52:55], a[200:203], v[200:203], a[52:55]
  v_mfma_f32_16x16x32_bf16 a[52:55], a[204:207], v[232:235], a[52:55]
  v_exp_f32 v169, v169
  v_mfma_f32_16x16x32_bf16 a[84:87], a[200:203], v[208:211], a[84:87]
  s_waitcnt vmcnt(6)
  s_barrier
  v_mfma_f32_16x16x32_bf16 a[84:87], a[204:207], v[240:243], a[84:87]
  v_cvt_pk_bf16_f32 v139, v142, v143
  v_exp_f32 v170, v170
  s_add_u32 m0, s44, 16384
  v_mfma_f32_16x16x32_bf16 a[116:119], a[200:203], v[216:219], a[116:119]
  v_mfma_f32_16x16x32_bf16 a[116:119], a[204:207], v[248:251], a[116:119]
  v_exp_f32 v171, v171
  s_waitcnt lgkmcnt(0)
  v_mfma_f32_16x16x32_bf16 a[24:27], a[208:211], v[192:195], a[24:27]
  buffer_load_dwordx4 v1, s[8:11], s86 offen offset:0 nt lds
  v_mfma_f32_16x16x32_bf16 a[24:27], a[212:215], v[224:227], a[24:27]
  ds_read_b128 a[192:195], v8 offset:0
  v_mfma_f32_16x16x32_bf16 a[56:59], a[208:211], v[200:203], a[56:59]
  v_mfma_f32_16x16x32_bf16 a[56:59], a[212:215], v[232:235], a[56:59]
  v_cvt_pk_bf16_f32 v168, v168, v169
  v_exp_f32 v172, v172
  ds_read_b128 a[196:199], v9 offset:0
  v_mfma_f32_16x16x32_bf16 a[88:91], a[208:211], v[208:211], a[88:91]
  v_mfma_f32_16x16x32_bf16 a[88:91], a[212:215], v[240:243], a[88:91]
  v_exp_f32 v173, v173
  v_cvt_pk_bf16_f32 v169, v170, v171
  ds_read_b128 a[200:203], v10 offset:0
  v_mfma_f32_16x16x32_bf16 a[120:123], a[208:211], v[216:219], a[120:123]
  buffer_load_dwordx4 v2, s[8:11], s86 offen offset:1024 nt lds
  v_mfma_f32_16x16x32_bf16 a[120:123], a[212:215], v[248:251], a[120:123]
  v_exp_f32 v174, v174
  ds_read_b128 a[204:207], v11 offset:0
  v_mfma_f32_16x16x32_bf16 a[28:31], a[216:219], v[192:195], a[28:31]
  v_mfma_f32_16x16x32_bf16 a[28:31], a[220:223], v[224:227], a[28:31]
  v_exp_f32 v175, v175
  v_cvt_pk_bf16_f32 v170, v172, v173
  v_mfma_f32_16x16x32_bf16 a[236:239], a[240:243], v[216:219], a[236:239]
  v_exp_f32 v144, v144
  v_mfma_f32_16x16x32_bf16 a[236:239], a[240:243], v[248:251], a[236:239]
  v_exp_f32 v145, v145
  v_mfma_f32_16x16x32_bf16 a[60:63], a[216:219], v[200:203], a[60:63]
  v_mfma_f32_16x16x32_bf16 a[60:63], a[220:223], v[232:235], a[60:63]
  v_cvt_pk_bf16_f32 v171, v174, v175
  v_exp_f32 v146, v146
  v_mfma_f32_16x16x32_bf16 a[92:95], a[216:219], v[208:211], a[92:95]
  buffer_load_dwordx4 v3, s[8:11], s86 offen offset:2048 nt lds
  v_mfma_f32_16x16x32_bf16 a[92:95], a[220:223], v[240:243], a[92:95]
  v_exp_f32 v147, v147
  v_cvt_pk_bf16_f32 v144, v144, v145
  v_mfma_f32_16x16x32_bf16 a[124:127], a[216:219], v[216:219], a[124:127]
  v_mfma_f32_16x16x32_bf16 a[124:127], a[220:223], v[248:251], a[124:127]
  v_exp_f32 v148, v148
  s_waitcnt lgkmcnt(0)
  s_cbranch_vccnz LS_t16
LS_b16:
  v_mfma_f32_16x16x32_bf16 v[192:195], a[192:195], a[128:131], v[20:23]
  buffer_load_dwordx4 v4, s[8:11], s86 offen offset:3072 nt lds
  v_mfma_f32_16x16x32_bf16 v[192:195], a[196:199], a[132:135], v[192:195]
  v_mfma_f32_16x16x32_bf16 v[192:195], a[200:203], a[136:139], v[192:195]
  v_mfma_f32_16x16x32_bf16 v[192:195], a[204:207], a[140:143], v[192:195]
  v_exp_f32 v149, v149
  v_cvt_pk_bf16_f32 v145, v146, v147
  v_exp_f32 v150, v150
  v_exp_f32 v151, v151
  ds_read_b128 a[208:211], v8 offset:4096
  ds_read_b128 a[212:215], v9 offset:4096
  v_mfma_f32_16x16x32_bf16 v[200:203], a[192:195], a[144:147], v[52:55]
  v_mfma_f32_16x16x32_bf16 v[200:203], a[196:199], a[148:151], v[200:203]
  v_mfma_f32_16x16x32_bf16 v[200:203], a[200:203], a[152:155], v[200:203]
  v_mfma_f32_16x16x32_bf16 v[200:203], a[204:207], a[156:159], v[200:203]
  ds_read_b128 a[216:219], v10 offset:4096
  v_cvt_pk_bf16_f32 v146, v148, v149
  v_max_f32 v44, v192, v193
  v_exp_f32 v176, v176
  v_max_f32 v45, v194, v195
  v_mfma_f32_16x16x32_bf16 v[208:211], a[192:195], a[160:163], v[56:59]
  v_mfma_f32_16x16x32_bf16 v[208:211], a[196:199], a[164:167], v[208:211]
  v_mfma_f32_16x16x32_bf16 v[208:211], a[200:203], a[168:171], v[208:211]
  v_mfma_f32_16x16x32_bf16 v[208:211], a[204:207], a[172:175], v[208:211]
  ds_read_b128 a[220:223], v11 offset:4096
  v_exp_f32 v177, v177
  v_max3_f32 v44, v44, v200, v201
  v_cvt_pk_bf16_f32 v147, v150, v151
  v_max3_f32 v45, v45, v202, v203
  v_exp_f32 v178, v178
  v_mfma_f32_16x16x32_bf16 v[216:219], a[192:195], a[176:179], v[60:63]
  v_mfma_f32_16x16x32_bf16 v[216:219], a[196:199], a[180:183], v[216:219]
  v_mfma_f32_16x16x32_bf16 v[216:219], a[200:203], a[184:187], v[216:219]
  s_add_u32 m0, s55, 4096
  s_add_u32 s46, s45, 4096
  v_mfma_f32_16x16x32_bf16 v[216:219], a[204:207], a[188:191], v[216:219]
  v_exp_f32 v179, v179
  v_max3_f32 v44, v44, v208, v209
  v_cvt_pk_bf16_f32 v176, v176, v177
  v_max3_f32 v45, v45, v210, v211
  s_waitcnt lgkmcnt(0)
  v_mfma_f32_16x16x32_bf16 v[196:199], a[208:211], a[128:131], v[20:23]
  v_mfma_f32_16x16x32_bf16 v[196:199], a[212:215], a[132:135], v[196:199]
  v_mfma_f32_16x16x32_bf16 v[196:199], a[216:219], a[136:139], v[196:199]
  buffer_load_dwordx4 v1, s[28:31], s46 offen offset:0 nt lds
  v_mfma_f32_16x16x32_bf16 v[196:199], a[220:223], a[140:143], v[196:199]
  v_exp_f32 v180, v180
  v_max3_f32 v44, v44, v216, v217
  v_exp_f32 v181, v181
  v_max3_f32 v45, v45, v218, v219
  v_cvt_pk_bf16_f32 v177, v178, v179
  ds_read_b128 a[192:195], v8 offset:8192
  ds_read_b128 a[196:199], v9 offset:8192
  v_mfma_f32_16x16x32_bf16 v[204:207], a[208:211], a[144:147], v[52:55]
  v_mfma_f32_16x16x32_bf16 v[204:207], a[212:215], a[148:151], v[204:207]
  v_mfma_f32_16x16x32_bf16 v[204:207], a[216:219], a[152:155], v[204:207]
  v_mfma_f32_16x16x32_bf16 v[204:207], a[220:223], a[156:159], v[204:207]
  ds_read_b128 a[200:203], v10 offset:8192
  v_exp_f32 v182, v182
  v_max3_f32 v44, v44, v196, v197
  v_exp_f32 v183, v183
  v_mfma_f32_16x16x32_bf16 v[212:215], a[208:211], a[160:163], v[56:59]
  buffer_load_dwordx4 v2, s[28:31], s46 offen offset:1024 nt lds
  v_mfma_f32_16x16x32_bf16 v[212:215], a[212:215], a[164:167], v[212:215]
  v_mfma_f32_16x16x32_bf16 v[212:215], a[216:219], a[168:171], v[212:215]
  v_mfma_f32_16x16x32_bf16 v[212:215], a[220:223], a[172:175], v[212:215]
  ds_read_b128 a[204:207], v11 offset:8192
  v_cvt_pk_bf16_f32 v178, v180, v181
  v_max3_f32 v45, v45, v198, v199
  v_exp_f32 v152, v152
  v_max3_f32 v44, v44, v204, v205
  v_mfma_f32_16x16x32_bf16 v[220:223], a[208:211], a[176:179], v[60:63]
  v_mfma_f32_16x16x32_bf16 v[220:223], a[212:215], a[180:183], v[220:223]
  v_mfma_f32_16x16x32_bf16 v[220:223], a[216:219], a[184:187], v[220:223]
  v_mfma_f32_16x16x32_bf16 v[220:223], a[220:223], a[188:191], v[220:223]
  v_exp_f32 v153, v153
  v_max3_f32 v45, v45, v206, v207
  v_cvt_pk_bf16_f32 v179, v182, v183
  v_max3_f32 v44, v44, v212, v213
  v_exp_f32 v154, v154
  s_waitcnt lgkmcnt(0)
  v_mfma_f32_16x16x32_bf16 v[224:227], a[192:195], a[128:131], v[20:23]
  v_mfma_f32_16x16x32_bf16 v[224:227], a[196:199], a[132:135], v[224:227]
  v_mfma_f32_16x16x32_bf16 v[224:227], a[200:203], a[136:139], v[224:227]
  v_mfma_f32_16x16x32_bf16 v[224:227], a[204:207], a[140:143], v[224:227]
  v_exp_f32 v155, v155
  v_max3_f32 v45, v45, v214, v215
  v_cvt_pk_bf16_f32 v152, v152, v153
  v_max3_f32 v44, v44, v220, v221
  v_exp_f32 v156, v156
  v_max3_f32 v45, v45, v222, v223
  ds_read_b128 a[208:211], v8 offset:12288
  ds_read_b128 a[212:215], v9 offset:12288
  v_mfma_f32_16x16x32_bf16 v[232:235], a[192:195], a[144:147], v[52:55]
  v_mfma_f32_16x16x32_bf16 v[232:235], a[196:199], a[148:151], v[232:235]
  v_mfma_f32_16x16x32_bf16 v[232:235], a[200:203], a[152:155], v[232:235]
  v_mfma_f32_16x16x32_bf16 v[232:235], a[204:207], a[156:159], v[232:235]
  ds_read_b128 a[216:219], v10 offset:12288
  v_exp_f32 v157, v157
  v_max3_f32 v44, v44, v224, v225
  v_cvt_pk_bf16_f32 v153, v154, v155
  v_max3_f32 v45, v45, v226, v227
  v_mfma_f32_16x16x32_bf16 v[240:243], a[192:195], a[160:163], v[56:59]
  v_mfma_f32_16x16x32_bf16 v[240:243], a[196:199], a[164:167], v[240:243]
  v_mfma_f32_16x16x32_bf16 v[240:243], a[200:203], a[168:171], v[240:243]
  v_mfma_f32_16x16x32_bf16 v[240:243], a[204:207], a[172:175], v[240:243]
  ds_read_b128 a[220:223], v11 offset:12288
  v_exp_f32 v158, v158
  v_max3_f32 v44, v44, v232, v233
  v_exp_f32 v159, v159
  v_max3_f32 v45, v45, v234, v235
  v_cvt_pk_bf16_f32 v154, v156, v157
  v_mfma_f32_16x16x32_bf16 v[248:251], a[192:195], a[176:179], v[60:63]
  s_waitcnt vmcnt(8)
  s_barrier
  v_mfma_f32_16x16x32_bf16 v[248:251], a[196:199], a[180:183], v[248:251]
  s_add_u32 m0, s44, 49152
  v_mfma_f32_16x16x32_bf16 v[248:251], a[200:203], a[184:187], v[248:251]
  v_mfma_f32_16x16x32_bf16 v[248:251], a[204:207], a[188:191], v[248:251]
  v_exp_f32 v184, v184
  v_max3_f32 v44, v44, v240, v241
  v_exp_f32 v185, v185
  s_waitcnt lgkmcnt(0)
  v_mfma_f32_16x16x32_bf16 v[228:231], a[208:211], a[128:131], v[20:23]
  buffer_load_dwordx4 v5, s[12:15], s85 offen offset:0 nt lds
  v_mfma_f32_16x16x32_bf16 v[228:231], a[212:215], a[132:135], v[228:231]
  v_mfma_f32_16x16x32_bf16 v[228:231], a[216:219], a[136:139], v[228:231]
  v_mfma_f32_16x16x32_bf16 v[228:231], a[220:223], a[140:143], v[228:231]
  v_cvt_pk_bf16_f32 v155, v158, v159
  v_max3_f32 v45, v45, v242, v243
  v_exp_f32 v186, v186
  v_max3_f32 v44, v44, v248, v249
  ds_read_b64_tr_b16 a[192:193], v12 offset:32768
  ds_read_b64_tr_b16 a[194:195], v12 offset:36864
  ds_read_b64_tr_b16 a[196:197], v12 offset:40960
  ds_read_b64_tr_b16 a[198:199], v12 offset:45056
  v_mfma_f32_16x16x32_bf16 v[236:239], a[208:211], a[144:147], v[52:55]
  v_mfma_f32_16x16x32_bf16 v[236:239], a[212:215], a[148:151], v[236:239]
  v_mfma_f32_16x16x32_bf16 v[236:239], a[216:219], a[152:155], v[236:239]
  buffer_load_dwordx4 v6, s[12:15], s85 offen offset:1024 nt lds
  v_mfma_f32_16x16x32_bf16 v[236:239], a[220:223], a[156:159], v[236:239]
  ds_read_b64_tr_b16 a[200:201], v13 offset:32768
  ds_read_b64_tr_b16 a[202:203], v13 offset:36864
  v_mfma_f32_16x16x32_bf16 v[244:247], a[208:211], a[160:163], v[56:59]
  v_mfma_f32_16x16x32_bf16 v[244:247], a[212:215], a[164:167], v[244:247]
  v_mfma_f32_16x16x32_bf16 v[244:247], a[216:219], a[168:171], v[244:247]
  v_mfma_f32_16x16x32_bf16 v[244:247], a[220:223], a[172:175], v[244:247]
  ds_read_b64_tr_b16 a[204:205], v13 offset:40960
  ds_read_b64_tr_b16 a[206:207], v13 offset:45056
  v_exp_f32 v187, v187
  v_max3_f32 v45, v45, v250, v251
  v_cvt_pk_bf16_f32 v184, v184, v185
  v_max3_f32 v44, v44, v228, v229
  v_exp_f32 v188, v188
  v_mfma_f32_16x16x32_bf16 v[252:255], a[208:211], a[176:179], v[60:63]
  buffer_load_dwordx4 v5, s[12:15], s85 offen offset:2048 nt lds
  v_mfma_f32_16x16x32_bf16 v[252:255], a[212:215], a[180:183], v[252:255]
  v_mfma_f32_16x16x32_bf16 v[252:255], a[216:219], a[184:187], v[252:255]
  v_mfma_f32_16x16x32_bf16 v[252:255], a[220:223], a[188:191], v[252:255]
  v_exp_f32 v189, v189
  v_max3_f32 v45, v45, v230, v231
  v_cvt_pk_bf16_f32 v185, v186, v187
  v_max3_f32 v44, v44, v236, v237
  s_waitcnt lgkmcnt(0)
  v_mfma_f32_16x16x32_bf16 a[0:3], a[192:195], v[128:131], a[0:3]
  buffer_load_dwordx4 v6, s[12:15], s85 offen offset:3072 nt lds
  v_mfma_f32_16x16x32_bf16 a[0:3], a[196:199], v[160:163], a[0:3]
  v_exp_f32 v190, v190
  ds_read_b64_tr_b16 a[208:209], v14 offset:32768
  ds_read_b64_tr_b16 a[210:211], v14 offset:36864
  v_mfma_f32_16x16x32_bf16 a[32:35], a[192:195], v[136:139], a[32:35]
  v_mfma_f32_16x16x32_bf16 a[32:35], a[196:199], v[168:171], a[32:35]
  v_exp_f32 v191, v191
  ds_read_b64_tr_b16 a[212:213], v14 offset:40960
  ds_read_b64_tr_b16 a[214:215], v14 offset:45056
  v_mfma_f32_16x16x32_bf16 a[64:67], a[192:195], v[144:147], a[64:67]
  v_mfma_f32_16x16x32_bf16 a[64:67], a[196:199], v[176:179], a[64:67]
  ds_read_b64_tr_b16 a[216:217], v15 offset:32768
  ds_read_b64_tr_b16 a[218:219], v15 offset:36864
  v_mfma_f32_16x16x32_bf16 a[96:99], a[192:195], v[152:155], a[96:99]
  v_cvt_pk_bf16_f32 v186, v188, v189
  v_cvt_pk_bf16_f32 v187, v190, v191
  s_nop 1
  v_mfma_f32_16x16x32_bf16 a[96:99], a[196:199], v[184:187], a[96:99]
  ds_read_b64_tr_b16 a[220:221], v15 offset:40960
  ds_read_b64_tr_b16 a[222:223], v15 offset:45056
  v_max3_f32 v45, v45, v238, v239
  v_max3_f32 v44, v44, v244, v245
  v_max3_f32 v45, v45, v246, v247
  v_mfma_f32_16x16x32_bf16 a[4:7], a[200:203], v[128:131], a[4:7]
  v_mfma_f32_16x16x32_bf16 a[4:7], a[204:207], v[160:163], a[4:7]
  v_max3_f32 v44, v44, v252, v253
  v_max3_f32 v45, v45, v254, v255
  v_max_f32 v44, v44, v45
  v_cmp_lt_f32 vcc, s48, v44
  v_add_u32 v36, s55, v8
  v_mfma_f32_16x16x32_bf16 a[224:227], a[240:243], v[128:131], a[224:227]
  v_add_u32 v37, s55, v9
  v_add_u32 v38, s55, v10
  v_mfma_f32_16x16x32_bf16 a[224:227], a[240:243], v[160:163], a[224:227]
  v_add_u32 v39, s55, v11
  v_mfma_f32_16x16x32_bf16 a[36:39], a[200:203], v[136:139], a[36:39]
  v_mfma_f32_16x16x32_bf16 a[36:39], a[204:207], v[168:171], a[36:39]
  s_waitcnt vmcnt(10)
  s_cbranch_vccnz LS_t2
LS_b2:
  v_exp_f32 v192, v192
  v_exp_f32 v193, v193
  v_exp_f32 v194, v194
  v_mfma_f32_16x16x32_bf16 a[68:71], a[200:203], v[144:147], a[68:71]
  ds_read_b128 v[64:67], v36 offset:0
  v_mfma_f32_16x16x32_bf16 a[68:71], a[204:207], v[176:179], a[68:71]
  ds_read_b128 v[68:71], v37 offset:0
  v_exp_f32 v195, v195
  v_cvt_pk_bf16_f32 v192, v192, v193
  v_exp_f32 v196, v196
  v_mfma_f32_16x16x32_bf16 a[100:103], a[200:203], v[152:155], a[100:103]
  ds_read_b128 v[72:75], v38 offset:0
  ds_read_b128 v[76:79], v39 offset:0
  v_mfma_f32_16x16x32_bf16 a[100:103], a[204:207], v[184:187], a[100:103]
  v_exp_f32 v197, v197
  v_cvt_pk_bf16_f32 v193, v194, v195
  s_waitcnt lgkmcnt(4)
  v_mfma_f32_16x16x32_bf16 a[8:11], a[208:211], v[128:131], a[8:11]
  v_mfma_f32_16x16x32_bf16 a[8:11], a[212:215], v[160:163], a[8:11]
  v_exp_f32 v198, v198
  v_exp_f32 v199, v199
  ds_read_b64_tr_b16 a[192:193], v16 offset:32768
  ds_read_b64_tr_b16 a[194:195], v16 offset:36864
  v_mfma_f32_16x16x32_bf16 a[40:43], a[208:211], v[136:139], a[40:43]
  v_mfma_f32_16x16x32_bf16 a[40:43], a[212:215], v[168:171], a[40:43]
  v_cvt_pk_bf16_f32 v194, v196, v197
  v_exp_f32 v224, v224
  ds_read_b64_tr_b16 a[196:197], v16 offset:40960
  ds_read_b64_tr_b16 a[198:199], v16 offset:45056
  v_mfma_f32_16x16x32_bf16 a[72:75], a[208:211], v[144:147], a[72:75]
  v_mfma_f32_16x16x32_bf16 a[72:75], a[212:215], v[176:179], a[72:75]
  ds_read_b64_tr_b16 a[200:201], v17 offset:32768
  ds_read_b64_tr_b16 a[202:203], v17 offset:36864
  v_mfma_f32_16x16x32_bf16 a[104:107], a[208:211], v[152:155], a[104:107]
  v_mfma_f32_16x16x32_bf16 a[104:107], a[212:215], v[184:187], a[104:107]
  ds_read_b64_tr_b16 a[204:205], v17 offset:40960
  ds_read_b64_tr_b16 a[206:207], v17 offset:45056
  v_exp_f32 v225, v225
  v_mfma_f32_16x16x32_bf16 a[12:15], a[216:219], v[128:131], a[12:15]
  v_mfma_f32_16x16x32_bf16 a[12:15], a[220:223], v[160:163], a[12:15]
  v_cvt_pk_bf16_f32 v195, v198, v199
  v_exp_f32 v226, v226
  s_waitcnt lgkmcnt(11)
  v_lshlrev_b32 v40, 16, v64
  v_mfma_f32_16x16x32_bf16 a[228:231], a[240:243], v[136:139], a[228:231]
  v_exp_f32 v227, v227
  v_mfma_f32_16x16x32_bf16 a[228:231], a[240:243], v[168:171], a[228:231]
  v_cvt_pk_bf16_f32 v224, v224, v225
  v_exp_f32 v228, v228
  v_mfma_f32_16x16x32_bf16 a[44:47], a[216:219], v[136:139], a[44:47]
  v_mfma_f32_16x16x32_bf16 a[44:47], a[220:223], v[168:171], a[44:47]
  v_exp_f32 v229, v229
  v_cvt_pk_bf16_f32 v225, v226, v227
  v_lshlrev_b32 v41, 16, v65
  v_mfma_f32_16x16x32_bf16 a[76:79], a[216:219], v[144:147], a[76:79]
  v_mfma_f32_16x16x32_bf16 a[76:79], a[220:223], v[176:179], a[76:79]
  v_exp_f32 v230, v230
  v_exp_f32 v231, v231
  v_and_b32 v64, 0xffff0000, v64
  v_and_b32 v65, 0xffff0000, v65
  s_add_u32 m0, s55, 4096
  s_add_u32 s46, s45, 4096
  v_mfma_f32_16x16x32_bf16 a[108:111], a[216:219], v[152:155], a[108:111]
  buffer_load_dwordx4 v3, s[28:31], s46 offen offset:2048 nt lds
  v_mfma_f32_16x16x32_bf16 a[108:111], a[220:223], v[184:187], a[108:111]
  v_mul_f32 v40, s47, v40
  s_waitcnt lgkmcnt(0)
  v_mfma_f32_16x16x32_bf16 a[16:19], a[192:195], v[128:131], a[16:19]
  v_mfma_f32_16x16x32_bf16 a[16:19], a[196:199], v[160:163], a[16:19]
  v_cvt_pk_bf16_f32 v226, v228, v229
  v_exp_f32 v200, v200
  v_mul_f32 v41, s47, v41
  ds_read_b64_tr_b16 a[208:209], v18 offset:32768
  ds_read_b64_tr_b16 a[210:211], v18 offset:36864
  v_mfma_f32_16x16x32_bf16 a[48:51], a[192:195], v[136:139], a[48:51]
  v_mfma_f32_16x16x32_bf16 a[48:51], a[196:199], v[168:171], a[48:51]
  v_exp_f32 v201, v201
  v_cvt_pk_bf16_f32 v227, v230, v231
  v_mul_f32 v64, s47, v64
  ds_read_b64_tr_b16 a[212:213], v18 offset:40960
  ds_read_b64_tr_b16 a[214:215], v18 offset:45056
  v_mfma_f32_16x16x32_bf16 a[80:83], a[192:195], v[144:147], a[80:83]
  buffer_load_dwordx4 v4, s[28:31], s46 offen offset:3072 nt lds
  v_mfma_f32_16x16x32_bf16 a[80:83], a[196:199], v[176:179], a[80:83]
  ds_read_b64_tr_b16 a[216:217], v19 offset:32768
  ds_read_b64_tr_b16 a[218:219], v19 offset:36864
  v_mul_f32 v65, s47, v65
  v_mfma_f32_16x16x32_bf16 a[112:115], a[192:195], v[152:155], a[112:115]
  v_mfma_f32_16x16x32_bf16 a[112:115], a[196:199], v[184:187], a[112:115]
  ds_read_b64_tr_b16 a[220:221], v19 offset:40960
  ds_read_b64_tr_b16 a[222:223], v19 offset:45056
  v_cvt_pk_bf16_f32 v64, v40, v64
  v_cvt_pk_bf16_f32 v65, v41, v65
  v_mfma_f32_16x16x32_bf16 a[20:23], a[200:203], v[128:131], a[20:23]
  v_mfma_f32_16x16x32_bf16 a[20:23], a[204:207], v[160:163], a[20:23]
  v_exp_f32 v202, v202
  v_exp_f32 v203, v203
  v_lshlrev_b32 v40, 16, v66
  v_mfma_f32_16x16x32_bf16 a[232:235], a[240:243], v[144:147], a[232:235]
  v_cvt_pk_bf16_f32 v200, v200, v201
  v_lshlrev_b32 v41, 16, v67
  v_mfma_f32_16x16x32_bf16 a[232:235], a[240:243], v[176:179], a[232:235]
  v_exp_f32 v204, v204
  v_exp_f32 v205, v205
  v_mfma_f32_16x16x32_bf16 a[52:55], a[200:203], v[136:139], a[52:55]
  v_mfma_f32_16x16x32_bf16 a[52:55], a[204:207], v[168:171], a[52:55]
  v_cvt_pk_bf16_f32 v201, v202, v203
  v_exp_f32 v206, v206
  v_mfma_f32_16x16x32_bf16 a[84:87], a[200:203], v[144:147], a[84:87]
  s_waitcnt vmcnt(8)
  s_barrier
  v_mfma_f32_16x16x32_bf16 a[84:87], a[204:207], v[176:179], a[84:87]
  v_exp_f32 v207, v207
  v_and_b32 v66, 0xffff0000, v66
  s_add_u32 m0, s44, 32768
  v_mfma_f32_16x16x32_bf16 a[116:119], a[200:203], v[152:155], a[116:119]
  v_mfma_f32_16x16x32_bf16 a[116:119], a[204:207], v[184:187], a[116:119]
  v_cvt_pk_bf16_f32 v202, v204, v205
  v_exp_f32 v232, v232
  v_and_b32 v67, 0xffff0000, v67
  s_waitcnt lgkmcnt(0)
  v_mfma_f32_16x16x32_bf16 a[24:27], a[208:211], v[128:131], a[24:27]
  buffer_load_dwordx4 v1, s[8:11], s87 offen offset:0 nt lds
  v_mfma_f32_16x16x32_bf16 a[24:27], a[212:215], v[160:163], a[24:27]
  v_exp_f32 v233, v233
  v_mul_f32 v40, s47, v40
  v_mul_f32 v41, s47, v41
  ds_read_b128 a[192:195], v8 offset:16384
  v_mfma_f32_16x16x32_bf16 a[56:59], a[208:211], v[136:139], a[56:59]
  v_mfma_f32_16x16x32_bf16 a[56:59], a[212:215], v[168:171], a[56:59]
  v_cvt_pk_bf16_f32 v203, v206, v207
  v_exp_f32 v234, v234
  v_mul_f32 v66, s47, v66
  ds_read_b128 a[196:199], v9 offset:16384
  v_mfma_f32_16x16x32_bf16 a[88:91], a[208:211], v[144:147], a[88:91]
  v_mfma_f32_16x16x32_bf16 a[88:91], a[212:215], v[176:179], a[88:91]
  ds_read_b128 a[200:203], v10 offset:16384
  v_exp_f32 v235, v235
  v_mul_f32 v67, s47, v67
  v_mfma_f32_16x16x32_bf16 a[120:123], a[208:211], v[152:155], a[120:123]
  buffer_load_dwordx4 v2, s[8:11], s87 offen offset:1024 nt lds
  v_mfma_f32_16x16x32_bf16 a[120:123], a[212:215], v[184:187], a[120:123]
  ds_read_b128 a[204:207], v11 offset:16384
  v_cvt_pk_bf16_f32 v232, v232, v233
  v_cvt_pk_bf16_f32 v66, v40, v66
  v_mfma_f32_16x16x32_bf16 a[28:31], a[216:219], v[128:131], a[28:31]
  v_mfma_f32_16x16x32_bf16 a[28:31], a[220:223], v[160:163], a[28:31]
  v_exp_f32 v236, v236
  v_exp_f32 v237, v237
  v_cvt_pk_bf16_f32 v67, v41, v67
  v_mfma_f32_16x16x32_bf16 a[236:239], a[240:243], v[152:155], a[236:239]
  v_cvt_pk_bf16_f32 v233, v234, v235
  v_lshlrev_b32 v40, 16, v68
  v_mfma_f32_16x16x32_bf16 a[236:239], a[240:243], v[184:187], a[236:239]
  v_exp_f32 v238, v238
  v_mfma_f32_16x16x32_bf16 a[60:63], a[216:219], v[136:139], a[60:63]
  v_mfma_f32_16x16x32_bf16 a[60:63], a[220:223], v[168:171], a[60:63]
  v_exp_f32 v239, v239
  v_cvt_pk_bf16_f32 v234, v236, v237
  v_exp_f32 v208, v208
  v_mfma_f32_16x16x32_bf16 a[92:95], a[216:219], v[144:147], a[92:95]
  buffer_load_dwordx4 v3, s[8:11], s87 offen offset:2048 nt lds
  v_mfma_f32_16x16x32_bf16 a[92:95], a[220:223], v[176:179], a[92:95]
  v_exp_f32 v209, v209
  v_lshlrev_b32 v41, 16, v69
  v_and_b32 v68, 0xffff0000, v68
  v_mfma_f32_16x16x32_bf16 a[124:127], a[216:219], v[152:155], a[124:127]
  v_mfma_f32_16x16x32_bf16 a[124:127], a[220:223], v[184:187], a[124:127]
  v_cvt_pk_bf16_f32 v235, v238, v239
  v_exp_f32 v210, v210
  v_and_b32 v69, 0xffff0000, v69
  s_waitcnt lgkmcnt(0)
  s_cbranch_vccnz LS_t17
LS_b17:
  v_mfma_f32_16x16x32_bf16 v[128:131], a[192:195], a[128:131], v[20:23]
  buffer_load_dwordx4 v4, s[8:11], s87 offen offset:3072 nt lds
  v_mfma_f32_16x16x32_bf16 v[128:131], a[196:199], a[132:135], v[128:131]
  v_mfma_f32_16x16x32_bf16 v[128:131], a[200:203], a[136:139], v[128:131]
  v_mfma_f32_16x16x32_bf16 v[128:131], a[204:207], a[140:143], v[128:131]
  ds_read_b128 a[208:211], v8 offset:20480
  ds_read_b128 a[212:215], v9 offset:20480
  v_exp_f32 v211, v211
  v_cvt_pk_bf16_f32 v208, v208, v209
  v_exp_f32 v212, v212
  v_mul_f32 v40, s47, v40
  v_mul_f32 v41, s47, v41
  v_mfma_f32_16x16x32_bf16 v[136:139], a[192:195], a[144:147], v[52:55]
  v_mfma_f32_16x16x32_bf16 v[136:139], a[196:199], a[148:151], v[136:139]
  v_mfma_f32_16x16x32_bf16 v[136:139], a[200:203], a[152:155], v[136:139]
  v_mfma_f32_16x16x32_bf16 v[136:139], a[204:207], a[156:159], v[136:139]
  ds_read_b128 a[216:219], v10 offset:20480
  v_exp_f32 v213, v213
  v_max_f32 v44, v128, v129
  v_cvt_pk_bf16_f32 v209, v210, v211
  v_max_f32 v45, v130, v131
  v_exp_f32 v214, v214
  v_mul_f32 v68, s47, v68
  v_mul_f32 v69, s47, v69
  v_cvt_pk_bf16_f32 v68, v40, v68
  v_mfma_f32_16x16x32_bf16 v[144:147], a[192:195], a[160:163], v[56:59]
  v_mfma_f32_16x16x32_bf16 v[144:147], a[196:199], a[164:167], v[144:147]
  v_mfma_f32_16x16x32_bf16 v[144:147], a[200:203], a[168:171], v[144:147]
  v_mfma_f32_16x16x32_bf16 v[144:147], a[204:207], a[172:175], v[144:147]
  ds_read_b128 a[220:223], v11 offset:20480
  v_exp_f32 v215, v215
  v_max3_f32 v44, v44, v136, v137
  v_cvt_pk_bf16_f32 v210, v212, v213
  v_max3_f32 v45, v45, v138, v139
  v_exp_f32 v240, v240
  v_cvt_pk_bf16_f32 v69, v41, v69
  v_lshlrev_b32 v40, 16, v70
  v_mfma_f32_16x16x32_bf16 v[152:155], a[192:195], a[176:179], v[60:63]
  v_mfma_f32_16x16x32_bf16 v[152:155], a[196:199], a[180:183], v[152:155]
  v_mfma_f32_16x16x32_bf16 v[152:155], a[200:203], a[184:187], v[152:155]
  v_mfma_f32_16x16x32_bf16 v[152:155], a[204:207], a[188:191], v[152:155]
  v_exp_f32 v241, v241
  v_max3_f32 v44, v44, v144, v145
  v_cvt_pk_bf16_f32 v211, v214, v215
  v_max3_f32 v45, v45, v146, v147
  v_exp_f32 v242, v242
  v_lshlrev_b32 v41, 16, v71
  v_and_b32 v70, 0xffff0000, v70
  s_waitcnt lgkmcnt(0)
  v_mfma_f32_16x16x32_bf16 v[132:135], a[208:211], a[128:131], v[20:23]
  v_mfma_f32_16x16x32_bf16 v[132:135], a[212:215], a[132:135], v[132:135]
  v_mfma_f32_16x16x32_bf16 v[132:135], a[216:219], a[136:139], v[132:135]
  v_mfma_f32_16x16x32_bf16 v[132:135], a[220:223], a[140:143], v[132:135]
  ds_read_b128 a[192:195], v8 offset:24576
  ds_read_b128 a[196:199], v9 offset:24576
  v_exp_f32 v243, v243
  v_max3_f32 v44, v44, v152, v153
  v_cvt_pk_bf16_f32 v240, v240, v241
  v_max3_f32 v45, v45, v154, v155
  v_and_b32 v71, 0xffff0000, v71
  v_mul_f32 v40, s47, v40
  v_mul_f32 v41, s47, v41
  v_mfma_f32_16x16x32_bf16 v[140:143], a[208:211], a[144:147], v[52:55]
  v_mfma_f32_16x16x32_bf16 v[140:143], a[212:215], a[148:151], v[140:143]
  v_mfma_f32_16x16x32_bf16 v[140:143], a[216:219], a[152:155], v[140:143]
  v_mfma_f32_16x16x32_bf16 v[140:143], a[220:223], a[156:159], v[140:143]
  ds_read_b128 a[200:203], v10 offset:24576
  v_exp_f32 v244, v244
  v_max3_f32 v44, v44, v132, v133
  v_exp_f32 v245, v245
  v_max3_f32 v45, v45, v134, v135
  v_cvt_pk_bf16_f32 v241, v242, v243
  v_mul_f32 v70, s47, v70
  v_mul_f32 v71, s47, v71
  v_mfma_f32_16x16x32_bf16 v[148:151], a[208:211], a[160:163], v[56:59]
  v_mfma_f32_16x16x32_bf16 v[148:151], a[212:215], a[164:167], v[148:151]
  v_mfma_f32_16x16x32_bf16 v[148:151], a[216:219], a[168:171], v[148:151]
  v_mfma_f32_16x16x32_bf16 v[148:151], a[220:223], a[172:175], v[148:151]
  ds_read_b128 a[204:207], v11 offset:24576
  v_exp_f32 v246, v246
  v_max3_f32 v44, v44, v140, v141
  v_exp_f32 v247, v247
  v_max3_f32 v45, v45, v142, v143
  v_cvt_pk_bf16_f32 v242, v244, v245
  v_cvt_pk_bf16_f32 v70, v40, v70
  v_cvt_pk_bf16_f32 v71, v41, v71
  v_mfma_f32_16x16x32_bf16 v[156:159], a[208:211], a[176:179], v[60:63]
  v_mfma_f32_16x16x32_bf16 v[156:159], a[212:215], a[180:183], v[156:159]
  v_mfma_f32_16x16x32_bf16 v[156:159], a[216:219], a[184:187], v[156:159]
  v_mfma_f32_16x16x32_bf16 v[156:159], a[220:223], a[188:191], v[156:159]
  v_exp_f32 v216, v216
  v_max3_f32 v44, v44, v148, v149
  v_exp_f32 v217, v217
  v_max3_f32 v45, v45, v150, v151
  v_cvt_pk_bf16_f32 v243, v246, v247
  v_exp_f32 v218, v218
  v_lshlrev_b32 v40, 16, v72
  v_lshlrev_b32 v41, 16, v73
  v_and_b32 v72, 0xffff0000, v72
  s_waitcnt lgkmcnt(0)
  v_mfma_f32_16x16x32_bf16 v[160:163], a[192:195], a[128:131], v[20:23]
  v_mfma_f32_16x16x32_bf16 v[160:163], a[196:199], a[132:135], v[160:163]
  v_mfma_f32_16x16x32_bf16 v[160:163], a[200:203], a[136:139], v[160:163]
  v_mfma_f32_16x16x32_bf16 v[160:163], a[204:207], a[140:143], v[160:163]
  ds_read_b128 a[208:211], v8 offset:28672
  ds_read_b128 a[212:215], v9 offset:28672
  v_exp_f32 v219, v219
  v_max3_f32 v44, v44, v156, v157
  v_cvt_pk_bf16_f32 v216, v216, v217
  v_max3_f32 v45, v45, v158, v159
  v_and_b32 v73, 0xffff0000, v73
  v_mul_f32 v40, s47, v40
  v_mfma_f32_16x16x32_bf16 v[168:171], a[192:195], a[144:147], v[52:55]
  v_mfma_f32_16x16x32_bf16 v[168:171], a[196:199], a[148:151], v[168:171]
  v_mfma_f32_16x16x32_bf16 v[168:171], a[200:203], a[152:155], v[168:171]
  v_mfma_f32_16x16x32_bf16 v[168:171], a[204:207], a[156:159], v[168:171]
  ds_read_b128 a[216:219], v10 offset:28672
  v_exp_f32 v220, v220
  v_max3_f32 v44, v44, v160, v161
  v_exp_f32 v221, v221
  v_max3_f32 v45, v45, v162, v163
  v_cvt_pk_bf16_f32 v217, v218, v219
  v_mul_f32 v41, s47, v41
  v_mul_f32 v72, s47, v72
  v_mul_f32 v73, s47, v73
  v_mfma_f32_16x16x32_bf16 v[176:179], a[192:195], a[160:163], v[56:59]
  v_mfma_f32_16x16x32_bf16 v[176:179], a[196:199], a[164:167], v[176:179]
  v_mfma_f32_16x16x32_bf16 v[176:179], a[200:203], a[168:171], v[176:179]
  v_mfma_f32_16x16x32_bf16 v[176:179], a[204:207], a[172:175], v[176:179]
  ds_read_b128 a[220:223], v11 offset:28672
  v_exp_f32 v222, v222
  v_max3_f32 v44, v44, v168, v169
  v_exp_f32 v223, v223
  v_max3_f32 v45, v45, v170, v171
  v_cvt_pk_bf16_f32 v218, v220, v221
  v_cvt_pk_bf16_f32 v72, v40, v72
  v_cvt_pk_bf16_f32 v73, v41, v73
  v_mfma_f32_16x16x32_bf16 v[184:187], a[192:195], a[176:179], v[60:63]
  s_waitcnt vmcnt(6)
  s_barrier
  v_mfma_f32_16x16x32_bf16 v[184:187], a[196:199], a[180:183], v[184:187]
  s_add_u32 m0, s44, 65536
  v_mfma_f32_16x16x32_bf16 v[184:187], a[200:203], a[184:187], v[184:187]
  v_mfma_f32_16x16x32_bf16 v[184:187], a[204:207], a[188:191], v[184:187]
  v_exp_f32 v248, v248
  v_max3_f32 v44, v44, v176, v177
  v_exp_f32 v249, v249
  v_lshlrev_b32 v40, 16, v74
  v_lshlrev_b32 v41, 16, v75
  s_waitcnt lgkmcnt(0)
  v_mfma_f32_16x16x32_bf16 v[164:167], a[208:211], a[128:131], v[20:23]
  buffer_load_dwordx4 v5, s[12:15], s86 offen offset:0 nt lds
  v_mfma_f32_16x16x32_bf16 v[164:167], a[212:215], a[132:135], v[164:167]
  v_mfma_f32_16x16x32_bf16 v[164:167], a[216:219], a[136:139], v[164:167]
  v_mfma_f32_16x16x32_bf16 v[164:167], a[220:223], a[140:143], v[164:167]
  ds_read_b64_tr_b16 a[192:193], v12 offset:0
  ds_read_b64_tr_b16 a[194:195], v12 offset:4096
  ds_read_b64_tr_b16 a[196:197], v12 offset:8192
  ds_read_b64_tr_b16 a[198:199], v12 offset:12288
  v_cvt_pk_bf16_f32 v219, v222, v223
  v_max3_f32 v45, v45, v178, v179
  v_and_b32 v74, 0xffff0000, v74
  v_and_b32 v75, 0xffff0000, v75
  v_mul_f32 v40, s47, v40
  v_mfma_f32_16x16x32_bf16 v[172:175], a[208:211], a[144:147], v[52:55]
  v_mfma_f32_16x16x32_bf16 v[172:175], a[212:215], a[148:151], v[172:175]
  v_mfma_f32_16x16x32_bf16 v[172:175], a[216:219], a[152:155], v[172:175]
  buffer_load_dwordx4 v6, s[12:15], s86 offen offset:1024 nt lds
  v_mfma_f32_16x16x32_bf16 v[172:175], a[220:223], a[156:159], v[172:175]
  ds_read_b64_tr_b16 a[200:201], v13 offset:0
  ds_read_b64_tr_b16 a[202:203], v13 offset:4096
  v_exp_f32 v250, v250
  v_max3_f32 v44, v44, v184, v185
  v_exp_f32 v251, v251
  v_mul_f32 v41, s47, v41
  v_mul_f32 v74, s47, v74
  v_mfma_f32_16x16x32_bf16 v[180:183], a[208:211], a[160:163], v[56:59]
  v_mfma_f32_16x16x32_bf16 v[180:183], a[212:215], a[164:167], v[180:183]
  v_mfma_f32_16x16x32_bf16 v[180:183], a[216:219], a[168:171], v[180:183]
  v_mfma_f32_16x16x32_bf16 v[180:183], a[220:223], a[172:175], v[180:183]
  ds_read_b64_tr_b16 a[204:205], v13 offset:8192
  ds_read_b64_tr_b16 a[206:207], v13 offset:12288
  v_cvt_pk_bf16_f32 v248, v248, v249
  v_max3_f32 v45, v45, v186, v187
  v_exp_f32 v252, v252
  v_max3_f32 v44, v44, v164, v165
  v_mul_f32 v75, s47, v75
  v_cvt_pk_bf16_f32 v74, v40, v74
  v_mfma_f32_16x16x32_bf16 v[188:191], a[208:211], a[176:179], v[60:63]
  buffer_load_dwordx4 v5, s[12:15], s86 offen offset:2048 nt lds
  v_mfma_f32_16x16x32_bf16 v[188:191], a[212:215], a[180:183], v[188:191]
  v_mfma_f32_16x16x32_bf16 v[188:191], a[216:219], a[184:187], v[188:191]
  v_mfma_f32_16x16x32_bf16 v[188:191], a[220:223], a[188:191], v[188:191]
  v_exp_f32 v253, v253
  v_max3_f32 v45, v45, v166, v167
  v_cvt_pk_bf16_f32 v249, v250, v251
  v_max3_f32 v44, v44, v172, v173
  v_cvt_pk_bf16_f32 v75, v41, v75
  v_lshlrev_b32 v40, 16, v76
  v_lshlrev_b32 v41, 16, v77
  s_waitcnt lgkmcnt(0)
  v_mfma_f32_16x16x32_bf16 a[0:3], a[192:195], v[192:195], a[0:3]
  buffer_load_dwordx4 v6, s[12:15], s86 offen offset:3072 nt lds
  v_mfma_f32_16x16x32_bf16 a[0:3], a[196:199], v[224:227], a[0:3]
  ds_read_b64_tr_b16 a[208:209], v14 offset:0
  ds_read_b64_tr_b16 a[210:211], v14 offset:4096
  v_and_b32 v76, 0xffff0000, v76
  v_mfma_f32_16x16x32_bf16 a[32:35], a[192:195], v[200:203], a[32:35]
  v_mfma_f32_16x16x32_bf16 a[32:35], a[196:199], v[232:235], a[32:35]
  ds_read_b64_tr_b16 a[212:213], v14 offset:8192
  ds_read_b64_tr_b16 a[214:215], v14 offset:12288
  v_exp_f32 v254, v254
  v_and_b32 v77, 0xffff0000, v77
  v_mfma_f32_16x16x32_bf16 a[64:67], a[192:195], v[208:211], a[64:67]
  v_mfma_f32_16x16x32_bf16 a[64:67], a[196:199], v[240:243], a[64:67]
  ds_read_b64_tr_b16 a[216:217], v15 offset:0
  ds_read_b64_tr_b16 a[218:219], v15 offset:4096
  v_exp_f32 v255, v255
  v_max3_f32 v45, v45, v174, v175
  v_mul_f32 v40, s47, v40
  v_mfma_f32_16x16x32_bf16 a[96:99], a[192:195], v[216:219], a[96:99]
  v_cvt_pk_bf16_f32 v250, v252, v253
  v_cvt_pk_bf16_f32 v251, v254, v255
  s_nop 1
  v_mfma_f32_16x16x32_bf16 a[96:99], a[196:199], v[248:251], a[96:99]
  ds_read_b64_tr_b16 a[220:221], v15 offset:8192
  ds_read_b64_tr_b16 a[222:223], v15 offset:12288
  v_max3_f32 v44, v44, v180, v181
  v_max3_f32 v45, v45, v182, v183
  v_mul_f32 v41, s47, v41
  v_mfma_f32_16x16x32_bf16 a[4:7], a[200:203], v[192:195], a[4:7]
  s_add_u32 m0, s55, 8192
  s_add_u32 s46, s45, 8192
  v_mfma_f32_16x16x32_bf16 a[4:7], a[204:207], v[224:227], a[4:7]
  v_max3_f32 v44, v44, v188, v189
  v_max3_f32 v45, v45, v190, v191
  v_mul_f32 v76, s47, v76
  v_mul_f32 v77, s47, v77
  v_mfma_f32_16x16x32_bf16 a[224:227], a[240:243], v[192:195], a[224:227]
  v_max_f32 v44, v44, v45
  v_cmp_lt_f32 vcc, s48, v44
  v_mfma_f32_16x16x32_bf16 a[224:227], a[240:243], v[224:227], a[224:227]
  v_cvt_pk_bf16_f32 v76, v40, v76
  v_cvt_pk_bf16_f32 v77, v41, v77
  v_mfma_f32_16x16x32_bf16 a[36:39], a[200:203], v[200:203], a[36:39]
  v_mfma_f32_16x16x32_bf16 a[36:39], a[204:207], v[232:235], a[36:39]
  s_cbranch_vccnz LS_t3
LS_b3:
  v_exp_f32 v128, v128
  v_exp_f32 v129, v129
  v_mfma_f32_16x16x32_bf16 a[68:71], a[200:203], v[208:211], a[68:71]
  buffer_load_dwordx4 v1, s[28:31], s46 offen offset:0 nt lds
  v_mfma_f32_16x16x32_bf16 a[68:71], a[204:207], v[240:243], a[68:71]
  v_exp_f32 v130, v130
  v_mfma_f32_16x16x32_bf16 a[100:103], a[200:203], v[216:219], a[100:103]
  v_mfma_f32_16x16x32_bf16 a[100:103], a[204:207], v[248:251], a[100:103]
  v_exp_f32 v131, v131
  v_cvt_pk_bf16_f32 v128, v128, v129
  v_lshlrev_b32 v40, 16, v78
  s_waitcnt lgkmcnt(0)
  v_mfma_f32_16x16x32_bf16 a[8:11], a[208:211], v[192:195], a[8:11]
  v_mfma_f32_16x16x32_bf16 a[8:11], a[212:215], v[224:227], a[8:11]
  ds_read_b64_tr_b16 a[192:193], v16 offset:0
  ds_read_b64_tr_b16 a[194:195], v16 offset:4096
  v_exp_f32 v132, v132
  v_exp_f32 v133, v133
  v_lshlrev_b32 v41, 16, v79
  v_mfma_f32_16x16x32_bf16 a[40:43], a[208:211], v[200:203], a[40:43]
  buffer_load_dwordx4 v2, s[28:31], s46 offen offset:1024 nt lds
  v_mfma_f32_16x16x32_bf16 a[40:43], a[212:215], v[232:235], a[40:43]
  ds_read_b64_tr_b16 a[196:197], v16 offset:8192
  ds_read_b64_tr_b16 a[198:199], v16 offset:12288
  v_and_b32 v78, 0xffff0000, v78
  v_and_b32 v79, 0xffff0000, v79
  v_mfma_f32_16x16x32_bf16 a[72:75], a[208:211], v[208:211], a[72:75]
  v_mfma_f32_16x16x32_bf16 a[72:75], a[212:215], v[240:243], a[72:75]
  ds_read_b64_tr_b16 a[200:201], v17 offset:0
  ds_read_b64_tr_b16 a[202:203], v17 offset:4096
  v_cvt_pk_bf16_f32 v129, v130, v131
  v_mul_f32 v40, s47, v40
  v_mfma_f32_16x16x32_bf16 a[104:107], a[208:211], v[216:219], a[104:107]
  v_mfma_f32_16x16x32_bf16 a[104:107], a[212:215], v[248:251], a[104:107]
  ds_read_b64_tr_b16 a[204:205], v17 offset:8192
  ds_read_b64_tr_b16 a[206:207], v17 offset:12288
  v_exp_f32 v134, v134
  v_mul_f32 v41, s47, v41
  v_mfma_f32_16x16x32_bf16 a[12:15], a[216:219], v[192:195], a[12:15]
  v_mfma_f32_16x16x32_bf16 a[12:15], a[220:223], v[224:227], a[12:15]
  v_exp_f32 v135, v135
  v_cvt_pk_bf16_f32 v130, v132, v133
  v_exp_f32 v160, v160
  v_mul_f32 v78, s47, v78
  v_mfma_f32_16x16x32_bf16 a[228:231], a[240:243], v[200:203], a[228:231]
  v_exp_f32 v161, v161
  v_mfma_f32_16x16x32_bf16 a[228:231], a[240:243], v[232:235], a[228:231]
  v_cvt_pk_bf16_f32 v131, v134, v135
  v_mul_f32 v79, s47, v79
  v_mfma_f32_16x16x32_bf16 a[44:47], a[216:219], v[200:203], a[44:47]
  v_mfma_f32_16x16x32_bf16 a[44:47], a[220:223], v[232:235], a[44:47]
  v_exp_f32 v162, v162
  v_exp_f32 v163, v163
  v_cvt_pk_bf16_f32 v160, v160, v161
  v_mfma_f32_16x16x32_bf16 a[76:79], a[216:219], v[208:211], a[76:79]
  v_mfma_f32_16x16x32_bf16 a[76:79], a[220:223], v[240:243], a[76:79]
  v_exp_f32 v164, v164
  v_exp_f32 v165, v165
  v_cvt_pk_bf16_f32 v78, v40, v78
  v_cvt_pk_bf16_f32 v79, v41, v79
  v_mfma_f32_16x16x32_bf16 a[108:111], a[216:219], v[216:219], a[108:111]
  s_waitcnt vmcnt(10)
  v_mfma_f32_16x16x32_bf16 a[108:111], a[220:223], v[248:251], a[108:111]
  ds_read_b128 v[80:83], v36 offset:4096
  v_cvt_pk_bf16_f32 v161, v162, v163
  v_exp_f32 v166, v166
  s_waitcnt lgkmcnt(1)
  v_mfma_f32_16x16x32_bf16 a[16:19], a[192:195], v[192:195], a[16:19]
  ds_read_b128 v[84:87], v37 offset:4096
  v_mfma_f32_16x16x32_bf16 a[16:19], a[196:199], v[224:227], a[16:19]
  ds_read_b64_tr_b16 a[208:209], v18 offset:0
  ds_read_b64_tr_b16 a[210:211], v18 offset:4096
  v_exp_f32 v167, v167
  v_mfma_f32_16x16x32_bf16 a[48:51], a[192:195], v[200:203], a[48:51]
  ds_read_b128 v[88:91], v38 offset:4096
  v_mfma_f32_16x16x32_bf16 a[48:51], a[196:199], v[232:235], a[48:51]
  ds_read_b64_tr_b16 a[212:213], v18 offset:8192
  ds_read_b64_tr_b16 a[214:215], v18 offset:12288
  ds_read_b128 v[92:95], v39 offset:4096
  v_cvt_pk_bf16_f32 v162, v164, v165
  v_mfma_f32_16x16x32_bf16 a[80:83], a[192:195], v[208:211], a[80:83]
  v_mfma_f32_16x16x32_bf16 a[80:83], a[196:199], v[240:243], a[80:83]
  ds_read_b64_tr_b16 a[216:217], v19 offset:0
  ds_read_b64_tr_b16 a[218:219], v19 offset:4096
  v_exp_f32 v136, v136
  v_mfma_f32_16x16x32_bf16 a[112:115], a[192:195], v[216:219], a[112:115]
  v_mfma_f32_16x16x32_bf16 a[112:115], a[196:199], v[248:251], a[112:115]
  ds_read_b64_tr_b16 a[220:221], v19 offset:8192
  ds_read_b64_tr_b16 a[222:223], v19 offset:12288
  v_exp_f32 v137, v137
  v_cvt_pk_bf16_f32 v163, v166, v167
  v_mfma_f32_16x16x32_bf16 a[20:23], a[200:203], v[192:195], a[20:23]
  v_mfma_f32_16x16x32_bf16 a[20:23], a[204:207], v[224:227], a[20:23]
  v_exp_f32 v138, v138
  v_exp_f32 v139, v139
  v_mfma_f32_16x16x32_bf16 a[232:235], a[240:243], v[208:211], a[232:235]
  v_cvt_pk_bf16_f32 v136, v136, v137
  v_exp_f32 v140, v140
  v_mfma_f32_16x16x32_bf16 a[232:235], a[240:243], v[240:243], a[232:235]
  v_exp_f32 v141, v141
  v_mfma_f32_16x16x32_bf16 a[52:55], a[200:203], v[200:203], a[52:55]
  v_mfma_f32_16x16x32_bf16 a[52:55], a[204:207], v[232:235], a[52:55]
  v_cvt_pk_bf16_f32 v137, v138, v139
  v_exp_f32 v142, v142
  v_mfma_f32_16x16x32_bf16 a[84:87], a[200:203], v[208:211], a[84:87]
  s_waitcnt vmcnt(6)
  s_barrier
  v_mfma_f32_16x16x32_bf16 a[84:87], a[204:207], v[240:243], a[84:87]
  s_add_u32 m0, s44, 0
  v_exp_f32 v143, v143
  s_waitcnt lgkmcnt(11)
  v_lshlrev_b32 v40, 16, v80
  v_mfma_f32_16x16x32_bf16 a[116:119], a[200:203], v[216:219], a[116:119]
  v_mfma_f32_16x16x32_bf16 a[116:119], a[204:207], v[248:251], a[116:119]
  v_cvt_pk_bf16_f32 v138, v140, v141
  v_exp_f32 v168, v168
  v_lshlrev_b32 v41, 16, v81
  s_waitcnt lgkmcnt(0)
  v_mfma_f32_16x16x32_bf16 a[24:27], a[208:211], v[192:195], a[24:27]
  buffer_load_dwordx4 v1, s[8:11], s88 offen offset:0 nt lds
  v_mfma_f32_16x16x32_bf16 a[24:27], a[212:215], v[224:227], a[24:27]
  ds_read_b128 a[192:195], v8 offset:32768
  v_and_b32 v80, 0xffff0000, v80
  v_mfma_f32_16x16x32_bf16 a[56:59], a[208:211], v[200:203], a[56:59]
  v_mfma_f32_16x16x32_bf16 a[56:59], a[212:215], v[232:235], a[56:59]
  ds_read_b128 a[196:199], v9 offset:32768
  v_exp_f32 v169, v169
  v_cvt_pk_bf16_f32 v139, v142, v143
  v_and_b32 v81, 0xffff0000, v81
  v_mfma_f32_16x16x32_bf16 a[88:91], a[208:211], v[208:211], a[88:91]
  v_mfma_f32_16x16x32_bf16 a[88:91], a[212:215], v[240:243], a[88:91]
  ds_read_b128 a[200:203], v10 offset:32768
  v_exp_f32 v170, v170
  v_exp_f32 v171, v171
  v_mul_f32 v40, s47, v40
  v_mfma_f32_16x16x32_bf16 a[120:123], a[208:211], v[216:219], a[120:123]
  buffer_load_dwordx4 v2, s[8:11], s88 offen offset:1024 nt lds
  v_mfma_f32_16x16x32_bf16 a[120:123], a[212:215], v[248:251], a[120:123]
  ds_read_b128 a[204:207], v11 offset:32768
  v_cvt_pk_bf16_f32 v168, v168, v169
  v_mul_f32 v41, s47, v41
  v_mfma_f32_16x16x32_bf16 a[28:31], a[216:219], v[192:195], a[28:31]
  v_mfma_f32_16x16x32_bf16 a[28:31], a[220:223], v[224:227], a[28:31]
  v_exp_f32 v172, v172
  v_exp_f32 v173, v173
  v_mul_f32 v80, s47, v80
  v_mfma_f32_16x16x32_bf16 a[236:239], a[240:243], v[216:219], a[236:239]
  v_cvt_pk_bf16_f32 v169, v170, v171
  v_mul_f32 v81, s47, v81
  v_mfma_f32_16x16x32_bf16 a[236:239], a[240:243], v[248:251], a[236:239]
  v_exp_f32 v174, v174
  v_mfma_f32_16x16x32_bf16 a[60:63], a[216:219], v[200:203], a[60:63]
  v_mfma_f32_16x16x32_bf16 a[60:63], a[220:223], v[232:235], a[60:63]
  v_exp_f32 v175, v175
  v_cvt_pk_bf16_f32 v170, v172, v173
  v_exp_f32 v144, v144
  v_mfma_f32_16x16x32_bf16 a[92:95], a[216:219], v[208:211], a[92:95]
  buffer_load_dwordx4 v3, s[8:11], s88 offen offset:2048 nt lds
  v_mfma_f32_16x16x32_bf16 a[92:95], a[220:223], v[240:243], a[92:95]
  v_exp_f32 v145, v145
  v_cvt_pk_bf16_f32 v80, v40, v80
  v_mfma_f32_16x16x32_bf16 a[124:127], a[216:219], v[216:219], a[124:127]
  v_mfma_f32_16x16x32_bf16 a[124:127], a[220:223], v[248:251], a[124:127]
  v_cvt_pk_bf16_f32 v171, v174, v175
  v_exp_f32 v146, v146
  v_cvt_pk_bf16_f32 v81, v41, v81
  s_waitcnt lgkmcnt(0)
  s_cbranch_vccnz LS_t18
LS_b18:
  v_mfma_f32_16x16x32_bf16 v[192:195], a[192:195], a[128:131], v[20:23]
  buffer_load_dwordx4 v4, s[8:11], s88 offen offset:3072 nt lds
  v_mfma_f32_16x16x32_bf16 v[192:195], a[196:199], a[132:135], v[192:195]
  ds_read_b128 a[208:211], v8 offset:36864
  v_mfma_f32_16x16x32_bf16 v[192:195], a[200:203], a[136:139], v[192:195]
  v_mfma_f32_16x16x32_bf16 v[192:195], a[204:207], a[140:143], v[192:195]
  v_exp_f32 v147, v147
  v_cvt_pk_bf16_f32 v144, v144, v145
  v_exp_f32 v148, v148
  v_lshlrev_b32 v40, 16, v82
  v_lshlrev_b32 v41, 16, v83
  v_mfma_f32_16x16x32_bf16 v[200:203], a[192:195], a[144:147], v[52:55]
  ds_read_b128 a[212:215], v9 offset:36864
  v_mfma_f32_16x16x32_bf16 v[200:203], a[196:199], a[148:151], v[200:203]
  v_mfma_f32_16x16x32_bf16 v[200:203], a[200:203], a[152:155], v[200:203]
  v_mfma_f32_16x16x32_bf16 v[200:203], a[204:207], a[156:159], v[200:203]
  ds_read_b128 a[216:219], v10 offset:36864
  v_exp_f32 v149, v149
  v_max_f32 v44, v192, v193
  v_cvt_pk_bf16_f32 v145, v146, v147
  v_max_f32 v45, v194, v195
  v_exp_f32 v150, v150
  v_and_b32 v82, 0xffff0000, v82
  v_and_b32 v83, 0xffff0000, v83
  v_mfma_f32_16x16x32_bf16 v[208:211], a[192:195], a[160:163], v[56:59]
  v_mfma_f32_16x16x32_bf16 v[208:211], a[196:199], a[164:167], v[208:211]
  v_mfma_f32_16x16x32_bf16 v[208:211], a[200:203], a[168:171], v[208:211]
  ds_read_b128 a[220:223], v11 offset:36864
  v_mfma_f32_16x16x32_bf16 v[208:211], a[204:207], a[172:175], v[208:211]
  s_add_u32 m0, s55, 8192
  s_add_u32 s46, s45, 8192
  v_exp_f32 v151, v151
  v_max3_f32 v44, v44, v200, v201
  v_cvt_pk_bf16_f32 v146, v148, v149
  v_mul_f32 v40, s47, v40
  v_mul_f32 v41, s47, v41
  v_mfma_f32_16x16x32_bf16 v[216:219], a[192:195], a[176:179], v[60:63]
  buffer_load_dwordx4 v3, s[28:31], s46 offen offset:2048 nt lds
  v_mfma_f32_16x16x32_bf16 v[216:219], a[196:199], a[180:183], v[216:219]
  v_mfma_f32_16x16x32_bf16 v[216:219], a[200:203], a[184:187], v[216:219]
  v_mfma_f32_16x16x32_bf16 v[216:219], a[204:207], a[188:191], v[216:219]
  v_exp_f32 v176, v176
  v_max3_f32 v45, v45, v202, v203
  v_exp_f32 v177, v177
  v_max3_f32 v44, v44, v208, v209
  v_mul_f32 v82, s47, v82
  v_mul_f32 v83, s47, v83
  s_waitcnt lgkmcnt(0)
  v_mfma_f32_16x16x32_bf16 v[196:199], a[208:211], a[128:131], v[20:23]
  v_mfma_f32_16x16x32_bf16 v[196:199], a[212:215], a[132:135], v[196:199]
  ds_read_b128 a[192:195], v8 offset:40960
  v_mfma_f32_16x16x32_bf16 v[196:199], a[216:219], a[136:139], v[196:199]
  buffer_load_dwordx4 v4, s[28:31], s46 offen offset:3072 nt lds
  v_mfma_f32_16x16x32_bf16 v[196:199], a[220:223], a[140:143], v[196:199]
  v_cvt_pk_bf16_f32 v147, v150, v151
  v_max3_f32 v45, v45, v210, v211
  v_exp_f32 v178, v178
  v_max3_f32 v44, v44, v216, v217
  v_cvt_pk_bf16_f32 v82, v40, v82
  v_cvt_pk_bf16_f32 v83, v41, v83
  v_mfma_f32_16x16x32_bf16 v[204:207], a[208:211], a[144:147], v[52:55]
  ds_read_b128 a[196:199], v9 offset:40960
  v_mfma_f32_16x16x32_bf16 v[204:207], a[212:215], a[148:151], v[204:207]
  v_mfma_f32_16x16x32_bf16 v[204:207], a[216:219], a[152:155], v[204:207]
  v_mfma_f32_16x16x32_bf16 v[204:207], a[220:223], a[156:159], v[204:207]
  ds_read_b128 a[200:203], v10 offset:40960
  v_exp_f32 v179, v179
  v_max3_f32 v45, v45, v218, v219
  v_cvt_pk_bf16_f32 v176, v176, v177
  v_max3_f32 v44, v44, v196, v197
  v_lshlrev_b32 v40, 16, v84
  v_lshlrev_b32 v41, 16, v85
  v_mfma_f32_16x16x32_bf16 v[212:215], a[208:211], a[160:163], v[56:59]
  v_mfma_f32_16x16x32_bf16 v[212:215], a[212:215], a[164:167], v[212:215]
  v_mfma_f32_16x16x32_bf16 v[212:215], a[216:219], a[168:171], v[212:215]
  ds_read_b128 a[204:207], v11 offset:40960
  v_mfma_f32_16x16x32_bf16 v[212:215], a[220:223], a[172:175], v[212:215]
  v_exp_f32 v180, v180
  v_max3_f32 v45, v45, v198, v199
  v_exp_f32 v181, v181
  v_max3_f32 v44, v44, v204, v205
  v_cvt_pk_bf16_f32 v177, v178, v179
  v_max3_f32 v45, v45, v206, v207
  v_and_b32 v84, 0xffff0000, v84
  v_and_b32 v85, 0xffff0000, v85
  v_mfma_f32_16x16x32_bf16 v[220:223], a[208:211], a[176:179], v[60:63]
  v_mfma_f32_16x16x32_bf16 v[220:223], a[212:215], a[180:183], v[220:223]
  v_mfma_f32_16x16x32_bf16 v[220:223], a[216:219], a[184:187], v[220:223]
  v_mfma_f32_16x16x32_bf16 v[220:223], a[220:223], a[188:191], v[220:223]
  v_exp_f32 v182, v182
  v_max3_f32 v44, v44, v212, v213
  v_exp_f32 v183, v183
  v_max3_f32 v45, v45, v214, v215
  v_cvt_pk_bf16_f32 v178, v180, v181
  v_mul_f32 v40, s47, v40
  v_mul_f32 v41, s47, v41
  s_waitcnt lgkmcnt(0)
  v_mfma_f32_16x16x32_bf16 v[224:227], a[192:195], a[128:131], v[20:23]
  v_mfma_f32_16x16x32_bf16 v[224:227], a[196:199], a[132:135], v[224:227]
  ds_read_b128 a[208:211], v8 offset:45056
  v_mfma_f32_16x16x32_bf16 v[224:227], a[200:203], a[136:139], v[224:227]
  v_mfma_f32_16x16x32_bf16 v[224:227], a[204:207], a[140:143], v[224:227]
  v_exp_f32 v152, v152
  v_max3_f32 v44, v44, v220, v221
  v_exp_f32 v153, v153
  v_max3_f32 v45, v45, v222, v223
  v_cvt_pk_bf16_f32 v179, v182, v183
  v_mul_f32 v84, s47, v84
  v_mul_f32 v85, s47, v85
  v_mfma_f32_16x16x32_bf16 v[232:235], a[192:195], a[144:147], v[52:55]
  ds_read_b128 a[212:215], v9 offset:45056
  v_mfma_f32_16x16x32_bf16 v[232:235], a[196:199], a[148:151], v[232:235]
  v_mfma_f32_16x16x32_bf16 v[232:235], a[200:203], a[152:155], v[232:235]
  v_mfma_f32_16x16x32_bf16 v[232:235], a[204:207], a[156:159], v[232:235]
  ds_read_b128 a[216:219], v10 offset:45056
  v_exp_f32 v154, v154
  v_max3_f32 v44, v44, v224, v225
  v_exp_f32 v155, v155
  v_max3_f32 v45, v45, v226, v227
  v_cvt_pk_bf16_f32 v152, v152, v153
  v_cvt_pk_bf16_f32 v84, v40, v84
  v_cvt_pk_bf16_f32 v85, v41, v85
  v_mfma_f32_16x16x32_bf16 v[240:243], a[192:195], a[160:163], v[56:59]
  v_mfma_f32_16x16x32_bf16 v[240:243], a[196:199], a[164:167], v[240:243]
  v_mfma_f32_16x16x32_bf16 v[240:243], a[200:203], a[168:171], v[240:243]
  ds_read_b128 a[220:223], v11 offset:45056
  v_mfma_f32_16x16x32_bf16 v[240:243], a[204:207], a[172:175], v[240:243]
  v_exp_f32 v156, v156
  v_max3_f32 v44, v44, v232, v233
  v_exp_f32 v157, v157
  v_max3_f32 v45, v45, v234, v235
  v_cvt_pk_bf16_f32 v153, v154, v155
  v_lshlrev_b32 v40, 16, v86
  v_lshlrev_b32 v41, 16, v87
  v_mfma_f32_16x16x32_bf16 v[248:251], a[192:195], a[176:179], v[60:63]
  s_waitcnt vmcnt(8)
  s_barrier
  v_mfma_f32_16x16x32_bf16 v[248:251], a[196:199], a[180:183], v[248:251]
  s_add_u32 m0, s44, 81920
  v_mfma_f32_16x16x32_bf16 v[248:251], a[200:203], a[184:187], v[248:251]
  v_mfma_f32_16x16x32_bf16 v[248:251], a[204:207], a[188:191], v[248:251]
  v_exp_f32 v158, v158
  v_max3_f32 v44, v44, v240, v241
  v_and_b32 v86, 0xffff0000, v86
  v_and_b32 v87, 0xffff0000, v87
  s_waitcnt lgkmcnt(0)
  v_mfma_f32_16x16x32_bf16 v[228:231], a[208:211], a[128:131], v[20:23]
  buffer_load_dwordx4 v5, s[12:15], s87 offen offset:0 nt lds
  v_mfma_f32_16x16x32_bf16 v[228:231], a[212:215], a[132:135], v[228:231]
  ds_read_b64_tr_b16 a[192:193], v12 offset:16384
  ds_read_b64_tr_b16 a[194:195], v12 offset:20480
  v_mfma_f32_16x16x32_bf16 v[228:231], a[216:219], a[136:139], v[228:231]
  v_mfma_f32_16x16x32_bf16 v[228:231], a[220:223], a[140:143], v[228:231]
  v_exp_f32 v159, v159
  v_max3_f32 v45, v45, v242, v243
  v_cvt_pk_bf16_f32 v154, v156, v157
  v_max3_f32 v44, v44, v248, v249
  v_mul_f32 v40, s47, v40
  v_mul_f32 v41, s47, v41
  v_mfma_f32_16x16x32_bf16 v[236:239], a[208:211], a[144:147], v[52:55]
  ds_read_b64_tr_b16 a[196:197], v12 offset:24576
  ds_read_b64_tr_b16 a[198:199], v12 offset:28672
  v_mfma_f32_16x16x32_bf16 v[236:239], a[212:215], a[148:151], v[236:239]
  v_mfma_f32_16x16x32_bf16 v[236:239], a[216:219], a[152:155], v[236:239]
  buffer_load_dwordx4 v6, s[12:15], s87 offen offset:1024 nt lds
  v_mfma_f32_16x16x32_bf16 v[236:239], a[220:223], a[156:159], v[236:239]
  ds_read_b64_tr_b16 a[200:201], v13 offset:16384
  ds_read_b64_tr_b16 a[202:203], v13 offset:20480
  v_exp_f32 v184, v184
  v_mul_f32 v86, s47, v86
  v_mul_f32 v87, s47, v87
  v_mfma_f32_16x16x32_bf16 v[244:247], a[208:211], a[160:163], v[56:59]
  v_mfma_f32_16x16x32_bf16 v[244:247], a[212:215], a[164:167], v[244:247]
  v_mfma_f32_16x16x32_bf16 v[244:247], a[216:219], a[168:171], v[244:247]
  ds_read_b64_tr_b16 a[204:205], v13 offset:24576
  ds_read_b64_tr_b16 a[206:207], v13 offset:28672
  v_mfma_f32_16x16x32_bf16 v[244:247], a[220:223], a[172:175], v[244:247]
  v_exp_f32 v185, v185
  v_max3_f32 v45, v45, v250, v251
  v_cvt_pk_bf16_f32 v155, v158, v159
  v_max3_f32 v44, v44, v228, v229
  v_exp_f32 v186, v186
  v_cvt_pk_bf16_f32 v86, v40, v86
  v_cvt_pk_bf16_f32 v87, v41, v87
  v_mfma_f32_16x16x32_bf16 v[252:255], a[208:211], a[176:179], v[60:63]
  buffer_load_dwordx4 v5, s[12:15], s87 offen offset:2048 nt lds
  v_mfma_f32_16x16x32_bf16 v[252:255], a[212:215], a[180:183], v[252:255]
  v_mfma_f32_16x16x32_bf16 v[252:255], a[216:219], a[184:187], v[252:255]
  v_mfma_f32_16x16x32_bf16 v[252:255], a[220:223], a[188:191], v[252:255]
  v_exp_f32 v187, v187
  v_max3_f32 v45, v45, v230, v231
  v_cvt_pk_bf16_f32 v184, v184, v185
  v_lshlrev_b32 v40, 16, v88
  v_lshlrev_b32 v41, 16, v89
  s_waitcnt lgkmcnt(0)
  v_mfma_f32_16x16x32_bf16 a[0:3], a[192:195], v[128:131], a[0:3]
  buffer_load_dwordx4 v6, s[12:15], s87 offen offset:3072 nt lds
  v_mfma_f32_16x16x32_bf16 a[0:3], a[196:199], v[160:163], a[0:3]
  ds_read_b64_tr_b16 a[208:209], v14 offset:16384
  ds_read_b64_tr_b16 a[210:211], v14 offset:20480
  v_and_b32 v88, 0xffff0000, v88
  v_mfma_f32_16x16x32_bf16 a[32:35], a[192:195], v[136:139], a[32:35]
  v_mfma_f32_16x16x32_bf16 a[32:35], a[196:199], v[168:171], a[32:35]
  v_exp_f32 v188, v188
  v_max3_f32 v44, v44, v236, v237
  v_exp_f32 v189, v189
  v_and_b32 v89, 0xffff0000, v89
  v_mfma_f32_16x16x32_bf16 a[64:67], a[192:195], v[144:147], a[64:67]
  ds_read_b64_tr_b16 a[212:213], v14 offset:24576
  ds_read_b64_tr_b16 a[214:215], v14 offset:28672
  v_mfma_f32_16x16x32_bf16 a[64:67], a[196:199], v[176:179], a[64:67]
  v_cvt_pk_bf16_f32 v185, v186, v187
  v_max3_f32 v45, v45, v238, v239
  v_mul_f32 v40, s47, v40
  v_mfma_f32_16x16x32_bf16 a[96:99], a[192:195], v[152:155], a[96:99]
  v_exp_f32 v190, v190
  v_exp_f32 v191, v191
  v_cvt_pk_bf16_f32 v186, v188, v189
  v_cvt_pk_bf16_f32 v187, v190, v191
  s_nop 1
  v_mfma_f32_16x16x32_bf16 a[96:99], a[196:199], v[184:187], a[96:99]
  ds_read_b64_tr_b16 a[216:217], v15 offset:16384
  ds_read_b64_tr_b16 a[218:219], v15 offset:20480
  v_max3_f32 v44, v44, v244, v245
  v_max3_f32 v45, v45, v246, v247
  v_mul_f32 v41, s47, v41
  v_mfma_f32_16x16x32_bf16 a[4:7], a[200:203], v[128:131], a[4:7]
  v_mfma_f32_16x16x32_bf16 a[4:7], a[204:207], v[160:163], a[4:7]
  v_max3_f32 v44, v44, v252, v253
  v_max3_f32 v45, v45, v254, v255
  v_max_f32 v44, v44, v45
  v_cmp_lt_f32 vcc, s48, v44
  v_mul_f32 v88, s47, v88
  v_mfma_f32_16x16x32_bf16 a[224:227], a[240:243], v[128:131], a[224:227]
  v_mul_f32 v89, s47, v89
  v_cvt_pk_bf16_f32 v88, v40, v88
  v_mfma_f32_16x16x32_bf16 a[224:227], a[240:243], v[160:163], a[224:227]
  v_cvt_pk_bf16_f32 v89, v41, v89
  v_lshlrev_b32 v40, 16, v90
  v_mfma_f32_16x16x32_bf16 a[36:39], a[200:203], v[136:139], a[36:39]
  ds_read_b64_tr_b16 a[220:221], v15 offset:24576
  ds_read_b64_tr_b16 a[222:223], v15 offset:28672
  v_mfma_f32_16x16x32_bf16 a[36:39], a[204:207], v[168:171], a[36:39]
  s_cbranch_vccnz LS_t4
LS_b4:
  v_exp_f32 v192, v192
  v_exp_f32 v193, v193
  v_mfma_f32_16x16x32_bf16 a[68:71], a[200:203], v[144:147], a[68:71]
  v_mfma_f32_16x16x32_bf16 a[68:71], a[204:207], v[176:179], a[68:71]
  v_exp_f32 v194, v194
  v_exp_f32 v195, v195
  v_cvt_pk_bf16_f32 v192, v192, v193
  v_mfma_f32_16x16x32_bf16 a[100:103], a[200:203], v[152:155], a[100:103]
  v_mfma_f32_16x16x32_bf16 a[100:103], a[204:207], v[184:187], a[100:103]
  v_exp_f32 v196, v196
  v_exp_f32 v197, v197
  s_waitcnt lgkmcnt(0)
  v_mfma_f32_16x16x32_bf16 a[8:11], a[208:211], v[128:131], a[8:11]
  v_mfma_f32_16x16x32_bf16 a[8:11], a[212:215], v[160:163], a[8:11]
  ds_read_b64_tr_b16 a[192:193], v16 offset:16384
  ds_read_b64_tr_b16 a[194:195], v16 offset:20480
  v_cvt_pk_bf16_f32 v193, v194, v195
  v_mfma_f32_16x16x32_bf16 a[40:43], a[208:211], v[136:139], a[40:43]
  v_mfma_f32_16x16x32_bf16 a[40:43], a[212:215], v[168:171], a[40:43]
  v_exp_f32 v198, v198
  v_exp_f32 v199, v199
  v_lshlrev_b32 v41, 16, v91
  v_mfma_f32_16x16x32_bf16 a[72:75], a[208:211], v[144:147], a[72:75]
  ds_read_b64_tr_b16 a[196:197], v16 offset:24576
  ds_read_b64_tr_b16 a[198:199], v16 offset:28672
  v_mfma_f32_16x16x32_bf16 a[72:75], a[212:215], v[176:179], a[72:75]
  v_cvt_pk_bf16_f32 v194, v196, v197
  v_exp_f32 v224, v224
  v_and_b32 v90, 0xffff0000, v90
  v_mfma_f32_16x16x32_bf16 a[104:107], a[208:211], v[152:155], a[104:107]
  v_mfma_f32_16x16x32_bf16 a[104:107], a[212:215], v[184:187], a[104:107]
  ds_read_b64_tr_b16 a[200:201], v17 offset:16384
  ds_read_b64_tr_b16 a[202:203], v17 offset:20480
  v_exp_f32 v225, v225
  v_and_b32 v91, 0xffff0000, v91
  v_mfma_f32_16x16x32_bf16 a[12:15], a[216:219], v[128:131], a[12:15]
  v_mfma_f32_16x16x32_bf16 a[12:15], a[220:223], v[160:163], a[12:15]
  v_cvt_pk_bf16_f32 v195, v198, v199
  v_exp_f32 v226, v226
  v_mul_f32 v40, s47, v40
  v_mfma_f32_16x16x32_bf16 a[228:231], a[240:243], v[136:139], a[228:231]
  v_exp_f32 v227, v227
  v_mfma_f32_16x16x32_bf16 a[228:231], a[240:243], v[168:171], a[228:231]
  v_cvt_pk_bf16_f32 v224, v224, v225
  v_exp_f32 v228, v228
  v_mfma_f32_16x16x32_bf16 a[44:47], a[216:219], v[136:139], a[44:47]
  ds_read_b64_tr_b16 a[204:205], v17 offset:24576
  ds_read_b64_tr_b16 a[206:207], v17 offset:28672
  v_mfma_f32_16x16x32_bf16 a[44:47], a[220:223], v[168:171], a[44:47]
  v_exp_f32 v229, v229
  v_mul_f32 v41, s47, v41
  v_mfma_f32_16x16x32_bf16 a[76:79], a[216:219], v[144:147], a[76:79]
  v_mfma_f32_16x16x32_bf16 a[76:79], a[220:223], v[176:179], a[76:79]
  s_add_u32 m0, s55, 12288
  s_add_u32 s46, s45, 12288
  v_cvt_pk_bf16_f32 v225, v226, v227
  v_mul_f32 v90, s47, v90
  v_mfma_f32_16x16x32_bf16 a[108:111], a[216:219], v[152:155], a[108:111]
  buffer_load_dwordx4 v1, s[28:31], s46 offen offset:0 nt lds
  v_mfma_f32_16x16x32_bf16 a[108:111], a[220:223], v[184:187], a[108:111]
  v_exp_f32 v230, v230
  v_mul_f32 v91, s47, v91
  s_waitcnt lgkmcnt(0)
  v_mfma_f32_16x16x32_bf16 a[16:19], a[192:195], v[128:131], a[16:19]
  v_mfma_f32_16x16x32_bf16 a[16:19], a[196:199], v[160:163], a[16:19]
  ds_read_b64_tr_b16 a[208:209], v18 offset:16384
  ds_read_b64_tr_b16 a[210:211], v18 offset:20480
  v_exp_f32 v231, v231
  v_cvt_pk_bf16_f32 v90, v40, v90
  v_mfma_f32_16x16x32_bf16 a[48:51], a[192:195], v[136:139], a[48:51]
  v_mfma_f32_16x16x32_bf16 a[48:51], a[196:199], v[168:171], a[48:51]
  v_cvt_pk_bf16_f32 v226, v228, v229
  v_exp_f32 v200, v200
  v_cvt_pk_bf16_f32 v91, v41, v91
  v_mfma_f32_16x16x32_bf16 a[80:83], a[192:195], v[144:147], a[80:83]
  ds_read_b64_tr_b16 a[212:213], v18 offset:24576
  ds_read_b64_tr_b16 a[214:215], v18 offset:28672
  v_mfma_f32_16x16x32_bf16 a[80:83], a[196:199], v[176:179], a[80:83]
  v_exp_f32 v201, v201
  v_cvt_pk_bf16_f32 v227, v230, v231
  v_lshlrev_b32 v40, 16, v92
  v_mfma_f32_16x16x32_bf16 a[112:115], a[192:195], v[152:155], a[112:115]
  v_mfma_f32_16x16x32_bf16 a[112:115], a[196:199], v[184:187], a[112:115]
  ds_read_b64_tr_b16 a[216:217], v19 offset:16384
  ds_read_b64_tr_b16 a[218:219], v19 offset:20480
  v_exp_f32 v202, v202
  v_lshlrev_b32 v41, 16, v93
  v_mfma_f32_16x16x32_bf16 a[20:23], a[200:203], v[128:131], a[20:23]
  v_mfma_f32_16x16x32_bf16 a[20:23], a[204:207], v[160:163], a[20:23]
  v_exp_f32 v203, v203
  v_cvt_pk_bf16_f32 v200, v200, v201
  v_exp_f32 v204, v204
  v_and_b32 v92, 0xffff0000, v92
  v_mfma_f32_16x16x32_bf16 a[232:235], a[240:243], v[144:147], a[232:235]
  v_exp_f32 v205, v205
  v_mfma_f32_16x16x32_bf16 a[232:235], a[240:243], v[176:179], a[232:235]
  v_cvt_pk_bf16_f32 v201, v202, v203
  v_and_b32 v93, 0xffff0000, v93
  v_mfma_f32_16x16x32_bf16 a[52:55], a[200:203], v[136:139], a[52:55]
  ds_read_b64_tr_b16 a[220:221], v19 offset:24576
  ds_read_b64_tr_b16 a[222:223], v19 offset:28672
  v_mfma_f32_16x16x32_bf16 a[52:55], a[204:207], v[168:171], a[52:55]
  v_exp_f32 v206, v206
  v_mfma_f32_16x16x32_bf16 a[84:87], a[200:203], v[144:147], a[84:87]
  s_waitcnt vmcnt(7)
  s_barrier
  v_mfma_f32_16x16x32_bf16 a[84:87], a[204:207], v[176:179], a[84:87]
  v_exp_f32 v207, v207
  v_mul_f32 v40, s47, v40
  v_mfma_f32_16x16x32_bf16 a[116:119], a[200:203], v[152:155], a[116:119]
  v_mfma_f32_16x16x32_bf16 a[116:119], a[204:207], v[184:187], a[116:119]
  v_cvt_pk_bf16_f32 v202, v204, v205
  v_exp_f32 v232, v232
  v_mul_f32 v41, s47, v41
  s_waitcnt lgkmcnt(0)
  v_mfma_f32_16x16x32_bf16 a[24:27], a[208:211], v[128:131], a[24:27]
  buffer_load_dwordx4 v2, s[28:31], s46 offen offset:1024 nt lds
  v_mfma_f32_16x16x32_bf16 a[24:27], a[212:215], v[160:163], a[24:27]
  ds_read_b128 a[192:195], v8 offset:0
  v_exp_f32 v233, v233
  v_mul_f32 v92, s47, v92
  v_mfma_f32_16x16x32_bf16 a[56:59], a[208:211], v[136:139], a[56:59]
  s_add_u32 m0, s44, 16384
  v_mfma_f32_16x16x32_bf16 a[56:59], a[212:215], v[168:171], a[56:59]
  v_cvt_pk_bf16_f32 v203, v206, v207
  v_exp_f32 v234, v234
  v_mul_f32 v93, s47, v93
  v_mfma_f32_16x16x32_bf16 a[88:91], a[208:211], v[144:147], a[88:91]
  ds_read_b128 a[196:199], v9 offset:0
  v_mfma_f32_16x16x32_bf16 a[88:91], a[212:215], v[176:179], a[88:91]
  v_exp_f32 v235, v235
  v_cvt_pk_bf16_f32 v232, v232, v233
  v_cvt_pk_bf16_f32 v92, v40, v92
  v_mfma_f32_16x16x32_bf16 a[120:123], a[208:211], v[152:155], a[120:123]
  buffer_load_dwordx4 v1, s[8:11], s89 offen offset:0 nt lds
  v_mfma_f32_16x16x32_bf16 a[120:123], a[212:215], v[184:187], a[120:123]
  ds_read_b128 a[200:203], v10 offset:0
  v_cvt_pk_bf16_f32 v93, v41, v93
  v_mfma_f32_16x16x32_bf16 a[28:31], a[216:219], v[128:131], a[28:31]
  v_mfma_f32_16x16x32_bf16 a[28:31], a[220:223], v[160:163], a[28:31]
  v_exp_f32 v236, v236
  v_exp_f32 v237, v237
  v_cvt_pk_bf16_f32 v233, v234, v235
  v_lshlrev_b32 v40, 16, v94
  v_mfma_f32_16x16x32_bf16 a[236:239], a[240:243], v[152:155], a[236:239]
  v_exp_f32 v238, v238
  v_mfma_f32_16x16x32_bf16 a[236:239], a[240:243], v[184:187], a[236:239]
  v_exp_f32 v239, v239
  v_mfma_f32_16x16x32_bf16 a[60:63], a[216:219], v[136:139], a[60:63]
  ds_read_b128 a[204:207], v11 offset:0
  v_mfma_f32_16x16x32_bf16 a[60:63], a[220:223], v[168:171], a[60:63]
  v_cvt_pk_bf16_f32 v234, v236, v237
  v_exp_f32 v208, v208
  v_lshlrev_b32 v41, 16, v95
  v_mfma_f32_16x16x32_bf16 a[92:95], a[216:219], v[144:147], a[92:95]
  buffer_load_dwordx4 v2, s[8:11], s89 offen offset:1024 nt lds
  v_mfma_f32_16x16x32_bf16 a[92:95], a[220:223], v[176:179], a[92:95]
  v_exp_f32 v209, v209
  v_and_b32 v94, 0xffff0000, v94
  v_mfma_f32_16x16x32_bf16 a[124:127], a[216:219], v[152:155], a[124:127]
  v_mfma_f32_16x16x32_bf16 a[124:127], a[220:223], v[184:187], a[124:127]
  v_cvt_pk_bf16_f32 v235, v238, v239
  v_exp_f32 v210, v210
  v_and_b32 v95, 0xffff0000, v95
  s_waitcnt lgkmcnt(0)
  s_cbranch_vccnz LS_t19
LS_b19:
  v_mfma_f32_16x16x32_bf16 v[128:131], a[192:195], a[128:131], v[20:23]
  buffer_load_dwordx4 v3, s[8:11], s89 offen offset:2048 nt lds
  v_mfma_f32_16x16x32_bf16 v[128:131], a[196:199], a[132:135], v[128:131]
  ds_read_b128 a[208:211], v8 offset:4096
  v_mfma_f32_16x16x32_bf16 v[128:131], a[200:203], a[136:139], v[128:131]
  v_mfma_f32_16x16x32_bf16 v[128:131], a[204:207], a[140:143], v[128:131]
  v_exp_f32 v211, v211
  v_cvt_pk_bf16_f32 v208, v208, v209
  v_exp_f32 v212, v212
  v_mul_f32 v40, s47, v40
  v_mul_f32 v41, s47, v41
  v_mfma_f32_16x16x32_bf16 v[136:139], a[192:195], a[144:147], v[52:55]
  ds_read_b128 a[212:215], v9 offset:4096
  v_mfma_f32_16x16x32_bf16 v[136:139], a[196:199], a[148:151], v[136:139]
  v_mfma_f32_16x16x32_bf16 v[136:139], a[200:203], a[152:155], v[136:139]
  buffer_load_dwordx4 v4, s[8:11], s89 offen offset:3072 nt lds
  v_mfma_f32_16x16x32_bf16 v[136:139], a[204:207], a[156:159], v[136:139]
  ds_read_b128 a[216:219], v10 offset:4096
  v_exp_f32 v213, v213
  v_max_f32 v44, v128, v129
  v_cvt_pk_bf16_f32 v209, v210, v211
  v_mul_f32 v94, s47, v94
  v_mul_f32 v95, s47, v95
  v_mfma_f32_16x16x32_bf16 v[144:147], a[192:195], a[160:163], v[56:59]
  v_mfma_f32_16x16x32_bf16 v[144:147], a[196:199], a[164:167], v[144:147]
  v_mfma_f32_16x16x32_bf16 v[144:147], a[200:203], a[168:171], v[144:147]
  ds_read_b128 a[220:223], v11 offset:4096
  v_mfma_f32_16x16x32_bf16 v[144:147], a[204:207], a[172:175], v[144:147]
  v_exp_f32 v214, v214
  v_max_f32 v45, v130, v131
  v_exp_f32 v215, v215
  v_max3_f32 v44, v44, v136, v137
  v_cvt_pk_bf16_f32 v210, v212, v213
  v_max3_f32 v45, v45, v138, v139
  v_cvt_pk_bf16_f32 v94, v40, v94
  v_cvt_pk_bf16_f32 v95, v41, v95
  v_mfma_f32_16x16x32_bf16 v[152:155], a[192:195], a[176:179], v[60:63]
  s_waitcnt vmcnt(10)
  ds_read_b128 v[96:99], v36 offset:8192
  v_mfma_f32_16x16x32_bf16 v[152:155], a[196:199], a[180:183], v[152:155]
  ds_read_b128 v[100:103], v37 offset:8192
  v_mfma_f32_16x16x32_bf16 v[152:155], a[200:203], a[184:187], v[152:155]
  v_mfma_f32_16x16x32_bf16 v[152:155], a[204:207], a[188:191], v[152:155]
  ds_read_b128 v[104:107], v38 offset:8192
  v_exp_f32 v240, v240
  v_max3_f32 v44, v44, v144, v145
  v_exp_f32 v241, v241
  v_max3_f32 v45, v45, v146, v147
  v_cvt_pk_bf16_f32 v211, v214, v215
  s_waitcnt lgkmcnt(3)
  v_mfma_f32_16x16x32_bf16 v[132:135], a[208:211], a[128:131], v[20:23]
  ds_read_b128 v[108:111], v39 offset:8192
  v_mfma_f32_16x16x32_bf16 v[132:135], a[212:215], a[132:135], v[132:135]
  ds_read_b128 a[192:195], v8 offset:8192
  v_mfma_f32_16x16x32_bf16 v[132:135], a[216:219], a[136:139], v[132:135]
  v_mfma_f32_16x16x32_bf16 v[132:135], a[220:223], a[140:143], v[132:135]
  v_exp_f32 v242, v242
  v_max3_f32 v44, v44, v152, v153
  v_exp_f32 v243, v243
  v_max3_f32 v45, v45, v154, v155
  v_cvt_pk_bf16_f32 v240, v240, v241
  v_mfma_f32_16x16x32_bf16 v[140:143], a[208:211], a[144:147], v[52:55]
  ds_read_b128 a[196:199], v9 offset:8192
  v_mfma_f32_16x16x32_bf16 v[140:143], a[212:215], a[148:151], v[140:143]
  v_mfma_f32_16x16x32_bf16 v[140:143], a[216:219], a[152:155], v[140:143]
  v_mfma_f32_16x16x32_bf16 v[140:143], a[220:223], a[156:159], v[140:143]
  ds_read_b128 a[200:203], v10 offset:8192
  v_exp_f32 v244, v244
  v_max3_f32 v44, v44, v132, v133
  v_exp_f32 v245, v245
  v_max3_f32 v45, v45, v134, v135
  v_mfma_f32_16x16x32_bf16 v[148:151], a[208:211], a[160:163], v[56:59]
  v_mfma_f32_16x16x32_bf16 v[148:151], a[212:215], a[164:167], v[148:151]
  v_mfma_f32_16x16x32_bf16 v[148:151], a[216:219], a[168:171], v[148:151]
  ds_read_b128 a[204:207], v11 offset:8192
  v_mfma_f32_16x16x32_bf16 v[148:151], a[220:223], a[172:175], v[148:151]
  v_cvt_pk_bf16_f32 v241, v242, v243
  v_max3_f32 v44, v44, v140, v141
  v_exp_f32 v246, v246
  v_max3_f32 v45, v45, v142, v143
  v_exp_f32 v247, v247
  s_waitcnt lgkmcnt(7)
  v_lshlrev_b32 v40, 16, v96
  v_mfma_f32_16x16x32_bf16 v[156:159], a[208:211], a[176:179], v[60:63]
  v_mfma_f32_16x16x32_bf16 v[156:159], a[212:215], a[180:183], v[156:159]
  s_add_u32 m0, s55, 12288
  s_add_u32 s46, s45, 12288
  v_mfma_f32_16x16x32_bf16 v[156:159], a[216:219], a[184:187], v[156:159]
  buffer_load_dwordx4 v3, s[28:31], s46 offen offset:2048 nt lds
  v_mfma_f32_16x16x32_bf16 v[156:159], a[220:223], a[188:191], v[156:159]
  v_cvt_pk_bf16_f32 v242, v244, v245
  v_max3_f32 v44, v44, v148, v149
  v_exp_f32 v216, v216
  v_lshlrev_b32 v41, 16, v97
  v_and_b32 v96, 0xffff0000, v96
  v_and_b32 v97, 0xffff0000, v97
  s_waitcnt lgkmcnt(0)
  v_mfma_f32_16x16x32_bf16 v[160:163], a[192:195], a[128:131], v[20:23]
  v_mfma_f32_16x16x32_bf16 v[160:163], a[196:199], a[132:135], v[160:163]
  ds_read_b128 a[208:211], v8 offset:12288
  v_mfma_f32_16x16x32_bf16 v[160:163], a[200:203], a[136:139], v[160:163]
  v_mfma_f32_16x16x32_bf16 v[160:163], a[204:207], a[140:143], v[160:163]
  v_exp_f32 v217, v217
  v_max3_f32 v45, v45, v150, v151
  v_cvt_pk_bf16_f32 v243, v246, v247
  v_max3_f32 v44, v44, v156, v157
  v_exp_f32 v218, v218
  v_mul_f32 v40, s47, v40
  v_mul_f32 v41, s47, v41
  v_mfma_f32_16x16x32_bf16 v[168:171], a[192:195], a[144:147], v[52:55]
  ds_read_b128 a[212:215], v9 offset:12288
  v_mfma_f32_16x16x32_bf16 v[168:171], a[196:199], a[148:151], v[168:171]
  v_mfma_f32_16x16x32_bf16 v[168:171], a[200:203], a[152:155], v[168:171]
  v_mfma_f32_16x16x32_bf16 v[168:171], a[204:207], a[156:159], v[168:171]
  ds_read_b128 a[216:219], v10 offset:12288
  v_exp_f32 v219, v219
  v_max3_f32 v45, v45, v158, v159
  v_cvt_pk_bf16_f32 v216, v216, v217
  v_max3_f32 v44, v44, v160, v161
  v_mul_f32 v96, s47, v96
  v_mul_f32 v97, s47, v97
  v_cvt_pk_bf16_f32 v96, v40, v96
  v_mfma_f32_16x16x32_bf16 v[176:179], a[192:195], a[160:163], v[56:59]
  v_mfma_f32_16x16x32_bf16 v[176:179], a[196:199], a[164:167], v[176:179]
  v_mfma_f32_16x16x32_bf16 v[176:179], a[200:203], a[168:171], v[176:179]
  ds_read_b128 a[220:223], v11 offset:12288
  v_mfma_f32_16x16x32_bf16 v[176:179], a[204:207], a[172:175], v[176:179]
  v_exp_f32 v220, v220
  v_max3_f32 v45, v45, v162, v163
  v_exp_f32 v221, v221
  v_max3_f32 v44, v44, v168, v169
  v_cvt_pk_bf16_f32 v217, v218, v219
  v_max3_f32 v45, v45, v170, v171
  v_cvt_pk_bf16_f32 v97, v41, v97
  v_lshlrev_b32 v40, 16, v98
  v_mfma_f32_16x16x32_bf16 v[184:187], a[192:195], a[176:179], v[60:63]
  s_waitcnt vmcnt(7)
  s_barrier
  v_mfma_f32_16x16x32_bf16 v[184:187], a[196:199], a[180:183], v[184:187]
  v_mfma_f32_16x16x32_bf16 v[184:187], a[200:203], a[184:187], v[184:187]
  v_mfma_f32_16x16x32_bf16 v[184:187], a[204:207], a[188:191], v[184:187]
  v_exp_f32 v222, v222
  v_max3_f32 v44, v44, v176, v177
  v_exp_f32 v223, v223
  v_lshlrev_b32 v41, 16, v99
  v_and_b32 v98, 0xffff0000, v98
  s_waitcnt lgkmcnt(0)
  v_mfma_f32_16x16x32_bf16 v[164:167], a[208:211], a[128:131], v[20:23]
  buffer_load_dwordx4 v4, s[28:31], s46 offen offset:3072 nt lds
  v_mfma_f32_16x16x32_bf16 v[164:167], a[212:215], a[132:135], v[164:167]
  ds_read_b64_tr_b16 a[192:193], v12 offset:32768
  ds_read_b64_tr_b16 a[194:195], v12 offset:36864
  v_mfma_f32_16x16x32_bf16 v[164:167], a[216:219], a[136:139], v[164:167]
  s_add_u32 m0, s44, 49152
  v_mfma_f32_16x16x32_bf16 v[164:167], a[220:223], a[140:143], v[164:167]
  v_cvt_pk_bf16_f32 v218, v220, v221
  v_max3_f32 v45, v45, v178, v179
  v_exp_f32 v248, v248
  v_and_b32 v99, 0xffff0000, v99
  v_mul_f32 v40, s47, v40
  v_mul_f32 v41, s47, v41
  v_mfma_f32_16x16x32_bf16 v[172:175], a[208:211], a[144:147], v[52:55]
  ds_read_b64_tr_b16 a[196:197], v12 offset:40960
  ds_read_b64_tr_b16 a[198:199], v12 offset:45056
  v_mfma_f32_16x16x32_bf16 v[172:175], a[212:215], a[148:151], v[172:175]
  v_mfma_f32_16x16x32_bf16 v[172:175], a[216:219], a[152:155], v[172:175]
  buffer_load_dwordx4 v5, s[12:15], s88 offen offset:0 nt lds
  v_mfma_f32_16x16x32_bf16 v[172:175], a[220:223], a[156:159], v[172:175]
  ds_read_b64_tr_b16 a[200:201], v13 offset:32768
  ds_read_b64_tr_b16 a[202:203], v13 offset:36864
  v_exp_f32 v249, v249
  v_mul_f32 v98, s47, v98
  v_mul_f32 v99, s47, v99
  v_mfma_f32_16x16x32_bf16 v[180:183], a[208:211], a[160:163], v[56:59]
  v_mfma_f32_16x16x32_bf16 v[180:183], a[212:215], a[164:167], v[180:183]
  v_mfma_f32_16x16x32_bf16 v[180:183], a[216:219], a[168:171], v[180:183]
  ds_read_b64_tr_b16 a[204:205], v13 offset:40960
  ds_read_b64_tr_b16 a[206:207], v13 offset:45056
  v_mfma_f32_16x16x32_bf16 v[180:183], a[220:223], a[172:175], v[180:183]
  v_cvt_pk_bf16_f32 v219, v222, v223
  v_max3_f32 v44, v44, v184, v185
  v_exp_f32 v250, v250
  v_max3_f32 v45, v45, v186, v187
  v_cvt_pk_bf16_f32 v98, v40, v98
  v_cvt_pk_bf16_f32 v99, v41, v99
  v_lshlrev_b32 v40, 16, v100
  v_mfma_f32_16x16x32_bf16 v[188:191], a[208:211], a[176:179], v[60:63]
  buffer_load_dwordx4 v6, s[12:15], s88 offen offset:1024 nt lds
  v_mfma_f32_16x16x32_bf16 v[188:191], a[212:215], a[180:183], v[188:191]
  v_mfma_f32_16x16x32_bf16 v[188:191], a[216:219], a[184:187], v[188:191]
  v_mfma_f32_16x16x32_bf16 v[188:191], a[220:223], a[188:191], v[188:191]
  v_exp_f32 v251, v251
  v_max3_f32 v44, v44, v164, v165
  v_cvt_pk_bf16_f32 v248, v248, v249
  v_max3_f32 v45, v45, v166, v167
  v_lshlrev_b32 v41, 16, v101
  v_and_b32 v100, 0xffff0000, v100
  s_waitcnt lgkmcnt(0)
  v_mfma_f32_16x16x32_bf16 a[0:3], a[192:195], v[192:195], a[0:3]
  buffer_load_dwordx4 v5, s[12:15], s88 offen offset:2048 nt lds
  v_mfma_f32_16x16x32_bf16 a[0:3], a[196:199], v[224:227], a[0:3]
  ds_read_b64_tr_b16 a[208:209], v14 offset:32768
  ds_read_b64_tr_b16 a[210:211], v14 offset:36864
  v_and_b32 v101, 0xffff0000, v101
  v_mfma_f32_16x16x32_bf16 a[32:35], a[192:195], v[200:203], a[32:35]
  v_mfma_f32_16x16x32_bf16 a[32:35], a[196:199], v[232:235], a[32:35]
  v_exp_f32 v252, v252
  v_max3_f32 v44, v44, v172, v173
  v_exp_f32 v253, v253
  v_mul_f32 v40, s47, v40
  v_mfma_f32_16x16x32_bf16 a[64:67], a[192:195], v[208:211], a[64:67]
  ds_read_b64_tr_b16 a[212:213], v14 offset:40960
  ds_read_b64_tr_b16 a[214:215], v14 offset:45056
  v_mfma_f32_16x16x32_bf16 a[64:67], a[196:199], v[240:243], a[64:67]
  v_cvt_pk_bf16_f32 v249, v250, v251
  v_max3_f32 v45, v45, v174, v175
  v_mul_f32 v41, s47, v41
  v_mul_f32 v100, s47, v100
  v_mfma_f32_16x16x32_bf16 a[96:99], a[192:195], v[216:219], a[96:99]
  buffer_load_dwordx4 v6, s[12:15], s88 offen offset:3072 nt lds
  v_exp_f32 v254, v254
  v_exp_f32 v255, v255
  v_cvt_pk_bf16_f32 v250, v252, v253
  v_cvt_pk_bf16_f32 v251, v254, v255
  s_nop 1
  v_mfma_f32_16x16x32_bf16 a[96:99], a[196:199], v[248:251], a[96:99]
  ds_read_b64_tr_b16 a[216:217], v15 offset:32768
  ds_read_b64_tr_b16 a[218:219], v15 offset:36864
  v_mul_f32 v101, s47, v101
  v_mfma_f32_16x16x32_bf16 a[4:7], a[200:203], v[192:195], a[4:7]
  v_mfma_f32_16x16x32_bf16 a[4:7], a[204:207], v[224:227], a[4:7]
  v_max3_f32 v44, v44, v180, v181
  v_max3_f32 v45, v45, v182, v183
  v_max3_f32 v44, v44, v188, v189
  v_max3_f32 v45, v45, v190, v191
  v_cvt_pk_bf16_f32 v100, v40, v100
  v_mfma_f32_16x16x32_bf16 a[224:227], a[240:243], v[192:195], a[224:227]
  v_max_f32 v44, v44, v45
  v_cmp_lt_f32 vcc, s48, v44
  v_mfma_f32_16x16x32_bf16 a[224:227], a[240:243], v[224:227], a[224:227]
  v_cvt_pk_bf16_f32 v101, v41, v101
  v_lshlrev_b32 v40, 16, v102
  v_mfma_f32_16x16x32_bf16 a[36:39], a[200:203], v[200:203], a[36:39]
  ds_read_b64_tr_b16 a[220:221], v15 offset:40960
  ds_read_b64_tr_b16 a[222:223], v15 offset:45056
  v_mfma_f32_16x16x32_bf16 a[36:39], a[204:207], v[232:235], a[36:39]
  s_cbranch_vccnz LS_t5
LS_b5:
  v_exp_f32 v128, v128
  v_exp_f32 v129, v129
  v_mfma_f32_16x16x32_bf16 a[68:71], a[200:203], v[208:211], a[68:71]
  v_mfma_f32_16x16x32_bf16 a[68:71], a[204:207], v[240:243], a[68:71]
  v_exp_f32 v130, v130
  v_exp_f32 v131, v131
  v_mfma_f32_16x16x32_bf16 a[100:103], a[200:203], v[216:219], a[100:103]
  v_mfma_f32_16x16x32_bf16 a[100:103], a[204:207], v[248:251], a[100:103]
  v_cvt_pk_bf16_f32 v128, v128, v129
  v_exp_f32 v132, v132
  v_lshlrev_b32 v41, 16, v103
  v_and_b32 v102, 0xffff0000, v102
  s_waitcnt lgkmcnt(0)
  v_mfma_f32_16x16x32_bf16 a[8:11], a[208:211], v[192:195], a[8:11]
  v_mfma_f32_16x16x32_bf16 a[8:11], a[212:215], v[224:227], a[8:11]
  ds_read_b64_tr_b16 a[192:193], v16 offset:32768
  ds_read_b64_tr_b16 a[194:195], v16 offset:36864
  v_exp_f32 v133, v133
  v_and_b32 v103, 0xffff0000, v103
  v_mfma_f32_16x16x32_bf16 a[40:43], a[208:211], v[200:203], a[40:43]
  v_mfma_f32_16x16x32_bf16 a[40:43], a[212:215], v[232:235], a[40:43]
  v_cvt_pk_bf16_f32 v129, v130, v131
  v_exp_f32 v134, v134
  v_mul_f32 v40, s47, v40
  v_mfma_f32_16x16x32_bf16 a[72:75], a[208:211], v[208:211], a[72:75]
  ds_read_b64_tr_b16 a[196:197], v16 offset:40960
  ds_read_b64_tr_b16 a[198:199], v16 offset:45056
  v_mfma_f32_16x16x32_bf16 a[72:75], a[212:215], v[240:243], a[72:75]
  v_exp_f32 v135, v135
  v_mul_f32 v41, s47, v41
  v_mfma_f32_16x16x32_bf16 a[104:107], a[208:211], v[216:219], a[104:107]
  v_mfma_f32_16x16x32_bf16 a[104:107], a[212:215], v[248:251], a[104:107]
  ds_read_b64_tr_b16 a[200:201], v17 offset:32768
  ds_read_b64_tr_b16 a[202:203], v17 offset:36864
  v_cvt_pk_bf16_f32 v130, v132, v133
  v_exp_f32 v160, v160
  v_mul_f32 v102, s47, v102
  v_mfma_f32_16x16x32_bf16 a[12:15], a[216:219], v[192:195], a[12:15]
  v_mfma_f32_16x16x32_bf16 a[12:15], a[220:223], v[224:227], a[12:15]
  v_exp_f32 v161, v161
  v_cvt_pk_bf16_f32 v131, v134, v135
  v_mul_f32 v103, s47, v103
  v_cvt_pk_bf16_f32 v102, v40, v102
  v_mfma_f32_16x16x32_bf16 a[228:231], a[240:243], v[200:203], a[228:231]
  v_exp_f32 v162, v162
  v_mfma_f32_16x16x32_bf16 a[228:231], a[240:243], v[232:235], a[228:231]
  v_exp_f32 v163, v163
  v_cvt_pk_bf16_f32 v160, v160, v161
  v_mfma_f32_16x16x32_bf16 a[44:47], a[216:219], v[200:203], a[44:47]
  ds_read_b64_tr_b16 a[204:205], v17 offset:40960
  ds_read_b64_tr_b16 a[206:207], v17 offset:45056
  v_mfma_f32_16x16x32_bf16 a[44:47], a[220:223], v[232:235], a[44:47]
  v_exp_f32 v164, v164
  v_cvt_pk_bf16_f32 v103, v41, v103
  v_mfma_f32_16x16x32_bf16 a[76:79], a[216:219], v[208:211], a[76:79]
  v_mfma_f32_16x16x32_bf16 a[76:79], a[220:223], v[240:243], a[76:79]
  v_exp_f32 v165, v165
  v_cvt_pk_bf16_f32 v161, v162, v163
  v_lshlrev_b32 v40, 16, v104
  v_mfma_f32_16x16x32_bf16 a[108:111], a[216:219], v[216:219], a[108:111]
  v_mfma_f32_16x16x32_bf16 a[108:111], a[220:223], v[248:251], a[108:111]
  v_exp_f32 v166, v166
  v_exp_f32 v167, v167
  v_lshlrev_b32 v41, 16, v105
  s_waitcnt lgkmcnt(0)
  v_mfma_f32_16x16x32_bf16 a[16:19], a[192:195], v[192:195], a[16:19]
  v_mfma_f32_16x16x32_bf16 a[16:19], a[196:199], v[224:227], a[16:19]
  ds_read_b64_tr_b16 a[208:209], v18 offset:32768
  ds_read_b64_tr_b16 a[210:211], v18 offset:36864
  v_cvt_pk_bf16_f32 v162, v164, v165
  v_and_b32 v104, 0xffff0000, v104
  v_mfma_f32_16x16x32_bf16 a[48:51], a[192:195], v[200:203], a[48:51]
  v_mfma_f32_16x16x32_bf16 a[48:51], a[196:199], v[232:235], a[48:51]
  v_exp_f32 v136, v136
  v_exp_f32 v137, v137
  v_cvt_pk_bf16_f32 v163, v166, v167
  v_and_b32 v105, 0xffff0000, v105
  v_mul_f32 v40, s47, v40
  v_mfma_f32_16x16x32_bf16 a[80:83], a[192:195], v[208:211], a[80:83]
  ds_read_b64_tr_b16 a[212:213], v18 offset:40960
  ds_read_b64_tr_b16 a[214:215], v18 offset:45056
  v_mfma_f32_16x16x32_bf16 a[80:83], a[196:199], v[240:243], a[80:83]
  v_exp_f32 v138, v138
  v_mul_f32 v41, s47, v41
  v_mfma_f32_16x16x32_bf16 a[112:115], a[192:195], v[216:219], a[112:115]
  v_mfma_f32_16x16x32_bf16 a[112:115], a[196:199], v[248:251], a[112:115]
  ds_read_b64_tr_b16 a[216:217], v19 offset:32768
  ds_read_b64_tr_b16 a[218:219], v19 offset:36864
  v_exp_f32 v139, v139
  v_mul_f32 v104, s47, v104
  v_mfma_f32_16x16x32_bf16 a[20:23], a[200:203], v[192:195], a[20:23]
  v_mfma_f32_16x16x32_bf16 a[20:23], a[204:207], v[224:227], a[20:23]
  v_cvt_pk_bf16_f32 v136, v136, v137
  v_exp_f32 v140, v140
  v_exp_f32 v141, v141
  v_mul_f32 v105, s47, v105
  v_mfma_f32_16x16x32_bf16 a[232:235], a[240:243], v[208:211], a[232:235]
  v_cvt_pk_bf16_f32 v137, v138, v139
  v_cvt_pk_bf16_f32 v104, v40, v104
  v_mfma_f32_16x16x32_bf16 a[232:235], a[240:243], v[240:243], a[232:235]
  v_exp_f32 v142, v142
  v_mfma_f32_16x16x32_bf16 a[52:55], a[200:203], v[200:203], a[52:55]
  ds_read_b64_tr_b16 a[220:221], v19 offset:40960
  ds_read_b64_tr_b16 a[222:223], v19 offset:45056
  v_mfma_f32_16x16x32_bf16 a[52:55], a[204:207], v[232:235], a[52:55]
  v_exp_f32 v143, v143
  v_mfma_f32_16x16x32_bf16 a[84:87], a[200:203], v[208:211], a[84:87]
  s_waitcnt vmcnt(6)
  s_barrier
  v_mfma_f32_16x16x32_bf16 a[84:87], a[204:207], v[240:243], a[84:87]
  s_add_u32 m0, s44, 32768
  v_cvt_pk_bf16_f32 v138, v140, v141
  v_cvt_pk_bf16_f32 v105, v41, v105
  v_lshlrev_b32 v40, 16, v106
  v_mfma_f32_16x16x32_bf16 a[116:119], a[200:203], v[216:219], a[116:119]
  v_mfma_f32_16x16x32_bf16 a[116:119], a[204:207], v[248:251], a[116:119]
  v_exp_f32 v168, v168
  v_exp_f32 v169, v169
  v_lshlrev_b32 v41, 16, v107
  s_waitcnt lgkmcnt(0)
  v_mfma_f32_16x16x32_bf16 a[24:27], a[208:211], v[192:195], a[24:27]
  buffer_load_dwordx4 v1, s[16:19], s82 offen offset:0 nt lds
  v_mfma_f32_16x16x32_bf16 a[24:27], a[212:215], v[224:227], a[24:27]
  ds_read_b128 a[192:195], v8 offset:16384
  v_cvt_pk_bf16_f32 v139, v142, v143
  v_and_b32 v106, 0xffff0000, v106
  v_mfma_f32_16x16x32_bf16 a[56:59], a[208:211], v[200:203], a[56:59]
  v_mfma_f32_16x16x32_bf16 a[56:59], a[212:215], v[232:235], a[56:59]
  v_exp_f32 v170, v170
  v_exp_f32 v171, v171
  v_and_b32 v107, 0xffff0000, v107
  v_mfma_f32_16x16x32_bf16 a[88:91], a[208:211], v[208:211], a[88:91]
  ds_read_b128 a[196:199], v9 offset:16384
  v_mfma_f32_16x16x32_bf16 a[88:91], a[212:215], v[240:243], a[88:91]
  v_cvt_pk_bf16_f32 v168, v168, v169
  v_exp_f32 v172, v172
  v_mul_f32 v40, s47, v40
  v_mfma_f32_16x16x32_bf16 a[120:123], a[208:211], v[216:219], a[120:123]
  buffer_load_dwordx4 v2, s[16:19], s82 offen offset:1024 nt lds
  v_mfma_f32_16x16x32_bf16 a[120:123], a[212:215], v[248:251], a[120:123]
  ds_read_b128 a[200:203], v10 offset:16384
  v_mul_f32 v41, s47, v41
  v_mul_f32 v106, s47, v106
  v_mfma_f32_16x16x32_bf16 a[28:31], a[216:219], v[192:195], a[28:31]
  v_mfma_f32_16x16x32_bf16 a[28:31], a[220:223], v[224:227], a[28:31]
  v_exp_f32 v173, v173
  v_cvt_pk_bf16_f32 v169, v170, v171
  v_exp_f32 v174, v174
  v_mul_f32 v107, s47, v107
  v_mfma_f32_16x16x32_bf16 a[236:239], a[240:243], v[216:219], a[236:239]
  v_exp_f32 v175, v175
  v_mfma_f32_16x16x32_bf16 a[236:239], a[240:243], v[248:251], a[236:239]
  v_cvt_pk_bf16_f32 v170, v172, v173
  v_cvt_pk_bf16_f32 v106, v40, v106
  v_mfma_f32_16x16x32_bf16 a[60:63], a[216:219], v[200:203], a[60:63]
  ds_read_b128 a[204:207], v11 offset:16384
  v_mfma_f32_16x16x32_bf16 a[60:63], a[220:223], v[232:235], a[60:63]
  v_exp_f32 v144, v144
  v_exp_f32 v145, v145
  v_mfma_f32_16x16x32_bf16 a[92:95], a[216:219], v[208:211], a[92:95]
  buffer_load_dwordx4 v3, s[16:19], s82 offen offset:2048 nt lds
  v_mfma_f32_16x16x32_bf16 a[92:95], a[220:223], v[240:243], a[92:95]
  v_cvt_pk_bf16_f32 v171, v174, v175
  v_exp_f32 v146, v146
  v_cvt_pk_bf16_f32 v107, v41, v107
  v_mfma_f32_16x16x32_bf16 a[124:127], a[216:219], v[216:219], a[124:127]
  v_mfma_f32_16x16x32_bf16 a[124:127], a[220:223], v[248:251], a[124:127]
  v_exp_f32 v147, v147
  v_lshlrev_b32 v40, 16, v108
  s_waitcnt lgkmcnt(0)
  s_cbranch_vccnz LS_t20
LS_b20:
  v_mfma_f32_16x16x32_bf16 v[192:195], a[192:195], a[128:131], v[20:23]
  buffer_load_dwordx4 v4, s[16:19], s82 offen offset:3072 nt lds
  v_mfma_f32_16x16x32_bf16 v[192:195], a[196:199], a[132:135], v[192:195]
  ds_read_b128 a[208:211], v8 offset:20480
  v_mfma_f32_16x16x32_bf16 v[192:195], a[200:203], a[136:139], v[192:195]
  v_mfma_f32_16x16x32_bf16 v[192:195], a[204:207], a[140:143], v[192:195]
  v_cvt_pk_bf16_f32 v144, v144, v145
  v_exp_f32 v148, v148
  v_exp_f32 v149, v149
  v_lshlrev_b32 v41, 16, v109
  v_and_b32 v108, 0xffff0000, v108
  v_and_b32 v109, 0xffff0000, v109
  v_mfma_f32_16x16x32_bf16 v[200:203], a[192:195], a[144:147], v[52:55]
  ds_read_b128 a[212:215], v9 offset:20480
  v_mfma_f32_16x16x32_bf16 v[200:203], a[196:199], a[148:151], v[200:203]
  v_mfma_f32_16x16x32_bf16 v[200:203], a[200:203], a[152:155], v[200:203]
  v_cvt_pk_bf16_f32 v145, v146, v147
  v_exp_f32 v150, v150
  v_mfma_f32_16x16x32_bf16 v[200:203], a[204:207], a[156:159], v[200:203]
  ds_read_b128 a[216:219], v10 offset:20480
  v_exp_f32 v151, v151
  v_max_f32 v44, v192, v193
  v_cvt_pk_bf16_f32 v146, v148, v149
  v_mul_f32 v40, s47, v40
  v_mul_f32 v41, s47, v41
  v_mfma_f32_16x16x32_bf16 v[208:211], a[192:195], a[160:163], v[56:59]
  v_mfma_f32_16x16x32_bf16 v[208:211], a[196:199], a[164:167], v[208:211]
  v_mfma_f32_16x16x32_bf16 v[208:211], a[200:203], a[168:171], v[208:211]
  ds_read_b128 a[220:223], v11 offset:20480
  v_mfma_f32_16x16x32_bf16 v[208:211], a[204:207], a[172:175], v[208:211]
  v_exp_f32 v176, v176
  v_max_f32 v45, v194, v195
  v_exp_f32 v177, v177
  v_max3_f32 v44, v44, v200, v201
  v_cvt_pk_bf16_f32 v147, v150, v151
  v_mul_f32 v108, s47, v108
  v_mul_f32 v109, s47, v109
  v_cvt_pk_bf16_f32 v108, v40, v108
  v_mfma_f32_16x16x32_bf16 v[216:219], a[192:195], a[176:179], v[60:63]
  v_mfma_f32_16x16x32_bf16 v[216:219], a[196:199], a[180:183], v[216:219]
  v_exp_f32 v178, v178
  v_mfma_f32_16x16x32_bf16 v[216:219], a[200:203], a[184:187], v[216:219]
  v_mfma_f32_16x16x32_bf16 v[216:219], a[204:207], a[188:191], v[216:219]
  v_exp_f32 v179, v179
  v_max3_f32 v45, v45, v202, v203
  v_cvt_pk_bf16_f32 v176, v176, v177
  v_max3_f32 v44, v44, v208, v209
  v_cvt_pk_bf16_f32 v109, v41, v109
  v_lshlrev_b32 v40, 16, v110
  s_waitcnt lgkmcnt(0)
  v_mfma_f32_16x16x32_bf16 v[196:199], a[208:211], a[128:131], v[20:23]
  v_mfma_f32_16x16x32_bf16 v[196:199], a[212:215], a[132:135], v[196:199]
  ds_read_b128 a[192:195], v8 offset:24576
  v_mfma_f32_16x16x32_bf16 v[196:199], a[216:219], a[136:139], v[196:199]
  v_mfma_f32_16x16x32_bf16 v[196:199], a[220:223], a[140:143], v[196:199]
  v_exp_f32 v180, v180
  v_max3_f32 v45, v45, v210, v211
  v_exp_f32 v181, v181
  v_max3_f32 v44, v44, v216, v217
  v_cvt_pk_bf16_f32 v177, v178, v179
  v_lshlrev_b32 v41, 16, v111
  v_and_b32 v110, 0xffff0000, v110
  v_mfma_f32_16x16x32_bf16 v[204:207], a[208:211], a[144:147], v[52:55]
  ds_read_b128 a[196:199], v9 offset:24576
  v_max3_f32 v45, v45, v218, v219
  v_mfma_f32_16x16x32_bf16 v[204:207], a[212:215], a[148:151], v[204:207]
  v_mfma_f32_16x16x32_bf16 v[204:207], a[216:219], a[152:155], v[204:207]
  v_mfma_f32_16x16x32_bf16 v[204:207], a[220:223], a[156:159], v[204:207]
  ds_read_b128 a[200:203], v10 offset:24576
  v_exp_f32 v182, v182
  v_max3_f32 v44, v44, v196, v197
  v_exp_f32 v183, v183
  v_and_b32 v111, 0xffff0000, v111
  v_mul_f32 v40, s47, v40
  v_mul_f32 v41, s47, v41
  v_mfma_f32_16x16x32_bf16 v[212:215], a[208:211], a[160:163], v[56:59]
  v_mfma_f32_16x16x32_bf16 v[212:215], a[212:215], a[164:167], v[212:215]
  v_mfma_f32_16x16x32_bf16 v[212:215], a[216:219], a[168:171], v[212:215]
  ds_read_b128 a[204:207], v11 offset:24576
  v_max3_f32 v45, v45, v198, v199
  v_mfma_f32_16x16x32_bf16 v[212:215], a[220:223], a[172:175], v[212:215]
  v_cvt_pk_bf16_f32 v178, v180, v181
  v_max3_f32 v44, v44, v204, v205
  v_exp_f32 v152, v152
  v_max3_f32 v45, v45, v206, v207
  v_exp_f32 v153, v153
  v_mul_f32 v110, s47, v110
  v_mul_f32 v111, s47, v111
  v_mfma_f32_16x16x32_bf16 v[220:223], a[208:211], a[176:179], v[60:63]
  v_mfma_f32_16x16x32_bf16 v[220:223], a[212:215], a[180:183], v[220:223]
  v_mfma_f32_16x16x32_bf16 v[220:223], a[216:219], a[184:187], v[220:223]
  v_mfma_f32_16x16x32_bf16 v[220:223], a[220:223], a[188:191], v[220:223]
  v_cvt_pk_bf16_f32 v179, v182, v183
  v_max3_f32 v44, v44, v212, v213
  v_exp_f32 v154, v154
  v_max3_f32 v45, v45, v214, v215
  v_exp_f32 v155, v155
  v_cvt_pk_bf16_f32 v110, v40, v110
  v_cvt_pk_bf16_f32 v111, v41, v111
  s_waitcnt lgkmcnt(0)
  v_mfma_f32_16x16x32_bf16 v[224:227], a[192:195], a[128:131], v[20:23]
  s_waitcnt vmcnt(8)
  ds_read_b128 v[112:115], v36 offset:12288
  ds_read_b128 v[116:119], v37 offset:12288
  v_mfma_f32_16x16x32_bf16 v[224:227], a[196:199], a[132:135], v[224:227]
  ds_read_b128 a[208:211], v8 offset:28672
  v_cvt_pk_bf16_f32 v152, v152, v153
  v_mfma_f32_16x16x32_bf16 v[224:227], a[200:203], a[136:139], v[224:227]
  ds_read_b128 v[120:123], v38 offset:12288
  v_mfma_f32_16x16x32_bf16 v[224:227], a[204:207], a[140:143], v[224:227]
  ds_read_b128 v[124:127], v39 offset:12288
  v_exp_f32 v156, v156
  v_max3_f32 v44, v44, v220, v221
  v_exp_f32 v157, v157
  v_max3_f32 v45, v45, v222, v223
  v_mfma_f32_16x16x32_bf16 v[232:235], a[192:195], a[144:147], v[52:55]
  ds_read_b128 a[212:215], v9 offset:28672
  v_mfma_f32_16x16x32_bf16 v[232:235], a[196:199], a[148:151], v[232:235]
  v_mfma_f32_16x16x32_bf16 v[232:235], a[200:203], a[152:155], v[232:235]
  v_mfma_f32_16x16x32_bf16 v[232:235], a[204:207], a[156:159], v[232:235]
  ds_read_b128 a[216:219], v10 offset:28672
  v_cvt_pk_bf16_f32 v153, v154, v155
  v_max3_f32 v44, v44, v224, v225
  v_exp_f32 v158, v158
  v_max3_f32 v45, v45, v226, v227
  v_mfma_f32_16x16x32_bf16 v[240:243], a[192:195], a[160:163], v[56:59]
  v_exp_f32 v159, v159
  v_mfma_f32_16x16x32_bf16 v[240:243], a[196:199], a[164:167], v[240:243]
  v_mfma_f32_16x16x32_bf16 v[240:243], a[200:203], a[168:171], v[240:243]
  ds_read_b128 a[220:223], v11 offset:28672
  v_mfma_f32_16x16x32_bf16 v[240:243], a[204:207], a[172:175], v[240:243]
  v_cvt_pk_bf16_f32 v154, v156, v157
  v_max3_f32 v44, v44, v232, v233
  v_exp_f32 v184, v184
  v_max3_f32 v45, v45, v234, v235
  v_mfma_f32_16x16x32_bf16 v[248:251], a[192:195], a[176:179], v[60:63]
  s_waitcnt vmcnt(4)
  s_barrier
  v_mfma_f32_16x16x32_bf16 v[248:251], a[196:199], a[180:183], v[248:251]
  s_add_u32 m0, s44, 65536
  v_mfma_f32_16x16x32_bf16 v[248:251], a[200:203], a[184:187], v[248:251]
  v_exp_f32 v185, v185
  v_mfma_f32_16x16x32_bf16 v[248:251], a[204:207], a[188:191], v[248:251]
  v_cvt_pk_bf16_f32 v155, v158, v159
  v_max3_f32 v44, v44, v240, v241
  v_exp_f32 v186, v186
  s_waitcnt lgkmcnt(7)
  v_lshlrev_b32 v40, 16, v112
  v_lshlrev_b32 v41, 16, v113
  v_and_b32 v112, 0xffff0000, v112
  s_waitcnt lgkmcnt(0)
  v_mfma_f32_16x16x32_bf16 v[228:231], a[208:211], a[128:131], v[20:23]
  buffer_load_dwordx4 v5, s[12:15], s89 offen offset:0 nt lds
  v_mfma_f32_16x16x32_bf16 v[228:231], a[212:215], a[132:135], v[228:231]
  ds_read_b64_tr_b16 a[192:193], v12 offset:0
  ds_read_b64_tr_b16 a[194:195], v12 offset:4096
  v_mfma_f32_16x16x32_bf16 v[228:231], a[216:219], a[136:139], v[228:231]
  v_mfma_f32_16x16x32_bf16 v[228:231], a[220:223], a[140:143], v[228:231]
  v_exp_f32 v187, v187
  v_max3_f32 v45, v45, v242, v243
  v_and_b32 v113, 0xffff0000, v113
  v_mul_f32 v40, s47, v40
  v_mul_f32 v41, s47, v41
  v_mul_f32 v112, s47, v112
  v_mfma_f32_16x16x32_bf16 v[236:239], a[208:211], a[144:147], v[52:55]
  ds_read_b64_tr_b16 a[196:197], v12 offset:8192
  ds_read_b64_tr_b16 a[198:199], v12 offset:12288
  v_mfma_f32_16x16x32_bf16 v[236:239], a[212:215], a[148:151], v[236:239]
  v_cvt_pk_bf16_f32 v184, v184, v185
  v_max3_f32 v44, v44, v248, v249
  v_mfma_f32_16x16x32_bf16 v[236:239], a[216:219], a[152:155], v[236:239]
  buffer_load_dwordx4 v6, s[12:15], s89 offen offset:1024 nt lds
  v_mfma_f32_16x16x32_bf16 v[236:239], a[220:223], a[156:159], v[236:239]
  ds_read_b64_tr_b16 a[200:201], v13 offset:0
  ds_read_b64_tr_b16 a[202:203], v13 offset:4096
  v_mul_f32 v113, s47, v113
  v_cvt_pk_bf16_f32 v112, v40, v112
  v_cvt_pk_bf16_f32 v113, v41, v113
  v_lshlrev_b32 v40, 16, v114
  v_mfma_f32_16x16x32_bf16 v[244:247], a[208:211], a[160:163], v[56:59]
  v_mfma_f32_16x16x32_bf16 v[244:247], a[212:215], a[164:167], v[244:247]
  v_mfma_f32_16x16x32_bf16 v[244:247], a[216:219], a[168:171], v[244:247]
  ds_read_b64_tr_b16 a[204:205], v13 offset:8192
  ds_read_b64_tr_b16 a[206:207], v13 offset:12288
  v_mfma_f32_16x16x32_bf16 v[244:247], a[220:223], a[172:175], v[244:247]
  v_exp_f32 v188, v188
  v_max3_f32 v45, v45, v250, v251
  v_exp_f32 v189, v189
  v_max3_f32 v44, v44, v228, v229
  v_lshlrev_b32 v41, 16, v115
  v_and_b32 v114, 0xffff0000, v114
  v_and_b32 v115, 0xffff0000, v115
  v_mul_f32 v40, s47, v40
  v_mfma_f32_16x16x32_bf16 v[252:255], a[208:211], a[176:179], v[60:63]
  buffer_load_dwordx4 v5, s[12:15], s89 offen offset:2048 nt lds
  v_mfma_f32_16x16x32_bf16 v[252:255], a[212:215], a[180:183], v[252:255]
  v_mfma_f32_16x16x32_bf16 v[252:255], a[216:219], a[184:187], v[252:255]
  v_mfma_f32_16x16x32_bf16 v[252:255], a[220:223], a[188:191], v[252:255]
  v_cvt_pk_bf16_f32 v185, v186, v187
  v_max3_f32 v45, v45, v230, v231
  v_exp_f32 v190, v190
  v_max3_f32 v44, v44, v236, v237
  v_mul_f32 v41, s47, v41
  v_mul_f32 v114, s47, v114
  v_mul_f32 v115, s47, v115
  v_cvt_pk_bf16_f32 v114, v40, v114
  s_waitcnt lgkmcnt(0)
  v_mfma_f32_16x16x32_bf16 a[0:3], a[192:195], v[128:131], a[0:3]
  buffer_load_dwordx4 v6, s[12:15], s89 offen offset:3072 nt lds
  v_mfma_f32_16x16x32_bf16 a[0:3], a[196:199], v[160:163], a[0:3]
  ds_read_b64_tr_b16 a[208:209], v14 offset:0
  ds_read_b64_tr_b16 a[210:211], v14 offset:4096
  v_exp_f32 v191, v191
  v_cvt_pk_bf16_f32 v115, v41, v115
  v_lshlrev_b32 v40, 16, v116
  v_mfma_f32_16x16x32_bf16 a[32:35], a[192:195], v[136:139], a[32:35]
  s_add_u32 m0, s44, 0
  v_lshlrev_b32 v41, 16, v117
  v_mfma_f32_16x16x32_bf16 a[32:35], a[196:199], v[168:171], a[32:35]
  v_cvt_pk_bf16_f32 v186, v188, v189
  v_max3_f32 v45, v45, v238, v239
  v_and_b32 v116, 0xffff0000, v116
  v_mfma_f32_16x16x32_bf16 a[64:67], a[192:195], v[144:147], a[64:67]
  ds_read_b64_tr_b16 a[212:213], v14 offset:8192
  ds_read_b64_tr_b16 a[214:215], v14 offset:12288
  v_mfma_f32_16x16x32_bf16 a[64:67], a[196:199], v[176:179], a[64:67]
  v_cvt_pk_bf16_f32 v187, v190, v191
  v_max3_f32 v44, v44, v244, v245
  v_max3_f32 v45, v45, v246, v247
  v_and_b32 v117, 0xffff0000, v117
  v_mul_f32 v40, s47, v40
  v_mfma_f32_16x16x32_bf16 a[96:99], a[192:195], v[152:155], a[96:99]
  buffer_load_dwordx4 v1, s[16:19], s83 offen offset:0 nt lds
  v_mfma_f32_16x16x32_bf16 a[96:99], a[196:199], v[184:187], a[96:99]
  ds_read_b64_tr_b16 a[216:217], v15 offset:0
  ds_read_b64_tr_b16 a[218:219], v15 offset:4096
  v_mul_f32 v41, s47, v41
  v_mfma_f32_16x16x32_bf16 a[4:7], a[200:203], v[128:131], a[4:7]
  v_max3_f32 v44, v44, v252, v253
  v_max3_f32 v45, v45, v254, v255
  v_mfma_f32_16x16x32_bf16 a[4:7], a[204:207], v[160:163], a[4:7]
  v_max_f32 v44, v44, v45
  v_cmp_lt_f32 vcc, s48, v44
  v_mul_f32 v116, s47, v116
  v_mul_f32 v117, s47, v117
  v_mfma_f32_16x16x32_bf16 a[224:227], a[240:243], v[128:131], a[224:227]
  v_cvt_pk_bf16_f32 v116, v40, v116
  v_cvt_pk_bf16_f32 v117, v41, v117
  v_mfma_f32_16x16x32_bf16 a[224:227], a[240:243], v[160:163], a[224:227]
  v_lshlrev_b32 v40, 16, v118
  v_lshlrev_b32 v41, 16, v119
  v_mfma_f32_16x16x32_bf16 a[36:39], a[200:203], v[136:139], a[36:39]
  ds_read_b64_tr_b16 a[220:221], v15 offset:8192
  ds_read_b64_tr_b16 a[222:223], v15 offset:12288
  v_mfma_f32_16x16x32_bf16 a[36:39], a[204:207], v[168:171], a[36:39]
  s_cbranch_vccnz LS_t6
LS_b6:
  v_exp_f32 v192, v192
  v_exp_f32 v193, v193
  v_exp_f32 v194, v194
  v_mfma_f32_16x16x32_bf16 a[68:71], a[200:203], v[144:147], a[68:71]
  v_mfma_f32_16x16x32_bf16 a[68:71], a[204:207], v[176:179], a[68:71]
  v_exp_f32 v195, v195
  v_cvt_pk_bf16_f32 v192, v192, v193
  v_exp_f32 v196, v196
  v_mfma_f32_16x16x32_bf16 a[100:103], a[200:203], v[152:155], a[100:103]
  v_mfma_f32_16x16x32_bf16 a[100:103], a[204:207], v[184:187], a[100:103]
  v_exp_f32 v197, v197
  v_cvt_pk_bf16_f32 v193, v194, v195
  v_and_b32 v118, 0xffff0000, v118
  v_and_b32 v119, 0xffff0000, v119
  s_waitcnt lgkmcnt(0)
  v_mfma_f32_16x16x32_bf16 a[8:11], a[208:211], v[128:131], a[8:11]
  v_exp_f32 v198, v198
  v_mfma_f32_16x16x32_bf16 a[8:11], a[212:215], v[160:163], a[8:11]
  ds_read_b64_tr_b16 a[192:193], v16 offset:0
  ds_read_b64_tr_b16 a[194:195], v16 offset:4096
  v_mul_f32 v40, s47, v40
  v_mul_f32 v41, s47, v41
  v_mfma_f32_16x16x32_bf16 a[40:43], a[208:211], v[136:139], a[40:43]
  v_mfma_f32_16x16x32_bf16 a[40:43], a[212:215], v[168:171], a[40:43]
  v_exp_f32 v199, v199
  v_cvt_pk_bf16_f32 v194, v196, v197
  v_exp_f32 v224, v224
  v_mul_f32 v118, s47, v118
  v_mul_f32 v119, s47, v119
  v_mfma_f32_16x16x32_bf16 a[72:75], a[208:211], v[144:147], a[72:75]
  ds_read_b64_tr_b16 a[196:197], v16 offset:8192
  ds_read_b64_tr_b16 a[198:199], v16 offset:12288
  v_mfma_f32_16x16x32_bf16 a[72:75], a[212:215], v[176:179], a[72:75]
  v_exp_f32 v225, v225
  v_cvt_pk_bf16_f32 v118, v40, v118
  v_cvt_pk_bf16_f32 v119, v41, v119
  v_mfma_f32_16x16x32_bf16 a[104:107], a[208:211], v[152:155], a[104:107]
  v_cvt_pk_bf16_f32 v195, v198, v199
  v_exp_f32 v226, v226
  v_mfma_f32_16x16x32_bf16 a[104:107], a[212:215], v[184:187], a[104:107]
  ds_read_b64_tr_b16 a[200:201], v17 offset:0
  ds_read_b64_tr_b16 a[202:203], v17 offset:4096
  v_lshlrev_b32 v40, 16, v120
  v_lshlrev_b32 v41, 16, v121
  v_mfma_f32_16x16x32_bf16 a[12:15], a[216:219], v[128:131], a[12:15]
  v_mfma_f32_16x16x32_bf16 a[12:15], a[220:223], v[160:163], a[12:15]
  v_exp_f32 v227, v227
  v_cvt_pk_bf16_f32 v224, v224, v225
  v_exp_f32 v228, v228
  v_and_b32 v120, 0xffff0000, v120
  v_and_b32 v121, 0xffff0000, v121
  v_mfma_f32_16x16x32_bf16 a[228:231], a[240:243], v[136:139], a[228:231]
  v_exp_f32 v229, v229
  v_mfma_f32_16x16x32_bf16 a[228:231], a[240:243], v[168:171], a[228:231]
  v_cvt_pk_bf16_f32 v225, v226, v227
  v_mul_f32 v40, s47, v40
  v_mfma_f32_16x16x32_bf16 a[44:47], a[216:219], v[136:139], a[44:47]
  ds_read_b64_tr_b16 a[204:205], v17 offset:8192
  ds_read_b64_tr_b16 a[206:207], v17 offset:12288
  v_mfma_f32_16x16x32_bf16 a[44:47], a[220:223], v[168:171], a[44:47]
  v_exp_f32 v230, v230
  v_exp_f32 v231, v231
  v_mul_f32 v41, s47, v41
  v_mfma_f32_16x16x32_bf16 a[76:79], a[216:219], v[144:147], a[76:79]
  v_cvt_pk_bf16_f32 v226, v228, v229
  v_mul_f32 v120, s47, v120
  v_mfma_f32_16x16x32_bf16 a[76:79], a[220:223], v[176:179], a[76:79]
  v_exp_f32 v200, v200
  v_mul_f32 v121, s47, v121
  v_mfma_f32_16x16x32_bf16 a[108:111], a[216:219], v[152:155], a[108:111]
  v_mfma_f32_16x16x32_bf16 a[108:111], a[220:223], v[184:187], a[108:111]
  v_exp_f32 v201, v201
  v_cvt_pk_bf16_f32 v227, v230, v231
  v_cvt_pk_bf16_f32 v120, v40, v120
  v_cvt_pk_bf16_f32 v121, v41, v121
  s_waitcnt lgkmcnt(0)
  v_mfma_f32_16x16x32_bf16 a[16:19], a[192:195], v[128:131], a[16:19]
  v_mfma_f32_16x16x32_bf16 a[16:19], a[196:199], v[160:163], a[16:19]
  ds_read_b64_tr_b16 a[208:209], v18 offset:0
  ds_read_b64_tr_b16 a[210:211], v18 offset:4096
  v_exp_f32 v202, v202
  v_exp_f32 v203, v203
  v_lshlrev_b32 v40, 16, v122
  v_lshlrev_b32 v41, 16, v123
  v_mfma_f32_16x16x32_bf16 a[48:51], a[192:195], v[136:139], a[48:51]
  v_mfma_f32_16x16x32_bf16 a[48:51], a[196:199], v[168:171], a[48:51]
  v_cvt_pk_bf16_f32 v200, v200, v201
  v_exp_f32 v204, v204
  v_and_b32 v122, 0xffff0000, v122
  v_mfma_f32_16x16x32_bf16 a[80:83], a[192:195], v[144:147], a[80:83]
  ds_read_b64_tr_b16 a[212:213], v18 offset:8192
  ds_read_b64_tr_b16 a[214:215], v18 offset:12288
  v_mfma_f32_16x16x32_bf16 a[80:83], a[196:199], v[176:179], a[80:83]
  v_exp_f32 v205, v205
  v_cvt_pk_bf16_f32 v201, v202, v203
  v_and_b32 v123, 0xffff0000, v123
  v_mul_f32 v40, s47, v40
  v_mfma_f32_16x16x32_bf16 a[112:115], a[192:195], v[152:155], a[112:115]
  v_mfma_f32_16x16x32_bf16 a[112:115], a[196:199], v[184:187], a[112:115]
  ds_read_b64_tr_b16 a[216:217], v19 offset:0
  ds_read_b64_tr_b16 a[218:219], v19 offset:4096
  v_exp_f32 v206, v206
  v_mul_f32 v41, s47, v41
  v_mul_f32 v122, s47, v122
  v_mfma_f32_16x16x32_bf16 a[20:23], a[200:203], v[128:131], a[20:23]
  v_mfma_f32_16x16x32_bf16 a[20:23], a[204:207], v[160:163], a[20:23]
  v_exp_f32 v207, v207
  v_cvt_pk_bf16_f32 v202, v204, v205
  v_exp_f32 v232, v232
  v_mul_f32 v123, s47, v123
  v_cvt_pk_bf16_f32 v122, v40, v122
  v_mfma_f32_16x16x32_bf16 a[232:235], a[240:243], v[144:147], a[232:235]
  v_exp_f32 v233, v233
  v_mfma_f32_16x16x32_bf16 a[232:235], a[240:243], v[176:179], a[232:235]
  v_cvt_pk_bf16_f32 v203, v206, v207
  v_exp_f32 v234, v234
  v_mfma_f32_16x16x32_bf16 a[52:55], a[200:203], v[136:139], a[52:55]
  ds_read_b64_tr_b16 a[220:221], v19 offset:8192
  ds_read_b64_tr_b16 a[222:223], v19 offset:12288
  v_mfma_f32_16x16x32_bf16 a[52:55], a[204:207], v[168:171], a[52:55]
  v_exp_f32 v235, v235
  v_cvt_pk_bf16_f32 v123, v41, v123
  v_lshlrev_b32 v40, 16, v124
  v_mfma_f32_16x16x32_bf16 a[84:87], a[200:203], v[144:147], a[84:87]
  s_waitcnt vmcnt(5)
  s_barrier
  v_mfma_f32_16x16x32_bf16 a[84:87], a[204:207], v[176:179], a[84:87]
  v_cvt_pk_bf16_f32 v232, v232, v233
  v_exp_f32 v236, v236
  v_lshlrev_b32 v41, 16, v125
  v_and_b32 v124, 0xffff0000, v124
  v_mfma_f32_16x16x32_bf16 a[116:119], a[200:203], v[152:155], a[116:119]
  v_mfma_f32_16x16x32_bf16 a[116:119], a[204:207], v[184:187], a[116:119]
  v_exp_f32 v237, v237
  v_and_b32 v125, 0xffff0000, v125
  v_mul_f32 v40, s47, v40
  s_waitcnt lgkmcnt(0)
  v_mfma_f32_16x16x32_bf16 a[24:27], a[208:211], v[128:131], a[24:27]
  buffer_load_dwordx4 v2, s[16:19], s83 offen offset:1024 nt lds
  v_mfma_f32_16x16x32_bf16 a[24:27], a[212:215], v[160:163], a[24:27]
  ds_read_b128 a[192:195], v8 offset:32768
  v_cvt_pk_bf16_f32 v233, v234, v235
  v_mul_f32 v41, s47, v41
  v_mul_f32 v124, s47, v124
  v_mfma_f32_16x16x32_bf16 a[56:59], a[208:211], v[136:139], a[56:59]
  v_mfma_f32_16x16x32_bf16 a[56:59], a[212:215], v[168:171], a[56:59]
  v_exp_f32 v238, v238
  v_exp_f32 v239, v239
  v_cvt_pk_bf16_f32 v234, v236, v237
  v_mul_f32 v125, s47, v125
  v_cvt_pk_bf16_f32 v124, v40, v124
  v_mfma_f32_16x16x32_bf16 a[88:91], a[208:211], v[144:147], a[88:91]
  ds_read_b128 a[196:199], v9 offset:32768
  v_mfma_f32_16x16x32_bf16 a[88:91], a[212:215], v[176:179], a[88:91]
  v_exp_f32 v208, v208
  v_exp_f32 v209, v209
  v_cvt_pk_bf16_f32 v125, v41, v125
  v_lshlrev_b32 v40, 16, v126
  v_mfma_f32_16x16x32_bf16 a[120:123], a[208:211], v[152:155], a[120:123]
  buffer_load_dwordx4 v3, s[16:19], s83 offen offset:2048 nt lds
  v_mfma_f32_16x16x32_bf16 a[120:123], a[212:215], v[184:187], a[120:123]
  ds_read_b128 a[200:203], v10 offset:32768
  v_cvt_pk_bf16_f32 v235, v238, v239
  v_lshlrev_b32 v41, 16, v127
  v_and_b32 v126, 0xffff0000, v126
  v_mfma_f32_16x16x32_bf16 a[28:31], a[216:219], v[128:131], a[28:31]
  v_exp_f32 v210, v210
  v_mfma_f32_16x16x32_bf16 a[28:31], a[220:223], v[160:163], a[28:31]
  v_exp_f32 v211, v211
  v_and_b32 v127, 0xffff0000, v127
  v_mul_f32 v40, s47, v40
  v_mfma_f32_16x16x32_bf16 a[236:239], a[240:243], v[152:155], a[236:239]
  v_cvt_pk_bf16_f32 v208, v208, v209
  v_exp_f32 v212, v212
  v_mfma_f32_16x16x32_bf16 a[236:239], a[240:243], v[184:187], a[236:239]
  v_exp_f32 v213, v213
  v_mfma_f32_16x16x32_bf16 a[60:63], a[216:219], v[136:139], a[60:63]
  ds_read_b128 a[204:207], v11 offset:32768
  v_mfma_f32_16x16x32_bf16 a[60:63], a[220:223], v[168:171], a[60:63]
  v_cvt_pk_bf16_f32 v209, v210, v211
  v_exp_f32 v214, v214
  v_mul_f32 v41, s47, v41
  v_mul_f32 v126, s47, v126
  v_mfma_f32_16x16x32_bf16 a[92:95], a[216:219], v[144:147], a[92:95]
  buffer_load_dwordx4 v4, s[16:19], s83 offen offset:3072 nt lds
  v_mfma_f32_16x16x32_bf16 a[92:95], a[220:223], v[176:179], a[92:95]
  s_add_u32 m0, s44, 81920
  v_exp_f32 v215, v215
  v_mul_f32 v127, s47, v127
  v_cvt_pk_bf16_f32 v126, v40, v126
  v_mfma_f32_16x16x32_bf16 a[124:127], a[216:219], v[152:155], a[124:127]
  v_cvt_pk_bf16_f32 v210, v212, v213
  v_cvt_pk_bf16_f32 v127, v41, v127
  v_mfma_f32_16x16x32_bf16 a[124:127], a[220:223], v[184:187], a[124:127]
  v_exp_f32 v240, v240
  s_waitcnt lgkmcnt(0)
  s_cbranch_vccnz LS_t21
LS_b21:
  v_mfma_f32_16x16x32_bf16 v[128:131], a[192:195], v[64:67], 0
  buffer_load_dwordx4 v5, s[20:23], s82 offen offset:0 nt lds
  v_mfma_f32_16x16x32_bf16 v[128:131], a[196:199], v[68:71], v[128:131]
  ds_read_b128 a[208:211], v8 offset:36864
  v_mfma_f32_16x16x32_bf16 v[128:131], a[200:203], v[72:75], v[128:131]
  v_exp_f32 v241, v241
  v_mfma_f32_16x16x32_bf16 v[128:131], a[204:207], v[76:79], v[128:131]
  v_cvt_pk_bf16_f32 v211, v214, v215
  v_exp_f32 v242, v242
  v_exp_f32 v243, v243
  v_cvt_pk_bf16_f32 v240, v240, v241
  v_exp_f32 v244, v244
  v_mfma_f32_16x16x32_bf16 v[136:139], a[192:195], v[80:83], 0
  ds_read_b128 a[212:215], v9 offset:36864
  v_mfma_f32_16x16x32_bf16 v[136:139], a[196:199], v[84:87], v[136:139]
  v_exp_f32 v245, v245
  v_mfma_f32_16x16x32_bf16 v[136:139], a[200:203], v[88:91], v[136:139]
  buffer_load_dwordx4 v6, s[20:23], s82 offen offset:1024 nt lds
  v_mfma_f32_16x16x32_bf16 v[136:139], a[204:207], v[92:95], v[136:139]
  ds_read_b128 a[216:219], v10 offset:36864
  v_cvt_pk_bf16_f32 v241, v242, v243
  v_exp_f32 v246, v246
  v_exp_f32 v247, v247
  v_cvt_pk_bf16_f32 v242, v244, v245
  v_exp_f32 v216, v216
  v_mfma_f32_16x16x32_bf16 v[144:147], a[192:195], v[96:99], 0
  v_mfma_f32_16x16x32_bf16 v[144:147], a[196:199], v[100:103], v[144:147]
  v_exp_f32 v217, v217
  v_mfma_f32_16x16x32_bf16 v[144:147], a[200:203], v[104:107], v[144:147]
  ds_read_b128 a[220:223], v11 offset:36864
  v_mfma_f32_16x16x32_bf16 v[144:147], a[204:207], v[108:111], v[144:147]
  v_cvt_pk_bf16_f32 v243, v246, v247
  v_exp_f32 v218, v218
  v_exp_f32 v219, v219
  v_cvt_pk_bf16_f32 v216, v216, v217
  v_exp_f32 v220, v220
  v_exp_f32 v221, v221
  v_mfma_f32_16x16x32_bf16 v[152:155], a[192:195], v[112:115], 0
  v_cvt_pk_bf16_f32 v217, v218, v219
  v_exp_f32 v222, v222
  v_mfma_f32_16x16x32_bf16 v[152:155], a[196:199], v[116:119], v[152:155]
  v_mfma_f32_16x16x32_bf16 v[152:155], a[200:203], v[120:123], v[152:155]
  v_mfma_f32_16x16x32_bf16 v[152:155], a[204:207], v[124:127], v[152:155]
  v_exp_f32 v223, v223
  v_cvt_pk_bf16_f32 v218, v220, v221
  v_exp_f32 v248, v248
  v_exp_f32 v249, v249
  v_cvt_pk_bf16_f32 v219, v222, v223
  s_waitcnt lgkmcnt(0)
  v_mfma_f32_16x16x32_bf16 v[132:135], a[208:211], v[64:67], 0
  v_exp_f32 v250, v250
  v_mfma_f32_16x16x32_bf16 v[132:135], a[212:215], v[68:71], v[132:135]
  ds_read_b128 a[192:195], v8 offset:40960
  v_mfma_f32_16x16x32_bf16 v[132:135], a[216:219], v[72:75], v[132:135]
  v_exp_f32 v251, v251
  v_mfma_f32_16x16x32_bf16 v[132:135], a[220:223], v[76:79], v[132:135]
  v_cvt_pk_bf16_f32 v248, v248, v249
  v_max3_f32 v40, v128, v129, v130
  v_exp_f32 v252, v252
  v_max3_f32 v41, v136, v137, v138
  v_exp_f32 v253, v253
  v_max3_f32 v42, v144, v145, v146
  v_mfma_f32_16x16x32_bf16 v[140:143], a[208:211], v[80:83], 0
  ds_read_b128 a[196:199], v9 offset:40960
  v_mfma_f32_16x16x32_bf16 v[140:143], a[212:215], v[84:87], v[140:143]
  v_mfma_f32_16x16x32_bf16 v[140:143], a[216:219], v[88:91], v[140:143]
  v_max3_f32 v43, v152, v153, v154
  v_max_f32 v40, v40, v131
  v_mfma_f32_16x16x32_bf16 v[140:143], a[220:223], v[92:95], v[140:143]
  ds_read_b128 a[200:203], v10 offset:40960
  v_cvt_pk_bf16_f32 v249, v250, v251
  v_max_f32 v41, v41, v139
  v_exp_f32 v254, v254
  v_max_f32 v42, v42, v147
  v_exp_f32 v255, v255
  v_max_f32 v43, v43, v155
  v_cvt_pk_bf16_f32 v250, v252, v253
  v_mfma_f32_16x16x32_bf16 v[148:151], a[208:211], v[96:99], 0
  v_mfma_f32_16x16x32_bf16 v[148:151], a[212:215], v[100:103], v[148:151]
  v_cvt_pk_bf16_f32 v251, v254, v255
  v_mov_b32 v36, v40
  v_mfma_f32_16x16x32_bf16 v[148:151], a[216:219], v[104:107], v[148:151]
  ds_read_b128 a[204:207], v11 offset:40960
  v_mfma_f32_16x16x32_bf16 v[148:151], a[220:223], v[108:111], v[148:151]
  v_mov_b32 v37, v41
  v_mov_b32 v38, v42
  v_mov_b32 v39, v43
  v_permlane32_swap_b32 v40, v36
  v_permlane32_swap_b32 v41, v37
  v_mfma_f32_16x16x32_bf16 v[156:159], a[208:211], v[112:115], 0
  v_mfma_f32_16x16x32_bf16 v[156:159], a[212:215], v[116:119], v[156:159]
  v_permlane32_swap_b32 v42, v38
  v_mfma_f32_16x16x32_bf16 v[156:159], a[216:219], v[120:123], v[156:159]
  v_mfma_f32_16x16x32_bf16 v[156:159], a[220:223], v[124:127], v[156:159]
  v_permlane32_swap_b32 v43, v39
  v_max_f32 v40, v40, v36
  v_max_f32 v41, v41, v37
  v_max_f32 v42, v42, v38
  v_max_f32 v43, v43, v39
  v_mov_b32 v36, v40
  v_mov_b32 v37, v41
  v_mov_b32 v38, v42
  s_waitcnt lgkmcnt(0)
  v_mfma_f32_16x16x32_bf16 v[160:163], a[192:195], v[64:67], 0
  v_mov_b32 v39, v43
  v_permlane16_swap_b32 v40, v36
  v_mfma_f32_16x16x32_bf16 v[160:163], a[196:199], v[68:71], v[160:163]
  ds_read_b128 a[208:211], v8 offset:45056
  v_mfma_f32_16x16x32_bf16 v[160:163], a[200:203], v[72:75], v[160:163]
  v_mfma_f32_16x16x32_bf16 v[160:163], a[204:207], v[76:79], v[160:163]
  v_permlane16_swap_b32 v41, v37
  v_permlane16_swap_b32 v42, v38
  v_permlane16_swap_b32 v43, v39
  v_mfma_f32_16x16x32_bf16 v[168:171], a[192:195], v[80:83], 0
  ds_read_b128 a[212:215], v9 offset:45056
  v_max_f32 v40, v40, v36
  v_mfma_f32_16x16x32_bf16 v[168:171], a[196:199], v[84:87], v[168:171]
  v_mfma_f32_16x16x32_bf16 v[168:171], a[200:203], v[88:91], v[168:171]
  v_max_f32 v41, v41, v37
  v_max_f32 v42, v42, v38
  v_mfma_f32_16x16x32_bf16 v[168:171], a[204:207], v[92:95], v[168:171]
  ds_read_b128 a[216:219], v10 offset:45056
  v_max_f32 v43, v43, v39
  v_sub_f32 v20, 0, v40
  v_sub_f32 v52, 0, v41
  v_sub_f32 v56, 0, v42
  v_sub_f32 v60, 0, v43
  v_sub_f32 v21, 0, v40
  v_sub_f32 v53, 0, v41
  v_mfma_f32_16x16x32_bf16 v[176:179], a[192:195], v[96:99], 0
  v_mfma_f32_16x16x32_bf16 v[176:179], a[196:199], v[100:103], v[176:179]
  v_mfma_f32_16x16x32_bf16 v[176:179], a[200:203], v[104:107], v[176:179]
  ds_read_b128 a[220:223], v11 offset:45056
  v_sub_f32 v57, 0, v42
  v_mfma_f32_16x16x32_bf16 v[176:179], a[204:207], v[108:111], v[176:179]
  v_sub_f32 v61, 0, v43
  v_sub_f32 v22, 0, v40
  v_sub_f32 v54, 0, v41
  v_sub_f32 v58, 0, v42
  v_sub_f32 v62, 0, v43
  v_sub_f32 v23, 0, v40
  v_sub_f32 v55, 0, v41
  v_sub_f32 v59, 0, v42
  v_sub_f32 v63, 0, v43
  v_add_f32 v128, v128, v20
  v_add_f32 v129, v129, v20
  v_mfma_f32_16x16x32_bf16 v[184:187], a[192:195], v[112:115], 0
  s_waitcnt vmcnt(6)
  s_barrier
  v_mfma_f32_16x16x32_bf16 v[184:187], a[196:199], v[116:119], v[184:187]
  v_add_f32 v130, v130, v20
  v_add_f32 v131, v131, v20
  v_mfma_f32_16x16x32_bf16 v[184:187], a[200:203], v[120:123], v[184:187]
  v_mfma_f32_16x16x32_bf16 v[184:187], a[204:207], v[124:127], v[184:187]
  v_add_f32 v136, v136, v52
  v_add_f32 v137, v137, v52
  v_add_f32 v138, v138, v52
  v_add_f32 v139, v139, v52
  v_max_f32 v44, v128, v129
  v_max_f32 v45, v130, v131
  v_add_f32 v144, v144, v56
  v_add_f32 v145, v145, v56
  s_waitcnt lgkmcnt(0)
  v_mfma_f32_16x16x32_bf16 v[164:167], a[208:211], v[64:67], 0
  buffer_load_dwordx4 v5, s[20:23], s82 offen offset:2048 nt lds
  v_mfma_f32_16x16x32_bf16 v[164:167], a[212:215], v[68:71], v[164:167]
  ds_read_b64_tr_b16 a[192:193], v12 offset:16384
  ds_read_b64_tr_b16 a[194:195], v12 offset:20480
  v_mfma_f32_16x16x32_bf16 v[164:167], a[216:219], v[72:75], v[164:167]
  v_mfma_f32_16x16x32_bf16 v[164:167], a[220:223], v[76:79], v[164:167]
  v_add_f32 v146, v146, v56
  v_add_f32 v147, v147, v56
  v_max3_f32 v44, v44, v136, v137
  v_max3_f32 v45, v45, v138, v139
  v_add_f32 v152, v152, v60
  v_add_f32 v153, v153, v60
  v_add_f32 v154, v154, v60
  v_add_f32 v155, v155, v60
  v_max3_f32 v44, v44, v144, v145
  v_mfma_f32_16x16x32_bf16 v[172:175], a[208:211], v[80:83], 0
  ds_read_b64_tr_b16 a[196:197], v12 offset:24576
  ds_read_b64_tr_b16 a[198:199], v12 offset:28672
  v_mfma_f32_16x16x32_bf16 v[172:175], a[212:215], v[84:87], v[172:175]
  v_mfma_f32_16x16x32_bf16 v[172:175], a[216:219], v[88:91], v[172:175]
  buffer_load_dwordx4 v6, s[20:23], s82 offen offset:3072 nt lds
  v_mfma_f32_16x16x32_bf16 v[172:175], a[220:223], v[92:95], v[172:175]
  ds_read_b64_tr_b16 a[200:201], v13 offset:16384
  ds_read_b64_tr_b16 a[202:203], v13 offset:20480
  v_max3_f32 v45, v45, v146, v147
  v_max3_f32 v44, v44, v152, v153
  v_max3_f32 v45, v45, v154, v155
  v_add_f32 v132, v132, v20
  v_add_f32 v133, v133, v20
  v_add_f32 v134, v134, v20
  v_add_f32 v135, v135, v20
  v_mfma_f32_16x16x32_bf16 v[180:183], a[208:211], v[96:99], 0
  s_add_u32 m0, s44, 16384
  v_add_f32 v140, v140, v52
  v_mfma_f32_16x16x32_bf16 v[180:183], a[212:215], v[100:103], v[180:183]
  v_mfma_f32_16x16x32_bf16 v[180:183], a[216:219], v[104:107], v[180:183]
  ds_read_b64_tr_b16 a[204:205], v13 offset:24576
  ds_read_b64_tr_b16 a[206:207], v13 offset:28672
  v_mfma_f32_16x16x32_bf16 v[180:183], a[220:223], v[108:111], v[180:183]
  v_add_f32 v141, v141, v52
  v_add_f32 v142, v142, v52
  v_add_f32 v143, v143, v52
  v_max3_f32 v44, v44, v132, v133
  v_max3_f32 v45, v45, v134, v135
  v_add_f32 v148, v148, v56
  v_add_f32 v149, v149, v56
  v_add_f32 v150, v150, v56
  v_add_f32 v151, v151, v56
  v_mfma_f32_16x16x32_bf16 v[188:191], a[208:211], v[112:115], 0
  buffer_load_dwordx4 v1, s[16:19], s84 offen offset:0 nt lds
  v_mfma_f32_16x16x32_bf16 v[188:191], a[212:215], v[116:119], v[188:191]
  v_mfma_f32_16x16x32_bf16 v[188:191], a[216:219], v[120:123], v[188:191]
  v_max3_f32 v44, v44, v140, v141
  v_max3_f32 v45, v45, v142, v143
  v_mfma_f32_16x16x32_bf16 v[188:191], a[220:223], v[124:127], v[188:191]
  v_add_f32 v156, v156, v60
  v_add_f32 v157, v157, v60
  v_add_f32 v158, v158, v60
  v_add_f32 v159, v159, v60
  v_max3_f32 v44, v44, v148, v149
  v_max3_f32 v45, v45, v150, v151
  v_max3_f32 v44, v44, v156, v157
  v_max3_f32 v45, v45, v158, v159
  s_waitcnt lgkmcnt(0)
  v_mfma_f32_16x16x32_bf16 a[0:3], a[192:195], v[192:195], a[0:3]
  buffer_load_dwordx4 v2, s[16:19], s84 offen offset:1024 nt lds
  v_mfma_f32_16x16x32_bf16 a[0:3], a[196:199], v[224:227], a[0:3]
  ds_read_b64_tr_b16 a[208:209], v14 offset:16384
  ds_read_b64_tr_b16 a[210:211], v14 offset:20480
  v_add_f32 v160, v160, v20
  v_add_f32 v161, v161, v20
  v_mfma_f32_16x16x32_bf16 a[32:35], a[192:195], v[200:203], a[32:35]
  v_add_f32 v162, v162, v20
  v_add_f32 v163, v163, v20
  v_mfma_f32_16x16x32_bf16 a[32:35], a[196:199], v[232:235], a[32:35]
  v_add_f32 v168, v168, v52
  v_add_f32 v169, v169, v52
  v_add_f32 v170, v170, v52
  v_add_f32 v171, v171, v52
  v_mfma_f32_16x16x32_bf16 a[64:67], a[192:195], v[208:211], a[64:67]
  ds_read_b64_tr_b16 a[212:213], v14 offset:24576
  ds_read_b64_tr_b16 a[214:215], v14 offset:28672
  v_mfma_f32_16x16x32_bf16 a[64:67], a[196:199], v[240:243], a[64:67]
  v_max3_f32 v44, v44, v160, v161
  v_max3_f32 v45, v45, v162, v163
  v_add_f32 v176, v176, v56
  v_mfma_f32_16x16x32_bf16 a[96:99], a[192:195], v[216:219], a[96:99]
  buffer_load_dwordx4 v3, s[16:19], s84 offen offset:2048 nt lds
  v_mfma_f32_16x16x32_bf16 a[96:99], a[196:199], v[248:251], a[96:99]
  ds_read_b64_tr_b16 a[216:217], v15 offset:16384
  ds_read_b64_tr_b16 a[218:219], v15 offset:20480
  v_add_f32 v177, v177, v56
  v_add_f32 v178, v178, v56
  v_mfma_f32_16x16x32_bf16 a[4:7], a[200:203], v[192:195], a[4:7]
  v_add_f32 v179, v179, v56
  v_max3_f32 v44, v44, v168, v169
  v_mfma_f32_16x16x32_bf16 a[4:7], a[204:207], v[224:227], a[4:7]
  v_max3_f32 v45, v45, v170, v171
  v_add_f32 v184, v184, v60
  v_add_f32 v185, v185, v60
  v_add_f32 v186, v186, v60
  v_mfma_f32_16x16x32_bf16 a[224:227], a[240:243], v[192:195], a[224:227]
  v_add_f32 v187, v187, v60
  v_max3_f32 v44, v44, v176, v177
  v_mfma_f32_16x16x32_bf16 a[224:227], a[240:243], v[224:227], a[224:227]
  v_max3_f32 v45, v45, v178, v179
  v_max3_f32 v44, v44, v184, v185
  v_max3_f32 v45, v45, v186, v187
  v_add_f32 v164, v164, v20
  v_mfma_f32_16x16x32_bf16 a[36:39], a[200:203], v[200:203], a[36:39]
  ds_read_b64_tr_b16 a[220:221], v15 offset:24576
  ds_read_b64_tr_b16 a[222:223], v15 offset:28672
  v_mfma_f32_16x16x32_bf16 a[36:39], a[204:207], v[232:235], a[36:39]
  v_add_f32 v165, v165, v20
  v_add_f32 v166, v166, v20
  v_add_f32 v167, v167, v20
  v_mfma_f32_16x16x32_bf16 a[68:71], a[200:203], v[208:211], a[68:71]
  v_add_f32 v172, v172, v52
  v_add_f32 v173, v173, v52
  v_mfma_f32_16x16x32_bf16 a[68:71], a[204:207], v[240:243], a[68:71]
  v_add_f32 v174, v174, v52
  v_add_f32 v175, v175, v52
  v_max3_f32 v44, v44, v164, v165
  v_max3_f32 v45, v45, v166, v167
  v_mfma_f32_16x16x32_bf16 a[100:103], a[200:203], v[216:219], a[100:103]
  v_mfma_f32_16x16x32_bf16 a[100:103], a[204:207], v[248:251], a[100:103]
  v_add_f32 v180, v180, v56
  v_add_f32 v181, v181, v56
  v_add_f32 v182, v182, v56
  v_add_f32 v183, v183, v56
  v_max3_f32 v44, v44, v172, v173
  s_waitcnt lgkmcnt(0)
  v_mfma_f32_16x16x32_bf16 a[8:11], a[208:211], v[192:195], a[8:11]
  v_mfma_f32_16x16x32_bf16 a[8:11], a[212:215], v[224:227], a[8:11]
  ds_read_b64_tr_b16 a[192:193], v16 offset:16384
  ds_read_b64_tr_b16 a[194:195], v16 offset:20480
  v_max3_f32 v45, v45, v174, v175
  v_add_f32 v188, v188, v60
  v_add_f32 v189, v189, v60
  v_add_f32 v190, v190, v60
  v_mfma_f32_16x16x32_bf16 a[40:43], a[208:211], v[200:203], a[40:43]
  v_add_f32 v191, v191, v60
  v_max3_f32 v44, v44, v180, v181
  v_mfma_f32_16x16x32_bf16 a[40:43], a[212:215], v[232:235], a[40:43]
  v_max3_f32 v45, v45, v182, v183
  v_max3_f32 v44, v44, v188, v189
  v_max3_f32 v45, v45, v190, v191
  v_mfma_f32_16x16x32_bf16 a[72:75], a[208:211], v[208:211], a[72:75]
  ds_read_b64_tr_b16 a[196:197], v16 offset:24576
  ds_read_b64_tr_b16 a[198:199], v16 offset:28672
  v_mfma_f32_16x16x32_bf16 a[72:75], a[212:215], v[240:243], a[72:75]
  v_max_f32 v44, v44, v45
  v_cmp_lt_f32 vcc, s48, v44
  v_mfma_f32_16x16x32_bf16 a[104:107], a[208:211], v[216:219], a[104:107]
  v_mfma_f32_16x16x32_bf16 a[104:107], a[212:215], v[248:251], a[104:107]
  ds_read_b64_tr_b16 a[200:201], v17 offset:16384
  ds_read_b64_tr_b16 a[202:203], v17 offset:20480
  s_cbranch_vccnz LS_t7
LS_b7:
  v_exp_f32 v128, v128
  v_exp_f32 v129, v129
  v_mfma_f32_16x16x32_bf16 a[12:15], a[216:219], v[192:195], a[12:15]
  v_mfma_f32_16x16x32_bf16 a[12:15], a[220:223], v[224:227], a[12:15]
  v_exp_f32 v130, v130
  v_exp_f32 v131, v131
  v_cvt_pk_bf16_f32 v128, v128, v129
  v_exp_f32 v132, v132
  v_mfma_f32_16x16x32_bf16 a[228:231], a[240:243], v[200:203], a[228:231]
  v_exp_f32 v133, v133
  v_mfma_f32_16x16x32_bf16 a[228:231], a[240:243], v[232:235], a[228:231]
  v_cvt_pk_bf16_f32 v129, v130, v131
  v_exp_f32 v134, v134
  v_mfma_f32_16x16x32_bf16 a[44:47], a[216:219], v[200:203], a[44:47]
  ds_read_b64_tr_b16 a[204:205], v17 offset:24576
  ds_read_b64_tr_b16 a[206:207], v17 offset:28672
  v_mfma_f32_16x16x32_bf16 a[44:47], a[220:223], v[232:235], a[44:47]
  v_exp_f32 v135, v135
  v_cvt_pk_bf16_f32 v130, v132, v133
  v_exp_f32 v160, v160
  v_mfma_f32_16x16x32_bf16 a[76:79], a[216:219], v[208:211], a[76:79]
  v_exp_f32 v161, v161
  v_mfma_f32_16x16x32_bf16 a[76:79], a[220:223], v[240:243], a[76:79]
  v_cvt_pk_bf16_f32 v131, v134, v135
  v_exp_f32 v162, v162
  v_mfma_f32_16x16x32_bf16 a[108:111], a[216:219], v[216:219], a[108:111]
  v_mfma_f32_16x16x32_bf16 a[108:111], a[220:223], v[248:251], a[108:111]
  v_exp_f32 v163, v163
  v_cvt_pk_bf16_f32 v160, v160, v161
  v_exp_f32 v164, v164
  s_waitcnt lgkmcnt(0)
  v_mfma_f32_16x16x32_bf16 a[16:19], a[192:195], v[192:195], a[16:19]
  v_exp_f32 v165, v165
  v_mfma_f32_16x16x32_bf16 a[16:19], a[196:199], v[224:227], a[16:19]
  ds_read_b64_tr_b16 a[208:209], v18 offset:16384
  ds_read_b64_tr_b16 a[210:211], v18 offset:20480
  v_cvt_pk_bf16_f32 v161, v162, v163
  v_mfma_f32_16x16x32_bf16 a[48:51], a[192:195], v[200:203], a[48:51]
  v_mfma_f32_16x16x32_bf16 a[48:51], a[196:199], v[232:235], a[48:51]
  v_exp_f32 v166, v166
  v_exp_f32 v167, v167
  v_cvt_pk_bf16_f32 v162, v164, v165
  v_exp_f32 v136, v136
  v_mfma_f32_16x16x32_bf16 a[80:83], a[192:195], v[208:211], a[80:83]
  ds_read_b64_tr_b16 a[212:213], v18 offset:24576
  ds_read_b64_tr_b16 a[214:215], v18 offset:28672
  v_mfma_f32_16x16x32_bf16 a[80:83], a[196:199], v[240:243], a[80:83]
  v_exp_f32 v137, v137
  v_cvt_pk_bf16_f32 v163, v166, v167
  v_mfma_f32_16x16x32_bf16 a[112:115], a[192:195], v[216:219], a[112:115]
  v_exp_f32 v138, v138
  v_mfma_f32_16x16x32_bf16 a[112:115], a[196:199], v[248:251], a[112:115]
  ds_read_b64_tr_b16 a[216:217], v19 offset:16384
  ds_read_b64_tr_b16 a[218:219], v19 offset:20480
  v_exp_f32 v139, v139
  v_mfma_f32_16x16x32_bf16 a[20:23], a[200:203], v[192:195], a[20:23]
  v_mfma_f32_16x16x32_bf16 a[20:23], a[204:207], v[224:227], a[20:23]
  v_cvt_pk_bf16_f32 v136, v136, v137
  v_exp_f32 v140, v140
  v_exp_f32 v141, v141
  v_mfma_f32_16x16x32_bf16 a[232:235], a[240:243], v[208:211], a[232:235]
  v_cvt_pk_bf16_f32 v137, v138, v139
  v_exp_f32 v142, v142
  v_mfma_f32_16x16x32_bf16 a[232:235], a[240:243], v[240:243], a[232:235]
  v_exp_f32 v143, v143
  v_cvt_pk_bf16_f32 v138, v140, v141
  v_mfma_f32_16x16x32_bf16 a[52:55], a[200:203], v[200:203], a[52:55]
  ds_read_b64_tr_b16 a[220:221], v19 offset:24576
  ds_read_b64_tr_b16 a[222:223], v19 offset:28672
  v_mfma_f32_16x16x32_bf16 a[52:55], a[204:207], v[232:235], a[52:55]
  v_exp_f32 v168, v168
  v_exp_f32 v169, v169
  v_mfma_f32_16x16x32_bf16 a[84:87], a[200:203], v[208:211], a[84:87]
  s_waitcnt vmcnt(7)
  s_barrier
  v_mfma_f32_16x16x32_bf16 a[84:87], a[204:207], v[240:243], a[84:87]
  v_cvt_pk_bf16_f32 v139, v142, v143
  v_exp_f32 v170, v170
  v_mfma_f32_16x16x32_bf16 a[116:119], a[200:203], v[216:219], a[116:119]
  v_mfma_f32_16x16x32_bf16 a[116:119], a[204:207], v[248:251], a[116:119]
  v_exp_f32 v171, v171
  v_cvt_pk_bf16_f32 v168, v168, v169
  v_exp_f32 v172, v172
  s_waitcnt lgkmcnt(0)
  v_mfma_f32_16x16x32_bf16 a[24:27], a[208:211], v[192:195], a[24:27]
  buffer_load_dwordx4 v4, s[16:19], s84 offen offset:3072 nt lds
  v_mfma_f32_16x16x32_bf16 a[24:27], a[212:215], v[224:227], a[24:27]
  ds_read_b128 a[192:195], v8 offset:0
  v_exp_f32 v173, v173
  v_cvt_pk_bf16_f32 v169, v170, v171
  v_mfma_f32_16x16x32_bf16 a[56:59], a[208:211], v[200:203], a[56:59]
  s_add_u32 m0, s44, 49152
  v_mfma_f32_16x16x32_bf16 a[56:59], a[212:215], v[232:235], a[56:59]
  v_exp_f32 v174, v174
  v_exp_f32 v175, v175
  v_cvt_pk_bf16_f32 v170, v172, v173
  v_mfma_f32_16x16x32_bf16 a[88:91], a[208:211], v[208:211], a[88:91]
  ds_read_b128 a[196:199], v9 offset:0
  v_exp_f32 v144, v144
  v_mfma_f32_16x16x32_bf16 a[88:91], a[212:215], v[240:243], a[88:91]
  v_exp_f32 v145, v145
  v_cvt_pk_bf16_f32 v171, v174, v175
  v_mfma_f32_16x16x32_bf16 a[120:123], a[208:211], v[216:219], a[120:123]
  buffer_load_dwordx4 v5, s[20:23], s83 offen offset:0 nt lds
  v_mfma_f32_16x16x32_bf16 a[120:123], a[212:215], v[248:251], a[120:123]
  ds_read_b128 a[200:203], v10 offset:0
  v_exp_f32 v146, v146
  v_mfma_f32_16x16x32_bf16 a[28:31], a[216:219], v[192:195], a[28:31]
  v_mfma_f32_16x16x32_bf16 a[28:31], a[220:223], v[224:227], a[28:31]
  v_exp_f32 v147, v147
  v_cvt_pk_bf16_f32 v144, v144, v145
  v_exp_f32 v148, v148
  v_exp_f32 v149, v149
  v_mfma_f32_16x16x32_bf16 a[236:239], a[240:243], v[216:219], a[236:239]
  v_cvt_pk_bf16_f32 v145, v146, v147
  v_exp_f32 v150, v150
  v_mfma_f32_16x16x32_bf16 a[236:239], a[240:243], v[248:251], a[236:239]
  v_exp_f32 v151, v151
  v_mfma_f32_16x16x32_bf16 a[60:63], a[216:219], v[200:203], a[60:63]
  ds_read_b128 a[204:207], v11 offset:0
  v_cvt_pk_bf16_f32 v146, v148, v149
  v_mfma_f32_16x16x32_bf16 a[60:63], a[220:223], v[232:235], a[60:63]
  v_exp_f32 v176, v176
  v_exp_f32 v177, v177
  v_mfma_f32_16x16x32_bf16 a[92:95], a[216:219], v[208:211], a[92:95]
  buffer_load_dwordx4 v6, s[20:23], s83 offen offset:1024 nt lds
  v_mfma_f32_16x16x32_bf16 a[92:95], a[220:223], v[240:243], a[92:95]
  v_cvt_pk_bf16_f32 v147, v150, v151
  v_exp_f32 v178, v178
  v_mfma_f32_16x16x32_bf16 a[124:127], a[216:219], v[216:219], a[124:127]
  v_exp_f32 v179, v179
  v_mfma_f32_16x16x32_bf16 a[124:127], a[220:223], v[248:251], a[124:127]
  v_cvt_pk_bf16_f32 v176, v176, v177
  v_exp_f32 v180, v180
  s_waitcnt lgkmcnt(0)
  v_mfma_f32_16x16x32_bf16 v[192:195], a[192:195], v[64:67], v[20:23]
  buffer_load_dwordx4 v5, s[20:23], s83 offen offset:2048 nt lds
  v_mfma_f32_16x16x32_bf16 v[192:195], a[196:199], v[68:71], v[192:195]
  ds_read_b128 a[208:211], v8 offset:4096
  v_exp_f32 v181, v181
  v_mfma_f32_16x16x32_bf16 v[192:195], a[200:203], v[72:75], v[192:195]
  v_mfma_f32_16x16x32_bf16 v[192:195], a[204:207], v[76:79], v[192:195]
  v_accvgpr_read_b32 v28, a224
  v_accvgpr_read_b32 v29, a228
  v_mfma_f32_16x16x32_bf16 v[200:203], a[192:195], v[80:83], v[52:55]
  ds_read_b128 a[212:215], v9 offset:4096
  v_accvgpr_read_b32 v30, a232
  v_mfma_f32_16x16x32_bf16 v[200:203], a[196:199], v[84:87], v[200:203]
  v_cvt_pk_bf16_f32 v177, v178, v179
  v_accvgpr_read_b32 v31, a236
  v_mfma_f32_16x16x32_bf16 v[200:203], a[200:203], v[88:91], v[200:203]
  buffer_load_dwordx4 v6, s[20:23], s83 offen offset:3072 nt lds
  v_mfma_f32_16x16x32_bf16 v[200:203], a[204:207], v[92:95], v[200:203]
  ds_read_b128 a[216:219], v10 offset:4096
  v_rcp_f32 v28, v28
  v_rcp_f32 v29, v29
  v_rcp_f32 v30, v30
  v_mfma_f32_16x16x32_bf16 v[208:211], a[192:195], v[96:99], v[56:59]
  v_max_f32 v44, v192, v193
  v_rcp_f32 v31, v31
  v_mfma_f32_16x16x32_bf16 v[208:211], a[196:199], v[100:103], v[208:211]
  v_mfma_f32_16x16x32_bf16 v[208:211], a[200:203], v[104:107], v[208:211]
  ds_read_b128 a[220:223], v11 offset:4096
  v_max_f32 v45, v194, v195
  v_mfma_f32_16x16x32_bf16 v[208:211], a[204:207], v[108:111], v[208:211]
  v_exp_f32 v182, v182
  v_accvgpr_read_b32 v36, a0
  v_accvgpr_read_b32 v37, a1
  v_accvgpr_read_b32 v38, a2
  v_accvgpr_read_b32 v39, a3
  v_mul_f32 v36, v36, v28
  v_mul_f32 v37, v37, v28
  v_mul_f32 v38, v38, v28
  v_mul_f32 v39, v39, v28
  v_cvt_pk_bf16_f32 v36, v36, v37
  v_cvt_pk_bf16_f32 v37, v38, v39
  v_mfma_f32_16x16x32_bf16 v[216:219], a[192:195], v[112:115], v[60:63]
  v_max3_f32 v44, v44, v200, v201
  v_accvgpr_read_b32 v40, a4
  v_mfma_f32_16x16x32_bf16 v[216:219], a[196:199], v[116:119], v[216:219]
  v_mfma_f32_16x16x32_bf16 v[216:219], a[200:203], v[120:123], v[216:219]
  v_max3_f32 v45, v45, v202, v203
  v_exp_f32 v183, v183
  v_mfma_f32_16x16x32_bf16 v[216:219], a[204:207], v[124:127], v[216:219]
  v_accvgpr_read_b32 v41, a5
  v_accvgpr_read_b32 v42, a6
  v_accvgpr_read_b32 v43, a7
  s_waitcnt lgkmcnt(0)
  v_mfma_f32_16x16x32_bf16 v[196:199], a[208:211], v[64:67], v[20:23]
  ds_write_b64 v32, v[36:37] offset:0
  v_mfma_f32_16x16x32_bf16 v[196:199], a[212:215], v[68:71], v[196:199]
  ds_read_b128 a[192:195], v8 offset:8192
  v_max3_f32 v44, v44, v208, v209
  v_mfma_f32_16x16x32_bf16 v[196:199], a[216:219], v[72:75], v[196:199]
  v_max3_f32 v45, v45, v210, v211
  v_cvt_pk_bf16_f32 v178, v180, v181
  v_mfma_f32_16x16x32_bf16 v[196:199], a[220:223], v[76:79], v[196:199]
  v_exp_f32 v152, v152
  v_mul_f32 v40, v40, v28
  v_mul_f32 v41, v41, v28
  v_mul_f32 v42, v42, v28
  v_mul_f32 v43, v43, v28
  v_cvt_pk_bf16_f32 v40, v40, v41
  v_cvt_pk_bf16_f32 v41, v42, v43
  v_accvgpr_read_b32 v36, a8
  v_accvgpr_read_b32 v37, a9
  v_accvgpr_read_b32 v38, a10
  v_accvgpr_read_b32 v39, a11
  v_mfma_f32_16x16x32_bf16 v[204:207], a[208:211], v[80:83], v[52:55]
  ds_read_b128 a[196:199], v9 offset:8192
  ds_write_b64 v33, v[40:41] offset:0
  v_mfma_f32_16x16x32_bf16 v[204:207], a[212:215], v[84:87], v[204:207]
  v_mul_f32 v36, v36, v28
  v_mul_f32 v37, v37, v28
  v_mfma_f32_16x16x32_bf16 v[204:207], a[216:219], v[88:91], v[204:207]
  v_mfma_f32_16x16x32_bf16 v[204:207], a[220:223], v[92:95], v[204:207]
  ds_read_b128 a[200:203], v10 offset:8192
  v_exp_f32 v153, v153
  v_mul_f32 v38, v38, v28
  v_mul_f32 v39, v39, v28
  v_cvt_pk_bf16_f32 v36, v36, v37
  v_cvt_pk_bf16_f32 v37, v38, v39
  v_accvgpr_read_b32 v40, a12
  v_accvgpr_read_b32 v41, a13
  v_accvgpr_read_b32 v42, a14
  v_accvgpr_read_b32 v43, a15
  v_mfma_f32_16x16x32_bf16 v[212:215], a[208:211], v[96:99], v[56:59]
  ds_write_b64 v34, v[36:37] offset:0
  v_mfma_f32_16x16x32_bf16 v[212:215], a[212:215], v[100:103], v[212:215]
  v_cvt_pk_bf16_f32 v179, v182, v183
  v_max3_f32 v44, v44, v216, v217
  v_mfma_f32_16x16x32_bf16 v[212:215], a[216:219], v[104:107], v[212:215]
  ds_read_b128 a[204:207], v11 offset:8192
  v_mfma_f32_16x16x32_bf16 v[212:215], a[220:223], v[108:111], v[212:215]
  v_exp_f32 v154, v154
  v_mul_f32 v40, v40, v28
  v_mul_f32 v41, v41, v28
  v_mul_f32 v42, v42, v28
  v_mul_f32 v43, v43, v28
  v_cvt_pk_bf16_f32 v40, v40, v41
  v_cvt_pk_bf16_f32 v41, v42, v43
  v_accvgpr_read_b32 v36, a16
  v_accvgpr_read_b32 v37, a17
  v_accvgpr_read_b32 v38, a18
  v_accvgpr_read_b32 v39, a19
  v_mfma_f32_16x16x32_bf16 v[220:223], a[208:211], v[112:115], v[60:63]
  ds_write_b64 v35, v[40:41] offset:0
  v_mfma_f32_16x16x32_bf16 v[220:223], a[212:215], v[116:119], v[220:223]
  v_mfma_f32_16x16x32_bf16 v[220:223], a[216:219], v[120:123], v[220:223]
  v_max3_f32 v45, v45, v218, v219
  v_max3_f32 v44, v44, v196, v197
  v_mfma_f32_16x16x32_bf16 v[220:223], a[220:223], v[124:127], v[220:223]
  v_exp_f32 v155, v155
  v_mul_f32 v36, v36, v28
  v_mul_f32 v37, v37, v28
  v_mul_f32 v38, v38, v28
  v_mul_f32 v39, v39, v28
  v_cvt_pk_bf16_f32 v36, v36, v37
  v_cvt_pk_bf16_f32 v37, v38, v39
  v_accvgpr_read_b32 v40, a20
  v_accvgpr_read_b32 v41, a21
  v_accvgpr_read_b32 v42, a22
  v_accvgpr_read_b32 v43, a23
  s_waitcnt lgkmcnt(1)
  v_mfma_f32_16x16x32_bf16 v[224:227], a[192:195], v[64:67], v[20:23]
  ds_write_b64 v32, v[36:37] offset:128
  v_mfma_f32_16x16x32_bf16 v[224:227], a[196:199], v[68:71], v[224:227]
  ds_read_b128 a[208:211], v8 offset:12288
  v_mfma_f32_16x16x32_bf16 v[224:227], a[200:203], v[72:75], v[224:227]
  v_max3_f32 v45, v45, v198, v199
  v_max3_f32 v44, v44, v204, v205
  v_mfma_f32_16x16x32_bf16 v[224:227], a[204:207], v[76:79], v[224:227]
  v_cvt_pk_bf16_f32 v152, v152, v153
  v_max3_f32 v45, v45, v206, v207
  v_mul_f32 v40, v40, v28
  v_mul_f32 v41, v41, v28
  v_mul_f32 v42, v42, v28
  v_mul_f32 v43, v43, v28
  v_cvt_pk_bf16_f32 v40, v40, v41
  v_cvt_pk_bf16_f32 v41, v42, v43
  v_accvgpr_read_b32 v36, a24
  v_accvgpr_read_b32 v37, a25
  v_accvgpr_read_b32 v38, a26
  v_accvgpr_read_b32 v39, a27
  v_mfma_f32_16x16x32_bf16 v[232:235], a[192:195], v[80:83], v[52:55]
  ds_read_b128 a[212:215], v9 offset:12288
  ds_write_b64 v33, v[40:41] offset:128
  v_mfma_f32_16x16x32_bf16 v[232:235], a[196:199], v[84:87], v[232:235]
  v_exp_f32 v156, v156
  v_mfma_f32_16x16x32_bf16 v[232:235], a[200:203], v[88:91], v[232:235]
  v_max3_f32 v44, v44, v212, v213
  v_mul_f32 v36, v36, v28
  v_mfma_f32_16x16x32_bf16 v[232:235], a[204:207], v[92:95], v[232:235]
  ds_read_b128 a[216:219], v10 offset:12288
  v_mul_f32 v37, v37, v28
  v_mul_f32 v38, v38, v28
  v_mul_f32 v39, v39, v28
  v_cvt_pk_bf16_f32 v36, v36, v37
  v_cvt_pk_bf16_f32 v37, v38, v39
  v_accvgpr_read_b32 v40, a28
  v_accvgpr_read_b32 v41, a29
  v_mfma_f32_16x16x32_bf16 v[240:243], a[192:195], v[96:99], v[56:59]
  v_mfma_f32_16x16x32_bf16 v[240:243], a[196:199], v[100:103], v[240:243]
  v_exp_f32 v157, v157
  v_mfma_f32_16x16x32_bf16 v[240:243], a[200:203], v[104:107], v[240:243]
  ds_read_b128 a[220:223], v11 offset:12288
  v_mfma_f32_16x16x32_bf16 v[240:243], a[204:207], v[108:111], v[240:243]
  v_cvt_pk_bf16_f32 v153, v154, v155
  v_max3_f32 v45, v45, v214, v215
  v_accvgpr_read_b32 v42, a30
  v_accvgpr_read_b32 v43, a31
  v_mfma_f32_16x16x32_bf16 v[248:251], a[192:195], v[112:115], v[60:63]
  s_waitcnt vmcnt(8)
  s_barrier
  ds_write_b64 v34, v[36:37] offset:128
  v_mfma_f32_16x16x32_bf16 v[248:251], a[196:199], v[116:119], v[248:251]
  s_add_u32 m0, s44, 32768
  v_mul_f32 v40, v40, v28
  v_mfma_f32_16x16x32_bf16 v[248:251], a[200:203], v[120:123], v[248:251]
  v_mfma_f32_16x16x32_bf16 v[248:251], a[204:207], v[124:127], v[248:251]
  v_exp_f32 v158, v158
  v_mul_f32 v41, v41, v28
  v_mul_f32 v42, v42, v28
  v_mul_f32 v43, v43, v28
  v_cvt_pk_bf16_f32 v40, v40, v41
  v_cvt_pk_bf16_f32 v41, v42, v43
  v_accvgpr_read_b32 v36, a32
  v_accvgpr_read_b32 v37, a33
  v_accvgpr_read_b32 v38, a34
  v_accvgpr_read_b32 v39, a35
  s_waitcnt lgkmcnt(1)
  v_mfma_f32_16x16x32_bf16 v[228:231], a[208:211], v[64:67], v[20:23]
  buffer_load_dwordx4 v1, s[16:19], s85 offen offset:0 nt lds
  ds_write_b64 v35, v[40:41] offset:128
  v_mfma_f32_16x16x32_bf16 v[228:231], a[212:215], v[68:71], v[228:231]
  ds_read_b64_tr_b16 a[192:193], v12 offset:32768
  ds_read_b64_tr_b16 a[194:195], v12 offset:36864
  v_mfma_f32_16x16x32_bf16 v[228:231], a[216:219], v[72:75], v[228:231]
  v_mul_f32 v36, v36, v29
  v_mul_f32 v37, v37, v29
  v_mfma_f32_16x16x32_bf16 v[228:231], a[220:223], v[76:79], v[228:231]
  v_mul_f32 v38, v38, v29
  v_mul_f32 v39, v39, v29
  v_cvt_pk_bf16_f32 v36, v36, v37
  v_cvt_pk_bf16_f32 v37, v38, v39
  v_accvgpr_read_b32 v40, a36
  v_accvgpr_read_b32 v41, a37
  v_accvgpr_read_b32 v42, a38
  v_accvgpr_read_b32 v43, a39
  v_mfma_f32_16x16x32_bf16 v[236:239], a[208:211], v[80:83], v[52:55]
  ds_read_b64_tr_b16 a[196:197], v12 offset:40960
  ds_read_b64_tr_b16 a[198:199], v12 offset:45056
  ds_write_b64 v32, v[36:37] offset:4096
  v_mfma_f32_16x16x32_bf16 v[236:239], a[212:215], v[84:87], v[236:239]
  v_mfma_f32_16x16x32_bf16 v[236:239], a[216:219], v[88:91], v[236:239]
  buffer_load_dwordx4 v2, s[16:19], s85 offen offset:1024 nt lds
  v_mfma_f32_16x16x32_bf16 v[236:239], a[220:223], v[92:95], v[236:239]
  ds_read_b64_tr_b16 a[200:201], v13 offset:32768
  ds_read_b64_tr_b16 a[202:203], v13 offset:36864
  v_mul_f32 v40, v40, v29
  v_mul_f32 v41, v41, v29
  v_mul_f32 v42, v42, v29
  v_mul_f32 v43, v43, v29
  v_cvt_pk_bf16_f32 v40, v40, v41
  v_cvt_pk_bf16_f32 v41, v42, v43
  v_accvgpr_read_b32 v36, a40
  v_accvgpr_read_b32 v37, a41
  v_accvgpr_read_b32 v38, a42
  v_accvgpr_read_b32 v39, a43
  v_mfma_f32_16x16x32_bf16 v[244:247], a[208:211], v[96:99], v[56:59]
  ds_write_b64 v33, v[40:41] offset:4096
  v_mfma_f32_16x16x32_bf16 v[244:247], a[212:215], v[100:103], v[244:247]
  v_exp_f32 v159, v159
  v_mfma_f32_16x16x32_bf16 v[244:247], a[216:219], v[104:107], v[244:247]
  ds_read_b64_tr_b16 a[204:205], v13 offset:40960
  ds_read_b64_tr_b16 a[206:207], v13 offset:45056
  v_mfma_f32_16x16x32_bf16 v[244:247], a[220:223], v[108:111], v[244:247]
  v_mul_f32 v36, v36, v29
  v_mul_f32 v37, v37, v29
  v_mul_f32 v38, v38, v29
  v_mul_f32 v39, v39, v29
  v_cvt_pk_bf16_f32 v36, v36, v37
  v_cvt_pk_bf16_f32 v37, v38, v39
  v_accvgpr_read_b32 v40, a44
  v_accvgpr_read_b32 v41, a45
  v_accvgpr_read_b32 v42, a46
  v_accvgpr_read_b32 v43, a47
  v_mfma_f32_16x16x32_bf16 v[252:255], a[208:211], v[112:115], v[60:63]
  buffer_load_dwordx4 v3, s[16:19], s85 offen offset:2048 nt lds
  ds_write_b64 v34, v[36:37] offset:4096
  v_mfma_f32_16x16x32_bf16 v[252:255], a[212:215], v[116:119], v[252:255]
  v_cvt_pk_bf16_f32 v154, v156, v157
  v_mul_f32 v40, v40, v29
  v_mfma_f32_16x16x32_bf16 v[252:255], a[216:219], v[120:123], v[252:255]
  v_mfma_f32_16x16x32_bf16 v[252:255], a[220:223], v[124:127], v[252:255]
  v_exp_f32 v184, v184
  v_mul_f32 v41, v41, v29
  v_mul_f32 v42, v42, v29
  v_mul_f32 v43, v43, v29
  v_cvt_pk_bf16_f32 v40, v40, v41
  v_cvt_pk_bf16_f32 v41, v42, v43
  s_waitcnt lgkmcnt(1)
  ds_write_b64 v35, v[40:41] offset:4096
  v_mfma_f32_16x16x32_bf16 a[128:131], a[192:195], v[128:131], 0
  buffer_load_dwordx4 v4, s[16:19], s85 offen offset:3072 nt lds
  v_mfma_f32_16x16x32_bf16 a[128:131], a[196:199], v[160:163], a[128:131]
  ds_read_b64_tr_b16 a[208:209], v14 offset:32768
  ds_read_b64_tr_b16 a[210:211], v14 offset:36864
  v_mfma_f32_16x16x32_bf16 a[160:163], a[192:195], v[136:139], 0
  s_add_u32 m0, s44, 65536
  v_mfma_f32_16x16x32_bf16 a[160:163], a[196:199], v[168:171], a[160:163]
  v_exp_f32 v185, v185
  v_max3_f32 v44, v44, v220, v221
  v_mfma_f32_16x16x32_bf16 a[244:247], a[192:195], v[144:147], 0
  ds_read_b64_tr_b16 a[212:213], v14 offset:40960
  ds_read_b64_tr_b16 a[214:215], v14 offset:45056
  v_mfma_f32_16x16x32_bf16 a[244:247], a[196:199], v[176:179], a[244:247]
  v_cvt_pk_bf16_f32 v155, v158, v159
  v_max3_f32 v45, v45, v222, v223
  s_nop 0
  v_mfma_f32_16x16x32_bf16 a[20:23], a[192:195], v[152:155], 0
  buffer_load_dwordx4 v5, s[20:23], s84 offen offset:0 nt lds
  v_exp_f32 v186, v186
  v_exp_f32 v187, v187
  v_cvt_pk_bf16_f32 v184, v184, v185
  v_exp_f32 v188, v188
  v_exp_f32 v189, v189
  v_cvt_pk_bf16_f32 v185, v186, v187
  v_exp_f32 v190, v190
  v_exp_f32 v191, v191
  v_cvt_pk_bf16_f32 v186, v188, v189
  v_cvt_pk_bf16_f32 v187, v190, v191
  s_nop 1
  v_mfma_f32_16x16x32_bf16 a[20:23], a[196:199], v[184:187], a[20:23]
  ds_read_b64_tr_b16 a[216:217], v15 offset:32768
  ds_read_b64_tr_b16 a[218:219], v15 offset:36864
  v_max3_f32 v44, v44, v224, v225
  v_mfma_f32_16x16x32_bf16 a[132:135], a[200:203], v[128:131], 0
  v_mfma_f32_16x16x32_bf16 a[132:135], a[204:207], v[160:163], a[132:135]
  v_max3_f32 v45, v45, v226, v227
  v_max3_f32 v44, v44, v232, v233
  v_max3_f32 v45, v45, v234, v235
  v_max3_f32 v44, v44, v240, v241
  v_max3_f32 v45, v45, v242, v243
  v_mfma_f32_16x16x32_bf16 a[224:227], a[240:243], v[128:131], 0
  v_max3_f32 v44, v44, v248, v249
  v_max3_f32 v45, v45, v250, v251
  v_mfma_f32_16x16x32_bf16 a[224:227], a[240:243], v[160:163], a[224:227]
  v_max3_f32 v44, v44, v228, v229
  v_max3_f32 v45, v45, v230, v231
  v_mfma_f32_16x16x32_bf16 a[164:167], a[200:203], v[136:139], 0
  ds_read_b64_tr_b16 a[220:221], v15 offset:40960
  ds_read_b64_tr_b16 a[222:223], v15 offset:45056
  v_mfma_f32_16x16x32_bf16 a[164:167], a[204:207], v[168:171], a[164:167]
  v_max3_f32 v44, v44, v236, v237
  v_max3_f32 v45, v45, v238, v239
  v_max3_f32 v44, v44, v244, v245
  v_mfma_f32_16x16x32_bf16 a[248:251], a[200:203], v[144:147], 0
  v_mfma_f32_16x16x32_bf16 a[248:251], a[204:207], v[176:179], a[248:251]
  v_max3_f32 v45, v45, v246, v247
  v_max3_f32 v44, v44, v252, v253
  v_max3_f32 v45, v45, v254, v255
  v_max_f32 v44, v44, v45
  v_mfma_f32_16x16x32_bf16 a[24:27], a[200:203], v[152:155], 0
  v_mfma_f32_16x16x32_bf16 a[24:27], a[204:207], v[184:187], a[24:27]
  v_cmp_lt_f32 vcc, s48, v44
  s_waitcnt lgkmcnt(0)
  v_mfma_f32_16x16x32_bf16 a[136:139], a[208:211], v[128:131], 0
  v_mfma_f32_16x16x32_bf16 a[136:139], a[212:215], v[160:163], a[136:139]
  ds_read_b64_tr_b16 a[192:193], v16 offset:32768
  ds_read_b64_tr_b16 a[194:195], v16 offset:36864
  s_cbranch_vccnz LS_t8
LS_b8:
  v_exp_f32 v192, v192
  v_exp_f32 v193, v193
  v_mfma_f32_16x16x32_bf16 a[168:171], a[208:211], v[136:139], 0
  v_mfma_f32_16x16x32_bf16 a[168:171], a[212:215], v[168:171], a[168:171]
  v_exp_f32 v194, v194
  v_exp_f32 v195, v195
  v_cvt_pk_bf16_f32 v192, v192, v193
  v_mfma_f32_16x16x32_bf16 a[252:255], a[208:211], v[144:147], 0
  ds_read_b64_tr_b16 a[196:197], v16 offset:40960
  ds_read_b64_tr_b16 a[198:199], v16 offset:45056
  v_mfma_f32_16x16x32_bf16 a[252:255], a[212:215], v[176:179], a[252:255]
  v_exp_f32 v196, v196
  v_mfma_f32_16x16x32_bf16 a[28:31], a[208:211], v[152:155], 0
  v_mfma_f32_16x16x32_bf16 a[28:31], a[212:215], v[184:187], a[28:31]
  ds_read_b64_tr_b16 a[200:201], v17 offset:32768
  ds_read_b64_tr_b16 a[202:203], v17 offset:36864
  v_exp_f32 v197, v197
  v_cvt_pk_bf16_f32 v193, v194, v195
  v_mfma_f32_16x16x32_bf16 a[140:143], a[216:219], v[128:131], 0
  v_mfma_f32_16x16x32_bf16 a[140:143], a[220:223], v[160:163], a[140:143]
  v_exp_f32 v198, v198
  v_exp_f32 v199, v199
  v_mfma_f32_16x16x32_bf16 a[228:231], a[240:243], v[136:139], 0
  v_cvt_pk_bf16_f32 v194, v196, v197
  v_exp_f32 v224, v224
  v_mfma_f32_16x16x32_bf16 a[228:231], a[240:243], v[168:171], a[228:231]
  v_exp_f32 v225, v225
  v_mfma_f32_16x16x32_bf16 a[172:175], a[216:219], v[136:139], 0
  ds_read_b64_tr_b16 a[204:205], v17 offset:40960
  ds_read_b64_tr_b16 a[206:207], v17 offset:45056
  v_mfma_f32_16x16x32_bf16 a[172:175], a[220:223], v[168:171], a[172:175]
  v_cvt_pk_bf16_f32 v195, v198, v199
  v_exp_f32 v226, v226
  v_mfma_f32_16x16x32_bf16 a[0:3], a[216:219], v[144:147], 0
  v_mfma_f32_16x16x32_bf16 a[0:3], a[220:223], v[176:179], a[0:3]
  v_exp_f32 v227, v227
  v_cvt_pk_bf16_f32 v224, v224, v225
  v_mfma_f32_16x16x32_bf16 a[32:35], a[216:219], v[152:155], 0
  v_exp_f32 v228, v228
  v_mfma_f32_16x16x32_bf16 a[32:35], a[220:223], v[184:187], a[32:35]
  v_exp_f32 v229, v229
  s_waitcnt lgkmcnt(0)
  v_mfma_f32_16x16x32_bf16 a[144:147], a[192:195], v[128:131], 0
  v_mfma_f32_16x16x32_bf16 a[144:147], a[196:199], v[160:163], a[144:147]
  ds_read_b64_tr_b16 a[208:209], v18 offset:32768
  ds_read_b64_tr_b16 a[210:211], v18 offset:36864
  v_cvt_pk_bf16_f32 v225, v226, v227
  v_exp_f32 v230, v230
  v_mfma_f32_16x16x32_bf16 a[176:179], a[192:195], v[136:139], 0
  v_mfma_f32_16x16x32_bf16 a[176:179], a[196:199], v[168:171], a[176:179]
  v_exp_f32 v231, v231
  v_cvt_pk_bf16_f32 v226, v228, v229
  v_exp_f32 v200, v200
  v_mfma_f32_16x16x32_bf16 a[4:7], a[192:195], v[144:147], 0
  ds_read_b64_tr_b16 a[212:213], v18 offset:40960
  ds_read_b64_tr_b16 a[214:215], v18 offset:45056
  v_mfma_f32_16x16x32_bf16 a[4:7], a[196:199], v[176:179], a[4:7]
  v_exp_f32 v201, v201
  v_mfma_f32_16x16x32_bf16 a[36:39], a[192:195], v[152:155], 0
  v_mfma_f32_16x16x32_bf16 a[36:39], a[196:199], v[184:187], a[36:39]
  ds_read_b64_tr_b16 a[216:217], v19 offset:32768
  ds_read_b64_tr_b16 a[218:219], v19 offset:36864
  v_cvt_pk_bf16_f32 v227, v230, v231
  v_exp_f32 v202, v202
  v_mfma_f32_16x16x32_bf16 a[148:151], a[200:203], v[128:131], 0
  v_exp_f32 v203, v203
  v_mfma_f32_16x16x32_bf16 a[148:151], a[204:207], v[160:163], a[148:151]
  v_cvt_pk_bf16_f32 v200, v200, v201
  v_exp_f32 v204, v204
  v_mfma_f32_16x16x32_bf16 a[232:235], a[240:243], v[144:147], 0
  v_exp_f32 v205, v205
  v_mfma_f32_16x16x32_bf16 a[232:235], a[240:243], v[176:179], a[232:235]
  v_cvt_pk_bf16_f32 v201, v202, v203
  v_exp_f32 v206, v206
  v_mfma_f32_16x16x32_bf16 a[180:183], a[200:203], v[136:139], 0
  ds_read_b64_tr_b16 a[220:221], v19 offset:40960
  ds_read_b64_tr_b16 a[222:223], v19 offset:45056
  v_mfma_f32_16x16x32_bf16 a[180:183], a[204:207], v[168:171], a[180:183]
  v_exp_f32 v207, v207
  v_mfma_f32_16x16x32_bf16 a[8:11], a[200:203], v[144:147], 0
  s_waitcnt vmcnt(9)
  s_barrier
  v_mfma_f32_16x16x32_bf16 a[8:11], a[204:207], v[176:179], a[8:11]
  v_cvt_pk_bf16_f32 v202, v204, v205
  v_exp_f32 v232, v232
  v_mfma_f32_16x16x32_bf16 a[40:43], a[200:203], v[152:155], 0
  v_mfma_f32_16x16x32_bf16 a[40:43], a[204:207], v[184:187], a[40:43]
  v_exp_f32 v233, v233
  s_waitcnt lgkmcnt(0)
  v_mfma_f32_16x16x32_bf16 a[152:155], a[208:211], v[128:131], 0
  buffer_load_dwordx4 v6, s[20:23], s84 offen offset:1024 nt lds
  v_mfma_f32_16x16x32_bf16 a[152:155], a[212:215], v[160:163], a[152:155]
  ds_read_b128 a[192:195], v8 offset:16384
  v_cvt_pk_bf16_f32 v203, v206, v207
  v_mfma_f32_16x16x32_bf16 a[184:187], a[208:211], v[136:139], 0
  v_exp_f32 v234, v234
  v_mfma_f32_16x16x32_bf16 a[184:187], a[212:215], v[168:171], a[184:187]
  v_exp_f32 v235, v235
  v_cvt_pk_bf16_f32 v232, v232, v233
  v_mfma_f32_16x16x32_bf16 a[12:15], a[208:211], v[144:147], 0
  ds_read_b128 a[196:199], v9 offset:16384
  v_mfma_f32_16x16x32_bf16 a[12:15], a[212:215], v[176:179], a[12:15]
  v_exp_f32 v236, v236
  v_exp_f32 v237, v237
  v_mfma_f32_16x16x32_bf16 a[44:47], a[208:211], v[152:155], 0
  buffer_load_dwordx4 v5, s[20:23], s84 offen offset:2048 nt lds
  v_mfma_f32_16x16x32_bf16 a[44:47], a[212:215], v[184:187], a[44:47]
  ds_read_b128 a[200:203], v10 offset:16384
  v_cvt_pk_bf16_f32 v233, v234, v235
  v_mfma_f32_16x16x32_bf16 a[156:159], a[216:219], v[128:131], 0
  v_mfma_f32_16x16x32_bf16 a[156:159], a[220:223], v[160:163], a[156:159]
  v_exp_f32 v238, v238
  v_exp_f32 v239, v239
  v_mfma_f32_16x16x32_bf16 a[236:239], a[240:243], v[152:155], 0
  v_cvt_pk_bf16_f32 v234, v236, v237
  v_exp_f32 v208, v208
  v_mfma_f32_16x16x32_bf16 a[236:239], a[240:243], v[184:187], a[236:239]
  v_exp_f32 v209, v209
  v_mfma_f32_16x16x32_bf16 a[188:191], a[216:219], v[136:139], 0
  ds_read_b128 a[204:207], v11 offset:16384
  v_mfma_f32_16x16x32_bf16 a[188:191], a[220:223], v[168:171], a[188:191]
  v_cvt_pk_bf16_f32 v235, v238, v239
  v_exp_f32 v210, v210
  v_mfma_f32_16x16x32_bf16 a[16:19], a[216:219], v[144:147], 0
  buffer_load_dwordx4 v6, s[20:23], s84 offen offset:3072 nt lds
  v_mfma_f32_16x16x32_bf16 a[16:19], a[220:223], v[176:179], a[16:19]
  s_add_u32 m0, s44, 0
  v_exp_f32 v211, v211
  v_mfma_f32_16x16x32_bf16 v[48:51], a[216:219], v[152:155], 0
  v_mfma_f32_16x16x32_bf16 v[48:51], a[220:223], v[184:187], v[48:51]
  v_cvt_pk_bf16_f32 v208, v208, v209
  v_exp_f32 v212, v212
  s_waitcnt lgkmcnt(0)
  s_cbranch_vccnz LS_t22
LS_b22:
  v_mfma_f32_16x16x32_bf16 v[128:131], a[192:195], v[64:67], v[20:23]
  buffer_load_dwordx4 v1, s[16:19], s86 offen offset:0 nt lds
  v_mfma_f32_16x16x32_bf16 v[128:131], a[196:199], v[68:71], v[128:131]
  v_mfma_f32_16x16x32_bf16 v[128:131], a[200:203], v[72:75], v[128:131]
  v_mfma_f32_16x16x32_bf16 v[128:131], a[204:207], v[76:79], v[128:131]
  ds_read_b128 a[208:211], v8 offset:20480
  ds_read_b128 a[212:215], v9 offset:20480
  v_exp_f32 v213, v213
  v_cvt_pk_bf16_f32 v209, v210, v211
  v_exp_f32 v214, v214
  v_accvgpr_read_b32 v36, a48
  v_accvgpr_read_b32 v37, a49
  v_accvgpr_read_b32 v38, a50
  v_mfma_f32_16x16x32_bf16 v[136:139], a[192:195], v[80:83], v[52:55]
  v_mfma_f32_16x16x32_bf16 v[136:139], a[196:199], v[84:87], v[136:139]
  v_mfma_f32_16x16x32_bf16 v[136:139], a[200:203], v[88:91], v[136:139]
  buffer_load_dwordx4 v2, s[16:19], s86 offen offset:1024 nt lds
  v_mfma_f32_16x16x32_bf16 v[136:139], a[204:207], v[92:95], v[136:139]
  ds_read_b128 a[216:219], v10 offset:20480
  v_exp_f32 v215, v215
  v_max_f32 v44, v128, v129
  v_cvt_pk_bf16_f32 v210, v212, v213
  v_accvgpr_read_b32 v39, a51
  v_mul_f32 v36, v36, v29
  v_mul_f32 v37, v37, v29
  v_mfma_f32_16x16x32_bf16 v[144:147], a[192:195], v[96:99], v[56:59]
  v_mfma_f32_16x16x32_bf16 v[144:147], a[196:199], v[100:103], v[144:147]
  v_mfma_f32_16x16x32_bf16 v[144:147], a[200:203], v[104:107], v[144:147]
  v_mfma_f32_16x16x32_bf16 v[144:147], a[204:207], v[108:111], v[144:147]
  ds_read_b128 a[220:223], v11 offset:20480
  v_exp_f32 v240, v240
  v_max_f32 v45, v130, v131
  v_exp_f32 v241, v241
  v_max3_f32 v44, v44, v136, v137
  v_cvt_pk_bf16_f32 v211, v214, v215
  v_mul_f32 v38, v38, v29
  v_mul_f32 v39, v39, v29
  v_mfma_f32_16x16x32_bf16 v[152:155], a[192:195], v[112:115], v[60:63]
  v_mfma_f32_16x16x32_bf16 v[152:155], a[196:199], v[116:119], v[152:155]
  v_mfma_f32_16x16x32_bf16 v[152:155], a[200:203], v[120:123], v[152:155]
  v_mfma_f32_16x16x32_bf16 v[152:155], a[204:207], v[124:127], v[152:155]
  v_exp_f32 v242, v242
  v_max3_f32 v45, v45, v138, v139
  v_exp_f32 v243, v243
  v_max3_f32 v44, v44, v144, v145
  v_cvt_pk_bf16_f32 v240, v240, v241
  v_max3_f32 v45, v45, v146, v147
  v_cvt_pk_bf16_f32 v36, v36, v37
  v_cvt_pk_bf16_f32 v37, v38, v39
  v_accvgpr_read_b32 v40, a52
  s_waitcnt lgkmcnt(0)
  v_mfma_f32_16x16x32_bf16 v[132:135], a[208:211], v[64:67], v[20:23]
  v_mfma_f32_16x16x32_bf16 v[132:135], a[212:215], v[68:71], v[132:135]
  v_mfma_f32_16x16x32_bf16 v[132:135], a[216:219], v[72:75], v[132:135]
  v_mfma_f32_16x16x32_bf16 v[132:135], a[220:223], v[76:79], v[132:135]
  ds_read_b128 a[192:195], v8 offset:24576
  ds_read_b128 a[196:199], v9 offset:24576
  v_exp_f32 v244, v244
  v_max3_f32 v44, v44, v152, v153
  v_exp_f32 v245, v245
  v_max3_f32 v45, v45, v154, v155
  v_accvgpr_read_b32 v41, a53
  v_accvgpr_read_b32 v42, a54
  v_mfma_f32_16x16x32_bf16 v[140:143], a[208:211], v[80:83], v[52:55]
  v_mfma_f32_16x16x32_bf16 v[140:143], a[212:215], v[84:87], v[140:143]
  v_mfma_f32_16x16x32_bf16 v[140:143], a[216:219], v[88:91], v[140:143]
  v_mfma_f32_16x16x32_bf16 v[140:143], a[220:223], v[92:95], v[140:143]
  ds_read_b128 a[200:203], v10 offset:24576
  v_cvt_pk_bf16_f32 v241, v242, v243
  v_max3_f32 v44, v44, v132, v133
  v_exp_f32 v246, v246
  v_max3_f32 v45, v45, v134, v135
  v_exp_f32 v247, v247
  v_accvgpr_read_b32 v43, a55
  v_mfma_f32_16x16x32_bf16 v[148:151], a[208:211], v[96:99], v[56:59]
  ds_write_b64 v32, v[36:37] offset:4224
  v_mfma_f32_16x16x32_bf16 v[148:151], a[212:215], v[100:103], v[148:151]
  v_mfma_f32_16x16x32_bf16 v[148:151], a[216:219], v[104:107], v[148:151]
  v_mfma_f32_16x16x32_bf16 v[148:151], a[220:223], v[108:111], v[148:151]
  ds_read_b128 a[204:207], v11 offset:24576
  v_cvt_pk_bf16_f32 v242, v244, v245
  v_max3_f32 v44, v44, v140, v141
  v_exp_f32 v216, v216
  v_max3_f32 v45, v45, v142, v143
  v_exp_f32 v217, v217
  v_mul_f32 v40, v40, v29
  v_mfma_f32_16x16x32_bf16 v[156:159], a[208:211], v[112:115], v[60:63]
  v_mfma_f32_16x16x32_bf16 v[156:159], a[212:215], v[116:119], v[156:159]
  v_mfma_f32_16x16x32_bf16 v[156:159], a[216:219], v[120:123], v[156:159]
  v_mfma_f32_16x16x32_bf16 v[156:159], a[220:223], v[124:127], v[156:159]
  v_cvt_pk_bf16_f32 v243, v246, v247
  v_max3_f32 v44, v44, v148, v149
  v_exp_f32 v218, v218
  v_max3_f32 v45, v45, v150, v151
  v_exp_f32 v219, v219
  v_mul_f32 v41, v41, v29
  v_mul_f32 v42, v42, v29
  v_mul_f32 v43, v43, v29
  s_waitcnt lgkmcnt(0)
  v_mfma_f32_16x16x32_bf16 v[160:163], a[192:195], v[64:67], v[20:23]
  v_mfma_f32_16x16x32_bf16 v[160:163], a[196:199], v[68:71], v[160:163]
  v_mfma_f32_16x16x32_bf16 v[160:163], a[200:203], v[72:75], v[160:163]
  v_mfma_f32_16x16x32_bf16 v[160:163], a[204:207], v[76:79], v[160:163]
  ds_read_b128 a[208:211], v8 offset:28672
  ds_read_b128 a[212:215], v9 offset:28672
  v_cvt_pk_bf16_f32 v216, v216, v217
  v_max3_f32 v44, v44, v156, v157
  v_exp_f32 v220, v220
  v_max3_f32 v45, v45, v158, v159
  v_exp_f32 v221, v221
  v_cvt_pk_bf16_f32 v40, v40, v41
  v_cvt_pk_bf16_f32 v41, v42, v43
  v_mfma_f32_16x16x32_bf16 v[168:171], a[192:195], v[80:83], v[52:55]
  v_mfma_f32_16x16x32_bf16 v[168:171], a[196:199], v[84:87], v[168:171]
  v_mfma_f32_16x16x32_bf16 v[168:171], a[200:203], v[88:91], v[168:171]
  v_mfma_f32_16x16x32_bf16 v[168:171], a[204:207], v[92:95], v[168:171]
  ds_read_b128 a[216:219], v10 offset:28672
  v_cvt_pk_bf16_f32 v217, v218, v219
  v_max3_f32 v44, v44, v160, v161
  v_exp_f32 v222, v222
  v_max3_f32 v45, v45, v162, v163
  v_exp_f32 v223, v223
  v_accvgpr_read_b32 v36, a56
  v_accvgpr_read_b32 v37, a57
  v_mfma_f32_16x16x32_bf16 v[176:179], a[192:195], v[96:99], v[56:59]
  v_mfma_f32_16x16x32_bf16 v[176:179], a[196:199], v[100:103], v[176:179]
  v_mfma_f32_16x16x32_bf16 v[176:179], a[200:203], v[104:107], v[176:179]
  v_mfma_f32_16x16x32_bf16 v[176:179], a[204:207], v[108:111], v[176:179]
  ds_read_b128 a[220:223], v11 offset:28672
  v_cvt_pk_bf16_f32 v218, v220, v221
  v_max3_f32 v44, v44, v168, v169
  v_exp_f32 v248, v248
  v_max3_f32 v45, v45, v170, v171
  v_exp_f32 v249, v249
  v_accvgpr_read_b32 v38, a58
  v_accvgpr_read_b32 v39, a59
  v_mfma_f32_16x16x32_bf16 v[184:187], a[192:195], v[112:115], v[60:63]
  s_waitcnt vmcnt(10)
  s_barrier
  v_mfma_f32_16x16x32_bf16 v[184:187], a[196:199], v[116:119], v[184:187]
  v_mfma_f32_16x16x32_bf16 v[184:187], a[200:203], v[120:123], v[184:187]
  ds_write_b64 v33, v[40:41] offset:4224
  v_mfma_f32_16x16x32_bf16 v[184:187], a[204:207], v[124:127], v[184:187]
  v_cvt_pk_bf16_f32 v219, v222, v223
  v_max3_f32 v44, v44, v176, v177
  v_exp_f32 v250, v250
  v_max3_f32 v45, v45, v178, v179
  s_waitcnt lgkmcnt(1)
  v_mfma_f32_16x16x32_bf16 v[164:167], a[208:211], v[64:67], v[20:23]
  buffer_load_dwordx4 v3, s[16:19], s86 offen offset:2048 nt lds
  v_mfma_f32_16x16x32_bf16 v[164:167], a[212:215], v[68:71], v[164:167]
  v_mfma_f32_16x16x32_bf16 v[164:167], a[216:219], v[72:75], v[164:167]
  v_mfma_f32_16x16x32_bf16 v[164:167], a[220:223], v[76:79], v[164:167]
  ds_read_b64_tr_b16 a[192:193], v12 offset:0
  ds_read_b64_tr_b16 a[194:195], v12 offset:4096
  ds_read_b64_tr_b16 a[196:197], v12 offset:8192
  ds_read_b64_tr_b16 a[198:199], v12 offset:12288
  v_exp_f32 v251, v251
  v_mul_f32 v36, v36, v29
  v_mfma_f32_16x16x32_bf16 v[172:175], a[208:211], v[80:83], v[52:55]
  v_mfma_f32_16x16x32_bf16 v[172:175], a[212:215], v[84:87], v[172:175]
  v_mfma_f32_16x16x32_bf16 v[172:175], a[216:219], v[88:91], v[172:175]
  buffer_load_dwordx4 v4, s[16:19], s86 offen offset:3072 nt lds
  v_mfma_f32_16x16x32_bf16 v[172:175], a[220:223], v[92:95], v[172:175]
  ds_read_b64_tr_b16 a[200:201], v13 offset:0
  ds_read_b64_tr_b16 a[202:203], v13 offset:4096
  v_cvt_pk_bf16_f32 v248, v248, v249
  v_max3_f32 v44, v44, v184, v185
  v_exp_f32 v252, v252
  v_mul_f32 v37, v37, v29
  v_mul_f32 v38, v38, v29
  v_mfma_f32_16x16x32_bf16 v[180:183], a[208:211], v[96:99], v[56:59]
  s_add_u32 m0, s44, 81920
  v_mfma_f32_16x16x32_bf16 v[180:183], a[212:215], v[100:103], v[180:183]
  v_mfma_f32_16x16x32_bf16 v[180:183], a[216:219], v[104:107], v[180:183]
  v_mfma_f32_16x16x32_bf16 v[180:183], a[220:223], v[108:111], v[180:183]
  ds_read_b64_tr_b16 a[204:205], v13 offset:8192
  ds_read_b64_tr_b16 a[206:207], v13 offset:12288
  v_exp_f32 v253, v253
  v_max3_f32 v45, v45, v186, v187
  v_cvt_pk_bf16_f32 v249, v250, v251
  v_max3_f32 v44, v44, v164, v165
  v_mul_f32 v39, v39, v29
  v_cvt_pk_bf16_f32 v36, v36, v37
  v_mfma_f32_16x16x32_bf16 v[188:191], a[208:211], v[112:115], v[60:63]
  buffer_load_dwordx4 v5, s[20:23], s85 offen offset:0 nt lds
  v_mfma_f32_16x16x32_bf16 v[188:191], a[212:215], v[116:119], v[188:191]
  v_mfma_f32_16x16x32_bf16 v[188:191], a[216:219], v[120:123], v[188:191]
  v_mfma_f32_16x16x32_bf16 v[188:191], a[220:223], v[124:127], v[188:191]
  v_exp_f32 v254, v254
  v_max3_f32 v45, v45, v166, v167
  v_exp_f32 v255, v255
  v_cvt_pk_bf16_f32 v37, v38, v39
  v_accvgpr_read_b32 v40, a60
  v_accvgpr_read_b32 v41, a61
  s_waitcnt lgkmcnt(0)
  v_mfma_f32_16x16x32_bf16 a[128:131], a[192:195], v[192:195], a[128:131]
  buffer_load_dwordx4 v6, s[20:23], s85 offen offset:1024 nt lds
  v_mfma_f32_16x16x32_bf16 a[128:131], a[196:199], v[224:227], a[128:131]
  ds_read_b64_tr_b16 a[208:209], v14 offset:0
  ds_read_b64_tr_b16 a[210:211], v14 offset:4096
  v_accvgpr_read_b32 v42, a62
  v_mfma_f32_16x16x32_bf16 a[160:163], a[192:195], v[200:203], a[160:163]
  v_mfma_f32_16x16x32_bf16 a[160:163], a[196:199], v[232:235], a[160:163]
  ds_read_b64_tr_b16 a[212:213], v14 offset:8192
  ds_read_b64_tr_b16 a[214:215], v14 offset:12288
  v_cvt_pk_bf16_f32 v250, v252, v253
  v_max3_f32 v44, v44, v172, v173
  v_cvt_pk_bf16_f32 v251, v254, v255
  v_accvgpr_read_b32 v43, a63
  v_mfma_f32_16x16x32_bf16 a[244:247], a[192:195], v[208:211], a[244:247]
  v_mfma_f32_16x16x32_bf16 a[244:247], a[196:199], v[240:243], a[244:247]
  ds_read_b64_tr_b16 a[216:217], v15 offset:0
  ds_read_b64_tr_b16 a[218:219], v15 offset:4096
  v_max3_f32 v45, v45, v174, v175
  v_max3_f32 v44, v44, v180, v181
  v_mfma_f32_16x16x32_bf16 a[20:23], a[192:195], v[216:219], a[20:23]
  buffer_load_dwordx4 v5, s[20:23], s85 offen offset:2048 nt lds
  v_mfma_f32_16x16x32_bf16 a[20:23], a[196:199], v[248:251], a[20:23]
  ds_read_b64_tr_b16 a[220:221], v15 offset:8192
  ds_read_b64_tr_b16 a[222:223], v15 offset:12288
  v_mfma_f32_16x16x32_bf16 a[132:135], a[200:203], v[192:195], a[132:135]
  ds_write_b64 v34, v[36:37] offset:4224
  v_mfma_f32_16x16x32_bf16 a[132:135], a[204:207], v[224:227], a[132:135]
  v_max3_f32 v45, v45, v182, v183
  v_max3_f32 v44, v44, v188, v189
  v_max3_f32 v45, v45, v190, v191
  v_max_f32 v44, v44, v45
  v_mfma_f32_16x16x32_bf16 a[224:227], a[240:243], v[192:195], a[224:227]
  v_cmp_lt_f32 vcc, s48, v44
  v_mul_f32 v40, v40, v29
  v_mfma_f32_16x16x32_bf16 a[224:227], a[240:243], v[224:227], a[224:227]
  v_mul_f32 v41, v41, v29
  v_mul_f32 v42, v42, v29
  v_mfma_f32_16x16x32_bf16 a[164:167], a[200:203], v[200:203], a[164:167]
  v_mfma_f32_16x16x32_bf16 a[164:167], a[204:207], v[232:235], a[164:167]
  s_cbranch_vccnz LS_t9
LS_b9:
  v_exp_f32 v128, v128
  v_exp_f32 v129, v129
  v_exp_f32 v130, v130
  v_mfma_f32_16x16x32_bf16 a[248:251], a[200:203], v[208:211], a[248:251]
  v_mfma_f32_16x16x32_bf16 a[248:251], a[204:207], v[240:243], a[248:251]
  v_exp_f32 v131, v131
  v_cvt_pk_bf16_f32 v128, v128, v129
  v_exp_f32 v132, v132
  v_mfma_f32_16x16x32_bf16 a[24:27], a[200:203], v[216:219], a[24:27]
  v_mfma_f32_16x16x32_bf16 a[24:27], a[204:207], v[248:251], a[24:27]
  v_exp_f32 v133, v133
  s_waitcnt lgkmcnt(1)
  v_mfma_f32_16x16x32_bf16 a[136:139], a[208:211], v[192:195], a[136:139]
  v_mfma_f32_16x16x32_bf16 a[136:139], a[212:215], v[224:227], a[136:139]
  ds_read_b64_tr_b16 a[192:193], v16 offset:0
  ds_read_b64_tr_b16 a[194:195], v16 offset:4096
  v_cvt_pk_bf16_f32 v129, v130, v131
  v_exp_f32 v134, v134
  v_mfma_f32_16x16x32_bf16 a[168:171], a[208:211], v[200:203], a[168:171]
  v_mfma_f32_16x16x32_bf16 a[168:171], a[212:215], v[232:235], a[168:171]
  ds_read_b64_tr_b16 a[196:197], v16 offset:8192
  ds_read_b64_tr_b16 a[198:199], v16 offset:12288
  v_exp_f32 v135, v135
  v_mul_f32 v43, v43, v29
  v_mfma_f32_16x16x32_bf16 a[252:255], a[208:211], v[208:211], a[252:255]
  v_mfma_f32_16x16x32_bf16 a[252:255], a[212:215], v[240:243], a[252:255]
  ds_read_b64_tr_b16 a[200:201], v17 offset:0
  ds_read_b64_tr_b16 a[202:203], v17 offset:4096
  v_cvt_pk_bf16_f32 v130, v132, v133
  v_cvt_pk_bf16_f32 v40, v40, v41
  v_mfma_f32_16x16x32_bf16 a[28:31], a[208:211], v[216:219], a[28:31]
  v_mfma_f32_16x16x32_bf16 a[28:31], a[212:215], v[248:251], a[28:31]
  ds_read_b64_tr_b16 a[204:205], v17 offset:8192
  ds_read_b64_tr_b16 a[206:207], v17 offset:12288
  v_exp_f32 v160, v160
  v_cvt_pk_bf16_f32 v41, v42, v43
  v_mfma_f32_16x16x32_bf16 a[140:143], a[216:219], v[192:195], a[140:143]
  v_mfma_f32_16x16x32_bf16 a[140:143], a[220:223], v[224:227], a[140:143]
  v_exp_f32 v161, v161
  v_cvt_pk_bf16_f32 v131, v134, v135
  v_exp_f32 v162, v162
  v_accvgpr_read_b32 v36, a64
  v_mfma_f32_16x16x32_bf16 a[228:231], a[240:243], v[200:203], a[228:231]
  v_exp_f32 v163, v163
  v_mfma_f32_16x16x32_bf16 a[228:231], a[240:243], v[232:235], a[228:231]
  v_cvt_pk_bf16_f32 v160, v160, v161
  v_accvgpr_read_b32 v37, a65
  v_mfma_f32_16x16x32_bf16 a[172:175], a[216:219], v[200:203], a[172:175]
  v_mfma_f32_16x16x32_bf16 a[172:175], a[220:223], v[232:235], a[172:175]
  v_exp_f32 v164, v164
  v_exp_f32 v165, v165
  v_cvt_pk_bf16_f32 v161, v162, v163
  v_mfma_f32_16x16x32_bf16 a[0:3], a[216:219], v[208:211], a[0:3]
  v_mfma_f32_16x16x32_bf16 a[0:3], a[220:223], v[240:243], a[0:3]
  v_exp_f32 v166, v166
  v_exp_f32 v167, v167
  v_accvgpr_read_b32 v38, a66
  v_mfma_f32_16x16x32_bf16 a[32:35], a[216:219], v[216:219], a[32:35]
  v_mfma_f32_16x16x32_bf16 a[32:35], a[220:223], v[248:251], a[32:35]
  v_cvt_pk_bf16_f32 v162, v164, v165
  v_exp_f32 v136, v136
  v_accvgpr_read_b32 v39, a67
  s_waitcnt lgkmcnt(0)
  v_mfma_f32_16x16x32_bf16 a[144:147], a[192:195], v[192:195], a[144:147]
  v_mfma_f32_16x16x32_bf16 a[144:147], a[196:199], v[224:227], a[144:147]
  ds_read_b64_tr_b16 a[208:209], v18 offset:0
  ds_read_b64_tr_b16 a[210:211], v18 offset:4096
  v_exp_f32 v137, v137
  v_mfma_f32_16x16x32_bf16 a[176:179], a[192:195], v[200:203], a[176:179]
  v_mfma_f32_16x16x32_bf16 a[176:179], a[196:199], v[232:235], a[176:179]
  ds_read_b64_tr_b16 a[212:213], v18 offset:8192
  ds_read_b64_tr_b16 a[214:215], v18 offset:12288
  ds_write_b64 v35, v[40:41] offset:4224
  v_cvt_pk_bf16_f32 v163, v166, v167
  v_mfma_f32_16x16x32_bf16 a[4:7], a[192:195], v[208:211], a[4:7]
  v_mfma_f32_16x16x32_bf16 a[4:7], a[196:199], v[240:243], a[4:7]
  ds_read_b64_tr_b16 a[216:217], v19 offset:0
  ds_read_b64_tr_b16 a[218:219], v19 offset:4096
  v_exp_f32 v138, v138
  v_mfma_f32_16x16x32_bf16 a[36:39], a[192:195], v[216:219], a[36:39]
  v_mfma_f32_16x16x32_bf16 a[36:39], a[196:199], v[248:251], a[36:39]
  ds_read_b64_tr_b16 a[220:221], v19 offset:8192
  ds_read_b64_tr_b16 a[222:223], v19 offset:12288
  v_exp_f32 v139, v139
  v_cvt_pk_bf16_f32 v136, v136, v137
  v_mul_f32 v36, v36, v30
  v_mfma_f32_16x16x32_bf16 a[148:151], a[200:203], v[192:195], a[148:151]
  v_mfma_f32_16x16x32_bf16 a[148:151], a[204:207], v[224:227], a[148:151]
  v_exp_f32 v140, v140
  v_exp_f32 v141, v141
  v_mul_f32 v37, v37, v30
  v_mfma_f32_16x16x32_bf16 a[232:235], a[240:243], v[208:211], a[232:235]
  v_cvt_pk_bf16_f32 v137, v138, v139
  v_exp_f32 v142, v142
  v_mfma_f32_16x16x32_bf16 a[232:235], a[240:243], v[240:243], a[232:235]
  v_exp_f32 v143, v143
  v_mfma_f32_16x16x32_bf16 a[180:183], a[200:203], v[200:203], a[180:183]
  v_mfma_f32_16x16x32_bf16 a[180:183], a[204:207], v[232:235], a[180:183]
  v_cvt_pk_bf16_f32 v138, v140, v141
  v_exp_f32 v168, v168
  v_mul_f32 v38, v38, v30
  v_mfma_f32_16x16x32_bf16 a[8:11], a[200:203], v[208:211], a[8:11]
  s_waitcnt vmcnt(11)
  s_barrier
  v_mfma_f32_16x16x32_bf16 a[8:11], a[204:207], v[240:243], a[8:11]
  v_exp_f32 v169, v169
  v_mul_f32 v39, v39, v30
  v_mfma_f32_16x16x32_bf16 a[40:43], a[200:203], v[216:219], a[40:43]
  v_mfma_f32_16x16x32_bf16 a[40:43], a[204:207], v[248:251], a[40:43]
  v_cvt_pk_bf16_f32 v139, v142, v143
  v_exp_f32 v170, v170
  s_waitcnt lgkmcnt(0)
  v_mfma_f32_16x16x32_bf16 a[152:155], a[208:211], v[192:195], a[152:155]
  buffer_load_dwordx4 v6, s[20:23], s85 offen offset:3072 nt lds
  v_mfma_f32_16x16x32_bf16 a[152:155], a[212:215], v[224:227], a[152:155]
  ds_read_b128 a[192:195], v8 offset:32768
  v_exp_f32 v171, v171
  v_cvt_pk_bf16_f32 v36, v36, v37
  v_mfma_f32_16x16x32_bf16 a[184:187], a[208:211], v[200:203], a[184:187]
  s_add_u32 m0, s44, 16384
  v_mfma_f32_16x16x32_bf16 a[184:187], a[212:215], v[232:235], a[184:187]
  ds_read_b128 a[196:199], v9 offset:32768
  v_cvt_pk_bf16_f32 v168, v168, v169
  v_cvt_pk_bf16_f32 v37, v38, v39
  v_mfma_f32_16x16x32_bf16 a[12:15], a[208:211], v[208:211], a[12:15]
  v_mfma_f32_16x16x32_bf16 a[12:15], a[212:215], v[240:243], a[12:15]
  ds_read_b128 a[200:203], v10 offset:32768
  v_exp_f32 v172, v172
  v_exp_f32 v173, v173
  v_mfma_f32_16x16x32_bf16 a[44:47], a[208:211], v[216:219], a[44:47]
  buffer_load_dwordx4 v1, s[16:19], s87 offen offset:0 nt lds
  ds_write_b64 v32, v[36:37] offset:8192
  v_mfma_f32_16x16x32_bf16 a[44:47], a[212:215], v[248:251], a[44:47]
  ds_read_b128 a[204:207], v11 offset:32768
  v_cvt_pk_bf16_f32 v169, v170, v171
  v_mfma_f32_16x16x32_bf16 a[156:159], a[216:219], v[192:195], a[156:159]
  v_mfma_f32_16x16x32_bf16 a[156:159], a[220:223], v[224:227], a[156:159]
  s_waitcnt lgkmcnt(1)
  v_exp_f32 v174, v174
  v_exp_f32 v175, v175
  v_mfma_f32_16x16x32_bf16 a[236:239], a[240:243], v[216:219], a[236:239]
  v_cvt_pk_bf16_f32 v170, v172, v173
  v_exp_f32 v144, v144
  v_mfma_f32_16x16x32_bf16 a[236:239], a[240:243], v[248:251], a[236:239]
  v_exp_f32 v145, v145
  v_mfma_f32_16x16x32_bf16 a[188:191], a[216:219], v[200:203], a[188:191]
  v_mfma_f32_16x16x32_bf16 a[188:191], a[220:223], v[232:235], a[188:191]
  ds_read_b128 a[48:51], v46 offset:0
  v_cvt_pk_bf16_f32 v171, v174, v175
  v_exp_f32 v146, v146
  v_mfma_f32_16x16x32_bf16 a[16:19], a[216:219], v[208:211], a[16:19]
  buffer_load_dwordx4 v2, s[16:19], s87 offen offset:1024 nt lds
  v_mfma_f32_16x16x32_bf16 a[16:19], a[220:223], v[240:243], a[16:19]
  ds_read_b128 a[56:59], v46 offset:2048
  v_exp_f32 v147, v147
  v_mfma_f32_16x16x32_bf16 v[48:51], a[216:219], v[216:219], v[48:51]
  v_mfma_f32_16x16x32_bf16 v[48:51], a[220:223], v[248:251], v[48:51]
  v_cvt_pk_bf16_f32 v144, v144, v145
  v_exp_f32 v148, v148
  s_waitcnt lgkmcnt(2)
  s_cbranch_vccnz LS_t23
LS_b23:
  v_mfma_f32_16x16x32_bf16 v[192:195], a[192:195], v[64:67], v[20:23]
  buffer_load_dwordx4 v3, s[16:19], s87 offen offset:2048 nt lds
  v_mfma_f32_16x16x32_bf16 v[192:195], a[196:199], v[68:71], v[192:195]
  v_mfma_f32_16x16x32_bf16 v[192:195], a[200:203], v[72:75], v[192:195]
  v_mfma_f32_16x16x32_bf16 v[192:195], a[204:207], v[76:79], v[192:195]
  ds_read_b128 a[208:211], v8 offset:36864
  ds_read_b128 a[212:215], v9 offset:36864
  v_exp_f32 v149, v149
  v_cvt_pk_bf16_f32 v145, v146, v147
  v_exp_f32 v150, v150
  v_xor_b32 v46, 64, v46
  v_mfma_f32_16x16x32_bf16 v[200:203], a[192:195], v[80:83], v[52:55]
  ds_read_b128 a[52:55], v46 offset:1024
  ds_read_b128 a[60:63], v46 offset:3072
  v_mfma_f32_16x16x32_bf16 v[200:203], a[196:199], v[84:87], v[200:203]
  v_mfma_f32_16x16x32_bf16 v[200:203], a[200:203], v[88:91], v[200:203]
  buffer_load_dwordx4 v4, s[16:19], s87 offen offset:3072 nt lds
  v_mfma_f32_16x16x32_bf16 v[200:203], a[204:207], v[92:95], v[200:203]
  ds_read_b128 a[216:219], v10 offset:36864
  v_exp_f32 v151, v151
  v_max_f32 v44, v192, v193
  v_cvt_pk_bf16_f32 v146, v148, v149
  v_mfma_f32_16x16x32_bf16 v[208:211], a[192:195], v[96:99], v[56:59]
  v_mfma_f32_16x16x32_bf16 v[208:211], a[196:199], v[100:103], v[208:211]
  v_mfma_f32_16x16x32_bf16 v[208:211], a[200:203], v[104:107], v[208:211]
  v_mfma_f32_16x16x32_bf16 v[208:211], a[204:207], v[108:111], v[208:211]
  ds_read_b128 a[220:223], v11 offset:36864
  v_exp_f32 v176, v176
  v_max_f32 v45, v194, v195
  v_exp_f32 v177, v177
  v_max3_f32 v44, v44, v200, v201
  v_cvt_pk_bf16_f32 v147, v150, v151
  v_max3_f32 v45, v45, v202, v203
  v_accvgpr_read_b32 v40, a68
  v_accvgpr_read_b32 v41, a69
  v_mfma_f32_16x16x32_bf16 v[216:219], a[192:195], v[112:115], v[60:63]
  v_mfma_f32_16x16x32_bf16 v[216:219], a[196:199], v[116:119], v[216:219]
  v_mfma_f32_16x16x32_bf16 v[216:219], a[200:203], v[120:123], v[216:219]
  v_mfma_f32_16x16x32_bf16 v[216:219], a[204:207], v[124:127], v[216:219]
  v_exp_f32 v178, v178
  v_max3_f32 v44, v44, v208, v209
  v_exp_f32 v179, v179
  v_max3_f32 v45, v45, v210, v211
  v_cvt_pk_bf16_f32 v176, v176, v177
  v_accvgpr_read_b32 v42, a70
  v_accvgpr_read_b32 v43, a71
  s_waitcnt lgkmcnt(0)
  v_mfma_f32_16x16x32_bf16 v[196:199], a[208:211], v[64:67], v[20:23]
  v_mfma_f32_16x16x32_bf16 v[196:199], a[212:215], v[68:71], v[196:199]
  v_mfma_f32_16x16x32_bf16 v[196:199], a[216:219], v[72:75], v[196:199]
  v_mfma_f32_16x16x32_bf16 v[196:199], a[220:223], v[76:79], v[196:199]
  ds_read_b128 a[192:195], v8 offset:40960
  ds_read_b128 a[196:199], v9 offset:40960
  v_exp_f32 v180, v180
  v_max3_f32 v44, v44, v216, v217
  v_exp_f32 v181, v181
  v_max3_f32 v45, v45, v218, v219
  v_mul_f32 v40, v40, v30
  v_mfma_f32_16x16x32_bf16 v[204:207], a[208:211], v[80:83], v[52:55]
  v_mfma_f32_16x16x32_bf16 v[204:207], a[212:215], v[84:87], v[204:207]
  v_mfma_f32_16x16x32_bf16 v[204:207], a[216:219], v[88:91], v[204:207]
  v_mfma_f32_16x16x32_bf16 v[204:207], a[220:223], v[92:95], v[204:207]
  ds_read_b128 a[200:203], v10 offset:40960
  v_cvt_pk_bf16_f32 v177, v178, v179
  v_max3_f32 v44, v44, v196, v197
  v_exp_f32 v182, v182
  v_max3_f32 v45, v45, v198, v199
  v_exp_f32 v183, v183
  v_mul_f32 v41, v41, v30
  v_mul_f32 v42, v42, v30
  v_mfma_f32_16x16x32_bf16 v[212:215], a[208:211], v[96:99], v[56:59]
  v_mfma_f32_16x16x32_bf16 v[212:215], a[212:215], v[100:103], v[212:215]
  v_mfma_f32_16x16x32_bf16 v[212:215], a[216:219], v[104:107], v[212:215]
  v_mfma_f32_16x16x32_bf16 v[212:215], a[220:223], v[108:111], v[212:215]
  ds_read_b128 a[204:207], v11 offset:40960
  v_cvt_pk_bf16_f32 v178, v180, v181
  v_max3_f32 v44, v44, v204, v205
  v_exp_f32 v152, v152
  v_max3_f32 v45, v45, v206, v207
  v_exp_f32 v153, v153
  v_mul_f32 v43, v43, v30
  v_cvt_pk_bf16_f32 v40, v40, v41
  v_mfma_f32_16x16x32_bf16 v[220:223], a[208:211], v[112:115], v[60:63]
  v_mfma_f32_16x16x32_bf16 v[220:223], a[212:215], v[116:119], v[220:223]
  v_mfma_f32_16x16x32_bf16 v[220:223], a[216:219], v[120:123], v[220:223]
  v_mfma_f32_16x16x32_bf16 v[220:223], a[220:223], v[124:127], v[220:223]
  v_cvt_pk_bf16_f32 v179, v182, v183
  v_max3_f32 v44, v44, v212, v213
  v_exp_f32 v154, v154
  v_max3_f32 v45, v45, v214, v215
  v_exp_f32 v155, v155
  v_cvt_pk_bf16_f32 v41, v42, v43
  v_accvgpr_read_b32 v36, a72
  s_waitcnt lgkmcnt(0)
  v_mfma_f32_16x16x32_bf16 v[224:227], a[192:195], v[64:67], v[20:23]
  v_mfma_f32_16x16x32_bf16 v[224:227], a[196:199], v[68:71], v[224:227]
  v_mfma_f32_16x16x32_bf16 v[224:227], a[200:203], v[72:75], v[224:227]
  v_mfma_f32_16x16x32_bf16 v[224:227], a[204:207], v[76:79], v[224:227]
  ds_read_b128 a[208:211], v8 offset:45056
  ds_read_b128 a[212:215], v9 offset:45056
  v_cvt_pk_bf16_f32 v152, v152, v153
  v_max3_f32 v44, v44, v220, v221
  v_exp_f32 v156, v156
  v_max3_f32 v45, v45, v222, v223
  v_exp_f32 v157, v157
  v_accvgpr_read_b32 v37, a73
  v_mfma_f32_16x16x32_bf16 v[232:235], a[192:195], v[80:83], v[52:55]
  v_mfma_f32_16x16x32_bf16 v[232:235], a[196:199], v[84:87], v[232:235]
  v_mfma_f32_16x16x32_bf16 v[232:235], a[200:203], v[88:91], v[232:235]
  v_mfma_f32_16x16x32_bf16 v[232:235], a[204:207], v[92:95], v[232:235]
  ds_read_b128 a[216:219], v10 offset:45056
  v_cvt_pk_bf16_f32 v153, v154, v155
  v_max3_f32 v44, v44, v224, v225
  v_exp_f32 v158, v158
  v_max3_f32 v45, v45, v226, v227
  v_exp_f32 v159, v159
  v_accvgpr_read_b32 v38, a74
  v_accvgpr_read_b32 v39, a75
  v_mfma_f32_16x16x32_bf16 v[240:243], a[192:195], v[96:99], v[56:59]
  v_mfma_f32_16x16x32_bf16 v[240:243], a[196:199], v[100:103], v[240:243]
  v_mfma_f32_16x16x32_bf16 v[240:243], a[200:203], v[104:107], v[240:243]
  v_mfma_f32_16x16x32_bf16 v[240:243], a[204:207], v[108:111], v[240:243]
  ds_read_b128 a[220:223], v11 offset:45056
  ds_write_b64 v33, v[40:41] offset:8192
  v_cvt_pk_bf16_f32 v154, v156, v157
  v_max3_f32 v44, v44, v232, v233
  v_exp_f32 v184, v184
  v_max3_f32 v45, v45, v234, v235
  v_exp_f32 v185, v185
  v_mfma_f32_16x16x32_bf16 v[248:251], a[192:195], v[112:115], v[60:63]
  s_waitcnt vmcnt(12)
  s_barrier
  v_mfma_f32_16x16x32_bf16 v[248:251], a[196:199], v[116:119], v[248:251]
  s_add_u32 m0, s44, 49152
  v_mfma_f32_16x16x32_bf16 v[248:251], a[200:203], v[120:123], v[248:251]
  v_mfma_f32_16x16x32_bf16 v[248:251], a[204:207], v[124:127], v[248:251]
  v_cvt_pk_bf16_f32 v155, v158, v159
  v_max3_f32 v44, v44, v240, v241
  v_exp_f32 v186, v186
  v_mul_f32 v36, v36, v30
  s_waitcnt lgkmcnt(1)
  v_mfma_f32_16x16x32_bf16 v[228:231], a[208:211], v[64:67], v[20:23]
  buffer_load_dwordx4 v5, s[20:23], s86 offen offset:0 nt lds
  v_mfma_f32_16x16x32_bf16 v[228:231], a[212:215], v[68:71], v[228:231]
  v_mfma_f32_16x16x32_bf16 v[228:231], a[216:219], v[72:75], v[228:231]
  v_mfma_f32_16x16x32_bf16 v[228:231], a[220:223], v[76:79], v[228:231]
  ds_read_b64_tr_b16 a[192:193], v12 offset:16384
  ds_read_b64_tr_b16 a[194:195], v12 offset:20480
  ds_read_b64_tr_b16 a[196:197], v12 offset:24576
  ds_read_b64_tr_b16 a[198:199], v12 offset:28672
  v_exp_f32 v187, v187
  v_mul_f32 v37, v37, v30
  v_mfma_f32_16x16x32_bf16 v[236:239], a[208:211], v[80:83], v[52:55]
  v_mfma_f32_16x16x32_bf16 v[236:239], a[212:215], v[84:87], v[236:239]
  v_mfma_f32_16x16x32_bf16 v[236:239], a[216:219], v[88:91], v[236:239]
  buffer_load_dwordx4 v6, s[20:23], s86 offen offset:1024 nt lds
  v_mfma_f32_16x16x32_bf16 v[236:239], a[220:223], v[92:95], v[236:239]
  ds_read_b64_tr_b16 a[200:201], v13 offset:16384
  ds_read_b64_tr_b16 a[202:203], v13 offset:20480
  v_cvt_pk_bf16_f32 v184, v184, v185
  v_max3_f32 v45, v45, v242, v243
  v_exp_f32 v188, v188
  v_mul_f32 v38, v38, v30
  v_mul_f32 v39, v39, v30
  v_mfma_f32_16x16x32_bf16 v[244:247], a[208:211], v[96:99], v[56:59]
  v_mfma_f32_16x16x32_bf16 v[244:247], a[212:215], v[100:103], v[244:247]
  v_mfma_f32_16x16x32_bf16 v[244:247], a[216:219], v[104:107], v[244:247]
  v_mfma_f32_16x16x32_bf16 v[244:247], a[220:223], v[108:111], v[244:247]
  ds_read_b64_tr_b16 a[204:205], v13 offset:24576
  ds_read_b64_tr_b16 a[206:207], v13 offset:28672
  v_exp_f32 v189, v189
  v_max3_f32 v44, v44, v248, v249
  v_cvt_pk_bf16_f32 v185, v186, v187
  v_max3_f32 v45, v45, v250, v251
  v_exp_f32 v190, v190
  v_cvt_pk_bf16_f32 v36, v36, v37
  v_cvt_pk_bf16_f32 v37, v38, v39
  v_mfma_f32_16x16x32_bf16 v[252:255], a[208:211], v[112:115], v[60:63]
  buffer_load_dwordx4 v5, s[20:23], s86 offen offset:2048 nt lds
  v_mfma_f32_16x16x32_bf16 v[252:255], a[212:215], v[116:119], v[252:255]
  v_mfma_f32_16x16x32_bf16 v[252:255], a[216:219], v[120:123], v[252:255]
  v_mfma_f32_16x16x32_bf16 v[252:255], a[220:223], v[124:127], v[252:255]
  v_exp_f32 v191, v191
  v_max3_f32 v44, v44, v228, v229
  v_cvt_pk_bf16_f32 v186, v188, v189
  v_max3_f32 v45, v45, v230, v231
  v_accvgpr_read_b32 v40, a76
  s_waitcnt lgkmcnt(0)
  v_mfma_f32_16x16x32_bf16 a[128:131], a[192:195], v[128:131], a[128:131]
  buffer_load_dwordx4 v6, s[20:23], s86 offen offset:3072 nt lds
  v_mfma_f32_16x16x32_bf16 a[128:131], a[196:199], v[160:163], a[128:131]
  ds_read_b64_tr_b16 a[208:209], v14 offset:16384
  ds_read_b64_tr_b16 a[210:211], v14 offset:20480
  v_accvgpr_read_b32 v41, a77
  v_mfma_f32_16x16x32_bf16 a[160:163], a[192:195], v[136:139], a[160:163]
  v_mfma_f32_16x16x32_bf16 a[160:163], a[196:199], v[168:171], a[160:163]
  ds_read_b64_tr_b16 a[212:213], v14 offset:24576
  ds_read_b64_tr_b16 a[214:215], v14 offset:28672
  v_cvt_pk_bf16_f32 v187, v190, v191
  v_max3_f32 v44, v44, v236, v237
  v_accvgpr_read_b32 v42, a78
  v_mfma_f32_16x16x32_bf16 a[244:247], a[192:195], v[144:147], a[244:247]
  v_mfma_f32_16x16x32_bf16 a[244:247], a[196:199], v[176:179], a[244:247]
  ds_read_b64_tr_b16 a[216:217], v15 offset:16384
  ds_read_b64_tr_b16 a[218:219], v15 offset:20480
  v_max3_f32 v45, v45, v238, v239
  v_max3_f32 v44, v44, v244, v245
  v_accvgpr_read_b32 v43, a79
  v_mfma_f32_16x16x32_bf16 a[20:23], a[192:195], v[152:155], a[20:23]
  v_mfma_f32_16x16x32_bf16 a[20:23], a[196:199], v[184:187], a[20:23]
  ds_read_b64_tr_b16 a[220:221], v15 offset:24576
  ds_read_b64_tr_b16 a[222:223], v15 offset:28672
  v_max3_f32 v45, v45, v246, v247
  v_max3_f32 v44, v44, v252, v253
  v_mfma_f32_16x16x32_bf16 a[132:135], a[200:203], v[128:131], a[132:135]
  v_mfma_f32_16x16x32_bf16 a[132:135], a[204:207], v[160:163], a[132:135]
  v_max3_f32 v45, v45, v254, v255
  v_max_f32 v44, v44, v45
  v_cmp_lt_f32 vcc, s48, v44
  v_mfma_f32_16x16x32_bf16 a[224:227], a[240:243], v[128:131], a[224:227]
  v_mfma_f32_16x16x32_bf16 a[224:227], a[240:243], v[160:163], a[224:227]
  v_mfma_f32_16x16x32_bf16 a[164:167], a[200:203], v[136:139], a[164:167]
  ds_write_b64 v34, v[36:37] offset:8192
  v_mfma_f32_16x16x32_bf16 a[164:167], a[204:207], v[168:171], a[164:167]
  s_cbranch_vccnz LS_t10
LS_b10:
  v_exp_f32 v192, v192
  v_exp_f32 v193, v193
  v_exp_f32 v194, v194
  v_exp_f32 v195, v195
  v_mfma_f32_16x16x32_bf16 a[248:251], a[200:203], v[144:147], a[248:251]
  v_mfma_f32_16x16x32_bf16 a[248:251], a[204:207], v[176:179], a[248:251]
  v_cvt_pk_bf16_f32 v192, v192, v193
  v_exp_f32 v196, v196
  v_exp_f32 v197, v197
  v_mfma_f32_16x16x32_bf16 a[24:27], a[200:203], v[152:155], a[24:27]
  v_mfma_f32_16x16x32_bf16 a[24:27], a[204:207], v[184:187], a[24:27]
  v_cvt_pk_bf16_f32 v193, v194, v195
  v_exp_f32 v198, v198
  v_mul_f32 v40, v40, v30
  s_waitcnt lgkmcnt(1)
  v_mfma_f32_16x16x32_bf16 a[136:139], a[208:211], v[128:131], a[136:139]
  v_mfma_f32_16x16x32_bf16 a[136:139], a[212:215], v[160:163], a[136:139]
  ds_read_b64_tr_b16 a[192:193], v16 offset:16384
  ds_read_b64_tr_b16 a[194:195], v16 offset:20480
  v_exp_f32 v199, v199
  v_mul_f32 v41, v41, v30
  v_mfma_f32_16x16x32_bf16 a[168:171], a[208:211], v[136:139], a[168:171]
  v_mfma_f32_16x16x32_bf16 a[168:171], a[212:215], v[168:171], a[168:171]
  ds_read_b64_tr_b16 a[196:197], v16 offset:24576
  ds_read_b64_tr_b16 a[198:199], v16 offset:28672
  v_cvt_pk_bf16_f32 v194, v196, v197
  v_mul_f32 v42, v42, v30
  v_mfma_f32_16x16x32_bf16 a[252:255], a[208:211], v[144:147], a[252:255]
  v_mfma_f32_16x16x32_bf16 a[252:255], a[212:215], v[176:179], a[252:255]
  ds_read_b64_tr_b16 a[200:201], v17 offset:16384
  ds_read_b64_tr_b16 a[202:203], v17 offset:20480
  v_exp_f32 v224, v224
  v_mfma_f32_16x16x32_bf16 a[28:31], a[208:211], v[152:155], a[28:31]
  v_mfma_f32_16x16x32_bf16 a[28:31], a[212:215], v[184:187], a[28:31]
  ds_read_b64_tr_b16 a[204:205], v17 offset:24576
  ds_read_b64_tr_b16 a[206:207], v17 offset:28672
  v_exp_f32 v225, v225
  v_mul_f32 v43, v43, v30
  v_mfma_f32_16x16x32_bf16 a[140:143], a[216:219], v[128:131], a[140:143]
  v_mfma_f32_16x16x32_bf16 a[140:143], a[220:223], v[160:163], a[140:143]
  v_cvt_pk_bf16_f32 v195, v198, v199
  v_exp_f32 v226, v226
  v_exp_f32 v227, v227
  v_cvt_pk_bf16_f32 v40, v40, v41
  v_mfma_f32_16x16x32_bf16 a[228:231], a[240:243], v[136:139], a[228:231]
  v_cvt_pk_bf16_f32 v224, v224, v225
  v_cvt_pk_bf16_f32 v41, v42, v43
  v_mfma_f32_16x16x32_bf16 a[228:231], a[240:243], v[168:171], a[228:231]
  v_exp_f32 v228, v228
  v_mfma_f32_16x16x32_bf16 a[172:175], a[216:219], v[136:139], a[172:175]
  v_mfma_f32_16x16x32_bf16 a[172:175], a[220:223], v[168:171], a[172:175]
  v_exp_f32 v229, v229
  v_cvt_pk_bf16_f32 v225, v226, v227
  v_exp_f32 v230, v230
  v_mfma_f32_16x16x32_bf16 a[0:3], a[216:219], v[144:147], a[0:3]
  v_mfma_f32_16x16x32_bf16 a[0:3], a[220:223], v[176:179], a[0:3]
  v_exp_f32 v231, v231
  v_cvt_pk_bf16_f32 v226, v228, v229
  v_accvgpr_read_b32 v36, a80
  v_mfma_f32_16x16x32_bf16 a[32:35], a[216:219], v[152:155], a[32:35]
  v_mfma_f32_16x16x32_bf16 a[32:35], a[220:223], v[184:187], a[32:35]
  v_exp_f32 v200, v200
  v_exp_f32 v201, v201
  s_waitcnt lgkmcnt(0)
  v_mfma_f32_16x16x32_bf16 a[144:147], a[192:195], v[128:131], a[144:147]
  v_mfma_f32_16x16x32_bf16 a[144:147], a[196:199], v[160:163], a[144:147]
  ds_read_b64_tr_b16 a[208:209], v18 offset:16384
  ds_read_b64_tr_b16 a[210:211], v18 offset:20480
  v_cvt_pk_bf16_f32 v227, v230, v231
  v_accvgpr_read_b32 v37, a81
  v_mfma_f32_16x16x32_bf16 a[176:179], a[192:195], v[136:139], a[176:179]
  v_mfma_f32_16x16x32_bf16 a[176:179], a[196:199], v[168:171], a[176:179]
  ds_read_b64_tr_b16 a[212:213], v18 offset:24576
  ds_read_b64_tr_b16 a[214:215], v18 offset:28672
  v_exp_f32 v202, v202
  v_exp_f32 v203, v203
  v_accvgpr_read_b32 v38, a82
  v_mfma_f32_16x16x32_bf16 a[4:7], a[192:195], v[144:147], a[4:7]
  v_mfma_f32_16x16x32_bf16 a[4:7], a[196:199], v[176:179], a[4:7]
  ds_read_b64_tr_b16 a[216:217], v19 offset:16384
  ds_read_b64_tr_b16 a[218:219], v19 offset:20480
  v_cvt_pk_bf16_f32 v200, v200, v201
  v_accvgpr_read_b32 v39, a83
  v_mfma_f32_16x16x32_bf16 a[36:39], a[192:195], v[152:155], a[36:39]
  v_mfma_f32_16x16x32_bf16 a[36:39], a[196:199], v[184:187], a[36:39]
  ds_read_b64_tr_b16 a[220:221], v19 offset:24576
  ds_read_b64_tr_b16 a[222:223], v19 offset:28672
  v_exp_f32 v204, v204
  v_mfma_f32_16x16x32_bf16 a[148:151], a[200:203], v[128:131], a[148:151]
  v_mfma_f32_16x16x32_bf16 a[148:151], a[204:207], v[160:163], a[148:151]
  v_exp_f32 v205, v205
  v_cvt_pk_bf16_f32 v201, v202, v203
  v_exp_f32 v206, v206
  v_mfma_f32_16x16x32_bf16 a[232:235], a[240:243], v[144:147], a[232:235]
  v_exp_f32 v207, v207
  v_mfma_f32_16x16x32_bf16 a[232:235], a[240:243], v[176:179], a[232:235]
  v_cvt_pk_bf16_f32 v202, v204, v205
  v_exp_f32 v232, v232
  v_mfma_f32_16x16x32_bf16 a[180:183], a[200:203], v[136:139], a[180:183]
  ds_write_b64 v35, v[40:41] offset:8192
  v_mfma_f32_16x16x32_bf16 a[180:183], a[204:207], v[168:171], a[180:183]
  v_exp_f32 v233, v233
  v_mfma_f32_16x16x32_bf16 a[8:11], a[200:203], v[144:147], a[8:11]
  s_waitcnt vmcnt(12)
  s_barrier
  v_mfma_f32_16x16x32_bf16 a[8:11], a[204:207], v[176:179], a[8:11]
  s_add_u32 m0, s44, 32768
  v_cvt_pk_bf16_f32 v203, v206, v207
  v_mfma_f32_16x16x32_bf16 a[40:43], a[200:203], v[152:155], a[40:43]
  v_mfma_f32_16x16x32_bf16 a[40:43], a[204:207], v[184:187], a[40:43]
  v_exp_f32 v234, v234
  v_exp_f32 v235, v235
  v_mul_f32 v36, v36, v30
  s_waitcnt lgkmcnt(1)
  v_mfma_f32_16x16x32_bf16 a[152:155], a[208:211], v[128:131], a[152:155]
  buffer_load_dwordx4 v1, s[16:19], s88 offen offset:0 nt lds
  v_mfma_f32_16x16x32_bf16 a[152:155], a[212:215], v[160:163], a[152:155]
  ds_read_b128 a[192:195], v8 offset:0
  v_cvt_pk_bf16_f32 v232, v232, v233
  v_mul_f32 v37, v37, v30
  v_mfma_f32_16x16x32_bf16 a[184:187], a[208:211], v[136:139], a[184:187]
  v_mfma_f32_16x16x32_bf16 a[184:187], a[212:215], v[168:171], a[184:187]
  ds_read_b128 a[196:199], v9 offset:0
  v_exp_f32 v236, v236
  v_mul_f32 v38, v38, v30
  v_mfma_f32_16x16x32_bf16 a[12:15], a[208:211], v[144:147], a[12:15]
  v_mfma_f32_16x16x32_bf16 a[12:15], a[212:215], v[176:179], a[12:15]
  ds_read_b128 a[200:203], v10 offset:0
  v_exp_f32 v237, v237
  v_cvt_pk_bf16_f32 v233, v234, v235
  v_mfma_f32_16x16x32_bf16 a[44:47], a[208:211], v[152:155], a[44:47]
  buffer_load_dwordx4 v2, s[16:19], s88 offen offset:1024 nt lds
  v_mfma_f32_16x16x32_bf16 a[44:47], a[212:215], v[184:187], a[44:47]
  ds_read_b128 a[204:207], v11 offset:0
  v_exp_f32 v238, v238
  v_mul_f32 v39, v39, v30
  v_mfma_f32_16x16x32_bf16 a[156:159], a[216:219], v[128:131], a[156:159]
  v_mfma_f32_16x16x32_bf16 a[156:159], a[220:223], v[160:163], a[156:159]
  v_exp_f32 v239, v239
  v_cvt_pk_bf16_f32 v234, v236, v237
  v_cvt_pk_bf16_f32 v36, v36, v37
  v_mfma_f32_16x16x32_bf16 a[236:239], a[240:243], v[152:155], a[236:239]
  v_exp_f32 v208, v208
  v_mfma_f32_16x16x32_bf16 a[236:239], a[240:243], v[184:187], a[236:239]
  v_exp_f32 v209, v209
  v_cvt_pk_bf16_f32 v235, v238, v239
  v_mfma_f32_16x16x32_bf16 a[188:191], a[216:219], v[136:139], a[188:191]
  v_mfma_f32_16x16x32_bf16 a[188:191], a[220:223], v[168:171], a[188:191]
  v_exp_f32 v210, v210
  v_exp_f32 v211, v211
  v_cvt_pk_bf16_f32 v37, v38, v39
  v_mfma_f32_16x16x32_bf16 a[16:19], a[216:219], v[144:147], a[16:19]
  buffer_load_dwordx4 v3, s[16:19], s88 offen offset:2048 nt lds
  v_mfma_f32_16x16x32_bf16 a[16:19], a[220:223], v[176:179], a[16:19]
  v_cvt_pk_bf16_f32 v208, v208, v209
  v_exp_f32 v212, v212
  v_mfma_f32_16x16x32_bf16 v[48:51], a[216:219], v[152:155], v[48:51]
  v_mfma_f32_16x16x32_bf16 v[48:51], a[220:223], v[184:187], v[48:51]
  v_exp_f32 v213, v213
  s_waitcnt lgkmcnt(0)
  s_cbranch_vccnz LS_t24
LS_b24:
  v_mfma_f32_16x16x32_bf16 v[128:131], a[192:195], v[64:67], v[20:23]
  buffer_load_dwordx4 v4, s[16:19], s88 offen offset:3072 nt lds
  ds_write_b64 v32, v[36:37] offset:8320
  v_mfma_f32_16x16x32_bf16 v[128:131], a[196:199], v[68:71], v[128:131]
  ds_read_b128 a[208:211], v8 offset:4096
  v_mfma_f32_16x16x32_bf16 v[128:131], a[200:203], v[72:75], v[128:131]
  v_mfma_f32_16x16x32_bf16 v[128:131], a[204:207], v[76:79], v[128:131]
  s_waitcnt lgkmcnt(1)
  v_cvt_pk_bf16_f32 v209, v210, v211
  v_exp_f32 v214, v214
  v_exp_f32 v215, v215
  v_mfma_f32_16x16x32_bf16 v[136:139], a[192:195], v[80:83], v[52:55]
  ds_read_b128 a[212:215], v9 offset:4096
  v_mfma_f32_16x16x32_bf16 v[136:139], a[196:199], v[84:87], v[136:139]
  ds_read_b128 a[68:71], v46 offset:5120
  v_mfma_f32_16x16x32_bf16 v[136:139], a[200:203], v[88:91], v[136:139]
  v_mfma_f32_16x16x32_bf16 v[136:139], a[204:207], v[92:95], v[136:139]
  ds_read_b128 a[216:219], v10 offset:4096
  v_cvt_pk_bf16_f32 v210, v212, v213
  v_max_f32 v44, v128, v129
  v_exp_f32 v240, v240
  v_max_f32 v45, v130, v131
  v_exp_f32 v241, v241
  v_mfma_f32_16x16x32_bf16 v[144:147], a[192:195], v[96:99], v[56:59]
  ds_read_b128 a[76:79], v46 offset:7168
  v_mfma_f32_16x16x32_bf16 v[144:147], a[196:199], v[100:103], v[144:147]
  v_mfma_f32_16x16x32_bf16 v[144:147], a[200:203], v[104:107], v[144:147]
  ds_read_b128 a[220:223], v11 offset:4096
  v_mfma_f32_16x16x32_bf16 v[144:147], a[204:207], v[108:111], v[144:147]
  v_cvt_pk_bf16_f32 v211, v214, v215
  v_max3_f32 v44, v44, v136, v137
  v_exp_f32 v242, v242
  v_max3_f32 v45, v45, v138, v139
  v_exp_f32 v243, v243
  v_mfma_f32_16x16x32_bf16 v[152:155], a[192:195], v[112:115], v[60:63]
  v_mfma_f32_16x16x32_bf16 v[152:155], a[196:199], v[116:119], v[152:155]
  v_mfma_f32_16x16x32_bf16 v[152:155], a[200:203], v[120:123], v[152:155]
  v_mfma_f32_16x16x32_bf16 v[152:155], a[204:207], v[124:127], v[152:155]
  v_cvt_pk_bf16_f32 v240, v240, v241
  v_max3_f32 v44, v44, v144, v145
  v_exp_f32 v244, v244
  v_max3_f32 v45, v45, v146, v147
  v_exp_f32 v245, v245
  v_xor_b32 v46, 64, v46
  s_waitcnt lgkmcnt(0)
  v_mfma_f32_16x16x32_bf16 v[132:135], a[208:211], v[64:67], v[20:23]
  ds_read_b128 a[64:67], v46 offset:4096
  ds_read_b128 a[72:75], v46 offset:6144
  v_mfma_f32_16x16x32_bf16 v[132:135], a[212:215], v[68:71], v[132:135]
  ds_read_b128 a[192:195], v8 offset:8192
  v_mfma_f32_16x16x32_bf16 v[132:135], a[216:219], v[72:75], v[132:135]
  v_mfma_f32_16x16x32_bf16 v[132:135], a[220:223], v[76:79], v[132:135]
  v_cvt_pk_bf16_f32 v241, v242, v243
  v_max3_f32 v44, v44, v152, v153
  v_exp_f32 v246, v246
  v_max3_f32 v45, v45, v154, v155
  v_exp_f32 v247, v247
  v_mfma_f32_16x16x32_bf16 v[140:143], a[208:211], v[80:83], v[52:55]
  ds_read_b128 a[196:199], v9 offset:8192
  v_mfma_f32_16x16x32_bf16 v[140:143], a[212:215], v[84:87], v[140:143]
  v_mfma_f32_16x16x32_bf16 v[140:143], a[216:219], v[88:91], v[140:143]
  v_mfma_f32_16x16x32_bf16 v[140:143], a[220:223], v[92:95], v[140:143]
  ds_read_b128 a[200:203], v10 offset:8192
  v_cvt_pk_bf16_f32 v242, v244, v245
  v_max3_f32 v44, v44, v132, v133
  v_exp_f32 v216, v216
  v_max3_f32 v45, v45, v134, v135
  v_exp_f32 v217, v217
  v_accvgpr_read_b32 v40, a84
  v_accvgpr_read_b32 v41, a85
  v_mfma_f32_16x16x32_bf16 v[148:151], a[208:211], v[96:99], v[56:59]
  v_mfma_f32_16x16x32_bf16 v[148:151], a[212:215], v[100:103], v[148:151]
  v_mfma_f32_16x16x32_bf16 v[148:151], a[216:219], v[104:107], v[148:151]
  ds_read_b128 a[204:207], v11 offset:8192
  v_mfma_f32_16x16x32_bf16 v[148:151], a[220:223], v[108:111], v[148:151]
  v_cvt_pk_bf16_f32 v243, v246, v247
  v_max3_f32 v44, v44, v140, v141
  v_exp_f32 v218, v218
  v_max3_f32 v45, v45, v142, v143
  v_exp_f32 v219, v219
  v_accvgpr_read_b32 v42, a86
  v_mfma_f32_16x16x32_bf16 v[156:159], a[208:211], v[112:115], v[60:63]
  v_mfma_f32_16x16x32_bf16 v[156:159], a[212:215], v[116:119], v[156:159]
  v_mfma_f32_16x16x32_bf16 v[156:159], a[216:219], v[120:123], v[156:159]
  v_mfma_f32_16x16x32_bf16 v[156:159], a[220:223], v[124:127], v[156:159]
  v_cvt_pk_bf16_f32 v216, v216, v217
  v_max3_f32 v44, v44, v148, v149
  v_exp_f32 v220, v220
  v_max3_f32 v45, v45, v150, v151
  v_exp_f32 v221, v221
  v_accvgpr_read_b32 v43, a87
  v_mul_f32 v40, v40, v30
  s_waitcnt lgkmcnt(0)
  v_mfma_f32_16x16x32_bf16 v[160:163], a[192:195], v[64:67], v[20:23]
  v_mfma_f32_16x16x32_bf16 v[160:163], a[196:199], v[68:71], v[160:163]
  ds_read_b128 a[208:211], v8 offset:12288
  v_mfma_f32_16x16x32_bf16 v[160:163], a[200:203], v[72:75], v[160:163]
  v_mfma_f32_16x16x32_bf16 v[160:163], a[204:207], v[76:79], v[160:163]
  v_cvt_pk_bf16_f32 v217, v218, v219
  v_max3_f32 v44, v44, v156, v157
  v_exp_f32 v222, v222
  v_max3_f32 v45, v45, v158, v159
  v_exp_f32 v223, v223
  v_mul_f32 v41, v41, v30
  v_mul_f32 v42, v42, v30
  v_mfma_f32_16x16x32_bf16 v[168:171], a[192:195], v[80:83], v[52:55]
  ds_read_b128 a[212:215], v9 offset:12288
  v_mfma_f32_16x16x32_bf16 v[168:171], a[196:199], v[84:87], v[168:171]
  v_mfma_f32_16x16x32_bf16 v[168:171], a[200:203], v[88:91], v[168:171]
  v_mfma_f32_16x16x32_bf16 v[168:171], a[204:207], v[92:95], v[168:171]
  ds_read_b128 a[216:219], v10 offset:12288
  v_cvt_pk_bf16_f32 v218, v220, v221
  v_max3_f32 v44, v44, v160, v161
  v_exp_f32 v248, v248
  v_max3_f32 v45, v45, v162, v163
  v_mul_f32 v43, v43, v30
  v_mfma_f32_16x16x32_bf16 v[176:179], a[192:195], v[96:99], v[56:59]
  v_mfma_f32_16x16x32_bf16 v[176:179], a[196:199], v[100:103], v[176:179]
  v_mfma_f32_16x16x32_bf16 v[176:179], a[200:203], v[104:107], v[176:179]
  ds_read_b128 a[220:223], v11 offset:12288
  v_mfma_f32_16x16x32_bf16 v[176:179], a[204:207], v[108:111], v[176:179]
  v_exp_f32 v249, v249
  v_max3_f32 v44, v44, v168, v169
  v_cvt_pk_bf16_f32 v219, v222, v223
  v_max3_f32 v45, v45, v170, v171
  v_exp_f32 v250, v250
  v_cvt_pk_bf16_f32 v40, v40, v41
  v_cvt_pk_bf16_f32 v41, v42, v43
  v_mfma_f32_16x16x32_bf16 v[184:187], a[192:195], v[112:115], v[60:63]
  s_waitcnt vmcnt(12)
  s_barrier
  v_mfma_f32_16x16x32_bf16 v[184:187], a[196:199], v[116:119], v[184:187]
  s_add_u32 m0, s44, 65536
  v_mfma_f32_16x16x32_bf16 v[184:187], a[200:203], v[120:123], v[184:187]
  v_mfma_f32_16x16x32_bf16 v[184:187], a[204:207], v[124:127], v[184:187]
  v_exp_f32 v251, v251
  v_max3_f32 v44, v44, v176, v177
  v_cvt_pk_bf16_f32 v248, v248, v249
  v_max3_f32 v45, v45, v178, v179
  v_accvgpr_read_b32 v36, a88
  s_waitcnt lgkmcnt(0)
  v_mfma_f32_16x16x32_bf16 v[164:167], a[208:211], v[64:67], v[20:23]
  buffer_load_dwordx4 v5, s[20:23], s87 offen offset:0 nt lds
  v_mfma_f32_16x16x32_bf16 v[164:167], a[212:215], v[68:71], v[164:167]
  ds_read_b64_tr_b16 a[192:193], v12 offset:32768
  ds_read_b64_tr_b16 a[194:195], v12 offset:36864
  v_mfma_f32_16x16x32_bf16 v[164:167], a[216:219], v[72:75], v[164:167]
  v_mfma_f32_16x16x32_bf16 v[164:167], a[220:223], v[76:79], v[164:167]
  v_exp_f32 v252, v252
  v_max3_f32 v44, v44, v184, v185
  v_exp_f32 v253, v253
  v_accvgpr_read_b32 v37, a89
  v_accvgpr_read_b32 v38, a90
  v_mfma_f32_16x16x32_bf16 v[172:175], a[208:211], v[80:83], v[52:55]
  ds_read_b64_tr_b16 a[196:197], v12 offset:40960
  ds_read_b64_tr_b16 a[198:199], v12 offset:45056
  v_mfma_f32_16x16x32_bf16 v[172:175], a[212:215], v[84:87], v[172:175]
  v_mfma_f32_16x16x32_bf16 v[172:175], a[216:219], v[88:91], v[172:175]
  buffer_load_dwordx4 v6, s[20:23], s87 offen offset:1024 nt lds
  v_mfma_f32_16x16x32_bf16 v[172:175], a[220:223], v[92:95], v[172:175]
  ds_read_b64_tr_b16 a[200:201], v13 offset:32768
  ds_read_b64_tr_b16 a[202:203], v13 offset:36864
  v_cvt_pk_bf16_f32 v249, v250, v251
  v_accvgpr_read_b32 v39, a91
  v_mfma_f32_16x16x32_bf16 v[180:183], a[208:211], v[96:99], v[56:59]
  v_mfma_f32_16x16x32_bf16 v[180:183], a[212:215], v[100:103], v[180:183]
  v_mfma_f32_16x16x32_bf16 v[180:183], a[216:219], v[104:107], v[180:183]
  ds_read_b64_tr_b16 a[204:205], v13 offset:40960
  ds_read_b64_tr_b16 a[206:207], v13 offset:45056
  v_mfma_f32_16x16x32_bf16 v[180:183], a[220:223], v[108:111], v[180:183]
  ds_write_b64 v33, v[40:41] offset:8320
  v_exp_f32 v254, v254
  v_max3_f32 v45, v45, v186, v187
  v_exp_f32 v255, v255
  v_max3_f32 v44, v44, v164, v165
  v_mfma_f32_16x16x32_bf16 v[188:191], a[208:211], v[112:115], v[60:63]
  buffer_load_dwordx4 v5, s[20:23], s87 offen offset:2048 nt lds
  v_mfma_f32_16x16x32_bf16 v[188:191], a[212:215], v[116:119], v[188:191]
  v_mfma_f32_16x16x32_bf16 v[188:191], a[216:219], v[120:123], v[188:191]
  v_mfma_f32_16x16x32_bf16 v[188:191], a[220:223], v[124:127], v[188:191]
  v_cvt_pk_bf16_f32 v250, v252, v253
  v_max3_f32 v45, v45, v166, v167
  v_cvt_pk_bf16_f32 v251, v254, v255
  v_max3_f32 v44, v44, v172, v173
  v_max3_f32 v45, v45, v174, v175
  v_max3_f32 v44, v44, v180, v181
  s_waitcnt lgkmcnt(1)
  v_mfma_f32_16x16x32_bf16 a[128:131], a[192:195], v[192:195], a[128:131]
  buffer_load_dwordx4 v6, s[20:23], s87 offen offset:3072 nt lds
  v_mfma_f32_16x16x32_bf16 a[128:131], a[196:199], v[224:227], a[128:131]
  ds_read_b64_tr_b16 a[208:209], v14 offset:32768
  ds_read_b64_tr_b16 a[210:211], v14 offset:36864
  v_mul_f32 v36, v36, v30
  v_mfma_f32_16x16x32_bf16 a[160:163], a[192:195], v[200:203], a[160:163]
  v_mfma_f32_16x16x32_bf16 a[160:163], a[196:199], v[232:235], a[160:163]
  v_max3_f32 v45, v45, v182, v183
  v_max3_f32 v44, v44, v188, v189
  v_max3_f32 v45, v45, v190, v191
  v_max_f32 v44, v44, v45
  v_mul_f32 v37, v37, v30
  v_mfma_f32_16x16x32_bf16 a[244:247], a[192:195], v[208:211], a[244:247]
  ds_read_b64_tr_b16 a[212:213], v14 offset:40960
  ds_read_b64_tr_b16 a[214:215], v14 offset:45056
  v_mfma_f32_16x16x32_bf16 a[244:247], a[196:199], v[240:243], a[244:247]
  v_cmp_lt_f32 vcc, s48, v44
  v_mul_f32 v38, v38, v30
  v_mfma_f32_16x16x32_bf16 a[20:23], a[192:195], v[216:219], a[20:23]
  v_mfma_f32_16x16x32_bf16 a[20:23], a[196:199], v[248:251], a[20:23]
  ds_read_b64_tr_b16 a[216:217], v15 offset:32768
  ds_read_b64_tr_b16 a[218:219], v15 offset:36864
  s_cbranch_vccnz LS_t11
LS_b11:
  v_exp_f32 v128, v128
  v_mfma_f32_16x16x32_bf16 a[132:135], a[200:203], v[192:195], a[132:135]
  v_mfma_f32_16x16x32_bf16 a[132:135], a[204:207], v[224:227], a[132:135]
  v_exp_f32 v129, v129
  v_exp_f32 v130, v130
  v_mul_f32 v39, v39, v30
  v_mfma_f32_16x16x32_bf16 a[224:227], a[240:243], v[192:195], a[224:227]
  v_exp_f32 v131, v131
  v_mfma_f32_16x16x32_bf16 a[224:227], a[240:243], v[224:227], a[224:227]
  v_cvt_pk_bf16_f32 v128, v128, v129
  v_exp_f32 v132, v132
  v_mfma_f32_16x16x32_bf16 a[164:167], a[200:203], v[200:203], a[164:167]
  ds_read_b64_tr_b16 a[220:221], v15 offset:40960
  ds_read_b64_tr_b16 a[222:223], v15 offset:45056
  v_mfma_f32_16x16x32_bf16 a[164:167], a[204:207], v[232:235], a[164:167]
  v_exp_f32 v133, v133
  v_cvt_pk_bf16_f32 v36, v36, v37
  v_mfma_f32_16x16x32_bf16 a[248:251], a[200:203], v[208:211], a[248:251]
  v_mfma_f32_16x16x32_bf16 a[248:251], a[204:207], v[240:243], a[248:251]
  v_cvt_pk_bf16_f32 v129, v130, v131
  v_exp_f32 v134, v134
  v_cvt_pk_bf16_f32 v37, v38, v39
  v_mfma_f32_16x16x32_bf16 a[24:27], a[200:203], v[216:219], a[24:27]
  v_mfma_f32_16x16x32_bf16 a[24:27], a[204:207], v[248:251], a[24:27]
  v_exp_f32 v135, v135
  v_cvt_pk_bf16_f32 v130, v132, v133
  s_waitcnt lgkmcnt(0)
  v_mfma_f32_16x16x32_bf16 a[136:139], a[208:211], v[192:195], a[136:139]
  v_mfma_f32_16x16x32_bf16 a[136:139], a[212:215], v[224:227], a[136:139]
  ds_read_b64_tr_b16 a[192:193], v16 offset:32768
  ds_read_b64_tr_b16 a[194:195], v16 offset:36864
  v_exp_f32 v160, v160
  v_accvgpr_read_b32 v40, a92
  v_mfma_f32_16x16x32_bf16 a[168:171], a[208:211], v[200:203], a[168:171]
  v_mfma_f32_16x16x32_bf16 a[168:171], a[212:215], v[232:235], a[168:171]
  v_exp_f32 v161, v161
  v_cvt_pk_bf16_f32 v131, v134, v135
  v_exp_f32 v162, v162
  v_accvgpr_read_b32 v41, a93
  v_mfma_f32_16x16x32_bf16 a[252:255], a[208:211], v[208:211], a[252:255]
  ds_read_b64_tr_b16 a[196:197], v16 offset:40960
  ds_read_b64_tr_b16 a[198:199], v16 offset:45056
  v_mfma_f32_16x16x32_bf16 a[252:255], a[212:215], v[240:243], a[252:255]
  v_exp_f32 v163, v163
  v_accvgpr_read_b32 v42, a94
  v_mfma_f32_16x16x32_bf16 a[28:31], a[208:211], v[216:219], a[28:31]
  v_mfma_f32_16x16x32_bf16 a[28:31], a[212:215], v[248:251], a[28:31]
  ds_read_b64_tr_b16 a[200:201], v17 offset:32768
  ds_read_b64_tr_b16 a[202:203], v17 offset:36864
  v_cvt_pk_bf16_f32 v160, v160, v161
  v_mfma_f32_16x16x32_bf16 a[140:143], a[216:219], v[192:195], a[140:143]
  v_mfma_f32_16x16x32_bf16 a[140:143], a[220:223], v[224:227], a[140:143]
  v_exp_f32 v164, v164
  v_exp_f32 v165, v165
  v_cvt_pk_bf16_f32 v161, v162, v163
  v_accvgpr_read_b32 v43, a95
  v_mfma_f32_16x16x32_bf16 a[228:231], a[240:243], v[200:203], a[228:231]
  v_exp_f32 v166, v166
  v_mfma_f32_16x16x32_bf16 a[228:231], a[240:243], v[232:235], a[228:231]
  v_exp_f32 v167, v167
  v_mfma_f32_16x16x32_bf16 a[172:175], a[216:219], v[200:203], a[172:175]
  ds_read_b64_tr_b16 a[204:205], v17 offset:40960
  ds_read_b64_tr_b16 a[206:207], v17 offset:45056
  v_mfma_f32_16x16x32_bf16 a[172:175], a[220:223], v[232:235], a[172:175]
  v_cvt_pk_bf16_f32 v162, v164, v165
  v_exp_f32 v136, v136
  v_mfma_f32_16x16x32_bf16 a[0:3], a[216:219], v[208:211], a[0:3]
  v_mfma_f32_16x16x32_bf16 a[0:3], a[220:223], v[240:243], a[0:3]
  ds_write_b64 v34, v[36:37] offset:8320
  v_exp_f32 v137, v137
  v_cvt_pk_bf16_f32 v163, v166, v167
  v_mfma_f32_16x16x32_bf16 a[32:35], a[216:219], v[216:219], a[32:35]
  v_mfma_f32_16x16x32_bf16 a[32:35], a[220:223], v[248:251], a[32:35]
  v_exp_f32 v138, v138
  s_waitcnt lgkmcnt(1)
  v_mfma_f32_16x16x32_bf16 a[144:147], a[192:195], v[192:195], a[144:147]
  v_mfma_f32_16x16x32_bf16 a[144:147], a[196:199], v[224:227], a[144:147]
  ds_read_b64_tr_b16 a[208:209], v18 offset:32768
  ds_read_b64_tr_b16 a[210:211], v18 offset:36864
  v_exp_f32 v139, v139
  v_cvt_pk_bf16_f32 v136, v136, v137
  v_mfma_f32_16x16x32_bf16 a[176:179], a[192:195], v[200:203], a[176:179]
  v_mfma_f32_16x16x32_bf16 a[176:179], a[196:199], v[232:235], a[176:179]
  v_exp_f32 v140, v140
  v_exp_f32 v141, v141
  v_mul_f32 v40, v40, v30
  v_mfma_f32_16x16x32_bf16 a[4:7], a[192:195], v[208:211], a[4:7]
  ds_read_b64_tr_b16 a[212:213], v18 offset:40960
  ds_read_b64_tr_b16 a[214:215], v18 offset:45056
  v_mfma_f32_16x16x32_bf16 a[4:7], a[196:199], v[240:243], a[4:7]
  v_cvt_pk_bf16_f32 v137, v138, v139
  v_exp_f32 v142, v142
  v_mul_f32 v41, v41, v30
  v_mfma_f32_16x16x32_bf16 a[36:39], a[192:195], v[216:219], a[36:39]
  v_mfma_f32_16x16x32_bf16 a[36:39], a[196:199], v[248:251], a[36:39]
  ds_read_b64_tr_b16 a[216:217], v19 offset:32768
  ds_read_b64_tr_b16 a[218:219], v19 offset:36864
  v_exp_f32 v143, v143
  v_mul_f32 v42, v42, v30
  v_mfma_f32_16x16x32_bf16 a[148:151], a[200:203], v[192:195], a[148:151]
  v_mfma_f32_16x16x32_bf16 a[148:151], a[204:207], v[224:227], a[148:151]
  v_cvt_pk_bf16_f32 v138, v140, v141
  v_exp_f32 v168, v168
  v_mfma_f32_16x16x32_bf16 a[232:235], a[240:243], v[208:211], a[232:235]
  v_exp_f32 v169, v169
  v_mfma_f32_16x16x32_bf16 a[232:235], a[240:243], v[240:243], a[232:235]
  v_cvt_pk_bf16_f32 v139, v142, v143
  v_exp_f32 v170, v170
  v_mfma_f32_16x16x32_bf16 a[180:183], a[200:203], v[200:203], a[180:183]
  ds_read_b64_tr_b16 a[220:221], v19 offset:40960
  ds_read_b64_tr_b16 a[222:223], v19 offset:45056
  v_mfma_f32_16x16x32_bf16 a[180:183], a[204:207], v[232:235], a[180:183]
  v_exp_f32 v171, v171
  v_mul_f32 v43, v43, v30
  v_mfma_f32_16x16x32_bf16 a[8:11], a[200:203], v[208:211], a[8:11]
  s_waitcnt vmcnt(12)
  s_barrier
  v_mfma_f32_16x16x32_bf16 a[8:11], a[204:207], v[240:243], a[8:11]
  s_add_u32 m0, s44, 0
  v_cvt_pk_bf16_f32 v168, v168, v169
  v_cvt_pk_bf16_f32 v40, v40, v41
  v_mfma_f32_16x16x32_bf16 a[40:43], a[200:203], v[216:219], a[40:43]
  v_mfma_f32_16x16x32_bf16 a[40:43], a[204:207], v[248:251], a[40:43]
  v_exp_f32 v172, v172
  v_cvt_pk_bf16_f32 v41, v42, v43
  s_waitcnt lgkmcnt(0)
  v_mfma_f32_16x16x32_bf16 a[152:155], a[208:211], v[192:195], a[152:155]
  buffer_load_dwordx4 v1, s[16:19], s89 offen offset:0 nt lds
  v_mfma_f32_16x16x32_bf16 a[152:155], a[212:215], v[224:227], a[152:155]
  ds_read_b128 a[192:195], v8 offset:16384
  v_exp_f32 v173, v173
  v_mfma_f32_16x16x32_bf16 a[184:187], a[208:211], v[200:203], a[184:187]
  v_mfma_f32_16x16x32_bf16 a[184:187], a[212:215], v[232:235], a[184:187]
  v_cvt_pk_bf16_f32 v169, v170, v171
  v_exp_f32 v174, v174
  v_accvgpr_read_b32 v36, a96
  v_mfma_f32_16x16x32_bf16 a[12:15], a[208:211], v[208:211], a[12:15]
  ds_read_b128 a[196:199], v9 offset:16384
  v_mfma_f32_16x16x32_bf16 a[12:15], a[212:215], v[240:243], a[12:15]
  v_exp_f32 v175, v175
  v_cvt_pk_bf16_f32 v170, v172, v173
  v_accvgpr_read_b32 v37, a97
  v_mfma_f32_16x16x32_bf16 a[44:47], a[208:211], v[216:219], a[44:47]
  buffer_load_dwordx4 v2, s[16:19], s89 offen offset:1024 nt lds
  v_mfma_f32_16x16x32_bf16 a[44:47], a[212:215], v[248:251], a[44:47]
  ds_read_b128 a[200:203], v10 offset:16384
  v_exp_f32 v144, v144
  v_accvgpr_read_b32 v38, a98
  v_mfma_f32_16x16x32_bf16 a[156:159], a[216:219], v[192:195], a[156:159]
  v_mfma_f32_16x16x32_bf16 a[156:159], a[220:223], v[224:227], a[156:159]
  v_exp_f32 v145, v145
  v_cvt_pk_bf16_f32 v171, v174, v175
  v_exp_f32 v146, v146
  v_mfma_f32_16x16x32_bf16 a[236:239], a[240:243], v[216:219], a[236:239]
  v_exp_f32 v147, v147
  v_mfma_f32_16x16x32_bf16 a[236:239], a[240:243], v[248:251], a[236:239]
  v_cvt_pk_bf16_f32 v144, v144, v145
  v_accvgpr_read_b32 v39, a99
  v_mfma_f32_16x16x32_bf16 a[188:191], a[216:219], v[200:203], a[188:191]
  ds_read_b128 a[204:207], v11 offset:16384
  v_mfma_f32_16x16x32_bf16 a[188:191], a[220:223], v[232:235], a[188:191]
  v_exp_f32 v148, v148
  v_exp_f32 v149, v149
  v_mfma_f32_16x16x32_bf16 a[16:19], a[216:219], v[208:211], a[16:19]
  buffer_load_dwordx4 v3, s[16:19], s89 offen offset:2048 nt lds
  v_mfma_f32_16x16x32_bf16 a[16:19], a[220:223], v[240:243], a[16:19]
  v_cvt_pk_bf16_f32 v145, v146, v147
  v_exp_f32 v150, v150
  v_mfma_f32_16x16x32_bf16 v[48:51], a[216:219], v[216:219], v[48:51]
  v_mfma_f32_16x16x32_bf16 v[48:51], a[220:223], v[248:251], v[48:51]
  v_exp_f32 v151, v151
  s_waitcnt lgkmcnt(0)
  s_cbranch_vccnz LS_t25
LS_b25:
  v_mfma_f32_16x16x32_bf16 v[192:195], a[192:195], v[64:67], v[20:23]
  buffer_load_dwordx4 v4, s[16:19], s89 offen offset:3072 nt lds
  ds_write_b64 v35, v[40:41] offset:8320
  v_mfma_f32_16x16x32_bf16 v[192:195], a[196:199], v[68:71], v[192:195]
  ds_read_b128 a[208:211], v8 offset:20480
  v_mfma_f32_16x16x32_bf16 v[192:195], a[200:203], v[72:75], v[192:195]
  v_mfma_f32_16x16x32_bf16 v[192:195], a[204:207], v[76:79], v[192:195]
  v_cvt_pk_bf16_f32 v146, v148, v149
  v_exp_f32 v176, v176
  v_exp_f32 v177, v177
  v_mfma_f32_16x16x32_bf16 v[200:203], a[192:195], v[80:83], v[52:55]
  ds_read_b128 a[212:215], v9 offset:20480
  v_mfma_f32_16x16x32_bf16 v[200:203], a[196:199], v[84:87], v[200:203]
  v_mfma_f32_16x16x32_bf16 v[200:203], a[200:203], v[88:91], v[200:203]
  v_mfma_f32_16x16x32_bf16 v[200:203], a[204:207], v[92:95], v[200:203]
  ds_read_b128 a[216:219], v10 offset:20480
  v_cvt_pk_bf16_f32 v147, v150, v151
  v_max_f32 v44, v192, v193
  v_exp_f32 v178, v178
  v_max_f32 v45, v194, v195
  v_mul_f32 v36, v36, v31
  v_mfma_f32_16x16x32_bf16 v[208:211], a[192:195], v[96:99], v[56:59]
  v_mfma_f32_16x16x32_bf16 v[208:211], a[196:199], v[100:103], v[208:211]
  v_mfma_f32_16x16x32_bf16 v[208:211], a[200:203], v[104:107], v[208:211]
  ds_read_b128 a[220:223], v11 offset:20480
  v_mfma_f32_16x16x32_bf16 v[208:211], a[204:207], v[108:111], v[208:211]
  v_exp_f32 v179, v179
  v_max3_f32 v44, v44, v200, v201
  v_cvt_pk_bf16_f32 v176, v176, v177
  v_max3_f32 v45, v45, v202, v203
  v_exp_f32 v180, v180
  v_mul_f32 v37, v37, v31
  v_mul_f32 v38, v38, v31
  v_mfma_f32_16x16x32_bf16 v[216:219], a[192:195], v[112:115], v[60:63]
  v_mfma_f32_16x16x32_bf16 v[216:219], a[196:199], v[116:119], v[216:219]
  v_mfma_f32_16x16x32_bf16 v[216:219], a[200:203], v[120:123], v[216:219]
  v_mfma_f32_16x16x32_bf16 v[216:219], a[204:207], v[124:127], v[216:219]
  v_exp_f32 v181, v181
  v_max3_f32 v44, v44, v208, v209
  v_cvt_pk_bf16_f32 v177, v178, v179
  v_max3_f32 v45, v45, v210, v211
  v_exp_f32 v182, v182
  v_mul_f32 v39, v39, v31
  s_waitcnt lgkmcnt(0)
  v_mfma_f32_16x16x32_bf16 v[196:199], a[208:211], v[64:67], v[20:23]
  v_mfma_f32_16x16x32_bf16 v[196:199], a[212:215], v[68:71], v[196:199]
  ds_read_b128 a[192:195], v8 offset:24576
  v_mfma_f32_16x16x32_bf16 v[196:199], a[216:219], v[72:75], v[196:199]
  v_mfma_f32_16x16x32_bf16 v[196:199], a[220:223], v[76:79], v[196:199]
  v_exp_f32 v183, v183
  v_max3_f32 v44, v44, v216, v217
  v_cvt_pk_bf16_f32 v178, v180, v181
  v_max3_f32 v45, v45, v218, v219
  v_exp_f32 v152, v152
  v_exp_f32 v153, v153
  v_cvt_pk_bf16_f32 v36, v36, v37
  v_cvt_pk_bf16_f32 v37, v38, v39
  v_mfma_f32_16x16x32_bf16 v[204:207], a[208:211], v[80:83], v[52:55]
  ds_read_b128 a[196:199], v9 offset:24576
  v_mfma_f32_16x16x32_bf16 v[204:207], a[212:215], v[84:87], v[204:207]
  v_mfma_f32_16x16x32_bf16 v[204:207], a[216:219], v[88:91], v[204:207]
  v_mfma_f32_16x16x32_bf16 v[204:207], a[220:223], v[92:95], v[204:207]
  ds_read_b128 a[200:203], v10 offset:24576
  v_cvt_pk_bf16_f32 v179, v182, v183
  v_max3_f32 v44, v44, v196, v197
  v_exp_f32 v154, v154
  v_max3_f32 v45, v45, v198, v199
  v_accvgpr_read_b32 v40, a100
  v_mfma_f32_16x16x32_bf16 v[212:215], a[208:211], v[96:99], v[56:59]
  v_mfma_f32_16x16x32_bf16 v[212:215], a[212:215], v[100:103], v[212:215]
  v_mfma_f32_16x16x32_bf16 v[212:215], a[216:219], v[104:107], v[212:215]
  ds_read_b128 a[204:207], v11 offset:24576
  v_mfma_f32_16x16x32_bf16 v[212:215], a[220:223], v[108:111], v[212:215]
  v_exp_f32 v155, v155
  v_max3_f32 v44, v44, v204, v205
  v_cvt_pk_bf16_f32 v152, v152, v153
  v_max3_f32 v45, v45, v206, v207
  v_exp_f32 v156, v156
  v_accvgpr_read_b32 v41, a101
  v_accvgpr_read_b32 v42, a102
  v_mfma_f32_16x16x32_bf16 v[220:223], a[208:211], v[112:115], v[60:63]
  v_mfma_f32_16x16x32_bf16 v[220:223], a[212:215], v[116:119], v[220:223]
  v_mfma_f32_16x16x32_bf16 v[220:223], a[216:219], v[120:123], v[220:223]
  v_mfma_f32_16x16x32_bf16 v[220:223], a[220:223], v[124:127], v[220:223]
  v_exp_f32 v157, v157
  v_max3_f32 v44, v44, v212, v213
  v_cvt_pk_bf16_f32 v153, v154, v155
  v_max3_f32 v45, v45, v214, v215
  v_exp_f32 v158, v158
  v_accvgpr_read_b32 v43, a103
  s_waitcnt lgkmcnt(0)
  v_mfma_f32_16x16x32_bf16 v[224:227], a[192:195], v[64:67], v[20:23]
  v_mfma_f32_16x16x32_bf16 v[224:227], a[196:199], v[68:71], v[224:227]
  ds_read_b128 a[208:211], v8 offset:28672
  v_mfma_f32_16x16x32_bf16 v[224:227], a[200:203], v[72:75], v[224:227]
  v_mfma_f32_16x16x32_bf16 v[224:227], a[204:207], v[76:79], v[224:227]
  ds_write_b64 v32, v[36:37] offset:12288
  v_exp_f32 v159, v159
  v_max3_f32 v44, v44, v220, v221
  v_cvt_pk_bf16_f32 v154, v156, v157
  v_max3_f32 v45, v45, v222, v223
  v_exp_f32 v184, v184
  v_mfma_f32_16x16x32_bf16 v[232:235], a[192:195], v[80:83], v[52:55]
  ds_read_b128 a[212:215], v9 offset:28672
  v_mfma_f32_16x16x32_bf16 v[232:235], a[196:199], v[84:87], v[232:235]
  v_mfma_f32_16x16x32_bf16 v[232:235], a[200:203], v[88:91], v[232:235]
  v_mfma_f32_16x16x32_bf16 v[232:235], a[204:207], v[92:95], v[232:235]
  ds_read_b128 a[216:219], v10 offset:28672
  v_exp_f32 v185, v185
  v_max3_f32 v44, v44, v224, v225
  v_cvt_pk_bf16_f32 v155, v158, v159
  v_max3_f32 v45, v45, v226, v227
  v_exp_f32 v186, v186
  v_mfma_f32_16x16x32_bf16 v[240:243], a[192:195], v[96:99], v[56:59]
  v_mfma_f32_16x16x32_bf16 v[240:243], a[196:199], v[100:103], v[240:243]
  v_mfma_f32_16x16x32_bf16 v[240:243], a[200:203], v[104:107], v[240:243]
  ds_read_b128 a[220:223], v11 offset:28672
  v_mfma_f32_16x16x32_bf16 v[240:243], a[204:207], v[108:111], v[240:243]
  v_exp_f32 v187, v187
  v_max3_f32 v44, v44, v232, v233
  v_cvt_pk_bf16_f32 v184, v184, v185
  v_max3_f32 v45, v45, v234, v235
  v_exp_f32 v188, v188
  v_mul_f32 v40, v40, v31
  v_mul_f32 v41, v41, v31
  v_mfma_f32_16x16x32_bf16 v[248:251], a[192:195], v[112:115], v[60:63]
  s_waitcnt vmcnt(12)
  s_barrier
  v_mfma_f32_16x16x32_bf16 v[248:251], a[196:199], v[116:119], v[248:251]
  s_add_u32 m0, s44, 81920
  v_mfma_f32_16x16x32_bf16 v[248:251], a[200:203], v[120:123], v[248:251]
  v_mfma_f32_16x16x32_bf16 v[248:251], a[204:207], v[124:127], v[248:251]
  v_exp_f32 v189, v189
  v_max3_f32 v44, v44, v240, v241
  v_cvt_pk_bf16_f32 v185, v186, v187
  v_mul_f32 v42, v42, v31
  s_waitcnt lgkmcnt(0)
  v_mfma_f32_16x16x32_bf16 v[228:231], a[208:211], v[64:67], v[20:23]
  buffer_load_dwordx4 v5, s[20:23], s88 offen offset:0 nt lds
  v_mfma_f32_16x16x32_bf16 v[228:231], a[212:215], v[68:71], v[228:231]
  ds_read_b64_tr_b16 a[192:193], v12 offset:0
  ds_read_b64_tr_b16 a[194:195], v12 offset:4096
  v_mfma_f32_16x16x32_bf16 v[228:231], a[216:219], v[72:75], v[228:231]
  v_mfma_f32_16x16x32_bf16 v[228:231], a[220:223], v[76:79], v[228:231]
  v_exp_f32 v190, v190
  v_max3_f32 v45, v45, v242, v243
  v_exp_f32 v191, v191
  v_mul_f32 v43, v43, v31
  v_cvt_pk_bf16_f32 v40, v40, v41
  v_mfma_f32_16x16x32_bf16 v[236:239], a[208:211], v[80:83], v[52:55]
  ds_read_b64_tr_b16 a[196:197], v12 offset:8192
  ds_read_b64_tr_b16 a[198:199], v12 offset:12288
  v_mfma_f32_16x16x32_bf16 v[236:239], a[212:215], v[84:87], v[236:239]
  v_mfma_f32_16x16x32_bf16 v[236:239], a[216:219], v[88:91], v[236:239]
  buffer_load_dwordx4 v6, s[20:23], s88 offen offset:1024 nt lds
  v_mfma_f32_16x16x32_bf16 v[236:239], a[220:223], v[92:95], v[236:239]
  ds_read_b64_tr_b16 a[200:201], v13 offset:0
  ds_read_b64_tr_b16 a[202:203], v13 offset:4096
  v_cvt_pk_bf16_f32 v186, v188, v189
  v_cvt_pk_bf16_f32 v41, v42, v43
  v_mfma_f32_16x16x32_bf16 v[244:247], a[208:211], v[96:99], v[56:59]
  v_mfma_f32_16x16x32_bf16 v[244:247], a[212:215], v[100:103], v[244:247]
  v_mfma_f32_16x16x32_bf16 v[244:247], a[216:219], v[104:107], v[244:247]
  ds_read_b64_tr_b16 a[204:205], v13 offset:8192
  ds_read_b64_tr_b16 a[206:207], v13 offset:12288
  v_mfma_f32_16x16x32_bf16 v[244:247], a[220:223], v[108:111], v[244:247]
  v_cvt_pk_bf16_f32 v187, v190, v191
  v_max3_f32 v44, v44, v248, v249
  v_max3_f32 v45, v45, v250, v251
  v_max3_f32 v44, v44, v228, v229
  v_max3_f32 v45, v45, v230, v231
  v_max3_f32 v44, v44, v236, v237
  v_max3_f32 v45, v45, v238, v239
  v_accvgpr_read_b32 v36, a104
  v_accvgpr_read_b32 v37, a105
  v_mfma_f32_16x16x32_bf16 v[252:255], a[208:211], v[112:115], v[60:63]
  buffer_load_dwordx4 v5, s[20:23], s88 offen offset:2048 nt lds
  v_mfma_f32_16x16x32_bf16 v[252:255], a[212:215], v[116:119], v[252:255]
  v_mfma_f32_16x16x32_bf16 v[252:255], a[216:219], v[120:123], v[252:255]
  v_mfma_f32_16x16x32_bf16 v[252:255], a[220:223], v[124:127], v[252:255]
  v_max3_f32 v44, v44, v244, v245
  v_max3_f32 v45, v45, v246, v247
  v_accvgpr_read_b32 v38, a106
  s_waitcnt lgkmcnt(0)
  v_mfma_f32_16x16x32_bf16 a[128:131], a[192:195], v[128:131], a[128:131]
  buffer_load_dwordx4 v6, s[20:23], s88 offen offset:3072 nt lds
  v_mfma_f32_16x16x32_bf16 a[128:131], a[196:199], v[160:163], a[128:131]
  ds_read_b64_tr_b16 a[208:209], v14 offset:0
  ds_read_b64_tr_b16 a[210:211], v14 offset:4096
  v_accvgpr_read_b32 v39, a107
  v_mfma_f32_16x16x32_bf16 a[160:163], a[192:195], v[136:139], a[160:163]
  v_mfma_f32_16x16x32_bf16 a[160:163], a[196:199], v[168:171], a[160:163]
  v_max3_f32 v44, v44, v252, v253
  v_max3_f32 v45, v45, v254, v255
  v_max_f32 v44, v44, v45
  v_cmp_lt_f32 vcc, s48, v44
  v_mfma_f32_16x16x32_bf16 a[244:247], a[192:195], v[144:147], a[244:247]
  ds_read_b64_tr_b16 a[212:213], v14 offset:8192
  ds_read_b64_tr_b16 a[214:215], v14 offset:12288
  v_mfma_f32_16x16x32_bf16 a[244:247], a[196:199], v[176:179], a[244:247]
  s_cbranch_vccnz LS_t12
LS_b12:
  v_exp_f32 v192, v192
  v_exp_f32 v193, v193
  v_mfma_f32_16x16x32_bf16 a[20:23], a[192:195], v[152:155], a[20:23]
  v_mfma_f32_16x16x32_bf16 a[20:23], a[196:199], v[184:187], a[20:23]
  ds_read_b64_tr_b16 a[216:217], v15 offset:0
  ds_read_b64_tr_b16 a[218:219], v15 offset:4096
  ds_write_b64 v33, v[40:41] offset:12288
  v_exp_f32 v194, v194
  v_mfma_f32_16x16x32_bf16 a[132:135], a[200:203], v[128:131], a[132:135]
  v_mfma_f32_16x16x32_bf16 a[132:135], a[204:207], v[160:163], a[132:135]
  v_exp_f32 v195, v195
  v_cvt_pk_bf16_f32 v192, v192, v193
  v_exp_f32 v196, v196
  v_mfma_f32_16x16x32_bf16 a[224:227], a[240:243], v[128:131], a[224:227]
  v_exp_f32 v197, v197
  v_mfma_f32_16x16x32_bf16 a[224:227], a[240:243], v[160:163], a[224:227]
  v_cvt_pk_bf16_f32 v193, v194, v195
  v_mul_f32 v36, v36, v31
  v_mfma_f32_16x16x32_bf16 a[164:167], a[200:203], v[136:139], a[164:167]
  ds_read_b64_tr_b16 a[220:221], v15 offset:8192
  ds_read_b64_tr_b16 a[222:223], v15 offset:12288
  v_mfma_f32_16x16x32_bf16 a[164:167], a[204:207], v[168:171], a[164:167]
  v_exp_f32 v198, v198
  v_mfma_f32_16x16x32_bf16 a[248:251], a[200:203], v[144:147], a[248:251]
  v_mfma_f32_16x16x32_bf16 a[248:251], a[204:207], v[176:179], a[248:251]
  v_exp_f32 v199, v199
  v_cvt_pk_bf16_f32 v194, v196, v197
  v_exp_f32 v224, v224
  v_mfma_f32_16x16x32_bf16 a[24:27], a[200:203], v[152:155], a[24:27]
  v_mfma_f32_16x16x32_bf16 a[24:27], a[204:207], v[184:187], a[24:27]
  v_exp_f32 v225, v225
  v_mul_f32 v37, v37, v31
  s_waitcnt lgkmcnt(0)
  v_mfma_f32_16x16x32_bf16 a[136:139], a[208:211], v[128:131], a[136:139]
  v_mfma_f32_16x16x32_bf16 a[136:139], a[212:215], v[160:163], a[136:139]
  ds_read_b64_tr_b16 a[192:193], v16 offset:0
  ds_read_b64_tr_b16 a[194:195], v16 offset:4096
  v_cvt_pk_bf16_f32 v195, v198, v199
  v_exp_f32 v226, v226
  v_mul_f32 v38, v38, v31
  v_mfma_f32_16x16x32_bf16 a[168:171], a[208:211], v[136:139], a[168:171]
  v_mfma_f32_16x16x32_bf16 a[168:171], a[212:215], v[168:171], a[168:171]
  v_exp_f32 v227, v227
  v_cvt_pk_bf16_f32 v224, v224, v225
  v_mfma_f32_16x16x32_bf16 a[252:255], a[208:211], v[144:147], a[252:255]
  ds_read_b64_tr_b16 a[196:197], v16 offset:8192
  ds_read_b64_tr_b16 a[198:199], v16 offset:12288
  v_mfma_f32_16x16x32_bf16 a[252:255], a[212:215], v[176:179], a[252:255]
  v_exp_f32 v228, v228
  v_mul_f32 v39, v39, v31
  v_mfma_f32_16x16x32_bf16 a[28:31], a[208:211], v[152:155], a[28:31]
  v_mfma_f32_16x16x32_bf16 a[28:31], a[212:215], v[184:187], a[28:31]
  ds_read_b64_tr_b16 a[200:201], v17 offset:0
  ds_read_b64_tr_b16 a[202:203], v17 offset:4096
  v_exp_f32 v229, v229
  v_cvt_pk_bf16_f32 v225, v226, v227
  v_cvt_pk_bf16_f32 v36, v36, v37
  v_mfma_f32_16x16x32_bf16 a[140:143], a[216:219], v[128:131], a[140:143]
  v_mfma_f32_16x16x32_bf16 a[140:143], a[220:223], v[160:163], a[140:143]
  v_exp_f32 v230, v230
  v_exp_f32 v231, v231
  v_mfma_f32_16x16x32_bf16 a[228:231], a[240:243], v[136:139], a[228:231]
  v_cvt_pk_bf16_f32 v226, v228, v229
  v_cvt_pk_bf16_f32 v37, v38, v39
  v_mfma_f32_16x16x32_bf16 a[228:231], a[240:243], v[168:171], a[228:231]
  v_exp_f32 v200, v200
  v_mfma_f32_16x16x32_bf16 a[172:175], a[216:219], v[136:139], a[172:175]
  ds_read_b64_tr_b16 a[204:205], v17 offset:8192
  ds_read_b64_tr_b16 a[206:207], v17 offset:12288
  v_mfma_f32_16x16x32_bf16 a[172:175], a[220:223], v[168:171], a[172:175]
  v_exp_f32 v201, v201
  v_cvt_pk_bf16_f32 v227, v230, v231
  v_mfma_f32_16x16x32_bf16 a[0:3], a[216:219], v[144:147], a[0:3]
  v_mfma_f32_16x16x32_bf16 a[0:3], a[220:223], v[176:179], a[0:3]
  v_exp_f32 v202, v202
  v_exp_f32 v203, v203
  v_mfma_f32_16x16x32_bf16 a[32:35], a[216:219], v[152:155], a[32:35]
  v_mfma_f32_16x16x32_bf16 a[32:35], a[220:223], v[184:187], a[32:35]
  v_cvt_pk_bf16_f32 v200, v200, v201
  v_exp_f32 v204, v204
  s_waitcnt lgkmcnt(0)
  v_mfma_f32_16x16x32_bf16 a[144:147], a[192:195], v[128:131], a[144:147]
  ds_write_b64 v34, v[36:37] offset:12288
  v_mfma_f32_16x16x32_bf16 a[144:147], a[196:199], v[160:163], a[144:147]
  ds_read_b64_tr_b16 a[208:209], v18 offset:0
  ds_read_b64_tr_b16 a[210:211], v18 offset:4096
  v_exp_f32 v205, v205
  v_mfma_f32_16x16x32_bf16 a[176:179], a[192:195], v[136:139], a[176:179]
  v_mfma_f32_16x16x32_bf16 a[176:179], a[196:199], v[168:171], a[176:179]
  s_waitcnt lgkmcnt(2)
  v_cvt_pk_bf16_f32 v201, v202, v203
  v_exp_f32 v206, v206
  v_exp_f32 v207, v207
  v_mfma_f32_16x16x32_bf16 a[4:7], a[192:195], v[144:147], a[4:7]
  ds_read_b64_tr_b16 a[212:213], v18 offset:8192
  ds_read_b64_tr_b16 a[214:215], v18 offset:12288
  v_mfma_f32_16x16x32_bf16 a[4:7], a[196:199], v[176:179], a[4:7]
  v_cvt_pk_bf16_f32 v202, v204, v205
  v_exp_f32 v232, v232
  v_mfma_f32_16x16x32_bf16 a[36:39], a[192:195], v[152:155], a[36:39]
  ds_read_b128 a[80:83], v46 offset:8192
  v_mfma_f32_16x16x32_bf16 a[36:39], a[196:199], v[184:187], a[36:39]
  ds_read_b64_tr_b16 a[216:217], v19 offset:0
  ds_read_b64_tr_b16 a[218:219], v19 offset:4096
  v_mfma_f32_16x16x32_bf16 a[148:151], a[200:203], v[128:131], a[148:151]
  v_mfma_f32_16x16x32_bf16 a[148:151], a[204:207], v[160:163], a[148:151]
  ds_read_b128 a[88:91], v46 offset:10240
  v_exp_f32 v233, v233
  v_cvt_pk_bf16_f32 v203, v206, v207
  v_exp_f32 v234, v234
  v_mfma_f32_16x16x32_bf16 a[232:235], a[240:243], v[144:147], a[232:235]
  v_exp_f32 v235, v235
  v_mfma_f32_16x16x32_bf16 a[232:235], a[240:243], v[176:179], a[232:235]
  v_cvt_pk_bf16_f32 v232, v232, v233
  v_xor_b32 v46, 64, v46
  v_mfma_f32_16x16x32_bf16 a[180:183], a[200:203], v[136:139], a[180:183]
  ds_read_b64_tr_b16 a[220:221], v19 offset:8192
  ds_read_b64_tr_b16 a[222:223], v19 offset:12288
  v_mfma_f32_16x16x32_bf16 a[180:183], a[204:207], v[168:171], a[180:183]
  v_exp_f32 v236, v236
  v_mfma_f32_16x16x32_bf16 a[8:11], a[200:203], v[144:147], a[8:11]
  s_waitcnt vmcnt(12)
  s_barrier
  v_mfma_f32_16x16x32_bf16 a[8:11], a[204:207], v[176:179], a[8:11]
  s_add_u32 m0, s44, 16384
  v_exp_f32 v237, v237
  v_mfma_f32_16x16x32_bf16 a[40:43], a[200:203], v[152:155], a[40:43]
  ds_read_b128 a[84:87], v46 offset:9216
  v_mfma_f32_16x16x32_bf16 a[40:43], a[204:207], v[184:187], a[40:43]
  v_cvt_pk_bf16_f32 v233, v234, v235
  v_exp_f32 v238, v238
  s_waitcnt lgkmcnt(1)
  v_mfma_f32_16x16x32_bf16 a[152:155], a[208:211], v[128:131], a[152:155]
  buffer_load_dwordx4 v5, s[20:23], s89 offen offset:0 nt lds
  v_mfma_f32_16x16x32_bf16 a[152:155], a[212:215], v[160:163], a[152:155]
  ds_read_b128 a[192:195], v8 offset:32768
  ds_read_b128 a[92:95], v46 offset:11264
  v_mfma_f32_16x16x32_bf16 a[184:187], a[208:211], v[136:139], a[184:187]
  v_mfma_f32_16x16x32_bf16 a[184:187], a[212:215], v[168:171], a[184:187]
  v_exp_f32 v239, v239
  v_cvt_pk_bf16_f32 v234, v236, v237
  v_exp_f32 v208, v208
  v_mfma_f32_16x16x32_bf16 a[12:15], a[208:211], v[144:147], a[12:15]
  ds_read_b128 a[196:199], v9 offset:32768
  v_mfma_f32_16x16x32_bf16 a[12:15], a[212:215], v[176:179], a[12:15]
  v_exp_f32 v209, v209
  v_cvt_pk_bf16_f32 v235, v238, v239
  v_mfma_f32_16x16x32_bf16 a[44:47], a[208:211], v[152:155], a[44:47]
  buffer_load_dwordx4 v6, s[20:23], s89 offen offset:1024 nt lds
  v_mfma_f32_16x16x32_bf16 a[44:47], a[212:215], v[184:187], a[44:47]
  ds_read_b128 a[200:203], v10 offset:32768
  v_exp_f32 v210, v210
  v_accvgpr_read_b32 v40, a108
  v_mfma_f32_16x16x32_bf16 a[156:159], a[216:219], v[128:131], a[156:159]
  v_mfma_f32_16x16x32_bf16 a[156:159], a[220:223], v[160:163], a[156:159]
  v_exp_f32 v211, v211
  v_cvt_pk_bf16_f32 v208, v208, v209
  v_accvgpr_read_b32 v41, a109
  v_mfma_f32_16x16x32_bf16 a[236:239], a[240:243], v[152:155], a[236:239]
  v_exp_f32 v212, v212
  v_mfma_f32_16x16x32_bf16 a[236:239], a[240:243], v[184:187], a[236:239]
  v_exp_f32 v213, v213
  v_mfma_f32_16x16x32_bf16 a[188:191], a[216:219], v[136:139], a[188:191]
  ds_read_b128 a[204:207], v11 offset:32768
  v_mfma_f32_16x16x32_bf16 a[188:191], a[220:223], v[168:171], a[188:191]
  v_cvt_pk_bf16_f32 v209, v210, v211
  v_exp_f32 v214, v214
  v_accvgpr_read_b32 v42, a110
  v_mfma_f32_16x16x32_bf16 a[16:19], a[216:219], v[144:147], a[16:19]
  buffer_load_dwordx4 v5, s[20:23], s89 offen offset:2048 nt lds
  v_mfma_f32_16x16x32_bf16 a[16:19], a[220:223], v[176:179], a[16:19]
  v_exp_f32 v215, v215
  v_mfma_f32_16x16x32_bf16 v[48:51], a[216:219], v[152:155], v[48:51]
  v_mfma_f32_16x16x32_bf16 v[48:51], a[220:223], v[184:187], v[48:51]
  v_cvt_pk_bf16_f32 v210, v212, v213
  v_exp_f32 v240, v240
  v_accvgpr_read_b32 v43, a111
  s_waitcnt lgkmcnt(0)
  s_cbranch_vccnz LS_t26
LS_b26:
  v_mfma_f32_16x16x32_bf16 v[128:131], a[192:195], v[64:67], v[20:23]
  buffer_load_dwordx4 v6, s[20:23], s89 offen offset:3072 nt lds
  v_mfma_f32_16x16x32_bf16 v[128:131], a[196:199], v[68:71], v[128:131]
  ds_read_b128 a[208:211], v8 offset:36864
  v_mfma_f32_16x16x32_bf16 v[128:131], a[200:203], v[72:75], v[128:131]
  v_mfma_f32_16x16x32_bf16 v[128:131], a[204:207], v[76:79], v[128:131]
  v_exp_f32 v241, v241
  v_cvt_pk_bf16_f32 v211, v214, v215
  v_exp_f32 v242, v242
  v_mul_f32 v40, v40, v31
  v_mfma_f32_16x16x32_bf16 v[136:139], a[192:195], v[80:83], v[52:55]
  ds_read_b128 a[212:215], v9 offset:36864
  v_mfma_f32_16x16x32_bf16 v[136:139], a[196:199], v[84:87], v[136:139]
  v_mfma_f32_16x16x32_bf16 v[136:139], a[200:203], v[88:91], v[136:139]
  v_mfma_f32_16x16x32_bf16 v[136:139], a[204:207], v[92:95], v[136:139]
  ds_read_b128 a[216:219], v10 offset:36864
  v_exp_f32 v243, v243
  v_max_f32 v44, v128, v129
  v_cvt_pk_bf16_f32 v240, v240, v241
  v_max_f32 v45, v130, v131
  v_exp_f32 v244, v244
  v_mul_f32 v41, v41, v31
  v_mul_f32 v42, v42, v31
  v_mfma_f32_16x16x32_bf16 v[144:147], a[192:195], v[96:99], v[56:59]
  v_mfma_f32_16x16x32_bf16 v[144:147], a[196:199], v[100:103], v[144:147]
  v_mfma_f32_16x16x32_bf16 v[144:147], a[200:203], v[104:107], v[144:147]
  ds_read_b128 a[220:223], v11 offset:36864
  v_mfma_f32_16x16x32_bf16 v[144:147], a[204:207], v[108:111], v[144:147]
  v_exp_f32 v245, v245
  v_max3_f32 v44, v44, v136, v137
  v_cvt_pk_bf16_f32 v241, v242, v243
  v_max3_f32 v45, v45, v138, v139
  v_exp_f32 v246, v246
  v_mul_f32 v43, v43, v31
  v_mfma_f32_16x16x32_bf16 v[152:155], a[192:195], v[112:115], v[60:63]
  v_mfma_f32_16x16x32_bf16 v[152:155], a[196:199], v[116:119], v[152:155]
  v_mfma_f32_16x16x32_bf16 v[152:155], a[200:203], v[120:123], v[152:155]
  v_mfma_f32_16x16x32_bf16 v[152:155], a[204:207], v[124:127], v[152:155]
  v_exp_f32 v247, v247
  v_max3_f32 v44, v44, v144, v145
  v_cvt_pk_bf16_f32 v242, v244, v245
  v_max3_f32 v45, v45, v146, v147
  v_exp_f32 v216, v216
  v_cvt_pk_bf16_f32 v40, v40, v41
  v_cvt_pk_bf16_f32 v41, v42, v43
  s_waitcnt lgkmcnt(0)
  v_mfma_f32_16x16x32_bf16 v[132:135], a[208:211], v[64:67], v[20:23]
  v_mfma_f32_16x16x32_bf16 v[132:135], a[212:215], v[68:71], v[132:135]
  ds_read_b128 a[192:195], v8 offset:40960
  v_mfma_f32_16x16x32_bf16 v[132:135], a[216:219], v[72:75], v[132:135]
  v_mfma_f32_16x16x32_bf16 v[132:135], a[220:223], v[76:79], v[132:135]
  v_exp_f32 v217, v217
  v_max3_f32 v44, v44, v152, v153
  v_cvt_pk_bf16_f32 v243, v246, v247
  v_max3_f32 v45, v45, v154, v155
  v_exp_f32 v218, v218
  v_accvgpr_read_b32 v36, a112
  v_mfma_f32_16x16x32_bf16 v[140:143], a[208:211], v[80:83], v[52:55]
  ds_read_b128 a[196:199], v9 offset:40960
  v_mfma_f32_16x16x32_bf16 v[140:143], a[212:215], v[84:87], v[140:143]
  v_mfma_f32_16x16x32_bf16 v[140:143], a[216:219], v[88:91], v[140:143]
  v_mfma_f32_16x16x32_bf16 v[140:143], a[220:223], v[92:95], v[140:143]
  ds_read_b128 a[200:203], v10 offset:40960
  v_exp_f32 v219, v219
  v_max3_f32 v44, v44, v132, v133
  v_cvt_pk_bf16_f32 v216, v216, v217
  v_max3_f32 v45, v45, v134, v135
  v_exp_f32 v220, v220
  v_accvgpr_read_b32 v37, a113
  v_mfma_f32_16x16x32_bf16 v[148:151], a[208:211], v[96:99], v[56:59]
  v_mfma_f32_16x16x32_bf16 v[148:151], a[212:215], v[100:103], v[148:151]
  v_mfma_f32_16x16x32_bf16 v[148:151], a[216:219], v[104:107], v[148:151]
  ds_read_b128 a[204:207], v11 offset:40960
  v_mfma_f32_16x16x32_bf16 v[148:151], a[220:223], v[108:111], v[148:151]
  v_exp_f32 v221, v221
  v_max3_f32 v44, v44, v140, v141
  v_cvt_pk_bf16_f32 v217, v218, v219
  v_max3_f32 v45, v45, v142, v143
  v_exp_f32 v222, v222
  v_accvgpr_read_b32 v38, a114
  v_accvgpr_read_b32 v39, a115
  v_mfma_f32_16x16x32_bf16 v[156:159], a[208:211], v[112:115], v[60:63]
  v_mfma_f32_16x16x32_bf16 v[156:159], a[212:215], v[116:119], v[156:159]
  v_mfma_f32_16x16x32_bf16 v[156:159], a[216:219], v[120:123], v[156:159]
  v_mfma_f32_16x16x32_bf16 v[156:159], a[220:223], v[124:127], v[156:159]
  v_exp_f32 v223, v223
  v_max3_f32 v44, v44, v148, v149
  v_cvt_pk_bf16_f32 v218, v220, v221
  v_max3_f32 v45, v45, v150, v151
  v_exp_f32 v248, v248
  s_waitcnt lgkmcnt(0)
  v_mfma_f32_16x16x32_bf16 v[160:163], a[192:195], v[64:67], v[20:23]
  v_mfma_f32_16x16x32_bf16 v[160:163], a[196:199], v[68:71], v[160:163]
  ds_read_b128 a[208:211], v8 offset:45056
  ds_write_b64 v35, v[40:41] offset:12288
  v_mfma_f32_16x16x32_bf16 v[160:163], a[200:203], v[72:75], v[160:163]
  v_mfma_f32_16x16x32_bf16 v[160:163], a[204:207], v[76:79], v[160:163]
  v_exp_f32 v249, v249
  v_max3_f32 v44, v44, v156, v157
  v_cvt_pk_bf16_f32 v219, v222, v223
  v_max3_f32 v45, v45, v158, v159
  v_exp_f32 v250, v250
  v_mfma_f32_16x16x32_bf16 v[168:171], a[192:195], v[80:83], v[52:55]
  ds_read_b128 a[212:215], v9 offset:45056
  v_mfma_f32_16x16x32_bf16 v[168:171], a[196:199], v[84:87], v[168:171]
  v_mfma_f32_16x16x32_bf16 v[168:171], a[200:203], v[88:91], v[168:171]
  v_mfma_f32_16x16x32_bf16 v[168:171], a[204:207], v[92:95], v[168:171]
  ds_read_b128 a[216:219], v10 offset:45056
  v_exp_f32 v251, v251
  v_max3_f32 v44, v44, v160, v161
  v_cvt_pk_bf16_f32 v248, v248, v249
  v_max3_f32 v45, v45, v162, v163
  v_mul_f32 v36, v36, v31
  v_mfma_f32_16x16x32_bf16 v[176:179], a[192:195], v[96:99], v[56:59]
  v_mfma_f32_16x16x32_bf16 v[176:179], a[196:199], v[100:103], v[176:179]
  v_mfma_f32_16x16x32_bf16 v[176:179], a[200:203], v[104:107], v[176:179]
  ds_read_b128 a[220:223], v11 offset:45056
  v_mfma_f32_16x16x32_bf16 v[176:179], a[204:207], v[108:111], v[176:179]
  v_exp_f32 v252, v252
  v_max3_f32 v44, v44, v168, v169
  v_exp_f32 v253, v253
  v_max3_f32 v45, v45, v170, v171
  v_cvt_pk_bf16_f32 v249, v250, v251
  v_exp_f32 v254, v254
  v_mul_f32 v37, v37, v31
  v_mfma_f32_16x16x32_bf16 v[184:187], a[192:195], v[112:115], v[60:63]
  s_waitcnt vmcnt(12)
  s_barrier
  v_mfma_f32_16x16x32_bf16 v[184:187], a[196:199], v[116:119], v[184:187]
  v_mfma_f32_16x16x32_bf16 v[184:187], a[200:203], v[120:123], v[184:187]
  v_mfma_f32_16x16x32_bf16 v[184:187], a[204:207], v[124:127], v[184:187]
  v_exp_f32 v255, v255
  v_max3_f32 v44, v44, v176, v177
  v_cvt_pk_bf16_f32 v250, v252, v253
  v_mul_f32 v38, v38, v31
  v_mul_f32 v39, v39, v31
  s_waitcnt lgkmcnt(0)
  v_mfma_f32_16x16x32_bf16 v[164:167], a[208:211], v[64:67], v[20:23]
  v_mfma_f32_16x16x32_bf16 v[164:167], a[212:215], v[68:71], v[164:167]
  ds_read_b64_tr_b16 a[192:193], v12 offset:16384
  ds_read_b64_tr_b16 a[194:195], v12 offset:20480
  v_mfma_f32_16x16x32_bf16 v[164:167], a[216:219], v[72:75], v[164:167]
  v_mfma_f32_16x16x32_bf16 v[164:167], a[220:223], v[76:79], v[164:167]
  v_cvt_pk_bf16_f32 v251, v254, v255
  v_max3_f32 v45, v45, v178, v179
  v_max3_f32 v44, v44, v184, v185
  v_max3_f32 v45, v45, v186, v187
  v_cvt_pk_bf16_f32 v36, v36, v37
  v_mfma_f32_16x16x32_bf16 v[172:175], a[208:211], v[80:83], v[52:55]
  ds_read_b64_tr_b16 a[196:197], v12 offset:24576
  ds_read_b64_tr_b16 a[198:199], v12 offset:28672
  v_mfma_f32_16x16x32_bf16 v[172:175], a[212:215], v[84:87], v[172:175]
  v_mfma_f32_16x16x32_bf16 v[172:175], a[216:219], v[88:91], v[172:175]
  v_mfma_f32_16x16x32_bf16 v[172:175], a[220:223], v[92:95], v[172:175]
  ds_read_b64_tr_b16 a[200:201], v13 offset:16384
  ds_read_b64_tr_b16 a[202:203], v13 offset:20480
  v_max3_f32 v44, v44, v164, v165
  v_max3_f32 v45, v45, v166, v167
  v_cvt_pk_bf16_f32 v37, v38, v39
  v_accvgpr_read_b32 v40, a116
  v_mfma_f32_16x16x32_bf16 v[180:183], a[208:211], v[96:99], v[56:59]
  v_mfma_f32_16x16x32_bf16 v[180:183], a[212:215], v[100:103], v[180:183]
  v_mfma_f32_16x16x32_bf16 v[180:183], a[216:219], v[104:107], v[180:183]
  ds_read_b64_tr_b16 a[204:205], v13 offset:24576
  ds_read_b64_tr_b16 a[206:207], v13 offset:28672
  v_mfma_f32_16x16x32_bf16 v[180:183], a[220:223], v[108:111], v[180:183]
  v_max3_f32 v44, v44, v172, v173
  v_max3_f32 v45, v45, v174, v175
  v_accvgpr_read_b32 v41, a117
  v_mfma_f32_16x16x32_bf16 v[188:191], a[208:211], v[112:115], v[60:63]
  v_mfma_f32_16x16x32_bf16 v[188:191], a[212:215], v[116:119], v[188:191]
  v_mfma_f32_16x16x32_bf16 v[188:191], a[216:219], v[120:123], v[188:191]
  v_mfma_f32_16x16x32_bf16 v[188:191], a[220:223], v[124:127], v[188:191]
  s_nop 0
  v_max3_f32 v44, v44, v180, v181
  v_max3_f32 v45, v45, v182, v183
  v_accvgpr_read_b32 v42, a118
  s_waitcnt lgkmcnt(0)
  v_mfma_f32_16x16x32_bf16 a[128:131], a[192:195], v[192:195], a[128:131]
  v_mfma_f32_16x16x32_bf16 a[128:131], a[196:199], v[224:227], a[128:131]
  ds_read_b64_tr_b16 a[208:209], v14 offset:16384
  ds_read_b64_tr_b16 a[210:211], v14 offset:20480
  v_accvgpr_read_b32 v43, a119
  v_mfma_f32_16x16x32_bf16 a[160:163], a[192:195], v[200:203], a[160:163]
  v_mfma_f32_16x16x32_bf16 a[160:163], a[196:199], v[232:235], a[160:163]
  v_max3_f32 v44, v44, v188, v189
  v_max3_f32 v45, v45, v190, v191
  v_max_f32 v44, v44, v45
  v_cmp_lt_f32 vcc, s48, v44
  v_mfma_f32_16x16x32_bf16 a[244:247], a[192:195], v[208:211], a[244:247]
  ds_read_b64_tr_b16 a[212:213], v14 offset:24576
  ds_read_b64_tr_b16 a[214:215], v14 offset:28672
  v_mfma_f32_16x16x32_bf16 a[244:247], a[196:199], v[240:243], a[244:247]
  s_cbranch_vccnz LS_t13
LS_b13:
  v_exp_f32 v128, v128
  v_exp_f32 v129, v129
  v_exp_f32 v130, v130
  v_exp_f32 v131, v131
  v_mfma_f32_16x16x32_bf16 a[20:23], a[192:195], v[216:219], a[20:23]
  ds_write_b64 v32, v[36:37] offset:12416
  v_mfma_f32_16x16x32_bf16 a[20:23], a[196:199], v[248:251], a[20:23]
  ds_read_b64_tr_b16 a[216:217], v15 offset:16384
  ds_read_b64_tr_b16 a[218:219], v15 offset:20480
  v_cvt_pk_bf16_f32 v128, v128, v129
  v_exp_f32 v132, v132
  v_mfma_f32_16x16x32_bf16 a[132:135], a[200:203], v[192:195], a[132:135]
  v_mfma_f32_16x16x32_bf16 a[132:135], a[204:207], v[224:227], a[132:135]
  v_exp_f32 v133, v133
  v_cvt_pk_bf16_f32 v129, v130, v131
  v_mfma_f32_16x16x32_bf16 a[224:227], a[240:243], v[192:195], a[224:227]
  v_exp_f32 v134, v134
  v_mfma_f32_16x16x32_bf16 a[224:227], a[240:243], v[224:227], a[224:227]
  v_exp_f32 v135, v135
  v_mfma_f32_16x16x32_bf16 a[164:167], a[200:203], v[200:203], a[164:167]
  ds_read_b64_tr_b16 a[220:221], v15 offset:24576
  ds_read_b64_tr_b16 a[222:223], v15 offset:28672
  v_mfma_f32_16x16x32_bf16 a[164:167], a[204:207], v[232:235], a[164:167]
  v_cvt_pk_bf16_f32 v130, v132, v133
  v_exp_f32 v160, v160
  v_mul_f32 v40, v40, v31
  v_mfma_f32_16x16x32_bf16 a[248:251], a[200:203], v[208:211], a[248:251]
  v_mfma_f32_16x16x32_bf16 a[248:251], a[204:207], v[240:243], a[248:251]
  v_exp_f32 v161, v161
  v_cvt_pk_bf16_f32 v131, v134, v135
  v_mfma_f32_16x16x32_bf16 a[24:27], a[200:203], v[216:219], a[24:27]
  v_mfma_f32_16x16x32_bf16 a[24:27], a[204:207], v[248:251], a[24:27]
  v_exp_f32 v162, v162
  v_exp_f32 v163, v163
  v_mul_f32 v41, v41, v31
  s_waitcnt lgkmcnt(0)
  v_mfma_f32_16x16x32_bf16 a[136:139], a[208:211], v[192:195], a[136:139]
  v_mfma_f32_16x16x32_bf16 a[136:139], a[212:215], v[224:227], a[136:139]
  ds_read_b64_tr_b16 a[192:193], v16 offset:16384
  ds_read_b64_tr_b16 a[194:195], v16 offset:20480
  v_cvt_pk_bf16_f32 v160, v160, v161
  v_mul_f32 v42, v42, v31
  v_mfma_f32_16x16x32_bf16 a[168:171], a[208:211], v[200:203], a[168:171]
  v_mfma_f32_16x16x32_bf16 a[168:171], a[212:215], v[232:235], a[168:171]
  s_add_u32 s56, s45, 0
  v_exp_f32 v164, v164
  v_exp_f32 v165, v165
  v_cvt_pk_bf16_f32 v161, v162, v163
  v_mfma_f32_16x16x32_bf16 a[252:255], a[208:211], v[208:211], a[252:255]
  ds_read_b64_tr_b16 a[196:197], v16 offset:24576
  ds_read_b64_tr_b16 a[198:199], v16 offset:28672
  v_mfma_f32_16x16x32_bf16 a[252:255], a[212:215], v[240:243], a[252:255]
  v_exp_f32 v166, v166
  v_mul_f32 v43, v43, v31
  v_mfma_f32_16x16x32_bf16 a[28:31], a[208:211], v[216:219], a[28:31]
  v_mfma_f32_16x16x32_bf16 a[28:31], a[212:215], v[248:251], a[28:31]
  ds_read_b64_tr_b16 a[200:201], v17 offset:16384
  ds_read_b64_tr_b16 a[202:203], v17 offset:20480
  v_exp_f32 v167, v167
  v_cvt_pk_bf16_f32 v40, v40, v41
  v_mfma_f32_16x16x32_bf16 a[140:143], a[216:219], v[192:195], a[140:143]
  v_mfma_f32_16x16x32_bf16 a[140:143], a[220:223], v[224:227], a[140:143]
  v_cvt_pk_bf16_f32 v162, v164, v165
  v_exp_f32 v136, v136
  v_mfma_f32_16x16x32_bf16 a[228:231], a[240:243], v[200:203], a[228:231]
  v_exp_f32 v137, v137
  v_mfma_f32_16x16x32_bf16 a[228:231], a[240:243], v[232:235], a[228:231]
  v_cvt_pk_bf16_f32 v163, v166, v167
  v_exp_f32 v138, v138
  v_mfma_f32_16x16x32_bf16 a[172:175], a[216:219], v[200:203], a[172:175]
  ds_read_b64_tr_b16 a[204:205], v17 offset:24576
  ds_read_b64_tr_b16 a[206:207], v17 offset:28672
  v_mfma_f32_16x16x32_bf16 a[172:175], a[220:223], v[232:235], a[172:175]
  v_exp_f32 v139, v139
  v_cvt_pk_bf16_f32 v41, v42, v43
  v_mfma_f32_16x16x32_bf16 a[0:3], a[216:219], v[208:211], a[0:3]
  v_mfma_f32_16x16x32_bf16 a[0:3], a[220:223], v[240:243], a[0:3]
  v_cvt_pk_bf16_f32 v136, v136, v137
  v_exp_f32 v140, v140
  v_exp_f32 v141, v141
  v_accvgpr_read_b32 v36, a120
  v_mfma_f32_16x16x32_bf16 a[32:35], a[216:219], v[216:219], a[32:35]
  v_mfma_f32_16x16x32_bf16 a[32:35], a[220:223], v[248:251], a[32:35]
  v_cvt_pk_bf16_f32 v137, v138, v139
  v_exp_f32 v142, v142
  s_waitcnt lgkmcnt(0)
  v_mfma_f32_16x16x32_bf16 a[144:147], a[192:195], v[192:195], a[144:147]
  buffer_store_dwordx4 a[48:51], v47, s[32:35], s56 offen offset:0 sc0 sc1
  v_mfma_f32_16x16x32_bf16 a[144:147], a[196:199], v[224:227], a[144:147]
  ds_read_b64_tr_b16 a[208:209], v18 offset:16384
  ds_read_b64_tr_b16 a[210:211], v18 offset:20480
  v_exp_f32 v143, v143
  v_accvgpr_read_b32 v37, a121
  v_mfma_f32_16x16x32_bf16 a[176:179], a[192:195], v[200:203], a[176:179]
  v_mfma_f32_16x16x32_bf16 a[176:179], a[196:199], v[232:235], a[176:179]
  v_cvt_pk_bf16_f32 v138, v140, v141
  v_exp_f32 v168, v168
  v_accvgpr_read_b32 v38, a122
  v_mfma_f32_16x16x32_bf16 a[4:7], a[192:195], v[208:211], a[4:7]
  ds_read_b64_tr_b16 a[212:213], v18 offset:24576
  ds_read_b64_tr_b16 a[214:215], v18 offset:28672
  v_mfma_f32_16x16x32_bf16 a[4:7], a[196:199], v[240:243], a[4:7]
  v_exp_f32 v169, v169
  v_accvgpr_read_b32 v39, a123
  v_mfma_f32_16x16x32_bf16 a[36:39], a[192:195], v[216:219], a[36:39]
  v_mfma_f32_16x16x32_bf16 a[36:39], a[196:199], v[248:251], a[36:39]
  ds_read_b64_tr_b16 a[216:217], v19 offset:16384
  ds_read_b64_tr_b16 a[218:219], v19 offset:20480
  v_cvt_pk_bf16_f32 v139, v142, v143
  v_exp_f32 v170, v170
  v_mfma_f32_16x16x32_bf16 a[148:151], a[200:203], v[192:195], a[148:151]
  v_mfma_f32_16x16x32_bf16 a[148:151], a[204:207], v[224:227], a[148:151]
  v_exp_f32 v171, v171
  v_cvt_pk_bf16_f32 v168, v168, v169
  v_mfma_f32_16x16x32_bf16 a[232:235], a[240:243], v[208:211], a[232:235]
  v_exp_f32 v172, v172
  v_mfma_f32_16x16x32_bf16 a[232:235], a[240:243], v[240:243], a[232:235]
  v_exp_f32 v173, v173
  v_cvt_pk_bf16_f32 v169, v170, v171
  v_mfma_f32_16x16x32_bf16 a[180:183], a[200:203], v[200:203], a[180:183]
  ds_read_b64_tr_b16 a[220:221], v19 offset:24576
  ds_read_b64_tr_b16 a[222:223], v19 offset:28672
  v_mfma_f32_16x16x32_bf16 a[180:183], a[204:207], v[232:235], a[180:183]
  buffer_store_dwordx4 a[52:55], v47, s[32:35], s56 offen offset:1024 sc0 sc1
  v_exp_f32 v174, v174
  v_mfma_f32_16x16x32_bf16 a[8:11], a[200:203], v[208:211], a[8:11]
  s_waitcnt vmcnt(10)
  s_barrier
  ds_write_b64 v33, v[40:41] offset:12416
  v_mfma_f32_16x16x32_bf16 a[8:11], a[204:207], v[240:243], a[8:11]
  v_exp_f32 v175, v175
  v_mfma_f32_16x16x32_bf16 a[40:43], a[200:203], v[216:219], a[40:43]
  v_mfma_f32_16x16x32_bf16 a[40:43], a[204:207], v[248:251], a[40:43]
  v_cvt_pk_bf16_f32 v170, v172, v173
  v_exp_f32 v144, v144
  s_waitcnt lgkmcnt(1)
  v_mfma_f32_16x16x32_bf16 a[152:155], a[208:211], v[192:195], a[152:155]
  v_mfma_f32_16x16x32_bf16 a[152:155], a[212:215], v[224:227], a[152:155]
  ds_read_b128 a[192:195], v8 offset:0
  v_exp_f32 v145, v145
  v_cvt_pk_bf16_f32 v171, v174, v175
  v_mul_f32 v36, v36, v31
  v_mfma_f32_16x16x32_bf16 a[184:187], a[208:211], v[200:203], a[184:187]
  v_mfma_f32_16x16x32_bf16 a[184:187], a[212:215], v[232:235], a[184:187]
  v_exp_f32 v146, v146
  v_exp_f32 v147, v147
  v_mfma_f32_16x16x32_bf16 a[12:15], a[208:211], v[208:211], a[12:15]
  ds_read_b128 a[196:199], v9 offset:0
  v_mfma_f32_16x16x32_bf16 a[12:15], a[212:215], v[240:243], a[12:15]
  v_cvt_pk_bf16_f32 v144, v144, v145
  v_exp_f32 v148, v148
  v_mul_f32 v37, v37, v31
  v_mfma_f32_16x16x32_bf16 a[44:47], a[208:211], v[216:219], a[44:47]
  v_mfma_f32_16x16x32_bf16 a[44:47], a[212:215], v[248:251], a[44:47]
  ds_read_b128 a[200:203], v10 offset:0
  v_exp_f32 v149, v149
  v_cvt_pk_bf16_f32 v145, v146, v147
  v_mul_f32 v38, v38, v31
  v_mfma_f32_16x16x32_bf16 a[156:159], a[216:219], v[192:195], a[156:159]
  buffer_store_dwordx4 a[56:59], v47, s[32:35], s56 offen offset:2048 sc0 sc1
  v_mfma_f32_16x16x32_bf16 a[156:159], a[220:223], v[224:227], a[156:159]
  v_exp_f32 v150, v150
  v_exp_f32 v151, v151
  v_mfma_f32_16x16x32_bf16 a[236:239], a[240:243], v[216:219], a[236:239]
  v_cvt_pk_bf16_f32 v146, v148, v149
  v_exp_f32 v176, v176
  v_mfma_f32_16x16x32_bf16 a[236:239], a[240:243], v[248:251], a[236:239]
  v_exp_f32 v177, v177
  v_mfma_f32_16x16x32_bf16 a[188:191], a[216:219], v[200:203], a[188:191]
  ds_read_b128 a[204:207], v11 offset:0
  v_mfma_f32_16x16x32_bf16 a[188:191], a[220:223], v[232:235], a[188:191]
  v_cvt_pk_bf16_f32 v147, v150, v151
  v_exp_f32 v178, v178
  v_mul_f32 v39, v39, v31
  v_mfma_f32_16x16x32_bf16 a[16:19], a[216:219], v[208:211], a[16:19]
  v_mfma_f32_16x16x32_bf16 a[16:19], a[220:223], v[240:243], a[16:19]
  v_exp_f32 v179, v179
  v_cvt_pk_bf16_f32 v176, v176, v177
  v_cvt_pk_bf16_f32 v36, v36, v37
  v_mfma_f32_16x16x32_bf16 v[48:51], a[216:219], v[216:219], v[48:51]
  v_mfma_f32_16x16x32_bf16 v[48:51], a[220:223], v[248:251], v[48:51]
  v_exp_f32 v180, v180
  v_exp_f32 v181, v181
  s_waitcnt lgkmcnt(0)
  s_cbranch_vccnz LS_t27
LS_b27:
  v_mfma_f32_16x16x32_bf16 v[192:195], a[192:195], v[64:67], v[20:23]
  v_mfma_f32_16x16x32_bf16 v[192:195], a[196:199], v[68:71], v[192:195]
  ds_read_b128 a[208:211], v8 offset:4096
  v_mfma_f32_16x16x32_bf16 v[192:195], a[200:203], v[72:75], v[192:195]
  v_mfma_f32_16x16x32_bf16 v[192:195], a[204:207], v[76:79], v[192:195]
  buffer_store_dwordx4 a[60:63], v47, s[32:35], s56 offen offset:3072 sc0 sc1
  v_cvt_pk_bf16_f32 v177, v178, v179
  v_exp_f32 v182, v182
  v_exp_f32 v183, v183
  v_cvt_pk_bf16_f32 v178, v180, v181
  v_cvt_pk_bf16_f32 v37, v38, v39
  v_accvgpr_read_b32 v40, a124
  v_mfma_f32_16x16x32_bf16 v[200:203], a[192:195], v[80:83], v[52:55]
  ds_read_b128 a[212:215], v9 offset:4096
  v_mfma_f32_16x16x32_bf16 v[200:203], a[196:199], v[84:87], v[200:203]
  v_mfma_f32_16x16x32_bf16 v[200:203], a[200:203], v[88:91], v[200:203]
  v_mfma_f32_16x16x32_bf16 v[200:203], a[204:207], v[92:95], v[200:203]
  ds_read_b128 a[216:219], v10 offset:4096
  v_exp_f32 v152, v152
  v_max_f32 v44, v192, v193
  v_exp_f32 v153, v153
  v_max_f32 v45, v194, v195
  v_cvt_pk_bf16_f32 v179, v182, v183
  v_accvgpr_read_b32 v41, a125
  v_mfma_f32_16x16x32_bf16 v[208:211], a[192:195], v[96:99], v[56:59]
  v_mfma_f32_16x16x32_bf16 v[208:211], a[196:199], v[100:103], v[208:211]
  s_add_u32 s56, s45, 4096
  v_mfma_f32_16x16x32_bf16 v[208:211], a[200:203], v[104:107], v[208:211]
  ds_read_b128 a[220:223], v11 offset:4096
  v_mfma_f32_16x16x32_bf16 v[208:211], a[204:207], v[108:111], v[208:211]
  v_exp_f32 v154, v154
  v_max3_f32 v44, v44, v200, v201
  v_exp_f32 v155, v155
  v_max3_f32 v45, v45, v202, v203
  v_cvt_pk_bf16_f32 v152, v152, v153
  v_accvgpr_read_b32 v42, a126
  v_accvgpr_read_b32 v43, a127
  v_mfma_f32_16x16x32_bf16 v[216:219], a[192:195], v[112:115], v[60:63]
  v_mfma_f32_16x16x32_bf16 v[216:219], a[196:199], v[116:119], v[216:219]
  v_mfma_f32_16x16x32_bf16 v[216:219], a[200:203], v[120:123], v[216:219]
  v_mfma_f32_16x16x32_bf16 v[216:219], a[204:207], v[124:127], v[216:219]
  v_exp_f32 v156, v156
  v_max3_f32 v44, v44, v208, v209
  v_exp_f32 v157, v157
  v_max3_f32 v45, v45, v210, v211
  v_cvt_pk_bf16_f32 v153, v154, v155
  s_waitcnt lgkmcnt(0)
  v_mfma_f32_16x16x32_bf16 v[196:199], a[208:211], v[64:67], v[20:23]
  v_mfma_f32_16x16x32_bf16 v[196:199], a[212:215], v[68:71], v[196:199]
  ds_read_b128 a[192:195], v8 offset:8192
  v_mfma_f32_16x16x32_bf16 v[196:199], a[216:219], v[72:75], v[196:199]
  ds_write_b64 v34, v[36:37] offset:12416
  v_mfma_f32_16x16x32_bf16 v[196:199], a[220:223], v[76:79], v[196:199]
  v_exp_f32 v158, v158
  v_max3_f32 v44, v44, v216, v217
  v_exp_f32 v159, v159
  v_max3_f32 v45, v45, v218, v219
  v_cvt_pk_bf16_f32 v154, v156, v157
  v_mfma_f32_16x16x32_bf16 v[204:207], a[208:211], v[80:83], v[52:55]
  ds_read_b128 a[196:199], v9 offset:8192
  v_mfma_f32_16x16x32_bf16 v[204:207], a[212:215], v[84:87], v[204:207]
  buffer_store_dwordx4 a[64:67], v47, s[32:35], s56 offen offset:0 sc0 sc1
  v_mfma_f32_16x16x32_bf16 v[204:207], a[216:219], v[88:91], v[204:207]
  v_mfma_f32_16x16x32_bf16 v[204:207], a[220:223], v[92:95], v[204:207]
  ds_read_b128 a[200:203], v10 offset:8192
  v_exp_f32 v184, v184
  v_max3_f32 v44, v44, v196, v197
  v_exp_f32 v185, v185
  v_max3_f32 v45, v45, v198, v199
  v_mul_f32 v40, v40, v31
  v_mfma_f32_16x16x32_bf16 v[212:215], a[208:211], v[96:99], v[56:59]
  v_mfma_f32_16x16x32_bf16 v[212:215], a[212:215], v[100:103], v[212:215]
  v_mfma_f32_16x16x32_bf16 v[212:215], a[216:219], v[104:107], v[212:215]
  ds_read_b128 a[204:207], v11 offset:8192
  v_mfma_f32_16x16x32_bf16 v[212:215], a[220:223], v[108:111], v[212:215]
  v_cvt_pk_bf16_f32 v155, v158, v159
  v_max3_f32 v44, v44, v204, v205
  v_exp_f32 v186, v186
  v_max3_f32 v45, v45, v206, v207
  v_exp_f32 v187, v187
  v_cvt_pk_bf16_f32 v184, v184, v185
  v_mul_f32 v41, v41, v31
  v_mfma_f32_16x16x32_bf16 v[220:223], a[208:211], v[112:115], v[60:63]
  v_mfma_f32_16x16x32_bf16 v[220:223], a[212:215], v[116:119], v[220:223]
  v_mfma_f32_16x16x32_bf16 v[220:223], a[216:219], v[120:123], v[220:223]
  v_mfma_f32_16x16x32_bf16 v[220:223], a[220:223], v[124:127], v[220:223]
  v_exp_f32 v188, v188
  v_max3_f32 v44, v44, v212, v213
  v_exp_f32 v189, v189
  v_max3_f32 v45, v45, v214, v215
  v_cvt_pk_bf16_f32 v185, v186, v187
  v_mul_f32 v42, v42, v31
  s_waitcnt lgkmcnt(0)
  v_mfma_f32_16x16x32_bf16 v[224:227], a[192:195], v[64:67], v[20:23]
  v_mfma_f32_16x16x32_bf16 v[224:227], a[196:199], v[68:71], v[224:227]
  ds_read_b128 a[208:211], v8 offset:12288
  v_mfma_f32_16x16x32_bf16 v[224:227], a[200:203], v[72:75], v[224:227]
  buffer_store_dwordx4 a[68:71], v47, s[32:35], s56 offen offset:1024 sc0 sc1
  v_mfma_f32_16x16x32_bf16 v[224:227], a[204:207], v[76:79], v[224:227]
  v_exp_f32 v190, v190
  v_max3_f32 v44, v44, v220, v221
  v_exp_f32 v191, v191
  v_max3_f32 v45, v45, v222, v223
  v_cvt_pk_bf16_f32 v186, v188, v189
  v_mul_f32 v43, v43, v31
  v_cvt_pk_bf16_f32 v40, v40, v41
  v_mfma_f32_16x16x32_bf16 v[232:235], a[192:195], v[80:83], v[52:55]
  ds_read_b128 a[212:215], v9 offset:12288
  v_mfma_f32_16x16x32_bf16 v[232:235], a[196:199], v[84:87], v[232:235]
  v_mfma_f32_16x16x32_bf16 v[232:235], a[200:203], v[88:91], v[232:235]
  v_mfma_f32_16x16x32_bf16 v[232:235], a[204:207], v[92:95], v[232:235]
  ds_read_b128 a[216:219], v10 offset:12288
  v_cvt_pk_bf16_f32 v187, v190, v191
  v_max3_f32 v44, v44, v224, v225
  v_max3_f32 v45, v45, v226, v227
  v_cvt_pk_bf16_f32 v41, v42, v43
  v_mfma_f32_16x16x32_bf16 v[240:243], a[192:195], v[96:99], v[56:59]
  v_mfma_f32_16x16x32_bf16 v[240:243], a[196:199], v[100:103], v[240:243]
  v_mfma_f32_16x16x32_bf16 v[240:243], a[200:203], v[104:107], v[240:243]
  ds_read_b128 a[220:223], v11 offset:12288
  v_mfma_f32_16x16x32_bf16 v[240:243], a[204:207], v[108:111], v[240:243]
  v_max3_f32 v44, v44, v232, v233
  v_max3_f32 v45, v45, v234, v235
  v_mfma_f32_16x16x32_bf16 v[248:251], a[192:195], v[112:115], v[60:63]
  s_waitcnt vmcnt(10)
  s_barrier
  v_mfma_f32_16x16x32_bf16 v[248:251], a[196:199], v[116:119], v[248:251]
  buffer_store_dwordx4 a[72:75], v47, s[32:35], s56 offen offset:2048 sc0 sc1
  ds_write_b64 v35, v[40:41] offset:12416
  v_mfma_f32_16x16x32_bf16 v[248:251], a[200:203], v[120:123], v[248:251]
  v_mfma_f32_16x16x32_bf16 v[248:251], a[204:207], v[124:127], v[248:251]
  v_max3_f32 v44, v44, v240, v241
  v_max3_f32 v45, v45, v242, v243
  s_waitcnt lgkmcnt(1)
  v_mfma_f32_16x16x32_bf16 v[228:231], a[208:211], v[64:67], v[20:23]
  s_waitcnt lgkmcnt(0)
  v_mfma_f32_16x16x32_bf16 v[228:231], a[212:215], v[68:71], v[228:231]
  ds_read_b64_tr_b16 a[192:193], v12 offset:32768
  ds_read_b64_tr_b16 a[194:195], v12 offset:36864
  v_mfma_f32_16x16x32_bf16 v[228:231], a[216:219], v[72:75], v[228:231]
  v_mfma_f32_16x16x32_bf16 v[228:231], a[220:223], v[76:79], v[228:231]
  ds_read_b128 a[100:103], v46 offset:13312
  v_max3_f32 v44, v44, v248, v249
  v_max3_f32 v45, v45, v250, v251
  v_mfma_f32_16x16x32_bf16 v[236:239], a[208:211], v[80:83], v[52:55]
  ds_read_b64_tr_b16 a[196:197], v12 offset:40960
  ds_read_b64_tr_b16 a[198:199], v12 offset:45056
  v_mfma_f32_16x16x32_bf16 v[236:239], a[212:215], v[84:87], v[236:239]
  v_mfma_f32_16x16x32_bf16 v[236:239], a[216:219], v[88:91], v[236:239]
  ds_read_b128 a[108:111], v46 offset:15360
  v_mfma_f32_16x16x32_bf16 v[236:239], a[220:223], v[92:95], v[236:239]
  ds_read_b64_tr_b16 a[200:201], v13 offset:32768
  ds_read_b64_tr_b16 a[202:203], v13 offset:36864
  v_max3_f32 v44, v44, v228, v229
  v_max3_f32 v45, v45, v230, v231
  v_mfma_f32_16x16x32_bf16 v[244:247], a[208:211], v[96:99], v[56:59]
  v_mfma_f32_16x16x32_bf16 v[244:247], a[212:215], v[100:103], v[244:247]
  buffer_store_dwordx4 a[76:79], v47, s[32:35], s56 offen offset:3072 sc0 sc1
  v_mfma_f32_16x16x32_bf16 v[244:247], a[216:219], v[104:107], v[244:247]
  ds_read_b64_tr_b16 a[204:205], v13 offset:40960
  ds_read_b64_tr_b16 a[206:207], v13 offset:45056
  v_mfma_f32_16x16x32_bf16 v[244:247], a[220:223], v[108:111], v[244:247]
  v_max3_f32 v44, v44, v236, v237
  v_max3_f32 v45, v45, v238, v239
  v_xor_b32 v46, 64, v46
  v_mfma_f32_16x16x32_bf16 v[252:255], a[208:211], v[112:115], v[60:63]
  ds_read_b128 a[96:99], v46 offset:12288
  v_mfma_f32_16x16x32_bf16 v[252:255], a[212:215], v[116:119], v[252:255]
  v_mfma_f32_16x16x32_bf16 v[252:255], a[216:219], v[120:123], v[252:255]
  ds_read_b128 a[104:107], v46 offset:14336
  v_mfma_f32_16x16x32_bf16 v[252:255], a[220:223], v[124:127], v[252:255]
  v_max3_f32 v44, v44, v244, v245
  v_max3_f32 v45, v45, v246, v247
  s_waitcnt lgkmcnt(2)
  v_mfma_f32_16x16x32_bf16 a[128:131], a[192:195], v[128:131], a[128:131]
  s_add_u32 s56, s45, 8192
  v_mfma_f32_16x16x32_bf16 a[128:131], a[196:199], v[160:163], a[128:131]
  ds_read_b64_tr_b16 a[208:209], v14 offset:32768
  ds_read_b64_tr_b16 a[210:211], v14 offset:36864
  v_mfma_f32_16x16x32_bf16 a[160:163], a[192:195], v[136:139], a[160:163]
  v_mfma_f32_16x16x32_bf16 a[160:163], a[196:199], v[168:171], a[160:163]
  v_max3_f32 v44, v44, v252, v253
  v_max3_f32 v45, v45, v254, v255
  v_max_f32 v44, v44, v45
  v_cmp_lt_f32 vcc, s48, v44
  v_mfma_f32_16x16x32_bf16 a[244:247], a[192:195], v[144:147], a[244:247]
  ds_read_b64_tr_b16 a[212:213], v14 offset:40960
  ds_read_b64_tr_b16 a[214:215], v14 offset:45056
  v_mfma_f32_16x16x32_bf16 a[244:247], a[196:199], v[176:179], a[244:247]
  s_cbranch_vccnz LS_t14
LS_b14:
  v_exp_f32 v192, v192
  v_exp_f32 v193, v193
  v_exp_f32 v194, v194
  v_exp_f32 v195, v195
  v_mfma_f32_16x16x32_bf16 a[20:23], a[192:195], v[152:155], a[20:23]
  v_mfma_f32_16x16x32_bf16 a[20:23], a[196:199], v[184:187], a[20:23]
  ds_read_b64_tr_b16 a[216:217], v15 offset:32768
  ds_read_b64_tr_b16 a[218:219], v15 offset:36864
  v_cvt_pk_bf16_f32 v192, v192, v193
  v_exp_f32 v196, v196
  v_mfma_f32_16x16x32_bf16 a[132:135], a[200:203], v[128:131], a[132:135]
  v_mfma_f32_16x16x32_bf16 a[132:135], a[204:207], v[160:163], a[132:135]
  v_exp_f32 v197, v197
  v_cvt_pk_bf16_f32 v193, v194, v195
  v_mfma_f32_16x16x32_bf16 a[224:227], a[240:243], v[128:131], a[224:227]
  v_exp_f32 v198, v198
  v_mfma_f32_16x16x32_bf16 a[224:227], a[240:243], v[160:163], a[224:227]
  v_exp_f32 v199, v199
  v_mfma_f32_16x16x32_bf16 a[164:167], a[200:203], v[136:139], a[164:167]
  ds_read_b64_tr_b16 a[220:221], v15 offset:40960
  ds_read_b64_tr_b16 a[222:223], v15 offset:45056
  v_mfma_f32_16x16x32_bf16 a[164:167], a[204:207], v[168:171], a[164:167]
  v_cvt_pk_bf16_f32 v194, v196, v197
  v_exp_f32 v224, v224
  v_mfma_f32_16x16x32_bf16 a[248:251], a[200:203], v[144:147], a[248:251]
  buffer_store_dwordx4 a[80:83], v47, s[32:35], s56 offen offset:0 sc0 sc1
  v_mfma_f32_16x16x32_bf16 a[248:251], a[204:207], v[176:179], a[248:251]
  v_exp_f32 v225, v225
  v_cvt_pk_bf16_f32 v195, v198, v199
  v_mfma_f32_16x16x32_bf16 a[24:27], a[200:203], v[152:155], a[24:27]
  v_mfma_f32_16x16x32_bf16 a[24:27], a[204:207], v[184:187], a[24:27]
  v_exp_f32 v226, v226
  v_exp_f32 v227, v227
  s_waitcnt lgkmcnt(0)
  v_mfma_f32_16x16x32_bf16 a[136:139], a[208:211], v[128:131], a[136:139]
  v_mfma_f32_16x16x32_bf16 a[136:139], a[212:215], v[160:163], a[136:139]
  ds_read_b64_tr_b16 a[192:193], v16 offset:32768
  ds_read_b64_tr_b16 a[194:195], v16 offset:36864
  v_cvt_pk_bf16_f32 v224, v224, v225
  v_mfma_f32_16x16x32_bf16 a[168:171], a[208:211], v[136:139], a[168:171]
  v_mfma_f32_16x16x32_bf16 a[168:171], a[212:215], v[168:171], a[168:171]
  v_exp_f32 v228, v228
  v_exp_f32 v229, v229
  v_cvt_pk_bf16_f32 v225, v226, v227
  v_mfma_f32_16x16x32_bf16 a[252:255], a[208:211], v[144:147], a[252:255]
  ds_read_b64_tr_b16 a[196:197], v16 offset:40960
  ds_read_b64_tr_b16 a[198:199], v16 offset:45056
  v_mfma_f32_16x16x32_bf16 a[252:255], a[212:215], v[176:179], a[252:255]
  v_exp_f32 v230, v230
  v_mfma_f32_16x16x32_bf16 a[28:31], a[208:211], v[152:155], a[28:31]
  v_mfma_f32_16x16x32_bf16 a[28:31], a[212:215], v[184:187], a[28:31]
  ds_read_b64_tr_b16 a[200:201], v17 offset:32768
  ds_read_b64_tr_b16 a[202:203], v17 offset:36864
  v_exp_f32 v231, v231
  v_mfma_f32_16x16x32_bf16 a[140:143], a[216:219], v[128:131], a[140:143]
  buffer_store_dwordx4 a[84:87], v47, s[32:35], s56 offen offset:1024 sc0 sc1
  v_mfma_f32_16x16x32_bf16 a[140:143], a[220:223], v[160:163], a[140:143]
  v_cvt_pk_bf16_f32 v226, v228, v229
  v_exp_f32 v200, v200
  v_mfma_f32_16x16x32_bf16 a[228:231], a[240:243], v[136:139], a[228:231]
  v_exp_f32 v201, v201
  v_mfma_f32_16x16x32_bf16 a[228:231], a[240:243], v[168:171], a[228:231]
  v_cvt_pk_bf16_f32 v227, v230, v231
  v_exp_f32 v202, v202
  v_mfma_f32_16x16x32_bf16 a[172:175], a[216:219], v[136:139], a[172:175]
  ds_read_b64_tr_b16 a[204:205], v17 offset:40960
  ds_read_b64_tr_b16 a[206:207], v17 offset:45056
  v_mfma_f32_16x16x32_bf16 a[172:175], a[220:223], v[168:171], a[172:175]
  v_exp_f32 v203, v203
  v_mfma_f32_16x16x32_bf16 a[0:3], a[216:219], v[144:147], a[0:3]
  v_mfma_f32_16x16x32_bf16 a[0:3], a[220:223], v[176:179], a[0:3]
  v_cvt_pk_bf16_f32 v200, v200, v201
  v_exp_f32 v204, v204
  v_exp_f32 v205, v205
  v_mfma_f32_16x16x32_bf16 a[32:35], a[216:219], v[152:155], a[32:35]
  v_mfma_f32_16x16x32_bf16 a[32:35], a[220:223], v[184:187], a[32:35]
  v_cvt_pk_bf16_f32 v201, v202, v203
  v_exp_f32 v206, v206
  s_waitcnt lgkmcnt(0)
  v_mfma_f32_16x16x32_bf16 a[144:147], a[192:195], v[128:131], a[144:147]
  v_mfma_f32_16x16x32_bf16 a[144:147], a[196:199], v[160:163], a[144:147]
  ds_read_b64_tr_b16 a[208:209], v18 offset:32768
  ds_read_b64_tr_b16 a[210:211], v18 offset:36864
  v_exp_f32 v207, v207
  v_mfma_f32_16x16x32_bf16 a[176:179], a[192:195], v[136:139], a[176:179]
  v_mfma_f32_16x16x32_bf16 a[176:179], a[196:199], v[168:171], a[176:179]
  v_cvt_pk_bf16_f32 v202, v204, v205
  v_exp_f32 v232, v232
  v_mfma_f32_16x16x32_bf16 a[4:7], a[192:195], v[144:147], a[4:7]
  ds_read_b64_tr_b16 a[212:213], v18 offset:40960
  ds_read_b64_tr_b16 a[214:215], v18 offset:45056
  v_mfma_f32_16x16x32_bf16 a[4:7], a[196:199], v[176:179], a[4:7]
  buffer_store_dwordx4 a[88:91], v47, s[32:35], s56 offen offset:2048 sc0 sc1
  v_exp_f32 v233, v233
  v_mfma_f32_16x16x32_bf16 a[36:39], a[192:195], v[152:155], a[36:39]
  v_mfma_f32_16x16x32_bf16 a[36:39], a[196:199], v[184:187], a[36:39]
  ds_read_b64_tr_b16 a[216:217], v19 offset:32768
  ds_read_b64_tr_b16 a[218:219], v19 offset:36864
  v_cvt_pk_bf16_f32 v203, v206, v207
  v_exp_f32 v234, v234
  v_mfma_f32_16x16x32_bf16 a[148:151], a[200:203], v[128:131], a[148:151]
  v_mfma_f32_16x16x32_bf16 a[148:151], a[204:207], v[160:163], a[148:151]
  v_exp_f32 v235, v235
  v_cvt_pk_bf16_f32 v232, v232, v233
  v_mfma_f32_16x16x32_bf16 a[232:235], a[240:243], v[144:147], a[232:235]
  v_exp_f32 v236, v236
  v_mfma_f32_16x16x32_bf16 a[232:235], a[240:243], v[176:179], a[232:235]
  v_exp_f32 v237, v237
  v_cvt_pk_bf16_f32 v233, v234, v235
  v_mfma_f32_16x16x32_bf16 a[180:183], a[200:203], v[136:139], a[180:183]
  ds_read_b64_tr_b16 a[220:221], v19 offset:40960
  ds_read_b64_tr_b16 a[222:223], v19 offset:45056
  v_mfma_f32_16x16x32_bf16 a[180:183], a[204:207], v[168:171], a[180:183]
  v_exp_f32 v238, v238
  v_mfma_f32_16x16x32_bf16 a[8:11], a[200:203], v[144:147], a[8:11]
  s_waitcnt vmcnt(11)
  s_barrier
  v_mfma_f32_16x16x32_bf16 a[8:11], a[204:207], v[176:179], a[8:11]
  v_exp_f32 v239, v239
  v_mfma_f32_16x16x32_bf16 a[40:43], a[200:203], v[152:155], a[40:43]
  v_mfma_f32_16x16x32_bf16 a[40:43], a[204:207], v[184:187], a[40:43]
  v_cvt_pk_bf16_f32 v234, v236, v237
  v_exp_f32 v208, v208
  s_waitcnt lgkmcnt(0)
  v_mfma_f32_16x16x32_bf16 a[152:155], a[208:211], v[128:131], a[152:155]
  v_subrev_u32 v12, 49152, v12
  v_subrev_u32 v13, 49152, v13
  v_subrev_u32 v14, 49152, v14
  v_subrev_u32 v15, 49152, v15
  v_subrev_u32 v16, 49152, v16
  v_subrev_u32 v17, 49152, v17
  v_subrev_u32 v18, 49152, v18
  v_subrev_u32 v19, 49152, v19
  v_mfma_f32_16x16x32_bf16 a[152:155], a[212:215], v[160:163], a[152:155]
  buffer_store_dwordx4 a[92:95], v47, s[32:35], s56 offen offset:3072 sc0 sc1
  v_mfma_f32_16x16x32_bf16 a[184:187], a[208:211], v[136:139], a[184:187]
  v_mfma_f32_16x16x32_bf16 a[184:187], a[212:215], v[168:171], a[184:187]
  ds_read_b64_tr_b16 v[64:65], v12 offset:16384
  v_exp_f32 v209, v209
  v_mfma_f32_16x16x32_bf16 a[12:15], a[208:211], v[144:147], a[12:15]
  ds_read_b64_tr_b16 v[66:67], v12 offset:20480
  v_mfma_f32_16x16x32_bf16 a[12:15], a[212:215], v[176:179], a[12:15]
  ds_read_b64_tr_b16 v[96:97], v12 offset:24576
  ds_read_b64_tr_b16 v[98:99], v12 offset:28672
  v_cvt_pk_bf16_f32 v235, v238, v239
  v_exp_f32 v210, v210
  v_mfma_f32_16x16x32_bf16 a[44:47], a[208:211], v[152:155], a[44:47]
  ds_read_b64_tr_b16 v[68:69], v13 offset:16384
  v_mfma_f32_16x16x32_bf16 a[44:47], a[212:215], v[184:187], a[44:47]
  ds_read_b64_tr_b16 v[70:71], v13 offset:20480
  v_exp_f32 v211, v211
  v_cvt_pk_bf16_f32 v208, v208, v209
  v_mfma_f32_16x16x32_bf16 a[156:159], a[216:219], v[128:131], a[156:159]
  ds_read_b64_tr_b16 v[100:101], v13 offset:24576
  ds_read_b64_tr_b16 v[102:103], v13 offset:28672
  v_mfma_f32_16x16x32_bf16 a[156:159], a[220:223], v[160:163], a[156:159]
  ds_read_b64_tr_b16 v[72:73], v14 offset:16384
  v_exp_f32 v212, v212
  v_exp_f32 v213, v213
  v_mfma_f32_16x16x32_bf16 a[236:239], a[240:243], v[152:155], a[236:239]
  s_add_u32 s56, s45, 12288
  v_cvt_pk_bf16_f32 v209, v210, v211
  v_mfma_f32_16x16x32_bf16 a[236:239], a[240:243], v[184:187], a[236:239]
  v_exp_f32 v214, v214
  v_exp_f32 v215, v215
  v_mfma_f32_16x16x32_bf16 a[188:191], a[216:219], v[136:139], a[188:191]
  ds_read_b64_tr_b16 v[74:75], v14 offset:20480
  v_mfma_f32_16x16x32_bf16 a[188:191], a[220:223], v[168:171], a[188:191]
  ds_read_b64_tr_b16 v[104:105], v14 offset:24576
  ds_read_b64_tr_b16 v[106:107], v14 offset:28672
  v_cvt_pk_bf16_f32 v210, v212, v213
  v_exp_f32 v240, v240
  v_mfma_f32_16x16x32_bf16 a[16:19], a[216:219], v[144:147], a[16:19]
  ds_read_b64_tr_b16 v[76:77], v15 offset:16384
  v_mfma_f32_16x16x32_bf16 a[16:19], a[220:223], v[176:179], a[16:19]
  ds_read_b64_tr_b16 v[78:79], v15 offset:20480
  v_exp_f32 v241, v241
  v_cvt_pk_bf16_f32 v211, v214, v215
  v_exp_f32 v242, v242
  v_mfma_f32_16x16x32_bf16 v[48:51], a[216:219], v[152:155], v[48:51]
  ds_read_b64_tr_b16 v[108:109], v15 offset:24576
  ds_read_b64_tr_b16 v[110:111], v15 offset:28672
  v_mfma_f32_16x16x32_bf16 v[48:51], a[220:223], v[184:187], v[48:51]
  v_exp_f32 v243, v243
  v_cvt_pk_bf16_f32 v240, v240, v241
  s_cbranch_vccnz LS_t28
LS_b28:
  s_waitcnt lgkmcnt(14)
  v_mfma_f32_16x16x32_bf16 a[128:131], v[64:67], v[192:195], a[128:131]
  ds_read_b64_tr_b16 v[80:81], v16 offset:16384
  ds_read_b64_tr_b16 v[82:83], v16 offset:20480
  s_waitcnt lgkmcnt(14)
  v_mfma_f32_16x16x32_bf16 a[128:131], v[96:99], v[224:227], a[128:131]
  ds_read_b64_tr_b16 v[112:113], v16 offset:24576
  ds_read_b64_tr_b16 v[114:115], v16 offset:28672
  ds_read_b64_tr_b16 v[84:85], v17 offset:16384
  v_exp_f32 v244, v244
  v_exp_f32 v245, v245
  v_mfma_f32_16x16x32_bf16 a[224:227], a[240:243], v[192:195], a[224:227]
  v_cvt_pk_bf16_f32 v241, v242, v243
  v_exp_f32 v246, v246
  v_mfma_f32_16x16x32_bf16 a[224:227], a[240:243], v[224:227], a[224:227]
  v_exp_f32 v247, v247
  s_waitcnt lgkmcnt(15)
  v_mfma_f32_16x16x32_bf16 a[132:135], v[68:71], v[192:195], a[132:135]
  ds_read_b64_tr_b16 v[86:87], v17 offset:20480
  ds_read_b64_tr_b16 v[116:117], v17 offset:24576
  ds_read_b64_tr_b16 v[118:119], v17 offset:28672
  s_waitcnt lgkmcnt(15)
  v_mfma_f32_16x16x32_bf16 a[132:135], v[100:103], v[224:227], a[132:135]
  ds_read_b64_tr_b16 v[88:89], v18 offset:16384
  ds_read_b64_tr_b16 v[90:91], v18 offset:20480
  v_cvt_pk_bf16_f32 v242, v244, v245
  s_waitcnt lgkmcnt(15)
  v_mfma_f32_16x16x32_bf16 a[136:139], v[72:75], v[192:195], a[136:139]
  ds_read_b64_tr_b16 v[120:121], v18 offset:24576
  ds_read_b64_tr_b16 v[122:123], v18 offset:28672
  ds_read_b64_tr_b16 v[92:93], v19 offset:16384
  s_waitcnt lgkmcnt(15)
  v_mfma_f32_16x16x32_bf16 a[136:139], v[104:107], v[224:227], a[136:139]
  ds_read_b64_tr_b16 v[94:95], v19 offset:20480
  ds_read_b64_tr_b16 v[124:125], v19 offset:24576
  ds_read_b64_tr_b16 v[126:127], v19 offset:28672
  v_exp_f32 v216, v216
  v_exp_f32 v217, v217
  v_mfma_f32_16x16x32_bf16 a[140:143], v[76:79], v[192:195], a[140:143]
  buffer_store_dwordx4 a[96:99], v47, s[32:35], s56 offen offset:0 sc0 sc1
  s_waitcnt lgkmcnt(15)
  v_mfma_f32_16x16x32_bf16 a[140:143], v[108:111], v[224:227], a[140:143]
  v_cvt_pk_bf16_f32 v243, v246, v247
  v_exp_f32 v218, v218
  s_waitcnt lgkmcnt(14)
  v_mfma_f32_16x16x32_bf16 a[144:147], v[80:83], v[192:195], a[144:147]
  v_exp_f32 v219, v219
  s_waitcnt lgkmcnt(12)
  v_mfma_f32_16x16x32_bf16 a[144:147], v[112:115], v[224:227], a[144:147]
  v_cvt_pk_bf16_f32 v216, v216, v217
  v_accvgpr_read_b32 v28, a224
  s_waitcnt lgkmcnt(10)
  v_mfma_f32_16x16x32_bf16 a[148:151], v[84:87], v[192:195], a[148:151]
  v_exp_f32 v220, v220
  s_waitcnt lgkmcnt(8)
  v_mfma_f32_16x16x32_bf16 a[148:151], v[116:119], v[224:227], a[148:151]
  v_exp_f32 v221, v221
  v_rcp_f32 v28, v28
  v_accvgpr_read_b32 v36, a128
  v_accvgpr_read_b32 v37, a129
  v_accvgpr_read_b32 v38, a130
  v_accvgpr_read_b32 v39, a131
  s_waitcnt lgkmcnt(6)
  v_mfma_f32_16x16x32_bf16 a[152:155], v[88:91], v[192:195], a[152:155]
  v_cvt_pk_bf16_f32 v217, v218, v219
  v_mul_f32 v36, v36, v28
  s_waitcnt lgkmcnt(4)
  v_mfma_f32_16x16x32_bf16 a[152:155], v[120:123], v[224:227], a[152:155]
  v_exp_f32 v222, v222
  v_mul_f32 v37, v37, v28
  v_mul_f32 v38, v38, v28
  v_mul_f32 v39, v39, v28
  v_cvt_pk_bf16_f32 v36, v36, v37
  v_cvt_pk_bf16_f32 v37, v38, v39
  v_accvgpr_read_b32 v40, a132
  v_accvgpr_read_b32 v41, a133
  v_accvgpr_read_b32 v42, a134
  v_accvgpr_read_b32 v43, a135
  s_waitcnt lgkmcnt(2)
  v_mfma_f32_16x16x32_bf16 a[156:159], v[92:95], v[192:195], a[156:159]
  buffer_store_dwordx4 a[100:103], v47, s[32:35], s56 offen offset:1024 sc0 sc1
  ds_write_b64 v32, v[36:37] offset:0
  s_waitcnt lgkmcnt(1)
  v_mfma_f32_16x16x32_bf16 a[156:159], v[124:127], v[224:227], a[156:159]
  v_exp_f32 v223, v223
  v_cvt_pk_bf16_f32 v218, v220, v221
  v_exp_f32 v248, v248
  v_mul_f32 v40, v40, v28
  v_mul_f32 v41, v41, v28
  v_mul_f32 v42, v42, v28
  v_mul_f32 v43, v43, v28
  v_cvt_pk_bf16_f32 v40, v40, v41
  v_cvt_pk_bf16_f32 v41, v42, v43
  v_accvgpr_read_b32 v36, a136
  v_accvgpr_read_b32 v37, a137
  v_accvgpr_read_b32 v38, a138
  v_accvgpr_read_b32 v39, a139
  v_mfma_f32_16x16x32_bf16 a[160:163], v[64:67], v[200:203], a[160:163]
  ds_write_b64 v33, v[40:41] offset:0
  v_mfma_f32_16x16x32_bf16 a[160:163], v[96:99], v[232:235], a[160:163]
  v_exp_f32 v249, v249
  v_cvt_pk_bf16_f32 v219, v222, v223
  v_mul_f32 v36, v36, v28
  v_mul_f32 v37, v37, v28
  v_mul_f32 v38, v38, v28
  v_mul_f32 v39, v39, v28
  v_cvt_pk_bf16_f32 v36, v36, v37
  v_cvt_pk_bf16_f32 v37, v38, v39
  v_accvgpr_read_b32 v40, a140
  v_accvgpr_read_b32 v41, a141
  v_accvgpr_read_b32 v42, a142
  v_accvgpr_read_b32 v43, a143
  v_mfma_f32_16x16x32_bf16 a[228:231], a[240:243], v[200:203], a[228:231]
  ds_write_b64 v34, v[36:37] offset:0
  v_mfma_f32_16x16x32_bf16 a[228:231], a[240:243], v[232:235], a[228:231]
  v_exp_f32 v250, v250
  v_exp_f32 v251, v251
  v_mul_f32 v40, v40, v28
  v_mul_f32 v41, v41, v28
  v_mul_f32 v42, v42, v28
  v_mul_f32 v43, v43, v28
  v_cvt_pk_bf16_f32 v40, v40, v41
  v_cvt_pk_bf16_f32 v41, v42, v43
  v_mfma_f32_16x16x32_bf16 a[164:167], v[68:71], v[200:203], a[164:167]
  v_cvt_pk_bf16_f32 v248, v248, v249
  v_accvgpr_read_b32 v36, a144
  v_mfma_f32_16x16x32_bf16 a[164:167], v[100:103], v[232:235], a[164:167]
  v_exp_f32 v252, v252
  v_accvgpr_read_b32 v37, a145
  v_accvgpr_read_b32 v38, a146
  v_accvgpr_read_b32 v39, a147
  v_mfma_f32_16x16x32_bf16 a[168:171], v[72:75], v[200:203], a[168:171]
  ds_write_b64 v35, v[40:41] offset:0
  v_mfma_f32_16x16x32_bf16 a[168:171], v[104:107], v[232:235], a[168:171]
  v_exp_f32 v253, v253
  v_cvt_pk_bf16_f32 v249, v250, v251
  v_mul_f32 v36, v36, v28
  v_mul_f32 v37, v37, v28
  v_mul_f32 v38, v38, v28
  v_mul_f32 v39, v39, v28
  v_cvt_pk_bf16_f32 v36, v36, v37
  v_cvt_pk_bf16_f32 v37, v38, v39
  v_accvgpr_read_b32 v40, a148
  v_accvgpr_read_b32 v41, a149
  v_accvgpr_read_b32 v42, a150
  v_accvgpr_read_b32 v43, a151
  v_mfma_f32_16x16x32_bf16 a[172:175], v[76:79], v[200:203], a[172:175]
  ds_write_b64 v32, v[36:37] offset:128
  v_mfma_f32_16x16x32_bf16 a[172:175], v[108:111], v[232:235], a[172:175]
  v_exp_f32 v254, v254
  v_exp_f32 v255, v255
  v_mul_f32 v40, v40, v28
  v_mul_f32 v41, v41, v28
  v_mul_f32 v42, v42, v28
  v_mul_f32 v43, v43, v28
  v_cvt_pk_bf16_f32 v40, v40, v41
  v_cvt_pk_bf16_f32 v41, v42, v43
  v_accvgpr_read_b32 v36, a152
  v_accvgpr_read_b32 v37, a153
  v_accvgpr_read_b32 v38, a154
  v_accvgpr_read_b32 v39, a155
  v_mfma_f32_16x16x32_bf16 a[176:179], v[80:83], v[200:203], a[176:179]
  ds_write_b64 v33, v[40:41] offset:128
  v_mfma_f32_16x16x32_bf16 a[176:179], v[112:115], v[232:235], a[176:179]
  v_cvt_pk_bf16_f32 v250, v252, v253
  v_cvt_pk_bf16_f32 v251, v254, v255
  v_mul_f32 v36, v36, v28
  v_mul_f32 v37, v37, v28
  v_mul_f32 v38, v38, v28
  v_mul_f32 v39, v39, v28
  v_cvt_pk_bf16_f32 v36, v36, v37
  v_cvt_pk_bf16_f32 v37, v38, v39
  v_accvgpr_read_b32 v40, a156
  v_accvgpr_read_b32 v41, a157
  v_accvgpr_read_b32 v42, a158
  v_accvgpr_read_b32 v43, a159
  v_mfma_f32_16x16x32_bf16 a[180:183], v[84:87], v[200:203], a[180:183]
  buffer_store_dwordx4 a[104:107], v47, s[32:35], s56 offen offset:2048 sc0 sc1
  ds_write_b64 v34, v[36:37] offset:128
  v_mfma_f32_16x16x32_bf16 a[180:183], v[116:119], v[232:235], a[180:183]
  v_mul_f32 v40, v40, v28
  v_mul_f32 v41, v41, v28
  v_mul_f32 v42, v42, v28
  v_mul_f32 v43, v43, v28
  v_cvt_pk_bf16_f32 v40, v40, v41
  v_cvt_pk_bf16_f32 v41, v42, v43
  v_accvgpr_read_b32 v29, a228
  v_rcp_f32 v29, v29
  v_accvgpr_read_b32 v36, a160
  v_accvgpr_read_b32 v37, a161
  v_mfma_f32_16x16x32_bf16 a[184:187], v[88:91], v[200:203], a[184:187]
  ds_write_b64 v35, v[40:41] offset:128
  v_mfma_f32_16x16x32_bf16 a[184:187], v[120:123], v[232:235], a[184:187]
  v_accvgpr_read_b32 v38, a162
  v_accvgpr_read_b32 v39, a163
  v_mul_f32 v36, v36, v29
  v_mul_f32 v37, v37, v29
  v_mul_f32 v38, v38, v29
  v_mul_f32 v39, v39, v29
  v_cvt_pk_bf16_f32 v36, v36, v37
  v_cvt_pk_bf16_f32 v37, v38, v39
  v_mfma_f32_16x16x32_bf16 a[188:191], v[92:95], v[200:203], a[188:191]
  ds_write_b64 v32, v[36:37] offset:4096
  s_waitcnt lgkmcnt(0)
  ds_read_b128 v[128:131], v46 offset:0
  ds_read_b128 v[136:139], v46 offset:2048
  v_mfma_f32_16x16x32_bf16 a[188:191], v[124:127], v[232:235], a[188:191]
  v_xor_b32 v46, 64, v46
  v_mfma_f32_16x16x32_bf16 a[244:247], v[64:67], v[208:211], a[244:247]
  ds_read_b128 v[132:135], v46 offset:1024
  ds_read_b128 v[140:143], v46 offset:3072
  v_mfma_f32_16x16x32_bf16 a[244:247], v[96:99], v[240:243], a[244:247]
  v_accvgpr_read_b32 v40, a164
  v_accvgpr_read_b32 v41, a165
  v_accvgpr_read_b32 v42, a166
  v_accvgpr_read_b32 v43, a167
  v_mul_f32 v40, v40, v29
  v_mul_f32 v41, v41, v29
  v_mul_f32 v42, v42, v29
  v_mul_f32 v43, v43, v29
  v_cvt_pk_bf16_f32 v40, v40, v41
  v_cvt_pk_bf16_f32 v41, v42, v43
  v_accvgpr_read_b32 v36, a168
  v_accvgpr_read_b32 v37, a169
  v_accvgpr_read_b32 v38, a170
  v_accvgpr_read_b32 v39, a171
  v_mfma_f32_16x16x32_bf16 a[232:235], a[240:243], v[208:211], a[232:235]
  ds_write_b64 v33, v[40:41] offset:4096
  v_mfma_f32_16x16x32_bf16 a[232:235], a[240:243], v[240:243], a[232:235]
  v_mul_f32 v36, v36, v29
  v_mul_f32 v37, v37, v29
  v_mul_f32 v38, v38, v29
  v_mul_f32 v39, v39, v29
  v_cvt_pk_bf16_f32 v36, v36, v37
  v_cvt_pk_bf16_f32 v37, v38, v39
  v_mfma_f32_16x16x32_bf16 a[248:251], v[68:71], v[208:211], a[248:251]
  ds_write_b64 v34, v[36:37] offset:4096
  s_add_u32 s54, s45, 0
  s_waitcnt lgkmcnt(5)
  buffer_store_dwordx4 v[128:131], v47, s[36:39], s54 offen offset:0 sc0 sc1
  s_waitcnt lgkmcnt(3)
  buffer_store_dwordx4 v[132:135], v47, s[36:39], s54 offen offset:1024 sc0 sc1
  buffer_store_dwordx4 v[136:139], v47, s[36:39], s54 offen offset:2048 sc0 sc1
  s_waitcnt lgkmcnt(2)
  buffer_store_dwordx4 v[140:143], v47, s[36:39], s54 offen offset:3072 sc0 sc1
  v_mfma_f32_16x16x32_bf16 a[248:251], v[100:103], v[240:243], a[248:251]
  v_accvgpr_read_b32 v40, a172
  v_accvgpr_read_b32 v41, a173
  v_accvgpr_read_b32 v42, a174
  v_accvgpr_read_b32 v43, a175
  v_mul_f32 v40, v40, v29
  v_mul_f32 v41, v41, v29
  v_mul_f32 v42, v42, v29
  v_mul_f32 v43, v43, v29
  v_cvt_pk_bf16_f32 v40, v40, v41
  v_cvt_pk_bf16_f32 v41, v42, v43
  v_accvgpr_read_b32 v36, a176
  v_accvgpr_read_b32 v37, a177
  v_accvgpr_read_b32 v38, a178
  v_accvgpr_read_b32 v39, a179
  v_mfma_f32_16x16x32_bf16 a[252:255], v[72:75], v[208:211], a[252:255]
  ds_write_b64 v35, v[40:41] offset:4096
  v_mfma_f32_16x16x32_bf16 a[252:255], v[104:107], v[240:243], a[252:255]
  v_mul_f32 v36, v36, v29
  v_mul_f32 v37, v37, v29
  v_mul_f32 v38, v38, v29
  v_mul_f32 v39, v39, v29
  v_cvt_pk_bf16_f32 v36, v36, v37
  v_cvt_pk_bf16_f32 v37, v38, v39
  v_accvgpr_read_b32 v40, a180
  v_accvgpr_read_b32 v41, a181
  v_accvgpr_read_b32 v42, a182
  v_accvgpr_read_b32 v43, a183
  v_mfma_f32_16x16x32_bf16 a[0:3], v[76:79], v[208:211], a[0:3]
  buffer_store_dwordx4 a[108:111], v47, s[32:35], s56 offen offset:3072 sc0 sc1
  ds_write_b64 v32, v[36:37] offset:4224
  v_mfma_f32_16x16x32_bf16 a[0:3], v[108:111], v[240:243], a[0:3]
  v_mul_f32 v40, v40, v29
  v_mul_f32 v41, v41, v29
  v_mul_f32 v42, v42, v29
  v_mul_f32 v43, v43, v29
  v_cvt_pk_bf16_f32 v40, v40, v41
  v_cvt_pk_bf16_f32 v41, v42, v43
  v_accvgpr_read_b32 v36, a184
  v_accvgpr_read_b32 v37, a185
  v_accvgpr_read_b32 v38, a186
  v_accvgpr_read_b32 v39, a187
  v_mfma_f32_16x16x32_bf16 a[4:7], v[80:83], v[208:211], a[4:7]
  ds_write_b64 v33, v[40:41] offset:4224
  v_mfma_f32_16x16x32_bf16 a[4:7], v[112:115], v[240:243], a[4:7]
  v_mul_f32 v36, v36, v29
  v_mul_f32 v37, v37, v29
  v_mul_f32 v38, v38, v29
  v_mul_f32 v39, v39, v29
  v_cvt_pk_bf16_f32 v36, v36, v37
  v_cvt_pk_bf16_f32 v37, v38, v39
  v_accvgpr_read_b32 v40, a188
  v_accvgpr_read_b32 v41, a189
  v_accvgpr_read_b32 v42, a190
  v_accvgpr_read_b32 v43, a191
  v_mfma_f32_16x16x32_bf16 a[8:11], v[84:87], v[208:211], a[8:11]
  ds_write_b64 v34, v[36:37] offset:4224
  v_mfma_f32_16x16x32_bf16 a[8:11], v[116:119], v[240:243], a[8:11]
  v_mul_f32 v40, v40, v29
  v_mul_f32 v41, v41, v29
  v_mul_f32 v42, v42, v29
  v_mul_f32 v43, v43, v29
  v_cvt_pk_bf16_f32 v40, v40, v41
  v_cvt_pk_bf16_f32 v41, v42, v43
  v_accvgpr_read_b32 v30, a232
  v_rcp_f32 v30, v30
  v_accvgpr_read_b32 v36, a244
  v_accvgpr_read_b32 v37, a245
  v_mfma_f32_16x16x32_bf16 a[12:15], v[88:91], v[208:211], a[12:15]
  ds_write_b64 v35, v[40:41] offset:4224
  v_mfma_f32_16x16x32_bf16 a[12:15], v[120:123], v[240:243], a[12:15]
  v_accvgpr_read_b32 v38, a246
  v_accvgpr_read_b32 v39, a247
  v_mul_f32 v36, v36, v30
  v_mul_f32 v37, v37, v30
  v_mul_f32 v38, v38, v30
  v_mul_f32 v39, v39, v30
  v_cvt_pk_bf16_f32 v36, v36, v37
  v_cvt_pk_bf16_f32 v37, v38, v39
  v_mfma_f32_16x16x32_bf16 a[16:19], v[92:95], v[208:211], a[16:19]
  ds_write_b64 v32, v[36:37] offset:8192
  s_waitcnt lgkmcnt(0)
  ds_read_b128 v[148:151], v46 offset:5120
  ds_read_b128 v[156:159], v46 offset:7168
  v_mfma_f32_16x16x32_bf16 a[16:19], v[124:127], v[240:243], a[16:19]
  v_xor_b32 v46, 64, v46
  v_mfma_f32_16x16x32_bf16 a[20:23], v[64:67], v[216:219], a[20:23]
  ds_read_b128 v[144:147], v46 offset:4096
  ds_read_b128 v[152:155], v46 offset:6144
  v_mfma_f32_16x16x32_bf16 a[20:23], v[96:99], v[248:251], a[20:23]
  v_accvgpr_read_b32 v40, a248
  v_accvgpr_read_b32 v41, a249
  v_accvgpr_read_b32 v42, a250
  v_accvgpr_read_b32 v43, a251
  v_mul_f32 v40, v40, v30
  v_mul_f32 v41, v41, v30
  v_mul_f32 v42, v42, v30
  v_mul_f32 v43, v43, v30
  v_cvt_pk_bf16_f32 v40, v40, v41
  v_cvt_pk_bf16_f32 v41, v42, v43
  v_accvgpr_read_b32 v36, a252
  v_accvgpr_read_b32 v37, a253
  v_accvgpr_read_b32 v38, a254
  v_accvgpr_read_b32 v39, a255
  v_mfma_f32_16x16x32_bf16 a[236:239], a[240:243], v[216:219], a[236:239]
  ds_write_b64 v33, v[40:41] offset:8192
  v_mfma_f32_16x16x32_bf16 a[236:239], a[240:243], v[248:251], a[236:239]
  v_mul_f32 v36, v36, v30
  v_mul_f32 v37, v37, v30
  v_mul_f32 v38, v38, v30
  v_mul_f32 v39, v39, v30
  v_cvt_pk_bf16_f32 v36, v36, v37
  v_cvt_pk_bf16_f32 v37, v38, v39
  v_mfma_f32_16x16x32_bf16 a[24:27], v[68:71], v[216:219], a[24:27]
  ds_write_b64 v34, v[36:37] offset:8192
  s_add_u32 s54, s45, 4096
  s_waitcnt lgkmcnt(3)
  buffer_store_dwordx4 v[144:147], v47, s[36:39], s54 offen offset:0 sc0 sc1
  buffer_store_dwordx4 v[148:151], v47, s[36:39], s54 offen offset:1024 sc0 sc1
  s_waitcnt lgkmcnt(2)
  buffer_store_dwordx4 v[152:155], v47, s[36:39], s54 offen offset:2048 sc0 sc1
  buffer_store_dwordx4 v[156:159], v47, s[36:39], s54 offen offset:3072 sc0 sc1
  v_mfma_f32_16x16x32_bf16 a[24:27], v[100:103], v[248:251], a[24:27]
  v_accvgpr_read_b32 v40, a0
  v_accvgpr_read_b32 v41, a1
  v_accvgpr_read_b32 v42, a2
  v_accvgpr_read_b32 v43, a3
  v_mul_f32 v40, v40, v30
  v_mul_f32 v41, v41, v30
  v_mul_f32 v42, v42, v30
  v_mul_f32 v43, v43, v30
  v_cvt_pk_bf16_f32 v40, v40, v41
  v_cvt_pk_bf16_f32 v41, v42, v43
  v_accvgpr_read_b32 v36, a4
  v_accvgpr_read_b32 v37, a5
  v_accvgpr_read_b32 v38, a6
  v_accvgpr_read_b32 v39, a7
  v_mfma_f32_16x16x32_bf16 a[28:31], v[72:75], v[216:219], a[28:31]
  ds_write_b64 v35, v[40:41] offset:8192
  v_mfma_f32_16x16x32_bf16 a[28:31], v[104:107], v[248:251], a[28:31]
  v_mul_f32 v36, v36, v30
  v_mul_f32 v37, v37, v30
  v_mul_f32 v38, v38, v30
  v_mul_f32 v39, v39, v30
  v_cvt_pk_bf16_f32 v36, v36, v37
  v_cvt_pk_bf16_f32 v37, v38, v39
  v_accvgpr_read_b32 v40, a8
  v_accvgpr_read_b32 v41, a9
  v_accvgpr_read_b32 v42, a10
  v_accvgpr_read_b32 v43, a11
  v_mfma_f32_16x16x32_bf16 a[32:35], v[76:79], v[216:219], a[32:35]
  ds_write_b64 v32, v[36:37] offset:8320
  v_mfma_f32_16x16x32_bf16 a[32:35], v[108:111], v[248:251], a[32:35]
  v_mul_f32 v40, v40, v30
  v_mul_f32 v41, v41, v30
  v_mul_f32 v42, v42, v30
  v_mul_f32 v43, v43, v30
  v_cvt_pk_bf16_f32 v40, v40, v41
  v_cvt_pk_bf16_f32 v41, v42, v43
  v_accvgpr_read_b32 v36, a12
  v_accvgpr_read_b32 v37, a13
  v_accvgpr_read_b32 v38, a14
  v_accvgpr_read_b32 v39, a15
  v_mfma_f32_16x16x32_bf16 a[36:39], v[80:83], v[216:219], a[36:39]
  ds_write_b64 v33, v[40:41] offset:8320
  v_mfma_f32_16x16x32_bf16 a[36:39], v[112:115], v[248:251], a[36:39]
  v_mul_f32 v36, v36, v30
  v_mul_f32 v37, v37, v30
  v_mul_f32 v38, v38, v30
  v_mul_f32 v39, v39, v30
  v_cvt_pk_bf16_f32 v36, v36, v37
  v_cvt_pk_bf16_f32 v37, v38, v39
  v_accvgpr_read_b32 v40, a16
  v_accvgpr_read_b32 v41, a17
  v_accvgpr_read_b32 v42, a18
  v_accvgpr_read_b32 v43, a19
  v_mfma_f32_16x16x32_bf16 a[40:43], v[84:87], v[216:219], a[40:43]
  ds_write_b64 v34, v[36:37] offset:8320
  v_mfma_f32_16x16x32_bf16 a[40:43], v[116:119], v[248:251], a[40:43]
  v_mul_f32 v40, v40, v30
  v_mul_f32 v41, v41, v30
  v_mul_f32 v42, v42, v30
  v_mul_f32 v43, v43, v30
  v_cvt_pk_bf16_f32 v40, v40, v41
  v_cvt_pk_bf16_f32 v41, v42, v43
  v_accvgpr_read_b32 v31, a236
  v_rcp_f32 v31, v31
  v_accvgpr_read_b32 v36, a20
  v_accvgpr_read_b32 v37, a21
  v_mfma_f32_16x16x32_bf16 a[44:47], v[88:91], v[216:219], a[44:47]
  ds_write_b64 v35, v[40:41] offset:8320
  v_mfma_f32_16x16x32_bf16 a[44:47], v[120:123], v[248:251], a[44:47]
  v_accvgpr_read_b32 v38, a22
  v_accvgpr_read_b32 v39, a23
  v_mul_f32 v36, v36, v31
  v_mul_f32 v37, v37, v31
  v_mul_f32 v38, v38, v31
  v_mul_f32 v39, v39, v31
  v_cvt_pk_bf16_f32 v36, v36, v37
  v_cvt_pk_bf16_f32 v37, v38, v39
  v_mfma_f32_16x16x32_bf16 v[48:51], v[92:95], v[216:219], v[48:51]
  ds_write_b64 v32, v[36:37] offset:12288
  s_waitcnt lgkmcnt(0)
  ds_read_b128 v[160:163], v46 offset:8192
  ds_read_b128 v[168:171], v46 offset:10240
  v_mfma_f32_16x16x32_bf16 v[48:51], v[124:127], v[248:251], v[48:51]
  v_xor_b32 v46, 64, v46
  ds_read_b128 v[164:167], v46 offset:9216
  ds_read_b128 v[172:175], v46 offset:11264
  v_accvgpr_read_b32 v40, a24
  v_accvgpr_read_b32 v41, a25
  v_accvgpr_read_b32 v42, a26
  v_accvgpr_read_b32 v43, a27
  v_mul_f32 v40, v40, v31
  v_mul_f32 v41, v41, v31
  v_mul_f32 v42, v42, v31
  v_mul_f32 v43, v43, v31
  v_cvt_pk_bf16_f32 v40, v40, v41
  v_cvt_pk_bf16_f32 v41, v42, v43
  v_accvgpr_read_b32 v36, a28
  v_accvgpr_read_b32 v37, a29
  v_accvgpr_read_b32 v38, a30
  v_accvgpr_read_b32 v39, a31
  ds_write_b64 v33, v[40:41] offset:12288
  v_mul_f32 v36, v36, v31
  v_mul_f32 v37, v37, v31
  v_mul_f32 v38, v38, v31
  v_mul_f32 v39, v39, v31
  v_cvt_pk_bf16_f32 v36, v36, v37
  v_cvt_pk_bf16_f32 v37, v38, v39
  ds_write_b64 v34, v[36:37] offset:12288
  s_add_u32 s54, s45, 8192
  s_waitcnt lgkmcnt(5)
  buffer_store_dwordx4 v[160:163], v47, s[36:39], s54 offen offset:0 sc0 sc1
  s_waitcnt lgkmcnt(3)
  buffer_store_dwordx4 v[164:167], v47, s[36:39], s54 offen offset:1024 sc0 sc1
  buffer_store_dwordx4 v[168:171], v47, s[36:39], s54 offen offset:2048 sc0 sc1
  s_waitcnt lgkmcnt(2)
  buffer_store_dwordx4 v[172:175], v47, s[36:39], s54 offen offset:3072 sc0 sc1
  v_accvgpr_read_b32 v40, a32
  v_accvgpr_read_b32 v41, a33
  v_accvgpr_read_b32 v42, a34
  v_accvgpr_read_b32 v43, a35
  v_mul_f32 v40, v40, v31
  v_mul_f32 v41, v41, v31
  v_mul_f32 v42, v42, v31
  v_mul_f32 v43, v43, v31
  v_cvt_pk_bf16_f32 v40, v40, v41
  v_cvt_pk_bf16_f32 v41, v42, v43
  v_accvgpr_read_b32 v36, a36
  v_accvgpr_read_b32 v37, a37
  v_accvgpr_read_b32 v38, a38
  v_accvgpr_read_b32 v39, a39
  ds_write_b64 v35, v[40:41] offset:12288
  v_mul_f32 v36, v36, v31
  v_mul_f32 v37, v37, v31
  v_mul_f32 v38, v38, v31
  v_mul_f32 v39, v39, v31
  v_cvt_pk_bf16_f32 v36, v36, v37
  v_cvt_pk_bf16_f32 v37, v38, v39
  v_accvgpr_read_b32 v40, a40
  v_accvgpr_read_b32 v41, a41
  v_accvgpr_read_b32 v42, a42
  v_accvgpr_read_b32 v43, a43
  ds_write_b64 v32, v[36:37] offset:12416
  v_mul_f32 v40, v40, v31
  v_mul_f32 v41, v41, v31
  v_mul_f32 v42, v42, v31
  v_mul_f32 v43, v43, v31
  v_cvt_pk_bf16_f32 v40, v40, v41
  v_cvt_pk_bf16_f32 v41, v42, v43
  v_accvgpr_read_b32 v36, a44
  v_accvgpr_read_b32 v37, a45
  v_accvgpr_read_b32 v38, a46
  v_accvgpr_read_b32 v39, a47
  ds_write_b64 v33, v[40:41] offset:12416
  v_mul_f32 v36, v36, v31
  v_mul_f32 v37, v37, v31
  v_mul_f32 v38, v38, v31
  v_mul_f32 v39, v39, v31
  v_cvt_pk_bf16_f32 v36, v36, v37
  v_cvt_pk_bf16_f32 v37, v38, v39
  v_mul_f32 v40, v48, v31
  v_mul_f32 v41, v49, v31
  v_mul_f32 v42, v50, v31
  v_mul_f32 v43, v51, v31
  ds_write_b64 v34, v[36:37] offset:12416
  v_cvt_pk_bf16_f32 v40, v40, v41
  v_cvt_pk_bf16_f32 v41, v42, v43
  ds_write_b64 v35, v[40:41] offset:12416
  s_waitcnt lgkmcnt(0)
  ds_read_b128 v[180:183], v46 offset:13312
  ds_read_b128 v[188:191], v46 offset:15360
  v_xor_b32 v46, 64, v46
  ds_read_b128 v[176:179], v46 offset:12288
  ds_read_b128 v[184:187], v46 offset:14336
  s_add_u32 s54, s45, 12288
  s_waitcnt lgkmcnt(1)
  buffer_store_dwordx4 v[176:179], v47, s[36:39], s54 offen offset:0 sc0 sc1
  buffer_store_dwordx4 v[180:183], v47, s[36:39], s54 offen offset:1024 sc0 sc1
  s_waitcnt lgkmcnt(0)
  buffer_store_dwordx4 v[184:187], v47, s[36:39], s54 offen offset:2048 sc0 sc1
  buffer_store_dwordx4 v[188:191], v47, s[36:39], s54 offen offset:3072 sc0 sc1
LS_end:
  s_endpgm
LS_t0:
  s_call_b64 s[50:51], LS_rare1_1_1
  s_branch LS_b0
LS_t1:
  s_call_b64 s[50:51], LS_rare1_0_1
  s_branch LS_b1
LS_t2:
  s_call_b64 s[50:51], LS_rare1_1_1
  s_branch LS_b2
LS_t3:
  s_call_b64 s[50:51], LS_rare1_0_1
  s_branch LS_b3
LS_t4:
  s_call_b64 s[50:51], LS_rare1_1_1
  s_branch LS_b4
LS_t5:
  s_call_b64 s[50:51], LS_rare1_0_1
  s_branch LS_b5
LS_t6:
  s_call_b64 s[50:51], LS_rare1_1_1
  s_branch LS_b6
LS_t7:
  s_call_b64 s[50:51], LS_rare1_0_1
  s_branch LS_b7
LS_t8:
  s_call_b64 s[50:51], LS_rare1_1_1
  s_branch LS_b8
LS_t9:
  s_call_b64 s[50:51], LS_rare1_0_1
  s_branch LS_b9
LS_t10:
  s_call_b64 s[50:51], LS_rare1_1_1
  s_branch LS_b10
LS_t11:
  s_call_b64 s[50:51], LS_rare1_0_1
  s_branch LS_b11
LS_t12:
  s_call_b64 s[50:51], LS_rare1_1_1
  s_branch LS_b12
LS_t13:
  s_call_b64 s[50:51], LS_rare1_0_1
  s_branch LS_b13
LS_t14:
  s_call_b64 s[50:51], LS_rare1_1_1
  s_branch LS_b14
LS_t15:
  s_call_b64 s[50:51], LS_rare2_0
  s_branch LS_b15
LS_t16:
  s_call_b64 s[50:51], LS_rare2_0
  s_branch LS_b16
LS_t17:
  s_call_b64 s[50:51], LS_rare2_0
  s_branch LS_b17
LS_t18:
  s_call_b64 s[50:51], LS_rare2_0
  s_branch LS_b18
LS_t19:
  s_call_b64 s[50:51], LS_rare2_0
  s_branch LS_b19
LS_t20:
  s_call_b64 s[50:51], LS_rare2_0
  s_branch LS_b20
LS_t21:
  s_call_b64 s[50:51], LS_rare2_0
  s_branch LS_b21
LS_t22:
  s_call_b64 s[50:51], LS_rare2_1
  s_branch LS_b22
LS_t23:
  s_call_b64 s[50:51], LS_rare2_1
  s_branch LS_b23
LS_t24:
  s_call_b64 s[50:51], LS_rare2_1
  s_branch LS_b24
LS_t25:
  s_call_b64 s[50:51], LS_rare2_1
  s_branch LS_b25
LS_t26:
  s_call_b64 s[50:51], LS_rare2_1
  s_branch LS_b26
LS_t27:
  s_call_b64 s[50:51], LS_rare2_1
  s_branch LS_b27
LS_t28:
  s_call_b64 s[50:51], LS_rare2_1
  s_branch LS_b28
LS_rare1_0_1:
  s_nop 3
  v_mov_b32 v44, 0
  v_max3_f32 v44, v44, v128, v129
  v_max3_f32 v44, v44, v130, v131
  v_max3_f32 v44, v44, v132, v133
  v_max3_f32 v44, v44, v134, v135
  v_max3_f32 v44, v44, v160, v161
  v_max3_f32 v44, v44, v162, v163
  v_max3_f32 v44, v44, v164, v165
  v_max3_f32 v44, v44, v166, v167
  v_mov_b32 v24, v44
  s_nop 1
  v_permlane32_swap_b32 v44, v24
  v_max_f32 v44, v44, v24
  v_mov_b32 v24, v44
  s_nop 1
  v_permlane16_swap_b32 v44, v24
  v_max_f32 v44, v44, v24
  v_sub_f32 v44, v20, v44
  v_sub_f32 v24, v44, v20
  v_mov_b32 v20, v44
  v_mov_b32 v21, v44
  v_mov_b32 v22, v44
  v_mov_b32 v23, v44
  v_add_f32 v128, v128, v24
  v_add_f32 v129, v129, v24
  v_add_f32 v130, v130, v24
  v_add_f32 v131, v131, v24
  v_add_f32 v132, v132, v24
  v_add_f32 v133, v133, v24
  v_add_f32 v134, v134, v24
  v_add_f32 v135, v135, v24
  v_add_f32 v160, v160, v24
  v_add_f32 v161, v161, v24
  v_add_f32 v162, v162, v24
  v_add_f32 v163, v163, v24
  v_add_f32 v164, v164, v24
  v_add_f32 v165, v165, v24
  v_add_f32 v166, v166, v24
  v_add_f32 v167, v167, v24
  v_exp_f32 v24, v24
  v_mov_b32 v44, 0
  v_max3_f32 v44, v44, v136, v137
  v_max3_f32 v44, v44, v138, v139
  v_max3_f32 v44, v44, v140, v141
  v_max3_f32 v44, v44, v142, v143
  v_max3_f32 v44, v44, v168, v169
  v_max3_f32 v44, v44, v170, v171
  v_max3_f32 v44, v44, v172, v173
  v_max3_f32 v44, v44, v174, v175
  v_mov_b32 v25, v44
  s_nop 1
  v_permlane32_swap_b32 v44, v25
  v_max_f32 v44, v44, v25
  v_mov_b32 v25, v44
  s_nop 1
  v_permlane16_swap_b32 v44, v25
  v_max_f32 v44, v44, v25
  v_sub_f32 v44, v52, v44
  v_sub_f32 v25, v44, v52
  v_mov_b32 v52, v44
  v_mov_b32 v53, v44
  v_mov_b32 v54, v44
  v_mov_b32 v55, v44
  v_add_f32 v136, v136, v25
  v_add_f32 v137, v137, v25
  v_add_f32 v138, v138, v25
  v_add_f32 v139, v139, v25
  v_add_f32 v140, v140, v25
  v_add_f32 v141, v141, v25
  v_add_f32 v142, v142, v25
  v_add_f32 v143, v143, v25
  v_add_f32 v168, v168, v25
  v_add_f32 v169, v169, v25
  v_add_f32 v170, v170, v25
  v_add_f32 v171, v171, v25
  v_add_f32 v172, v172, v25
  v_add_f32 v173, v173, v25
  v_add_f32 v174, v174, v25
  v_add_f32 v175, v175, v25
  v_exp_f32 v25, v25
  v_mov_b32 v44, 0
  v_max3_f32 v44, v44, v144, v145
  v_max3_f32 v44, v44, v146, v147
  v_max3_f32 v44, v44, v148, v149
  v_max3_f32 v44, v44, v150, v151
  v_max3_f32 v44, v44, v176, v177
  v_max3_f32 v44, v44, v178, v179
  v_max3_f32 v44, v44, v180, v181
  v_max3_f32 v44, v44, v182, v183
  v_mov_b32 v26, v44
  s_nop 1
  v_permlane32_swap_b32 v44, v26
  v_max_f32 v44, v44, v26
  v_mov_b32 v26, v44
  s_nop 1
  v_permlane16_swap_b32 v44, v26
  v_max_f32 v44, v44, v26
  v_sub_f32 v44, v56, v44
  v_sub_f32 v26, v44, v56
  v_mov_b32 v56, v44
  v_mov_b32 v57, v44
  v_mov_b32 v58, v44
  v_mov_b32 v59, v44
  v_add_f32 v144, v144, v26
  v_add_f32 v145, v145, v26
  v_add_f32 v146, v146, v26
  v_add_f32 v147, v147, v26
  v_add_f32 v148, v148, v26
  v_add_f32 v149, v149, v26
  v_add_f32 v150, v150, v26
  v_add_f32 v151, v151, v26
  v_add_f32 v176, v176, v26
  v_add_f32 v177, v177, v26
  v_add_f32 v178, v178, v26
  v_add_f32 v179, v179, v26
  v_add_f32 v180, v180, v26
  v_add_f32 v181, v181, v26
  v_add_f32 v182, v182, v26
  v_add_f32 v183, v183, v26
  v_exp_f32 v26, v26
  v_mov_b32 v44, 0
  v_max3_f32 v44, v44, v152, v153
  v_max3_f32 v44, v44, v154, v155
  v_max3_f32 v44, v44, v156, v157
  v_max3_f32 v44, v44, v158, v159
  v_max3_f32 v44, v44, v184, v185
  v_max3_f32 v44, v44, v186, v187
  v_max3_f32 v44, v44, v188, v189
  v_max3_f32 v44, v44, v190, v191
  v_mov_b32 v27, v44
  s_nop 1
  v_permlane32_swap_b32 v44, v27
  v_max_f32 v44, v44, v27
  v_mov_b32 v27, v44
  s_nop 1
  v_permlane16_swap_b32 v44, v27
  v_max_f32 v44, v44, v27
  v_sub_f32 v44, v60, v44
  v_sub_f32 v27, v44, v60
  v_mov_b32 v60, v44
  v_mov_b32 v61, v44
  v_mov_b32 v62, v44
  v_mov_b32 v63, v44
  v_add_f32 v152, v152, v27
  v_add_f32 v153, v153, v27
  v_add_f32 v154, v154, v27
  v_add_f32 v155, v155, v27
  v_add_f32 v156, v156, v27
  v_add_f32 v157, v157, v27
  v_add_f32 v158, v158, v27
  v_add_f32 v159, v159, v27
  v_add_f32 v184, v184, v27
  v_add_f32 v185, v185, v27
  v_add_f32 v186, v186, v27
  v_add_f32 v187, v187, v27
  v_add_f32 v188, v188, v27
  v_add_f32 v189, v189, v27
  v_add_f32 v190, v190, v27
  v_add_f32 v191, v191, v27
  v_exp_f32 v27, v27
  s_nop 1
  s_setpc_b64 s[50:51]
LS_rare1_1_1:
  s_nop 3
  v_mov_b32 v44, 0
  v_max3_f32 v44, v44, v192, v193
  v_max3_f32 v44, v44, v194, v195
  v_max3_f32 v44, v44, v196, v197
  v_max3_f32 v44, v44, v198, v199
  v_max3_f32 v44, v44, v224, v225
  v_max3_f32 v44, v44, v226, v227
  v_max3_f32 v44, v44, v228, v229
  v_max3_f32 v44, v44, v230, v231
  v_mov_b32 v24, v44
  s_nop 1
  v_permlane32_swap_b32 v44, v24
  v_max_f32 v44, v44, v24
  v_mov_b32 v24, v44
  s_nop 1
  v_permlane16_swap_b32 v44, v24
  v_max_f32 v44, v44, v24
  v_sub_f32 v44, v20, v44
  v_sub_f32 v24, v44, v20
  v_mov_b32 v20, v44
  v_mov_b32 v21, v44
  v_mov_b32 v22, v44
  v_mov_b32 v23, v44
  v_add_f32 v192, v192, v24
  v_add_f32 v193, v193, v24
  v_add_f32 v194, v194, v24
  v_add_f32 v195, v195, v24
  v_add_f32 v196, v196, v24
  v_add_f32 v197, v197, v24
  v_add_f32 v198, v198, v24
  v_add_f32 v199, v199, v24
  v_add_f32 v224, v224, v24
  v_add_f32 v225, v225, v24
  v_add_f32 v226, v226, v24
  v_add_f32 v227, v227, v24
  v_add_f32 v228, v228, v24
  v_add_f32 v229, v229, v24
  v_add_f32 v230, v230, v24
  v_add_f32 v231, v231, v24
  v_exp_f32 v24, v24
  v_mov_b32 v44, 0
  v_max3_f32 v44, v44, v200, v201
  v_max3_f32 v44, v44, v202, v203
  v_max3_f32 v44, v44, v204, v205
  v_max3_f32 v44, v44, v206, v207
  v_max3_f32 v44, v44, v232, v233
  v_max3_f32 v44, v44, v234, v235
  v_max3_f32 v44, v44, v236, v237
  v_max3_f32 v44, v44, v238, v239
  v_mov_b32 v25, v44
  s_nop 1
  v_permlane32_swap_b32 v44, v25
  v_max_f32 v44, v44, v25
  v_mov_b32 v25, v44
  s_nop 1
  v_permlane16_swap_b32 v44, v25
  v_max_f32 v44, v44, v25
  v_sub_f32 v44, v52, v44
  v_sub_f32 v25, v44, v52
  v_mov_b32 v52, v44
  v_mov_b32 v53, v44
  v_mov_b32 v54, v44
  v_mov_b32 v55, v44
  v_add_f32 v200, v200, v25
  v_add_f32 v201, v201, v25
  v_add_f32 v202, v202, v25
  v_add_f32 v203, v203, v25
  v_add_f32 v204, v204, v25
  v_add_f32 v205, v205, v25
  v_add_f32 v206, v206, v25
  v_add_f32 v207, v207, v25
  v_add_f32 v232, v232, v25
  v_add_f32 v233, v233, v25
  v_add_f32 v234, v234, v25
  v_add_f32 v235, v235, v25
  v_add_f32 v236, v236, v25
  v_add_f32 v237, v237, v25
  v_add_f32 v238, v238, v25
  v_add_f32 v239, v239, v25
  v_exp_f32 v25, v25
  v_mov_b32 v44, 0
  v_max3_f32 v44, v44, v208, v209
  v_max3_f32 v44, v44, v210, v211
  v_max3_f32 v44, v44, v212, v213
  v_max3_f32 v44, v44, v214, v215
  v_max3_f32 v44, v44, v240, v241
  v_max3_f32 v44, v44, v242, v243
  v_max3_f32 v44, v44, v244, v245
  v_max3_f32 v44, v44, v246, v247
  v_mov_b32 v26, v44
  s_nop 1
  v_permlane32_swap_b32 v44, v26
  v_max_f32 v44, v44, v26
  v_mov_b32 v26, v44
  s_nop 1
  v_permlane16_swap_b32 v44, v26
  v_max_f32 v44, v44, v26
  v_sub_f32 v44, v56, v44
  v_sub_f32 v26, v44, v56
  v_mov_b32 v56, v44
  v_mov_b32 v57, v44
  v_mov_b32 v58, v44
  v_mov_b32 v59, v44
  v_add_f32 v208, v208, v26
  v_add_f32 v209, v209, v26
  v_add_f32 v210, v210, v26
  v_add_f32 v211, v211, v26
  v_add_f32 v212, v212, v26
  v_add_f32 v213, v213, v26
  v_add_f32 v214, v214, v26
  v_add_f32 v215, v215, v26
  v_add_f32 v240, v240, v26
  v_add_f32 v241, v241, v26
  v_add_f32 v242, v242, v26
  v_add_f32 v243, v243, v26
  v_add_f32 v244, v244, v26
  v_add_f32 v245, v245, v26
  v_add_f32 v246, v246, v26
  v_add_f32 v247, v247, v26
  v_exp_f32 v26, v26
  v_mov_b32 v44, 0
  v_max3_f32 v44, v44, v216, v217
  v_max3_f32 v44, v44, v218, v219
  v_max3_f32 v44, v44, v220, v221
  v_max3_f32 v44, v44, v222, v223
  v_max3_f32 v44, v44, v248, v249
  v_max3_f32 v44, v44, v250, v251
  v_max3_f32 v44, v44, v252, v253
  v_max3_f32 v44, v44, v254, v255
  v_mov_b32 v27, v44
  s_nop 1
  v_permlane32_swap_b32 v44, v27
  v_max_f32 v44, v44, v27
  v_mov_b32 v27, v44
  s_nop 1
  v_permlane16_swap_b32 v44, v27
  v_max_f32 v44, v44, v27
  v_sub_f32 v44, v60, v44
  v_sub_f32 v27, v44, v60
  v_mov_b32 v60, v44
  v_mov_b32 v61, v44
  v_mov_b32 v62, v44
  v_mov_b32 v63, v44
  v_add_f32 v216, v216, v27
  v_add_f32 v217, v217, v27
  v_add_f32 v218, v218, v27
  v_add_f32 v219, v219, v27
  v_add_f32 v220, v220, v27
  v_add_f32 v221, v221, v27
  v_add_f32 v222, v222, v27
  v_add_f32 v223, v223, v27
  v_add_f32 v248, v248, v27
  v_add_f32 v249, v249, v27
  v_add_f32 v250, v250, v27
  v_add_f32 v251, v251, v27
  v_add_f32 v252, v252, v27
  v_add_f32 v253, v253, v27
  v_add_f32 v254, v254, v27
  v_add_f32 v255, v255, v27
  v_exp_f32 v27, v27
  s_nop 1
  s_setpc_b64 s[50:51]
LS_rare2_0:
  s_nop 15
  v_accvgpr_read_b32 v44, a224
  v_mul_f32 v44, v44, v24
  v_accvgpr_write_b32 a224, v44
  v_accvgpr_read_b32 v44, a0
  v_mul_f32 v44, v44, v24
  v_accvgpr_write_b32 a0, v44
  v_accvgpr_read_b32 v44, a1
  v_mul_f32 v44, v44, v24
  v_accvgpr_write_b32 a1, v44
  v_accvgpr_read_b32 v44, a2
  v_mul_f32 v44, v44, v24
  v_accvgpr_write_b32 a2, v44
  v_accvgpr_read_b32 v44, a3
  v_mul_f32 v44, v44, v24
  v_accvgpr_write_b32 a3, v44
  v_accvgpr_read_b32 v44, a4
  v_mul_f32 v44, v44, v24
  v_accvgpr_write_b32 a4, v44
  v_accvgpr_read_b32 v44, a5
  v_mul_f32 v44, v44, v24
  v_accvgpr_write_b32 a5, v44
  v_accvgpr_read_b32 v44, a6
  v_mul_f32 v44, v44, v24
  v_accvgpr_write_b32 a6, v44
  v_accvgpr_read_b32 v44, a7
  v_mul_f32 v44, v44, v24
  v_accvgpr_write_b32 a7, v44
  v_accvgpr_read_b32 v44, a8
  v_mul_f32 v44, v44, v24
  v_accvgpr_write_b32 a8, v44
  v_accvgpr_read_b32 v44, a9
  v_mul_f32 v44, v44, v24
  v_accvgpr_write_b32 a9, v44
  v_accvgpr_read_b32 v44, a10
  v_mul_f32 v44, v44, v24
  v_accvgpr_write_b32 a10, v44
  v_accvgpr_read_b32 v44, a11
  v_mul_f32 v44, v44, v24
  v_accvgpr_write_b32 a11, v44
  v_accvgpr_read_b32 v44, a12
  v_mul_f32 v44, v44, v24
  v_accvgpr_write_b32 a12, v44
  v_accvgpr_read_b32 v44, a13
  v_mul_f32 v44, v44, v24
  v_accvgpr_write_b32 a13, v44
  v_accvgpr_read_b32 v44, a14
  v_mul_f32 v44, v44, v24
  v_accvgpr_write_b32 a14, v44
  v_accvgpr_read_b32 v44, a15
  v_mul_f32 v44, v44, v24
  v_accvgpr_write_b32 a15, v44
  v_accvgpr_read_b32 v44, a16
  v_mul_f32 v44, v44, v24
  v_accvgpr_write_b32 a16, v44
  v_accvgpr_read_b32 v44, a17
  v_mul_f32 v44, v44, v24
  v_accvgpr_write_b32 a17, v44
  v_accvgpr_read_b32 v44, a18
  v_mul_f32 v44, v44, v24
  v_accvgpr_write_b32 a18, v44
  v_accvgpr_read_b32 v44, a19
  v_mul_f32 v44, v44, v24
  v_accvgpr_write_b32 a19, v44
  v_accvgpr_read_b32 v44, a20
  v_mul_f32 v44, v44, v24
  v_accvgpr_write_b32 a20, v44
  v_accvgpr_read_b32 v44, a21
  v_mul_f32 v44, v44, v24
  v_accvgpr_write_b32 a21, v44
  v_accvgpr_read_b32 v44, a22
  v_mul_f32 v44, v44, v24
  v_accvgpr_write_b32 a22, v44
  v_accvgpr_read_b32 v44, a23
  v_mul_f32 v44, v44, v24
  v_accvgpr_write_b32 a23, v44
  v_accvgpr_read_b32 v44, a24
  v_mul_f32 v44, v44, v24
  v_accvgpr_write_b32 a24, v44
  v_accvgpr_read_b32 v44, a25
  v_mul_f32 v44, v44, v24
  v_accvgpr_write_b32 a25, v44
  v_accvgpr_read_b32 v44, a26
  v_mul_f32 v44, v44, v24
  v_accvgpr_write_b32 a26, v44
  v_accvgpr_read_b32 v44, a27
  v_mul_f32 v44, v44, v24
  v_accvgpr_write_b32 a27, v44
  v_accvgpr_read_b32 v44, a28
  v_mul_f32 v44, v44, v24
  v_accvgpr_write_b32 a28, v44
  v_accvgpr_read_b32 v44, a29
  v_mul_f32 v44, v44, v24
  v_accvgpr_write_b32 a29, v44
  v_accvgpr_read_b32 v44, a30
  v_mul_f32 v44, v44, v24
  v_accvgpr_write_b32 a30, v44
  v_accvgpr_read_b32 v44, a31
  v_mul_f32 v44, v44, v24
  v_accvgpr_write_b32 a31, v44
  v_accvgpr_read_b32 v44, a228
  v_mul_f32 v44, v44, v25
  v_accvgpr_write_b32 a228, v44
  v_accvgpr_read_b32 v44, a32
  v_mul_f32 v44, v44, v25
  v_accvgpr_write_b32 a32, v44
  v_accvgpr_read_b32 v44, a33
  v_mul_f32 v44, v44, v25
  v_accvgpr_write_b32 a33, v44
  v_accvgpr_read_b32 v44, a34
  v_mul_f32 v44, v44, v25
  v_accvgpr_write_b32 a34, v44
  v_accvgpr_read_b32 v44, a35
  v_mul_f32 v44, v44, v25
  v_accvgpr_write_b32 a35, v44
  v_accvgpr_read_b32 v44, a36
  v_mul_f32 v44, v44, v25
  v_accvgpr_write_b32 a36, v44
  v_accvgpr_read_b32 v44, a37
  v_mul_f32 v44, v44, v25
  v_accvgpr_write_b32 a37, v44
  v_accvgpr_read_b32 v44, a38
  v_mul_f32 v44, v44, v25
  v_accvgpr_write_b32 a38, v44
  v_accvgpr_read_b32 v44, a39
  v_mul_f32 v44, v44, v25
  v_accvgpr_write_b32 a39, v44
  v_accvgpr_read_b32 v44, a40
  v_mul_f32 v44, v44, v25
  v_accvgpr_write_b32 a40, v44
  v_accvgpr_read_b32 v44, a41
  v_mul_f32 v44, v44, v25
  v_accvgpr_write_b32 a41, v44
  v_accvgpr_read_b32 v44, a42
  v_mul_f32 v44, v44, v25
  v_accvgpr_write_b32 a42, v44
  v_accvgpr_read_b32 v44, a43
  v_mul_f32 v44, v44, v25
  v_accvgpr_write_b32 a43, v44
  v_accvgpr_read_b32 v44, a44
  v_mul_f32 v44, v44, v25
  v_accvgpr_write_b32 a44, v44
  v_accvgpr_read_b32 v44, a45
  v_mul_f32 v44, v44, v25
  v_accvgpr_write_b32 a45, v44
  v_accvgpr_read_b32 v44, a46
  v_mul_f32 v44, v44, v25
  v_accvgpr_write_b32 a46, v44
  v_accvgpr_read_b32 v44, a47
  v_mul_f32 v44, v44, v25
  v_accvgpr_write_b32 a47, v44
  v_accvgpr_read_b32 v44, a48
  v_mul_f32 v44, v44, v25
  v_accvgpr_write_b32 a48, v44
  v_accvgpr_read_b32 v44, a49
  v_mul_f32 v44, v44, v25
  v_accvgpr_write_b32 a49, v44
  v_accvgpr_read_b32 v44, a50
  v_mul_f32 v44, v44, v25
  v_accvgpr_write_b32 a50, v44
  v_accvgpr_read_b32 v44, a51
  v_mul_f32 v44, v44, v25
  v_accvgpr_write_b32 a51, v44
  v_accvgpr_read_b32 v44, a52
  v_mul_f32 v44, v44, v25
  v_accvgpr_write_b32 a52, v44
  v_accvgpr_read_b32 v44, a53
  v_mul_f32 v44, v44, v25
  v_accvgpr_write_b32 a53, v44
  v_accvgpr_read_b32 v44, a54
  v_mul_f32 v44, v44, v25
  v_accvgpr_write_b32 a54, v44
  v_accvgpr_read_b32 v44, a55
  v_mul_f32 v44, v44, v25
  v_accvgpr_write_b32 a55, v44
  v_accvgpr_read_b32 v44, a56
  v_mul_f32 v44, v44, v25
  v_accvgpr_write_b32 a56, v44
  v_accvgpr_read_b32 v44, a57
  v_mul_f32 v44, v44, v25
  v_accvgpr_write_b32 a57, v44
  v_accvgpr_read_b32 v44, a58
  v_mul_f32 v44, v44, v25
  v_accvgpr_write_b32 a58, v44
  v_accvgpr_read_b32 v44, a59
  v_mul_f32 v44, v44, v25
  v_accvgpr_write_b32 a59, v44
  v_accvgpr_read_b32 v44, a60
  v_mul_f32 v44, v44, v25
  v_accvgpr_write_b32 a60, v44
  v_accvgpr_read_b32 v44, a61
  v_mul_f32 v44, v44, v25
  v_accvgpr_write_b32 a61, v44
  v_accvgpr_read_b32 v44, a62
  v_mul_f32 v44, v44, v25
  v_accvgpr_write_b32 a62, v44
  v_accvgpr_read_b32 v44, a63
  v_mul_f32 v44, v44, v25
  v_accvgpr_write_b32 a63, v44
  v_accvgpr_read_b32 v44, a232
  v_mul_f32 v44, v44, v26
  v_accvgpr_write_b32 a232, v44
  v_accvgpr_read_b32 v44, a64
  v_mul_f32 v44, v44, v26
  v_accvgpr_write_b32 a64, v44
  v_accvgpr_read_b32 v44, a65
  v_mul_f32 v44, v44, v26
  v_accvgpr_write_b32 a65, v44
  v_accvgpr_read_b32 v44, a66
  v_mul_f32 v44, v44, v26
  v_accvgpr_write_b32 a66, v44
  v_accvgpr_read_b32 v44, a67
  v_mul_f32 v44, v44, v26
  v_accvgpr_write_b32 a67, v44
  v_accvgpr_read_b32 v44, a68
  v_mul_f32 v44, v44, v26
  v_accvgpr_write_b32 a68, v44
  v_accvgpr_read_b32 v44, a69
  v_mul_f32 v44, v44, v26
  v_accvgpr_write_b32 a69, v44
  v_accvgpr_read_b32 v44, a70
  v_mul_f32 v44, v44, v26
  v_accvgpr_write_b32 a70, v44
  v_accvgpr_read_b32 v44, a71
  v_mul_f32 v44, v44, v26
  v_accvgpr_write_b32 a71, v44
  v_accvgpr_read_b32 v44, a72
  v_mul_f32 v44, v44, v26
  v_accvgpr_write_b32 a72, v44
  v_accvgpr_read_b32 v44, a73
  v_mul_f32 v44, v44, v26
  v_accvgpr_write_b32 a73, v44
  v_accvgpr_read_b32 v44, a74
  v_mul_f32 v44, v44, v26
  v_accvgpr_write_b32 a74, v44
  v_accvgpr_read_b32 v44, a75
  v_mul_f32 v44, v44, v26
  v_accvgpr_write_b32 a75, v44
  v_accvgpr_read_b32 v44, a76
  v_mul_f32 v44, v44, v26
  v_accvgpr_write_b32 a76, v44
  v_accvgpr_read_b32 v44, a77
  v_mul_f32 v44, v44, v26
  v_accvgpr_write_b32 a77, v44
  v_accvgpr_read_b32 v44, a78
  v_mul_f32 v44, v44, v26
  v_accvgpr_write_b32 a78, v44
  v_accvgpr_read_b32 v44, a79
  v_mul_f32 v44, v44, v26
  v_accvgpr_write_b32 a79, v44
  v_accvgpr_read_b32 v44, a80
  v_mul_f32 v44, v44, v26
  v_accvgpr_write_b32 a80, v44
  v_accvgpr_read_b32 v44, a81
  v_mul_f32 v44, v44, v26
  v_accvgpr_write_b32 a81, v44
  v_accvgpr_read_b32 v44, a82
  v_mul_f32 v44, v44, v26
  v_accvgpr_write_b32 a82, v44
  v_accvgpr_read_b32 v44, a83
  v_mul_f32 v44, v44, v26
  v_accvgpr_write_b32 a83, v44
  v_accvgpr_read_b32 v44, a84
  v_mul_f32 v44, v44, v26
  v_accvgpr_write_b32 a84, v44
  v_accvgpr_read_b32 v44, a85
  v_mul_f32 v44, v44, v26
  v_accvgpr_write_b32 a85, v44
  v_accvgpr_read_b32 v44, a86
  v_mul_f32 v44, v44, v26
  v_accvgpr_write_b32 a86, v44
  v_accvgpr_read_b32 v44, a87
  v_mul_f32 v44, v44, v26
  v_accvgpr_write_b32 a87, v44
  v_accvgpr_read_b32 v44, a88
  v_mul_f32 v44, v44, v26
  v_accvgpr_write_b32 a88, v44
  v_accvgpr_read_b32 v44, a89
  v_mul_f32 v44, v44, v26
  v_accvgpr_write_b32 a89, v44
  v_accvgpr_read_b32 v44, a90
  v_mul_f32 v44, v44, v26
  v_accvgpr_write_b32 a90, v44
  v_accvgpr_read_b32 v44, a91
  v_mul_f32 v44, v44, v26
  v_accvgpr_write_b32 a91, v44
  v_accvgpr_read_b32 v44, a92
  v_mul_f32 v44, v44, v26
  v_accvgpr_write_b32 a92, v44
  v_accvgpr_read_b32 v44, a93
  v_mul_f32 v44, v44, v26
  v_accvgpr_write_b32 a93, v44
  v_accvgpr_read_b32 v44, a94
  v_mul_f32 v44, v44, v26
  v_accvgpr_write_b32 a94, v44
  v_accvgpr_read_b32 v44, a95
  v_mul_f32 v44, v44, v26
  v_accvgpr_write_b32 a95, v44
  v_accvgpr_read_b32 v44, a236
  v_mul_f32 v44, v44, v27
  v_accvgpr_write_b32 a236, v44
  v_accvgpr_read_b32 v44, a96
  v_mul_f32 v44, v44, v27
  v_accvgpr_write_b32 a96, v44
  v_accvgpr_read_b32 v44, a97
  v_mul_f32 v44, v44, v27
  v_accvgpr_write_b32 a97, v44
  v_accvgpr_read_b32 v44, a98
  v_mul_f32 v44, v44, v27
  v_accvgpr_write_b32 a98, v44
  v_accvgpr_read_b32 v44, a99
  v_mul_f32 v44, v44, v27
  v_accvgpr_write_b32 a99, v44
  v_accvgpr_read_b32 v44, a100
  v_mul_f32 v44, v44, v27
  v_accvgpr_write_b32 a100, v44
  v_accvgpr_read_b32 v44, a101
  v_mul_f32 v44, v44, v27
  v_accvgpr_write_b32 a101, v44
  v_accvgpr_read_b32 v44, a102
  v_mul_f32 v44, v44, v27
  v_accvgpr_write_b32 a102, v44
  v_accvgpr_read_b32 v44, a103
  v_mul_f32 v44, v44, v27
  v_accvgpr_write_b32 a103, v44
  v_accvgpr_read_b32 v44, a104
  v_mul_f32 v44, v44, v27
  v_accvgpr_write_b32 a104, v44
  v_accvgpr_read_b32 v44, a105
  v_mul_f32 v44, v44, v27
  v_accvgpr_write_b32 a105, v44
  v_accvgpr_read_b32 v44, a106
  v_mul_f32 v44, v44, v27
  v_accvgpr_write_b32 a106, v44
  v_accvgpr_read_b32 v44, a107
  v_mul_f32 v44, v44, v27
  v_accvgpr_write_b32 a107, v44
  v_accvgpr_read_b32 v44, a108
  v_mul_f32 v44, v44, v27
  v_accvgpr_write_b32 a108, v44
  v_accvgpr_read_b32 v44, a109
  v_mul_f32 v44, v44, v27
  v_accvgpr_write_b32 a109, v44
  v_accvgpr_read_b32 v44, a110
  v_mul_f32 v44, v44, v27
  v_accvgpr_write_b32 a110, v44
  v_accvgpr_read_b32 v44, a111
  v_mul_f32 v44, v44, v27
  v_accvgpr_write_b32 a111, v44
  v_accvgpr_read_b32 v44, a112
  v_mul_f32 v44, v44, v27
  v_accvgpr_write_b32 a112, v44
  v_accvgpr_read_b32 v44, a113
  v_mul_f32 v44, v44, v27
  v_accvgpr_write_b32 a113, v44
  v_accvgpr_read_b32 v44, a114
  v_mul_f32 v44, v44, v27
  v_accvgpr_write_b32 a114, v44
  v_accvgpr_read_b32 v44, a115
  v_mul_f32 v44, v44, v27
  v_accvgpr_write_b32 a115, v44
  v_accvgpr_read_b32 v44, a116
  v_mul_f32 v44, v44, v27
  v_accvgpr_write_b32 a116, v44
  v_accvgpr_read_b32 v44, a117
  v_mul_f32 v44, v44, v27
  v_accvgpr_write_b32 a117, v44
  v_accvgpr_read_b32 v44, a118
  v_mul_f32 v44, v44, v27
  v_accvgpr_write_b32 a118, v44
  v_accvgpr_read_b32 v44, a119
  v_mul_f32 v44, v44, v27
  v_accvgpr_write_b32 a119, v44
  v_accvgpr_read_b32 v44, a120
  v_mul_f32 v44, v44, v27
  v_accvgpr_write_b32 a120, v44
  v_accvgpr_read_b32 v44, a121
  v_mul_f32 v44, v44, v27
  v_accvgpr_write_b32 a121, v44
  v_accvgpr_read_b32 v44, a122
  v_mul_f32 v44, v44, v27
  v_accvgpr_write_b32 a122, v44
  v_accvgpr_read_b32 v44, a123
  v_mul_f32 v44, v44, v27
  v_accvgpr_write_b32 a123, v44
  v_accvgpr_read_b32 v44, a124
  v_mul_f32 v44, v44, v27
  v_accvgpr_write_b32 a124, v44
  v_accvgpr_read_b32 v44, a125
  v_mul_f32 v44, v44, v27
  v_accvgpr_write_b32 a125, v44
  v_accvgpr_read_b32 v44, a126
  v_mul_f32 v44, v44, v27
  v_accvgpr_write_b32 a126, v44
  v_accvgpr_read_b32 v44, a127
  v_mul_f32 v44, v44, v27
  v_accvgpr_write_b32 a127, v44
  s_nop 3
  s_setpc_b64 s[50:51]
LS_rare2_1:
  s_nop 15
  v_accvgpr_read_b32 v44, a224
  v_mul_f32 v44, v44, v24
  v_accvgpr_write_b32 a224, v44
  v_accvgpr_read_b32 v44, a128
  v_mul_f32 v44, v44, v24
  v_accvgpr_write_b32 a128, v44
  v_accvgpr_read_b32 v44, a129
  v_mul_f32 v44, v44, v24
  v_accvgpr_write_b32 a129, v44
  v_accvgpr_read_b32 v44, a130
  v_mul_f32 v44, v44, v24
  v_accvgpr_write_b32 a130, v44
  v_accvgpr_read_b32 v44, a131
  v_mul_f32 v44, v44, v24
  v_accvgpr_write_b32 a131, v44
  v_accvgpr_read_b32 v44, a132
  v_mul_f32 v44, v44, v24
  v_accvgpr_write_b32 a132, v44
  v_accvgpr_read_b32 v44, a133
  v_mul_f32 v44, v44, v24
  v_accvgpr_write_b32 a133, v44
  v_accvgpr_read_b32 v44, a134
  v_mul_f32 v44, v44, v24
  v_accvgpr_write_b32 a134, v44
  v_accvgpr_read_b32 v44, a135
  v_mul_f32 v44, v44, v24
  v_accvgpr_write_b32 a135, v44
  v_accvgpr_read_b32 v44, a136
  v_mul_f32 v44, v44, v24
  v_accvgpr_write_b32 a136, v44
  v_accvgpr_read_b32 v44, a137
  v_mul_f32 v44, v44, v24
  v_accvgpr_write_b32 a137, v44
  v_accvgpr_read_b32 v44, a138
  v_mul_f32 v44, v44, v24
  v_accvgpr_write_b32 a138, v44
  v_accvgpr_read_b32 v44, a139
  v_mul_f32 v44, v44, v24
  v_accvgpr_write_b32 a139, v44
  v_accvgpr_read_b32 v44, a140
  v_mul_f32 v44, v44, v24
  v_accvgpr_write_b32 a140, v44
  v_accvgpr_read_b32 v44, a141
  v_mul_f32 v44, v44, v24
  v_accvgpr_write_b32 a141, v44
  v_accvgpr_read_b32 v44, a142
  v_mul_f32 v44, v44, v24
  v_accvgpr_write_b32 a142, v44
  v_accvgpr_read_b32 v44, a143
  v_mul_f32 v44, v44, v24
  v_accvgpr_write_b32 a143, v44
  v_accvgpr_read_b32 v44, a144
  v_mul_f32 v44, v44, v24
  v_accvgpr_write_b32 a144, v44
  v_accvgpr_read_b32 v44, a145
  v_mul_f32 v44, v44, v24
  v_accvgpr_write_b32 a145, v44
  v_accvgpr_read_b32 v44, a146
  v_mul_f32 v44, v44, v24
  v_accvgpr_write_b32 a146, v44
  v_accvgpr_read_b32 v44, a147
  v_mul_f32 v44, v44, v24
  v_accvgpr_write_b32 a147, v44
  v_accvgpr_read_b32 v44, a148
  v_mul_f32 v44, v44, v24
  v_accvgpr_write_b32 a148, v44
  v_accvgpr_read_b32 v44, a149
  v_mul_f32 v44, v44, v24
  v_accvgpr_write_b32 a149, v44
  v_accvgpr_read_b32 v44, a150
  v_mul_f32 v44, v44, v24
  v_accvgpr_write_b32 a150, v44
  v_accvgpr_read_b32 v44, a151
  v_mul_f32 v44, v44, v24
  v_accvgpr_write_b32 a151, v44
  v_accvgpr_read_b32 v44, a152
  v_mul_f32 v44, v44, v24
  v_accvgpr_write_b32 a152, v44
  v_accvgpr_read_b32 v44, a153
  v_mul_f32 v44, v44, v24
  v_accvgpr_write_b32 a153, v44
  v_accvgpr_read_b32 v44, a154
  v_mul_f32 v44, v44, v24
  v_accvgpr_write_b32 a154, v44
  v_accvgpr_read_b32 v44, a155
  v_mul_f32 v44, v44, v24
  v_accvgpr_write_b32 a155, v44
  v_accvgpr_read_b32 v44, a156
  v_mul_f32 v44, v44, v24
  v_accvgpr_write_b32 a156, v44
  v_accvgpr_read_b32 v44, a157
  v_mul_f32 v44, v44, v24
  v_accvgpr_write_b32 a157, v44
  v_accvgpr_read_b32 v44, a158
  v_mul_f32 v44, v44, v24
  v_accvgpr_write_b32 a158, v44
  v_accvgpr_read_b32 v44, a159
  v_mul_f32 v44, v44, v24
  v_accvgpr_write_b32 a159, v44
  v_accvgpr_read_b32 v44, a228
  v_mul_f32 v44, v44, v25
  v_accvgpr_write_b32 a228, v44
  v_accvgpr_read_b32 v44, a160
  v_mul_f32 v44, v44, v25
  v_accvgpr_write_b32 a160, v44
  v_accvgpr_read_b32 v44, a161
  v_mul_f32 v44, v44, v25
  v_accvgpr_write_b32 a161, v44
  v_accvgpr_read_b32 v44, a162
  v_mul_f32 v44, v44, v25
  v_accvgpr_write_b32 a162, v44
  v_accvgpr_read_b32 v44, a163
  v_mul_f32 v44, v44, v25
  v_accvgpr_write_b32 a163, v44
  v_accvgpr_read_b32 v44, a164
  v_mul_f32 v44, v44, v25
  v_accvgpr_write_b32 a164, v44
  v_accvgpr_read_b32 v44, a165
  v_mul_f32 v44, v44, v25
  v_accvgpr_write_b32 a165, v44
  v_accvgpr_read_b32 v44, a166
  v_mul_f32 v44, v44, v25
  v_accvgpr_write_b32 a166, v44
  v_accvgpr_read_b32 v44, a167
  v_mul_f32 v44, v44, v25
  v_accvgpr_write_b32 a167, v44
  v_accvgpr_read_b32 v44, a168
  v_mul_f32 v44, v44, v25
  v_accvgpr_write_b32 a168, v44
  v_accvgpr_read_b32 v44, a169
  v_mul_f32 v44, v44, v25
  v_accvgpr_write_b32 a169, v44
  v_accvgpr_read_b32 v44, a170
  v_mul_f32 v44, v44, v25
  v_accvgpr_write_b32 a170, v44
  v_accvgpr_read_b32 v44, a171
  v_mul_f32 v44, v44, v25
  v_accvgpr_write_b32 a171, v44
  v_accvgpr_read_b32 v44, a172
  v_mul_f32 v44, v44, v25
  v_accvgpr_write_b32 a172, v44
  v_accvgpr_read_b32 v44, a173
  v_mul_f32 v44, v44, v25
  v_accvgpr_write_b32 a173, v44
  v_accvgpr_read_b32 v44, a174
  v_mul_f32 v44, v44, v25
  v_accvgpr_write_b32 a174, v44
  v_accvgpr_read_b32 v44, a175
  v_mul_f32 v44, v44, v25
  v_accvgpr_write_b32 a175, v44
  v_accvgpr_read_b32 v44, a176
  v_mul_f32 v44, v44, v25
  v_accvgpr_write_b32 a176, v44
  v_accvgpr_read_b32 v44, a177
  v_mul_f32 v44, v44, v25
  v_accvgpr_write_b32 a177, v44
  v_accvgpr_read_b32 v44, a178
  v_mul_f32 v44, v44, v25
  v_accvgpr_write_b32 a178, v44
  v_accvgpr_read_b32 v44, a179
  v_mul_f32 v44, v44, v25
  v_accvgpr_write_b32 a179, v44
  v_accvgpr_read_b32 v44, a180
  v_mul_f32 v44, v44, v25
  v_accvgpr_write_b32 a180, v44
  v_accvgpr_read_b32 v44, a181
  v_mul_f32 v44, v44, v25
  v_accvgpr_write_b32 a181, v44
  v_accvgpr_read_b32 v44, a182
  v_mul_f32 v44, v44, v25
  v_accvgpr_write_b32 a182, v44
  v_accvgpr_read_b32 v44, a183
  v_mul_f32 v44, v44, v25
  v_accvgpr_write_b32 a183, v44
  v_accvgpr_read_b32 v44, a184
  v_mul_f32 v44, v44, v25
  v_accvgpr_write_b32 a184, v44
  v_accvgpr_read_b32 v44, a185
  v_mul_f32 v44, v44, v25
  v_accvgpr_write_b32 a185, v44
  v_accvgpr_read_b32 v44, a186
  v_mul_f32 v44, v44, v25
  v_accvgpr_write_b32 a186, v44
  v_accvgpr_read_b32 v44, a187
  v_mul_f32 v44, v44, v25
  v_accvgpr_write_b32 a187, v44
  v_accvgpr_read_b32 v44, a188
  v_mul_f32 v44, v44, v25
  v_accvgpr_write_b32 a188, v44
  v_accvgpr_read_b32 v44, a189
  v_mul_f32 v44, v44, v25
  v_accvgpr_write_b32 a189, v44
  v_accvgpr_read_b32 v44, a190
  v_mul_f32 v44, v44, v25
  v_accvgpr_write_b32 a190, v44
  v_accvgpr_read_b32 v44, a191
  v_mul_f32 v44, v44, v25
  v_accvgpr_write_b32 a191, v44
  v_accvgpr_read_b32 v44, a232
  v_mul_f32 v44, v44, v26
  v_accvgpr_write_b32 a232, v44
  v_accvgpr_read_b32 v44, a244
  v_mul_f32 v44, v44, v26
  v_accvgpr_write_b32 a244, v44
  v_accvgpr_read_b32 v44, a245
  v_mul_f32 v44, v44, v26
  v_accvgpr_write_b32 a245, v44
  v_accvgpr_read_b32 v44, a246
  v_mul_f32 v44, v44, v26
  v_accvgpr_write_b32 a246, v44
  v_accvgpr_read_b32 v44, a247
  v_mul_f32 v44, v44, v26
  v_accvgpr_write_b32 a247, v44
  v_accvgpr_read_b32 v44, a248
  v_mul_f32 v44, v44, v26
  v_accvgpr_write_b32 a248, v44
  v_accvgpr_read_b32 v44, a249
  v_mul_f32 v44, v44, v26
  v_accvgpr_write_b32 a249, v44
  v_accvgpr_read_b32 v44, a250
  v_mul_f32 v44, v44, v26
  v_accvgpr_write_b32 a250, v44
  v_accvgpr_read_b32 v44, a251
  v_mul_f32 v44, v44, v26
  v_accvgpr_write_b32 a251, v44
  v_accvgpr_read_b32 v44, a252
  v_mul_f32 v44, v44, v26
  v_accvgpr_write_b32 a252, v44
  v_accvgpr_read_b32 v44, a253
  v_mul_f32 v44, v44, v26
  v_accvgpr_write_b32 a253, v44
  v_accvgpr_read_b32 v44, a254
  v_mul_f32 v44, v44, v26
  v_accvgpr_write_b32 a254, v44
  v_accvgpr_read_b32 v44, a255
  v_mul_f32 v44, v44, v26
  v_accvgpr_write_b32 a255, v44
  v_accvgpr_read_b32 v44, a0
  v_mul_f32 v44, v44, v26
  v_accvgpr_write_b32 a0, v44
  v_accvgpr_read_b32 v44, a1
  v_mul_f32 v44, v44, v26
  v_accvgpr_write_b32 a1, v44
  v_accvgpr_read_b32 v44, a2
  v_mul_f32 v44, v44, v26
  v_accvgpr_write_b32 a2, v44
  v_accvgpr_read_b32 v44, a3
  v_mul_f32 v44, v44, v26
  v_accvgpr_write_b32 a3, v44
  v_accvgpr_read_b32 v44, a4
  v_mul_f32 v44, v44, v26
  v_accvgpr_write_b32 a4, v44
  v_accvgpr_read_b32 v44, a5
  v_mul_f32 v44, v44, v26
  v_accvgpr_write_b32 a5, v44
  v_accvgpr_read_b32 v44, a6
  v_mul_f32 v44, v44, v26
  v_accvgpr_write_b32 a6, v44
  v_accvgpr_read_b32 v44, a7
  v_mul_f32 v44, v44, v26
  v_accvgpr_write_b32 a7, v44
  v_accvgpr_read_b32 v44, a8
  v_mul_f32 v44, v44, v26
  v_accvgpr_write_b32 a8, v44
  v_accvgpr_read_b32 v44, a9
  v_mul_f32 v44, v44, v26
  v_accvgpr_write_b32 a9, v44
  v_accvgpr_read_b32 v44, a10
  v_mul_f32 v44, v44, v26
  v_accvgpr_write_b32 a10, v44
  v_accvgpr_read_b32 v44, a11
  v_mul_f32 v44, v44, v26
  v_accvgpr_write_b32 a11, v44
  v_accvgpr_read_b32 v44, a12
  v_mul_f32 v44, v44, v26
  v_accvgpr_write_b32 a12, v44
  v_accvgpr_read_b32 v44, a13
  v_mul_f32 v44, v44, v26
  v_accvgpr_write_b32 a13, v44
  v_accvgpr_read_b32 v44, a14
  v_mul_f32 v44, v44, v26
  v_accvgpr_write_b32 a14, v44
  v_accvgpr_read_b32 v44, a15
  v_mul_f32 v44, v44, v26
  v_accvgpr_write_b32 a15, v44
  v_accvgpr_read_b32 v44, a16
  v_mul_f32 v44, v44, v26
  v_accvgpr_write_b32 a16, v44
  v_accvgpr_read_b32 v44, a17
  v_mul_f32 v44, v44, v26
  v_accvgpr_write_b32 a17, v44
  v_accvgpr_read_b32 v44, a18
  v_mul_f32 v44, v44, v26
  v_accvgpr_write_b32 a18, v44
  v_accvgpr_read_b32 v44, a19
  v_mul_f32 v44, v44, v26
  v_accvgpr_write_b32 a19, v44
  v_accvgpr_read_b32 v44, a236
  v_mul_f32 v44, v44, v27
  v_accvgpr_write_b32 a236, v44
  v_accvgpr_read_b32 v44, a20
  v_mul_f32 v44, v44, v27
  v_accvgpr_write_b32 a20, v44
  v_accvgpr_read_b32 v44, a21
  v_mul_f32 v44, v44, v27
  v_accvgpr_write_b32 a21, v44
  v_accvgpr_read_b32 v44, a22
  v_mul_f32 v44, v44, v27
  v_accvgpr_write_b32 a22, v44
  v_accvgpr_read_b32 v44, a23
  v_mul_f32 v44, v44, v27
  v_accvgpr_write_b32 a23, v44
  v_accvgpr_read_b32 v44, a24
  v_mul_f32 v44, v44, v27
  v_accvgpr_write_b32 a24, v44
  v_accvgpr_read_b32 v44, a25
  v_mul_f32 v44, v44, v27
  v_accvgpr_write_b32 a25, v44
  v_accvgpr_read_b32 v44, a26
  v_mul_f32 v44, v44, v27
  v_accvgpr_write_b32 a26, v44
  v_accvgpr_read_b32 v44, a27
  v_mul_f32 v44, v44, v27
  v_accvgpr_write_b32 a27, v44
  v_accvgpr_read_b32 v44, a28
  v_mul_f32 v44, v44, v27
  v_accvgpr_write_b32 a28, v44
  v_accvgpr_read_b32 v44, a29
  v_mul_f32 v44, v44, v27
  v_accvgpr_write_b32 a29, v44
  v_accvgpr_read_b32 v44, a30
  v_mul_f32 v44, v44, v27
  v_accvgpr_write_b32 a30, v44
  v_accvgpr_read_b32 v44, a31
  v_mul_f32 v44, v44, v27
  v_accvgpr_write_b32 a31, v44
  v_accvgpr_read_b32 v44, a32
  v_mul_f32 v44, v44, v27
  v_accvgpr_write_b32 a32, v44
  v_accvgpr_read_b32 v44, a33
  v_mul_f32 v44, v44, v27
  v_accvgpr_write_b32 a33, v44
  v_accvgpr_read_b32 v44, a34
  v_mul_f32 v44, v44, v27
  v_accvgpr_write_b32 a34, v44
  v_accvgpr_read_b32 v44, a35
  v_mul_f32 v44, v44, v27
  v_accvgpr_write_b32 a35, v44
  v_accvgpr_read_b32 v44, a36
  v_mul_f32 v44, v44, v27
  v_accvgpr_write_b32 a36, v44
  v_accvgpr_read_b32 v44, a37
  v_mul_f32 v44, v44, v27
  v_accvgpr_write_b32 a37, v44
  v_accvgpr_read_b32 v44, a38
  v_mul_f32 v44, v44, v27
  v_accvgpr_write_b32 a38, v44
  v_accvgpr_read_b32 v44, a39
  v_mul_f32 v44, v44, v27
  v_accvgpr_write_b32 a39, v44
  v_accvgpr_read_b32 v44, a40
  v_mul_f32 v44, v44, v27
  v_accvgpr_write_b32 a40, v44
  v_accvgpr_read_b32 v44, a41
  v_mul_f32 v44, v44, v27
  v_accvgpr_write_b32 a41, v44
  v_accvgpr_read_b32 v44, a42
  v_mul_f32 v44, v44, v27
  v_accvgpr_write_b32 a42, v44
  v_accvgpr_read_b32 v44, a43
  v_mul_f32 v44, v44, v27
  v_accvgpr_write_b32 a43, v44
  v_accvgpr_read_b32 v44, a44
  v_mul_f32 v44, v44, v27
  v_accvgpr_write_b32 a44, v44
  v_accvgpr_read_b32 v44, a45
  v_mul_f32 v44, v44, v27
  v_accvgpr_write_b32 a45, v44
  v_accvgpr_read_b32 v44, a46
  v_mul_f32 v44, v44, v27
  v_accvgpr_write_b32 a46, v44
  v_accvgpr_read_b32 v44, a47
  v_mul_f32 v44, v44, v27
  v_accvgpr_write_b32 a47, v44
  v_mul_f32 v48, v48, v27
  v_mul_f32 v49, v49, v27
  v_mul_f32 v50, v50, v27
  v_mul_f32 v51, v51, v27
  s_nop 3
  s_setpc_b64 s[50:51]
L_codeend:
.section .rodata,"a"
.p2align 6
.amdhsa_kernel standalone__mha_softmax__near_ridge_kernel
  .amdhsa_next_free_vgpr 512
  .amdhsa_next_free_sgpr 100
  .amdhsa_accum_offset 256
  .amdhsa_group_segment_fixed_size 0
  .amdhsa_kernarg_size 48
  .amdhsa_user_sgpr_count 2
  .amdhsa_user_sgpr_kernarg_segment_ptr 1
  .amdhsa_system_sgpr_workgroup_id_x 1
.end_amdhsa_kernel
```
